```python
import torch

def _softmax(x, axis=-1):
    return torch.softmax(x, dim=axis)
def _gelu(x):
    return torch.nn.functional.gelu(x, approximate="tanh")
def _silu(x):
    return torch.nn.functional.silu(x)
def _sigmoid(x):
    return torch.sigmoid(x)
def _layernorm(x, axis=-1, eps=1e-5):
    m = x.mean(dim=axis, keepdim=True)
    v = x.var(dim=axis, keepdim=True, unbiased=False)
    return (x - m) / torch.sqrt(v + eps)
def _scatter_add(tgt, idx, src, axis=0):
    return tgt.clone().index_add_(axis, idx, src)
def _segment_sum(src, seg, n):
    out = torch.zeros((n,) + src.shape[1:], dtype=src.dtype)
    return out.index_add_(0, seg, src)
def _pad(x, pw):
    flat = tuple(v for pair in reversed(pw) for v in pair)
    return torch.nn.functional.pad(x, flat)

kernel_name = 'recurrent_scan__mha_block_cached__mixer_token_mlp__prompt'

def setup_inputs():

    _w = (lambda a: (lambda t: t.to(torch.bfloat16) if t.is_floating_point() else t)(torch.as_tensor(a)))
    def _A_setup():
        B, Sq, D = 1, 2048, 640
        H, Sk, Dh = 32, 2048, 128
        return {
            "x": _w((lambda *s: torch.randn(*s, dtype=torch.bfloat16) * 0.1)(B, Sq, D)),
            "k_cache": _w((lambda *s: torch.randn(*s, dtype=torch.bfloat16) * 0.8)(B, H, Sk, Dh)),
            "v_cache": _w((lambda *s: torch.randn(*s, dtype=torch.bfloat16) * 3.2)(B, H, Sk, Dh)),
            "wq": _w((lambda *s: torch.randn(*s, dtype=torch.bfloat16) * 0.8)(D, H * Dh) * (D ** -0.5)),
            "wo": _w((lambda *s: torch.randn(*s, dtype=torch.bfloat16) * 3.2)(H * Dh, D) * ((H * Dh) ** -0.5)),
        }
    _A_in = _A_setup()

    def _B_setup():
        B, S, D, F = 1, 2048, 640, 1728
        return {
            "x": _w((lambda *s: torch.randn(*s, dtype=torch.bfloat16) * 0.1)(B, S, D)),
            "w1": _w((lambda *s: torch.randn(*s, dtype=torch.bfloat16) * 3.2)(S, F) * (S ** -0.5)),
            "b1": _w((lambda *s: torch.randn(*s, dtype=torch.bfloat16) * 3.2)(F) * 0.02),
            "w2": _w((lambda *s: torch.randn(*s, dtype=torch.bfloat16) * 3.2)(F, S) * (F ** -0.5)),
            "b2": _w((lambda *s: torch.randn(*s, dtype=torch.bfloat16) * 3.2)(S) * 0.02),
        }
    _B_in = _B_setup()

    return {
        "A_x": _A_in["x"],
        "A_k_cache": _A_in["k_cache"],
        "A_v_cache": _A_in["v_cache"],
        "A_wq": _A_in["wq"],
        "A_wo": _A_in["wo"],
        "B_x": _B_in["x"],
        "B_w1": _B_in["w1"],
        "B_b1": _B_in["b1"],
        "B_w2": _B_in["w2"],
        "B_b2": _B_in["b2"],
    }

def reference(A_x, A_k_cache, A_v_cache, A_wq, A_wo, B_x, B_w1, B_b1, B_w2, B_b2):
    def _A_ref(x, k_cache, v_cache, wq, wo):
        B, Sq, D = x.shape
        H, Dh = 32, 128
        q = (lambda x, *d: x.permute(*d))((x @ wq).reshape(B, Sq, H, Dh), 0, 2, 1, 3)
        scores = torch.einsum("bhqd,bhkd->bhqk", q, k_cache) * (Dh ** -0.5)
        p = _softmax(scores, axis=-1)
        o = torch.einsum("bhqk,bhkd->bhqd", p, v_cache)
        return (lambda x, *d: x.permute(*d))(o, 0, 2, 1, 3).reshape(B, Sq, H * Dh) @ wo

    def _B_ref(x, w1, b1, w2, b2):
        B, S, D = x.shape
        h = _layernorm(x, axis=-1)
        u = torch.einsum("bsd,sf->bdf", h, w1) + b1
        u = _gelu(u)
        y = torch.einsum("bdf,fs->bds", u, w2) + b2
        return (lambda x, *d: x.permute(*d))(y, 0, 2, 1)

    x = A_x
    xn = _layernorm(x, axis=-1)
    s = _A_ref(xn, A_k_cache, A_v_cache, A_wq, A_wo)
    g = _silu(_B_ref(xn, B_w1, B_b1, B_w2, B_b2))
    return x + s * g
```

```asm
; @launch grid=(256,1,1) block=(256,1,1) lds=163840
.amdgcn_target "amdgcn-amd-amdhsa--gfx950"
.text
.globl recurrent_scan__mha_block_cached__mixer_token_mlp__prompt_kernel
.p2align 8
.type recurrent_scan__mha_block_cached__mixer_token_mlp__prompt_kernel,@function
recurrent_scan__mha_block_cached__mixer_token_mlp__prompt_kernel:
  s_cmp_ge_u32 s2, 256
  s_cbranch_scc1 L_END
  s_mov_b32 s37, 0
  s_mov_b32 s31, 0
L_RESTART:
  s_load_dwordx16 s[40:55], s[0:1], 0
  s_load_dwordx8 s[56:63], s[0:1], 64
  s_load_dwordx2 s[64:65], s[0:1], 96
  s_getpc_b64 s[100:101]
L_PC:
  v_lshrrev_b32 v1, 6, v0
  v_and_b32 v2, 63, v0
  s_bfe_u32 s3, s2, 0x40003
  s_lshl_b32 s3, s3, 4
  v_and_b32 v6, 3, v2
  v_lshl_add_u32 v0, v1, 2, v6
  v_add_u32 v0, s3, v0
  v_lshlrev_b32 v0, 7, v0
  global_load_dword a255, v0, s[100:101]
  v_readfirstlane_b32 s28, v1
  v_lshrrev_b32 v8, 5, v2
  v_and_b32 v9, 31, v2
  v_mul_u32_u24 v7, 20480, v8
  v_lshl_add_u32 v7, v9, 3, v7
  s_lshr_b32 s79, s2, 2
  s_lshl_b32 s79, s79, 5
  s_and_b32 s38, s2, 3
  s_lshl_b32 s38, s38, 2
  s_add_u32 s38, s38, s28
  s_add_u32 s79, s79, s38
  s_mul_i32 s3, s79, 1280
  s_and_b32 s29, s2, 31
  s_lshr_b32 s30, s2, 5
  v_and_b32 v3, 15, v2
  v_lshrrev_b32 v4, 4, v2
  v_bfe_u32 v5, v2, 2, 2
  v_lshrrev_b32 v1, 3, v2
  v_mul_u32_u24 v1, 1280, v1
  v_and_b32 v10, 7, v2
  v_xor_b32 v10, v10, v4
  v_lshl_add_u32 v244, v10, 4, v1
  v_xor_b32 v10, 4, v10
  v_lshl_add_u32 v245, v10, 4, v1
  v_lshlrev_b32 v1, 2, v4
  v_xor_b32 v1, v3, v1
  v_lshlrev_b32 v1, 4, v1
  v_lshl_add_u32 v33, v4, 13, v1
  s_lshl_b32 s39, s28, 16
  v_add_u32 v33, s39, v33
  s_and_b32 s76, s30, 3
  s_mul_i32 s76, s76, 5
  s_lshr_b32 s76, s76, 1
  s_lshl_b32 s77, s76, 7
  s_lshl_b32 s76, s76, 19
  s_lshr_b32 s69, s28, 1
  s_lshl_b32 s69, s69, 11
  s_add_u32 s69, s69, 40960
  s_and_b32 s70, s28, 1
  s_mul_i32 s70, s70, 24584
  s_sub_u32 s69, s69, s70
  s_lshl_b32 s70, s28, 13
  s_lshl_b32 s39, s30, 2
  s_add_u32 s39, s39, s28
  s_mul_i32 s66, s39, 81920
  s_lshl_b32 s36, s29, 8
  s_waitcnt lgkmcnt(0)
  s_mov_b32 s24, s40
  s_and_b32 s25, s41, 0xffff
  s_mov_b32 s26, 2621440
  s_mov_b32 s27, 0x20000
  buffer_load_dwordx2 v[212:213], v7, s[24:27], s3 offen offset:0
  buffer_load_dwordx2 v[214:215], v7, s[24:27], s3 offen offset:256
  buffer_load_dwordx2 v[216:217], v7, s[24:27], s3 offen offset:512
  buffer_load_dwordx2 v[218:219], v7, s[24:27], s3 offen offset:768
  buffer_load_dwordx2 v[220:221], v7, s[24:27], s3 offen offset:1024
  v_mov_b32 v149, 14942208
  global_load_dword v148, v149, s[64:65] sc1
  s_add_u32 s16, s40, s66
  s_addc_u32 s17, s41, 0
  s_and_b32 s17, s17, 0xffff
  s_mov_b32 s18, 81920
  s_mov_b32 s19, 0x20000
  s_add_u32 s12, s46, s36
  s_addc_u32 s13, s47, 0
  s_and_b32 s13, s13, 0xffff
  s_mov_b32 s14, 5234944
  s_mov_b32 s15, 0x20000
  s_add_u32 m0, s69, 16384
  s_nop 0
  buffer_load_dwordx4 v33, s[12:15], s76 offen lds
  s_add_u32 s76, s76, 32768
  s_add_u32 m0, s69, 17408
  s_nop 0
  buffer_load_dwordx4 v33, s[12:15], s76 offen lds
  s_add_u32 s76, s76, 229376
  s_add_u32 m0, s69, 20480
  s_nop 0
  buffer_load_dwordx4 v33, s[12:15], s76 offen lds
  s_add_u32 s76, s76, 32768
  s_add_u32 m0, s69, 21504
  s_nop 0
  buffer_load_dwordx4 v33, s[12:15], s76 offen lds
  s_add_u32 s76, s76, 229376
  s_cmp_eq_u32 s76, 5242880
  s_cselect_b32 s76, 0, s76
  s_add_u32 m0, s70, 98304
  s_nop 0
  buffer_load_dwordx4 v244, s[16:19], s77 offen lds
  s_add_u32 s77, s77, 10240
  s_add_u32 m0, s70, 99328
  s_nop 0
  buffer_load_dwordx4 v245, s[16:19], s77 offen lds
  s_add_u32 s77, s77, 10240
  s_add_u32 m0, s70, 100352
  s_nop 0
  buffer_load_dwordx4 v244, s[16:19], s77 offen lds
  s_add_u32 s77, s77, 10240
  s_add_u32 m0, s70, 101376
  s_nop 0
  buffer_load_dwordx4 v245, s[16:19], s77 offen lds
  s_add_u32 s77, s77, 10240
  s_add_u32 m0, s70, 102400
  s_nop 0
  buffer_load_dwordx4 v244, s[16:19], s77 offen lds
  s_add_u32 s77, s77, 10240
  s_add_u32 m0, s70, 103424
  s_nop 0
  buffer_load_dwordx4 v245, s[16:19], s77 offen lds
  s_add_u32 s77, s77, 10240
  s_add_u32 m0, s70, 104448
  s_nop 0
  buffer_load_dwordx4 v244, s[16:19], s77 offen lds
  s_add_u32 s77, s77, 10240
  s_add_u32 m0, s70, 105472
  s_nop 0
  buffer_load_dwordx4 v245, s[16:19], s77 offen lds
  s_sub_u32 s77, s77, 71552
  s_cmp_eq_u32 s77, 1280
  s_cselect_b32 s77, 0, s77
  s_mov_b32 s20, s64
  s_and_b32 s21, s65, 0xffff
  s_mov_b32 s22, 39845888
  s_mov_b32 s23, 0x20000
  s_lshl_b32 s38, s29, 19
  s_add_u32 s4, s42, s38
  s_addc_u32 s5, s43, 0
  s_and_b32 s5, s5, 0xffff
  s_mov_b32 s6, 524288
  s_mov_b32 s7, 0x20000
  s_add_u32 s8, s44, s38
  s_addc_u32 s9, s45, 0
  s_and_b32 s9, s9, 0xffff
  s_mov_b32 s10, 524288
  s_mov_b32 s11, 0x20000
  v_lshlrev_b32 v26, 4, v2
  v_add_u32 v27, 4096, v26
  v_lshlrev_b32 v253, 2, v8
  v_add_u32 v253, s28, v253
  v_mul_u32_u24 v253, 1296, v253
  v_lshl_add_u32 v253, v9, 3, v253
  v_add_u32 v253, 0, v253
  v_lshlrev_b32 v254, 4, v8
  v_add_u32 v254, s79, v254
  v_lshlrev_b32 v254, 4, v254
  s_lshl_b32 s38, s39, 6
  v_add_u32 v249, s38, v3
  v_lshlrev_b32 v249, 4, v249
  v_lshrrev_b32 v1, 1, v3
  v_xor_b32 v1, v1, v4
  v_lshlrev_b32 v10, 7, v3
  v_add_u32 v10, s70, v10
  v_add_u32 v10, 65536, v10
  v_lshl_add_u32 v240, v1, 4, v10
  v_xor_b32 v1, 4, v1
  v_lshl_add_u32 v241, v1, 4, v10
  v_add_u32 v242, 65536, v240
  v_add_u32 v243, 65536, v241
  v_lshrrev_b32 v10, 1, v4
  v_lshl_add_u32 v10, v10, 3, v5
  v_lshlrev_b32 v10, 8, v10
  v_lshl_add_u32 v10, v6, 4, v10
  v_add_u32 v10, 40960, v10
  v_and_b32 v1, 1, v4
  v_mul_u32_u24 v1, 24584, v1
  v_sub_u32 v10, v10, v1
  s_add_u32 s38, s28, 0
  s_and_b32 s38, s38, 3
  v_xor_b32 v1, s38, v5
  v_lshl_add_u32 v28, v1, 6, v10
  s_add_u32 s38, s28, 1
  s_and_b32 s38, s38, 3
  v_xor_b32 v1, s38, v5
  v_lshl_add_u32 v29, v1, 6, v10
  s_add_u32 s38, s28, 2
  s_and_b32 s38, s38, 3
  v_xor_b32 v1, s38, v5
  v_lshl_add_u32 v30, v1, 6, v10
  s_add_u32 s38, s28, 3
  s_and_b32 s38, s38, 3
  v_xor_b32 v1, s38, v5
  v_lshl_add_u32 v31, v1, 6, v10
  v_lshlrev_b32 v248, 4, v4
  s_lshl_b32 s38, s28, 7
  v_add_u32 v248, s38, v248
  v_add_u32 v248, 90112, v248
  v_mul_u32_u24 v232, 1296, v5
  v_lshl_add_u32 v232, v6, 3, v232
  v_lshl_add_u32 v232, v4, 5, v232
  s_add_u32 s38, s38, 0
  v_add_u32 v232, s38, v232
  s_lshr_b32 s66, s2, 2
  s_mul_i32 s66, s66, 5120
  s_and_b32 s38, s2, 3
  s_lshl_b32 s38, s38, 8
  s_add_u32 s66, s66, s38
  s_add_u32 s66, s66, 3145728
  s_lshl_b32 s38, s28, 2
  s_add_u32 s38, s38, 0
  v_add_u32 v1, s38, v4
  v_mul_u32_u24 v7, 205, v1
  v_lshrrev_b32 v7, 10, v7
  v_mul_u32_u24 v150, 5, v7
  v_sub_u32 v150, v1, v150
  v_mul_u32_u24 v7, 327680, v7
  v_lshl_add_u32 v7, v150, 10, v7
  v_lshl_add_u32 v233, v3, 4, v7
  s_lshl_b32 s38, s28, 2
  s_add_u32 s38, s38, 16
  v_add_u32 v1, s38, v4
  v_mul_u32_u24 v7, 205, v1
  v_lshrrev_b32 v7, 10, v7
  v_mul_u32_u24 v150, 5, v7
  v_sub_u32 v150, v1, v150
  v_mul_u32_u24 v7, 327680, v7
  v_lshl_add_u32 v7, v150, 10, v7
  v_lshl_add_u32 v234, v3, 4, v7
  s_lshl_b32 s38, s28, 2
  s_add_u32 s38, s38, 32
  v_add_u32 v1, s38, v4
  v_mul_u32_u24 v7, 205, v1
  v_lshrrev_b32 v7, 10, v7
  v_mul_u32_u24 v150, 5, v7
  v_sub_u32 v150, v1, v150
  v_mul_u32_u24 v7, 327680, v7
  v_lshl_add_u32 v7, v150, 10, v7
  v_lshl_add_u32 v235, v3, 4, v7
  s_cmp_lt_u32 s28, 2
  s_cselect_b32 s79, s66, 0x8000000
  v_mov_b32 v7, 0x3f803f80
  v_accvgpr_write_b32 a248, v7
  v_accvgpr_write_b32 a249, v7
  v_accvgpr_write_b32 a250, v7
  v_accvgpr_write_b32 a251, v7
  s_waitcnt vmcnt(12)
  v_readfirstlane_b32 s67, v148
  v_lshlrev_b32 v100, 16, v212
  v_and_b32 v101, 0xffff0000, v212
  v_lshlrev_b32 v102, 16, v213
  v_and_b32 v103, 0xffff0000, v213
  v_lshlrev_b32 v104, 16, v214
  v_and_b32 v105, 0xffff0000, v214
  v_lshlrev_b32 v106, 16, v215
  v_and_b32 v107, 0xffff0000, v215
  s_add_u32 m0, s69, 0
  s_nop 0
  buffer_load_dwordx4 v33, s[12:15], s76 offen lds
  s_add_u32 s76, s76, 32768
  v_lshlrev_b32 v108, 16, v216
  v_and_b32 v109, 0xffff0000, v216
  v_lshlrev_b32 v110, 16, v217
  v_and_b32 v111, 0xffff0000, v217
  v_lshlrev_b32 v112, 16, v218
  v_and_b32 v113, 0xffff0000, v218
  v_lshlrev_b32 v114, 16, v219
  v_and_b32 v115, 0xffff0000, v219
  v_lshlrev_b32 v116, 16, v220
  v_and_b32 v117, 0xffff0000, v220
  v_lshlrev_b32 v118, 16, v221
  v_and_b32 v119, 0xffff0000, v221
  v_pk_add_f32 v[120:121], v[100:101], v[102:103]
  v_pk_add_f32 v[122:123], v[104:105], v[106:107]
  v_pk_add_f32 v[120:121], v[120:121], v[108:109]
  s_add_u32 m0, s69, 1024
  s_nop 0
  buffer_load_dwordx4 v33, s[12:15], s76 offen lds
  s_add_u32 s76, s76, 229376
  v_pk_add_f32 v[122:123], v[122:123], v[110:111]
  v_pk_add_f32 v[120:121], v[120:121], v[112:113]
  v_pk_add_f32 v[122:123], v[122:123], v[114:115]
  v_pk_add_f32 v[120:121], v[120:121], v[116:117]
  v_pk_add_f32 v[122:123], v[122:123], v[118:119]
  v_pk_add_f32 v[120:121], v[120:121], v[122:123]
  v_add_f32 v120, v120, v121
  s_nop 1
  v_add_f32_dpp v120, v120, v120 row_ror:8 row_mask:0xf bank_mask:0xf
  s_nop 1
  v_add_f32_dpp v120, v120, v120 row_ror:4 row_mask:0xf bank_mask:0xf
  s_nop 1
  v_add_f32_dpp v120, v120, v120 row_ror:2 row_mask:0xf bank_mask:0xf
  s_nop 1
  v_add_f32_dpp v120, v120, v120 row_ror:1 row_mask:0xf bank_mask:0xf
  v_mov_b32 v121, v120
  s_nop 1
  v_permlane16_swap_b32 v120, v121
  s_nop 1
  v_add_f32 v120, v120, v121
  v_mul_f32 v122, 0xbacccccd, v120
  v_mov_b32 v123, v122
  v_pk_add_f32 v[128:129], v[100:101], v[122:123]
  v_pk_add_f32 v[130:131], v[102:103], v[122:123]
  v_pk_add_f32 v[132:133], v[104:105], v[122:123]
  v_pk_add_f32 v[134:135], v[106:107], v[122:123]
  v_pk_add_f32 v[136:137], v[108:109], v[122:123]
  v_pk_add_f32 v[138:139], v[110:111], v[122:123]
  v_pk_add_f32 v[140:141], v[112:113], v[122:123]
  v_pk_add_f32 v[142:143], v[114:115], v[122:123]
  s_add_u32 m0, s69, 4096
  s_nop 0
  buffer_load_dwordx4 v33, s[12:15], s76 offen lds
  s_add_u32 s76, s76, 32768
  v_pk_add_f32 v[144:145], v[116:117], v[122:123]
  v_pk_add_f32 v[146:147], v[118:119], v[122:123]
  v_pk_mul_f32 v[120:121], v[128:129], v[128:129]
  v_pk_mul_f32 v[124:125], v[130:131], v[130:131]
  v_pk_fma_f32 v[120:121], v[132:133], v[132:133], v[120:121]
  v_pk_fma_f32 v[124:125], v[134:135], v[134:135], v[124:125]
  v_pk_fma_f32 v[120:121], v[136:137], v[136:137], v[120:121]
  v_pk_fma_f32 v[124:125], v[138:139], v[138:139], v[124:125]
  v_pk_fma_f32 v[120:121], v[140:141], v[140:141], v[120:121]
  v_pk_fma_f32 v[124:125], v[142:143], v[142:143], v[124:125]
  v_pk_fma_f32 v[120:121], v[144:145], v[144:145], v[120:121]
  v_pk_fma_f32 v[124:125], v[146:147], v[146:147], v[124:125]
  v_pk_add_f32 v[120:121], v[120:121], v[124:125]
  v_add_f32 v120, v120, v121
  v_cvt_pk_bf16_f32 v122, v122, v122
  v_and_b32 v122, 0xffff0000, v122
  s_add_u32 m0, s69, 5120
  s_nop 0
  buffer_load_dwordx4 v33, s[12:15], s76 offen lds
  s_add_u32 s76, s76, 229376
  s_cmp_eq_u32 s76, 5242880
  s_cselect_b32 s76, 0, s76
  v_mov_b32 v123, v122
  s_nop 1
  v_add_f32_dpp v120, v120, v120 row_ror:8 row_mask:0xf bank_mask:0xf
  s_nop 1
  v_add_f32_dpp v120, v120, v120 row_ror:4 row_mask:0xf bank_mask:0xf
  s_nop 1
  v_add_f32_dpp v120, v120, v120 row_ror:2 row_mask:0xf bank_mask:0xf
  s_nop 1
  v_add_f32_dpp v120, v120, v120 row_ror:1 row_mask:0xf bank_mask:0xf
  v_mov_b32 v121, v120
  s_nop 1
  v_permlane16_swap_b32 v120, v121
  s_nop 1
  v_add_f32 v120, v120, v121
  v_mul_f32 v120, 0x3acccccd, v120
  v_cvt_pk_bf16_f32 v120, v120, v120
  v_and_b32 v120, 0xffff0000, v120
  v_add_f32 v120, 0x3727c5ac, v120
  v_cvt_pk_bf16_f32 v120, v120, v120
  v_and_b32 v120, 0xffff0000, v120
  v_sqrt_f32 v120, v120
  v_pk_add_f32 v[128:129], v[100:101], v[122:123]
  v_pk_add_f32 v[130:131], v[102:103], v[122:123]
  v_pk_add_f32 v[132:133], v[104:105], v[122:123]
  v_pk_add_f32 v[134:135], v[106:107], v[122:123]
  v_pk_add_f32 v[136:137], v[108:109], v[122:123]
  v_pk_add_f32 v[138:139], v[110:111], v[122:123]
  v_pk_add_f32 v[140:141], v[112:113], v[122:123]
  v_pk_add_f32 v[142:143], v[114:115], v[122:123]
  v_pk_add_f32 v[144:145], v[116:117], v[122:123]
  v_pk_add_f32 v[146:147], v[118:119], v[122:123]
  v_cvt_pk_bf16_f32 v120, v120, v120
  s_add_u32 m0, s70, 65536
  s_nop 0
  buffer_load_dwordx4 v244, s[16:19], s77 offen lds
  s_add_u32 s77, s77, 10240
  v_and_b32 v120, 0xffff0000, v120
  v_rcp_f32 v120, v120
  v_cvt_pk_bf16_f32 v212, v128, v129
  v_cvt_pk_bf16_f32 v213, v130, v131
  v_cvt_pk_bf16_f32 v214, v132, v133
  v_cvt_pk_bf16_f32 v215, v134, v135
  v_cvt_pk_bf16_f32 v216, v136, v137
  v_cvt_pk_bf16_f32 v217, v138, v139
  v_cvt_pk_bf16_f32 v218, v140, v141
  v_cvt_pk_bf16_f32 v219, v142, v143
  v_cvt_pk_bf16_f32 v220, v144, v145
  v_cvt_pk_bf16_f32 v221, v146, v147
  v_mov_b32 v121, v120
  v_lshlrev_b32 v128, 16, v212
  v_and_b32 v129, 0xffff0000, v212
  v_lshlrev_b32 v130, 16, v213
  v_and_b32 v131, 0xffff0000, v213
  s_add_u32 m0, s70, 66560
  s_nop 0
  buffer_load_dwordx4 v245, s[16:19], s77 offen lds
  s_add_u32 s77, s77, 10240
  v_lshlrev_b32 v132, 16, v214
  v_and_b32 v133, 0xffff0000, v214
  v_lshlrev_b32 v134, 16, v215
  v_and_b32 v135, 0xffff0000, v215
  v_lshlrev_b32 v136, 16, v216
  v_and_b32 v137, 0xffff0000, v216
  v_lshlrev_b32 v138, 16, v217
  v_and_b32 v139, 0xffff0000, v217
  v_lshlrev_b32 v140, 16, v218
  v_and_b32 v141, 0xffff0000, v218
  v_lshlrev_b32 v142, 16, v219
  v_and_b32 v143, 0xffff0000, v219
  v_lshlrev_b32 v144, 16, v220
  v_and_b32 v145, 0xffff0000, v220
  s_add_u32 m0, s70, 67584
  s_nop 0
  buffer_load_dwordx4 v244, s[16:19], s77 offen lds
  s_add_u32 s77, s77, 10240
  v_lshlrev_b32 v146, 16, v221
  v_and_b32 v147, 0xffff0000, v221
  s_mul_i32 s67, s67, 0x9E3779B1
  s_add_u32 s67, s67, 0x7F4A7C15
  s_cmp_eq_u32 s37, 0
  s_cselect_b32 s31, s67, s31
  v_mov_b32 v84, v122
  v_mov_b32 v85, s31
  v_mul_f32 v86, 0x3e0293ee, v120
  v_mov_b32 v87, s31
  s_mov_b32 s38, 15204352
  s_mov_b32 exec_lo, 1
  s_mov_b32 exec_hi, 1
  buffer_store_dwordx4 v[84:87], v254, s[20:23], s38 offen sc1
  s_mov_b64 exec, -1
  v_pk_mul_f32 v[128:129], v[128:129], v[120:121]
  v_pk_mul_f32 v[130:131], v[130:131], v[120:121]
  v_pk_mul_f32 v[132:133], v[132:133], v[120:121]
  v_pk_mul_f32 v[134:135], v[134:135], v[120:121]
  v_pk_mul_f32 v[136:137], v[136:137], v[120:121]
  v_pk_mul_f32 v[138:139], v[138:139], v[120:121]
  v_pk_mul_f32 v[140:141], v[140:141], v[120:121]
  v_pk_mul_f32 v[142:143], v[142:143], v[120:121]
  v_pk_mul_f32 v[144:145], v[144:145], v[120:121]
  v_pk_mul_f32 v[146:147], v[146:147], v[120:121]
  v_cvt_pk_bf16_f32 v212, v128, v129
  v_cvt_pk_bf16_f32 v213, v130, v131
  v_cvt_pk_bf16_f32 v214, v132, v133
  s_add_u32 m0, s70, 68608
  s_nop 0
  buffer_load_dwordx4 v245, s[16:19], s77 offen lds
  s_add_u32 s77, s77, 10240
  v_cvt_pk_bf16_f32 v215, v134, v135
  v_cvt_pk_bf16_f32 v216, v136, v137
  v_cvt_pk_bf16_f32 v217, v138, v139
  v_cvt_pk_bf16_f32 v218, v140, v141
  v_cvt_pk_bf16_f32 v219, v142, v143
  v_cvt_pk_bf16_f32 v220, v144, v145
  v_cvt_pk_bf16_f32 v221, v146, v147
  s_waitcnt vmcnt(9)
  s_barrier
  ds_read_b128 a[0:3], v240 offset:32768
  ds_read_b128 a[16:19], v241 offset:32768
  ds_read_b64_tr_b16 a[128:129], v28 offset:16384
  ds_read_b64_tr_b16 a[130:131], v28 offset:17408
  ds_read_b64_tr_b16 a[132:133], v28 offset:20480
  ds_read_b64_tr_b16 a[134:135], v28 offset:21504
  ds_read_b128 a[4:7], v240 offset:34816
  ds_read_b128 a[20:23], v241 offset:34816
  ds_read_b128 a[8:11], v240 offset:36864
  ds_read_b128 a[24:27], v241 offset:36864
  ds_read_b128 a[12:15], v240 offset:38912
  ds_read_b128 a[28:31], v241 offset:38912
  ds_read_b64_tr_b16 a[136:137], v28 offset:16392
  ds_read_b64_tr_b16 a[138:139], v28 offset:17416
  ds_read_b64_tr_b16 a[140:141], v28 offset:20488
  ds_read_b64_tr_b16 a[142:143], v28 offset:21512
  ds_read_b64_tr_b16 a[144:145], v29 offset:16384
  ds_read_b64_tr_b16 a[146:147], v29 offset:17408
  ds_read_b64_tr_b16 a[148:149], v29 offset:20480
  ds_read_b64_tr_b16 a[150:151], v29 offset:21504
  s_add_u32 m0, s70, 69632
  s_nop 0
  buffer_load_dwordx4 v244, s[16:19], s77 offen lds
  s_add_u32 s77, s77, 10240
  s_add_u32 m0, s70, 70656
  s_nop 0
  buffer_load_dwordx4 v245, s[16:19], s77 offen lds
  s_add_u32 s77, s77, 10240
  s_add_u32 m0, s70, 71680
  s_nop 0
  buffer_load_dwordx4 v244, s[16:19], s77 offen lds
  s_add_u32 s77, s77, 10240
  s_add_u32 m0, s70, 72704
  s_nop 0
  buffer_load_dwordx4 v245, s[16:19], s77 offen lds
  s_sub_u32 s77, s77, 71552
  s_cmp_eq_u32 s77, 1280
  s_cselect_b32 s77, 0, s77
  s_add_u32 m0, s69, 8192
  s_nop 0
  buffer_load_dwordx4 v33, s[12:15], s76 offen lds
  s_add_u32 s76, s76, 32768
  s_add_u32 m0, s69, 9216
  s_nop 0
  buffer_load_dwordx4 v33, s[12:15], s76 offen lds
  s_add_u32 s76, s76, 229376
  s_add_u32 m0, s69, 12288
  s_nop 0
  buffer_load_dwordx4 v33, s[12:15], s76 offen lds
  s_add_u32 s76, s76, 32768
  s_add_u32 m0, s69, 13312
  s_nop 0
  buffer_load_dwordx4 v33, s[12:15], s76 offen lds
  s_add_u32 s76, s76, 229376
  s_cmp_eq_u32 s76, 5242880
  s_cselect_b32 s76, 0, s76
  s_waitcnt lgkmcnt(8)
  v_mfma_f32_16x16x32_bf16 v[64:67], a[128:131], a[0:3], 0
  s_add_u32 m0, s70, 131072
  ds_read_b64_tr_b16 a[152:153], v29 offset:16392
  ds_read_b64_tr_b16 a[154:155], v29 offset:17416
  v_mfma_f32_16x16x32_bf16 v[64:67], a[132:135], a[16:19], v[64:67]
  s_lshl_b32 s32, s28, 11
  buffer_load_dwordx4 v244, s[16:19], s77 offen lds
  v_mfma_f32_16x16x32_bf16 v[68:71], a[132:135], a[20:23], 0
  s_add_u32 s77, s77, 10240
  ds_read_b64_tr_b16 a[156:157], v29 offset:20488
  ds_read_b64_tr_b16 a[158:159], v29 offset:21512
  v_mfma_f32_16x16x32_bf16 v[68:71], a[128:131], a[4:7], v[68:71]
  s_add_u32 m0, s70, 132096
  v_lshlrev_b32 v192, 16, v212
  v_and_b32 v193, 0xffff0000, v212
  v_mfma_f32_16x16x32_bf16 v[72:75], a[128:131], a[8:11], 0
  s_add_u32 s33, s32, 65536
  buffer_load_dwordx4 v245, s[16:19], s77 offen lds
  v_mfma_f32_16x16x32_bf16 v[72:75], a[132:135], a[24:27], v[72:75]
  s_add_u32 s77, s77, 10240
  ds_read_b64_tr_b16 a[160:161], v30 offset:16384
  ds_read_b64_tr_b16 a[162:163], v30 offset:17408
  v_mfma_f32_16x16x32_bf16 v[76:79], a[132:135], a[28:31], 0
  s_lshl_b32 s78, s28, 10
  ds_read_b64_tr_b16 a[164:165], v30 offset:20480
  ds_read_b64_tr_b16 a[166:167], v30 offset:21504
  v_mfma_f32_16x16x32_bf16 v[76:79], a[128:131], a[12:15], v[76:79]
  s_waitcnt vmcnt(15)
  v_lshlrev_b32 v194, 16, v213
  v_and_b32 v195, 0xffff0000, v213
  v_mfma_f32_16x16x32_bf16 a[64:67], a[128:131], a[248:251], 0
  s_barrier
  ds_read_b64_tr_b16 a[168:169], v30 offset:16392
  ds_read_b64_tr_b16 a[170:171], v30 offset:17416
  v_mfma_f32_16x16x32_bf16 a[64:67], a[132:135], a[248:251], a[64:67]
  s_waitcnt lgkmcnt(14)
  ds_read_b64_tr_b16 a[172:173], v30 offset:20488
  ds_read_b64_tr_b16 a[174:175], v30 offset:21512
  v_mfma_f32_16x16x32_bf16 v[80:83], a[136:139], a[0:3], 0
  s_add_u32 m0, s70, 133120
  ds_read_b64_tr_b16 a[128:129], v28 offset:0
  ds_read_b64_tr_b16 a[130:131], v28 offset:1024
  v_mfma_f32_16x16x32_bf16 v[80:83], a[140:143], a[16:19], v[80:83]
  s_add_u32 s78, s78, 65536
  buffer_load_dwordx4 v244, s[16:19], s77 offen lds
  v_mfma_f32_16x16x32_bf16 v[84:87], a[140:143], a[20:23], 0
  s_add_u32 s77, s77, 10240
  ds_read_b64_tr_b16 a[132:133], v28 offset:4096
  ds_read_b64_tr_b16 a[134:135], v28 offset:5120
  v_mfma_f32_16x16x32_bf16 v[84:87], a[136:139], a[4:7], v[84:87]
  s_mul_i32 s34, s29, 16384
  ds_read_b64_tr_b16 a[176:177], v31 offset:16384
  ds_read_b64_tr_b16 a[178:179], v31 offset:17408
  v_mfma_f32_16x16x32_bf16 v[88:91], a[136:139], a[8:11], 0
  s_add_u32 m0, s70, 134144
  ds_read_b64_tr_b16 a[180:181], v31 offset:20480
  ds_read_b64_tr_b16 a[182:183], v31 offset:21504
  v_mfma_f32_16x16x32_bf16 v[88:91], a[140:143], a[24:27], v[88:91]
  s_and_b32 s34, s34, 0x7ffff
  buffer_load_dwordx4 v245, s[16:19], s77 offen lds
  v_mfma_f32_16x16x32_bf16 v[92:95], a[140:143], a[28:31], 0
  s_add_u32 s77, s77, 10240
  ds_read_b64_tr_b16 a[184:185], v31 offset:16392
  ds_read_b64_tr_b16 a[186:187], v31 offset:17416
  v_mfma_f32_16x16x32_bf16 v[92:95], a[136:139], a[12:15], v[92:95]
  s_mov_b32 s35, s34
  ds_read_b64_tr_b16 a[188:189], v31 offset:20488
  ds_read_b64_tr_b16 a[190:191], v31 offset:21512
  v_mfma_f32_16x16x32_bf16 a[68:71], a[136:139], a[248:251], 0
  s_add_u32 m0, s70, 135168
  v_lshlrev_b32 v196, 16, v214
  v_and_b32 v197, 0xffff0000, v214
  v_mfma_f32_16x16x32_bf16 a[68:71], a[140:143], a[248:251], a[68:71]
  s_waitcnt lgkmcnt(15)
  buffer_load_dwordx4 v244, s[16:19], s77 offen lds
  v_mfma_f32_16x16x32_bf16 v[96:99], a[144:147], a[0:3], 0
  s_add_u32 s77, s77, 10240
  ds_read_b64_tr_b16 a[136:137], v28 offset:8
  ds_read_b64_tr_b16 a[138:139], v28 offset:1032
  v_mfma_f32_16x16x32_bf16 v[96:99], a[148:151], a[16:19], v[96:99]
  s_and_b32 s38, s2, 7
  v_lshlrev_b32 v198, 16, v215
  v_and_b32 v199, 0xffff0000, v215
  v_mfma_f32_16x16x32_bf16 v[100:103], a[148:151], a[20:23], 0
  s_lshr_b32 s39, s2, 3
  ds_read_b64_tr_b16 a[140:141], v28 offset:4104
  ds_read_b64_tr_b16 a[142:143], v28 offset:5128
  v_mfma_f32_16x16x32_bf16 v[100:103], a[144:147], a[4:7], v[100:103]
  s_mul_i32 s72, s38, 27
  v_lshlrev_b32 v200, 16, v216
  v_and_b32 v201, 0xffff0000, v216
  v_mfma_f32_16x16x32_bf16 v[104:107], a[144:147], a[8:11], 0
  s_add_u32 s72, s72, s39
  v_lshlrev_b32 v202, 16, v217
  v_and_b32 v203, 0xffff0000, v217
  v_mfma_f32_16x16x32_bf16 v[104:107], a[148:151], a[24:27], v[104:107]
  s_cmp_lt_u32 s39, 27
  s_cselect_b32 s72, s72, s2
  v_lshlrev_b32 v204, 16, v218
  v_and_b32 v205, 0xffff0000, v218
  v_mfma_f32_16x16x32_bf16 v[108:111], a[148:151], a[28:31], 0
  s_add_u32 m0, s70, 136192
  v_lshlrev_b32 v206, 16, v219
  v_and_b32 v207, 0xffff0000, v219
  v_mfma_f32_16x16x32_bf16 v[108:111], a[144:147], a[12:15], v[108:111]
  s_waitcnt lgkmcnt(15)
  buffer_load_dwordx4 v245, s[16:19], s77 offen lds
  v_mfma_f32_16x16x32_bf16 v[112:115], a[152:155], a[0:3], 0
  s_add_u32 s77, s77, 10240
  ds_read_b64_tr_b16 a[144:145], v29 offset:0
  ds_read_b64_tr_b16 a[146:147], v29 offset:1024
  v_mfma_f32_16x16x32_bf16 v[112:115], a[156:159], a[16:19], v[112:115]
  s_and_b32 s73, s72, 7
  v_lshlrev_b32 v208, 16, v220
  v_and_b32 v209, 0xffff0000, v220
  v_mfma_f32_16x16x32_bf16 v[116:119], a[156:159], a[20:23], 0
  s_add_u32 m0, s70, 137216
  ds_read_b64_tr_b16 a[148:149], v29 offset:4096
  ds_read_b64_tr_b16 a[150:151], v29 offset:5120
  v_mfma_f32_16x16x32_bf16 v[116:119], a[152:155], a[4:7], v[116:119]
  s_lshr_b32 s74, s38, 1
  buffer_load_dwordx4 v244, s[16:19], s77 offen lds
  v_mfma_f32_16x16x32_bf16 v[120:123], a[152:155], a[8:11], 0
  s_waitcnt vmcnt(11)
  ds_read_b128 a[32:35], v240 offset:0
  v_lshlrev_b32 v210, 16, v221
  v_mfma_f32_16x16x32_bf16 v[120:123], a[156:159], a[24:27], v[120:123]
  s_add_u32 s77, s77, 10240
  v_and_b32 v211, 0xffff0000, v221
  v_add_f32 v222, v192, v193
  v_mfma_f32_16x16x32_bf16 v[124:127], a[156:159], a[28:31], 0
  s_add_u32 m0, s70, 138240
  ds_read_b128 a[36:39], v240 offset:2048
  v_add_f32 v224, v194, v195
  v_mfma_f32_16x16x32_bf16 v[124:127], a[152:155], a[12:15], v[124:127]
  s_waitcnt lgkmcnt(10)
  buffer_load_dwordx4 v245, s[16:19], s77 offen lds
  v_mfma_f32_16x16x32_bf16 v[128:131], a[160:163], a[0:3], 0
  s_barrier
  ds_read_b64_tr_b16 a[152:153], v29 offset:8
  ds_read_b64_tr_b16 a[154:155], v29 offset:1032
  v_mfma_f32_16x16x32_bf16 v[128:131], a[164:167], a[16:19], v[128:131]
  s_sub_u32 s77, s77, 71552
  v_add_f32 v222, v222, v196
  v_add_f32 v224, v224, v197
  v_mfma_f32_16x16x32_bf16 v[132:135], a[164:167], a[20:23], 0
  s_add_u32 m0, s70, 98304
  ds_read_b64_tr_b16 a[156:157], v29 offset:4104
  ds_read_b64_tr_b16 a[158:159], v29 offset:5128
  v_mfma_f32_16x16x32_bf16 v[132:135], a[160:163], a[4:7], v[132:135]
  s_cmp_eq_u32 s77, 1280
  s_cselect_b32 s77, 0, s77
  buffer_load_dwordx4 v244, s[16:19], s77 offen lds
  v_mfma_f32_16x16x32_bf16 v[136:139], a[160:163], a[8:11], 0
  s_add_u32 s77, s77, 10240
  ds_read_b128 a[40:43], v240 offset:4096
  v_add_f32 v222, v222, v198
  v_mfma_f32_16x16x32_bf16 v[136:139], a[164:167], a[24:27], v[136:139]
  s_lshl_b32 s74, s74, 3
  v_add_f32 v224, v224, v199
  v_add_f32 v222, v222, v200
  v_mfma_f32_16x16x32_bf16 v[140:143], a[164:167], a[28:31], 0
  s_add_u32 m0, s70, 99328
  ds_read_b128 a[44:47], v240 offset:6144
  v_add_f32 v224, v224, v201
  v_mfma_f32_16x16x32_bf16 v[140:143], a[160:163], a[12:15], v[140:143]
  s_lshr_b32 s3, s39, 2
  buffer_load_dwordx4 v245, s[16:19], s77 offen lds
  v_mfma_f32_16x16x32_bf16 v[144:147], a[168:171], a[0:3], 0
  s_add_u32 s77, s77, 10240
  ds_read_b64_tr_b16 a[160:161], v30 offset:0
  ds_read_b64_tr_b16 a[162:163], v30 offset:1024
  v_mfma_f32_16x16x32_bf16 v[144:147], a[172:175], a[16:19], v[144:147]
  s_add_u32 s74, s74, s3
  v_add_f32 v222, v222, v202
  v_add_f32 v224, v224, v203
  v_mfma_f32_16x16x32_bf16 v[148:151], a[172:175], a[20:23], 0
  s_add_u32 m0, s69, 16384
  ds_read_b64_tr_b16 a[164:165], v30 offset:4096
  ds_read_b64_tr_b16 a[166:167], v30 offset:5120
  v_mfma_f32_16x16x32_bf16 v[148:151], a[168:171], a[4:7], v[148:151]
  s_and_b32 s75, s38, 1
  buffer_load_dwordx4 v33, s[12:15], s76 offen lds
  v_mfma_f32_16x16x32_bf16 v[152:155], a[168:171], a[8:11], 0
  s_add_u32 s76, s76, 32768
  ds_read_b128 a[48:51], v241 offset:0
  v_add_f32 v222, v222, v204
  v_mfma_f32_16x16x32_bf16 v[152:155], a[172:175], a[24:27], v[152:155]
  s_lshl_b32 s75, s75, 2
  v_add_f32 v224, v224, v205
  v_add_f32 v222, v222, v206
  v_mfma_f32_16x16x32_bf16 v[156:159], a[172:175], a[28:31], 0
  s_and_b32 s3, s39, 3
  ds_read_b128 a[52:55], v241 offset:2048
  v_add_f32 v224, v224, v207
  v_mfma_f32_16x16x32_bf16 v[156:159], a[168:171], a[12:15], v[156:159]
  s_add_u32 s75, s75, s3
  v_add_f32 v222, v222, v208
  v_add_f32 v224, v224, v209
  v_mfma_f32_16x16x32_bf16 v[160:163], a[176:179], a[0:3], 0
  s_mov_b32 s44, s48
  ds_read_b64_tr_b16 a[168:169], v30 offset:8
  ds_read_b64_tr_b16 a[170:171], v30 offset:1032
  v_mfma_f32_16x16x32_bf16 v[160:163], a[180:183], a[16:19], v[160:163]
  s_and_b32 s45, s49, 0xffff
  v_add_f32 v222, v222, v210
  v_add_f32 v224, v224, v211
  v_mfma_f32_16x16x32_bf16 v[164:167], a[180:183], a[20:23], 0
  s_add_u32 m0, s69, 17408
  ds_read_b64_tr_b16 a[172:173], v30 offset:4104
  ds_read_b64_tr_b16 a[174:175], v30 offset:5128
  v_mfma_f32_16x16x32_bf16 v[164:167], a[176:179], a[4:7], v[164:167]
  s_mov_b32 s46, 5242880
  buffer_load_dwordx4 v33, s[12:15], s76 offen lds
  v_mfma_f32_16x16x32_bf16 v[168:171], a[176:179], a[8:11], 0
  s_add_u32 s76, s76, 229376
  ds_read_b128 a[56:59], v241 offset:4096
  v_add_f32 v222, v222, v224
  v_mfma_f32_16x16x32_bf16 v[168:171], a[180:183], a[24:27], v[168:171]
  s_mov_b32 s47, 0x20000
  v_mfma_f32_16x16x32_bf16 v[172:175], a[180:183], a[28:31], 0
  s_add_u32 m0, s69, 20480
  ds_read_b128 a[60:63], v241 offset:6144
  v_add_f32_dpp v222, v222, v222 row_ror:8 row_mask:0xf bank_mask:0xf
  v_mfma_f32_16x16x32_bf16 v[172:175], a[176:179], a[12:15], v[172:175]
  s_lshr_b32 s38, s2, 1
  buffer_load_dwordx4 v33, s[12:15], s76 offen lds
  v_mfma_f32_16x16x32_bf16 v[176:179], a[184:187], a[0:3], 0
  s_add_u32 s76, s76, 32768
  ds_read_b64_tr_b16 a[176:177], v31 offset:0
  ds_read_b64_tr_b16 a[178:179], v31 offset:1024
  v_mfma_f32_16x16x32_bf16 v[176:179], a[188:191], a[16:19], v[176:179]
  s_and_b32 s39, s2, 1
  v_add_f32_dpp v222, v222, v222 row_ror:4 row_mask:0xf bank_mask:0xf
  v_mfma_f32_16x16x32_bf16 v[180:183], a[188:191], a[20:23], 0
  s_add_u32 m0, s69, 21504
  ds_read_b64_tr_b16 a[180:181], v31 offset:4096
  ds_read_b64_tr_b16 a[182:183], v31 offset:5120
  v_mfma_f32_16x16x32_bf16 v[180:183], a[184:187], a[4:7], v[180:183]
  s_mul_i32 s39, s39, 20
  buffer_load_dwordx4 v33, s[12:15], s76 offen lds
  v_mfma_f32_16x16x32_bf16 v[184:187], a[184:187], a[8:11], 0
  s_add_u32 s76, s76, 229376
  v_add_f32_dpp v222, v222, v222 row_ror:2 row_mask:0xf bank_mask:0xf
  v_mfma_f32_16x16x32_bf16 v[184:187], a[188:191], a[24:27], v[184:187]
  s_cmp_eq_u32 s76, 5242880
  s_cselect_b32 s76, 0, s76
  v_mfma_f32_16x16x32_bf16 v[188:191], a[188:191], a[28:31], 0
  s_add_u32 s50, s39, s28
  ds_read_b64_tr_b16 a[188:189], v31 offset:4104
  ds_read_b64_tr_b16 a[190:191], v31 offset:5128
  v_mfma_f32_16x16x32_bf16 v[188:191], a[184:187], a[12:15], v[188:191]
  s_waitcnt lgkmcnt(6)
  ds_read_b64_tr_b16 a[184:185], v31 offset:8
  ds_read_b64_tr_b16 a[186:187], v31 offset:1032
  v_mfma_f32_16x16x32_bf16 v[64:67], a[128:131], a[32:35], v[64:67]
  s_add_u32 m0, s70, 100352
  v_add_f32_dpp v222, v222, v222 row_ror:1 row_mask:0xf bank_mask:0xf
  v_mov_b32 v224, v222
  v_mfma_f32_16x16x32_bf16 v[64:67], a[132:135], a[48:51], v[64:67]
  s_mul_i32 s42, s38, 40960
  buffer_load_dwordx4 v244, s[16:19], s77 offen lds
  v_mfma_f32_16x16x32_bf16 v[68:71], a[132:135], a[52:55], v[68:71]
  s_add_u32 s77, s77, 10240
  v_permlane16_swap_b32 v222, v224
  v_mfma_f32_16x16x32_bf16 v[68:71], a[128:131], a[36:39], v[68:71]
  s_add_u32 m0, s70, 101376
  v_mfma_f32_16x16x32_bf16 v[72:75], a[128:131], a[40:43], v[72:75]
  s_lshl_b32 s3, s50, 5
  buffer_load_dwordx4 v245, s[16:19], s77 offen lds
  v_mfma_f32_16x16x32_bf16 v[72:75], a[132:135], a[56:59], v[72:75]
  s_add_u32 s77, s77, 10240
  v_add_f32 v222, v222, v224
  v_mul_f32 v223, 0xbacccccd, v222
  v_mfma_f32_16x16x32_bf16 v[76:79], a[132:135], a[60:63], v[76:79]
  s_add_u32 s42, s42, s3
  v_add_f32 v224, v192, v223
  v_add_f32 v225, v193, v223
  v_mfma_f32_16x16x32_bf16 v[76:79], a[128:131], a[44:47], v[76:79]
  s_waitcnt lgkmcnt(0)
  v_mul_f32 v222, v224, v224
  v_fmac_f32 v222, v225, v225
  v_mfma_f32_16x16x32_bf16 a[64:67], a[128:131], a[248:251], a[64:67]
  s_waitcnt vmcnt(16)
  v_add_f32 v224, v194, v223
  v_add_f32 v225, v195, v223
  v_mfma_f32_16x16x32_bf16 a[64:67], a[132:135], a[248:251], a[64:67]
  s_barrier
  v_fmac_f32 v222, v224, v224
  v_fmac_f32 v222, v225, v225
  v_mfma_f32_16x16x32_bf16 v[80:83], a[136:139], a[32:35], v[80:83]
  s_add_u32 m0, s69, 0
  ds_read_b64_tr_b16 a[128:129], v28 offset:8192
  ds_read_b64_tr_b16 a[130:131], v28 offset:9216
  v_mfma_f32_16x16x32_bf16 v[80:83], a[140:143], a[48:51], v[80:83]
  s_mul_i32 s51, s38, 5
  buffer_load_dwordx4 v33, s[12:15], s76 offen lds
  v_mfma_f32_16x16x32_bf16 v[84:87], a[140:143], a[52:55], v[84:87]
  s_add_u32 s76, s76, 32768
  ds_read_b64_tr_b16 a[132:133], v28 offset:12288
  ds_read_b64_tr_b16 a[134:135], v28 offset:13312
  v_mfma_f32_16x16x32_bf16 v[84:87], a[136:139], a[36:39], v[84:87]
  s_add_u32 s51, s51, 9216
  v_add_f32 v224, v196, v223
  v_add_f32 v225, v197, v223
  v_mfma_f32_16x16x32_bf16 v[88:91], a[136:139], a[40:43], v[88:91]
  s_add_u32 m0, s69, 1024
  v_fmac_f32 v222, v224, v224
  v_fmac_f32 v222, v225, v225
  v_mfma_f32_16x16x32_bf16 v[88:91], a[140:143], a[56:59], v[88:91]
  buffer_load_dwordx4 v33, s[12:15], s76 offen lds
  v_mfma_f32_16x16x32_bf16 v[92:95], a[140:143], a[60:63], v[92:95]
  s_add_u32 s76, s76, 229376
  v_add_f32 v224, v198, v223
  v_add_f32 v225, v199, v223
  v_mfma_f32_16x16x32_bf16 v[92:95], a[136:139], a[44:47], v[92:95]
  v_fmac_f32 v222, v224, v224
  v_fmac_f32 v222, v225, v225
  v_mfma_f32_16x16x32_bf16 a[68:71], a[136:139], a[248:251], a[68:71]
  s_add_u32 m0, s69, 4096
  v_add_f32 v224, v200, v223
  v_add_f32 v225, v201, v223
  v_mfma_f32_16x16x32_bf16 a[68:71], a[140:143], a[248:251], a[68:71]
  buffer_load_dwordx4 v33, s[12:15], s76 offen lds
  v_mfma_f32_16x16x32_bf16 v[96:99], a[144:147], a[32:35], v[96:99]
  s_add_u32 s76, s76, 32768
  ds_read_b64_tr_b16 a[136:137], v28 offset:8200
  ds_read_b64_tr_b16 a[138:139], v28 offset:9224
  v_mfma_f32_16x16x32_bf16 v[96:99], a[148:151], a[48:51], v[96:99]
  v_fmac_f32 v222, v224, v224
  v_fmac_f32 v222, v225, v225
  v_mfma_f32_16x16x32_bf16 v[100:103], a[148:151], a[52:55], v[100:103]
  ds_read_b64_tr_b16 a[140:141], v28 offset:12296
  ds_read_b64_tr_b16 a[142:143], v28 offset:13320
  v_mfma_f32_16x16x32_bf16 v[100:103], a[144:147], a[36:39], v[100:103]
  v_add_f32 v224, v202, v223
  v_add_f32 v225, v203, v223
  v_mfma_f32_16x16x32_bf16 v[104:107], a[144:147], a[40:43], v[104:107]
  v_fmac_f32 v222, v224, v224
  v_fmac_f32 v222, v225, v225
  v_mfma_f32_16x16x32_bf16 v[104:107], a[148:151], a[56:59], v[104:107]
  v_add_f32 v224, v204, v223
  v_add_f32 v225, v205, v223
  v_mfma_f32_16x16x32_bf16 v[108:111], a[148:151], a[60:63], v[108:111]
  s_add_u32 m0, s69, 5120
  v_fmac_f32 v222, v224, v224
  v_fmac_f32 v222, v225, v225
  v_mfma_f32_16x16x32_bf16 v[108:111], a[144:147], a[44:47], v[108:111]
  buffer_load_dwordx4 v33, s[12:15], s76 offen lds
  v_mfma_f32_16x16x32_bf16 v[112:115], a[152:155], a[32:35], v[112:115]
  s_add_u32 s76, s76, 229376
  ds_read_b64_tr_b16 a[144:145], v29 offset:8192
  ds_read_b64_tr_b16 a[146:147], v29 offset:9216
  v_mfma_f32_16x16x32_bf16 v[112:115], a[156:159], a[48:51], v[112:115]
  s_cmp_eq_u32 s76, 5242880
  s_cselect_b32 s76, 0, s76
  v_add_f32 v224, v206, v223
  v_add_f32 v225, v207, v223
  v_mfma_f32_16x16x32_bf16 v[116:119], a[156:159], a[52:55], v[116:119]
  s_add_u32 m0, s70, 102400
  ds_read_b64_tr_b16 a[148:149], v29 offset:12288
  ds_read_b64_tr_b16 a[150:151], v29 offset:13312
  v_mfma_f32_16x16x32_bf16 v[116:119], a[152:155], a[36:39], v[116:119]
  buffer_load_dwordx4 v244, s[16:19], s77 offen lds
  v_mfma_f32_16x16x32_bf16 v[120:123], a[152:155], a[40:43], v[120:123]
  s_waitcnt vmcnt(13)
  ds_read_b128 a[0:3], v242 offset:0
  v_fmac_f32 v222, v224, v224
  v_mfma_f32_16x16x32_bf16 v[120:123], a[156:159], a[56:59], v[120:123]
  s_add_u32 s77, s77, 10240
  v_fmac_f32 v222, v225, v225
  v_add_f32 v224, v208, v223
  v_mfma_f32_16x16x32_bf16 v[124:127], a[156:159], a[60:63], v[124:127]
  s_add_u32 m0, s70, 103424
  ds_read_b128 a[4:7], v242 offset:2048
  v_add_f32 v225, v209, v223
  v_mfma_f32_16x16x32_bf16 v[124:127], a[152:155], a[44:47], v[124:127]
  buffer_load_dwordx4 v245, s[16:19], s77 offen lds
  v_mfma_f32_16x16x32_bf16 v[128:131], a[160:163], a[32:35], v[128:131]
  s_add_u32 s77, s77, 10240
  ds_read_b64_tr_b16 a[152:153], v29 offset:8200
  ds_read_b64_tr_b16 a[154:155], v29 offset:9224
  v_mfma_f32_16x16x32_bf16 v[128:131], a[164:167], a[48:51], v[128:131]
  v_fmac_f32 v222, v224, v224
  v_fmac_f32 v222, v225, v225
  v_mfma_f32_16x16x32_bf16 v[132:135], a[164:167], a[52:55], v[132:135]
  s_add_u32 m0, s70, 104448
  ds_read_b64_tr_b16 a[156:157], v29 offset:12296
  ds_read_b64_tr_b16 a[158:159], v29 offset:13320
  v_mfma_f32_16x16x32_bf16 v[132:135], a[160:163], a[36:39], v[132:135]
  buffer_load_dwordx4 v244, s[16:19], s77 offen lds
  v_mfma_f32_16x16x32_bf16 v[136:139], a[160:163], a[40:43], v[136:139]
  s_add_u32 s77, s77, 10240
  ds_read_b128 a[8:11], v242 offset:4096
  v_add_f32 v224, v210, v223
  v_mfma_f32_16x16x32_bf16 v[136:139], a[164:167], a[56:59], v[136:139]
  v_add_f32 v225, v211, v223
  v_fmac_f32 v222, v224, v224
  v_mfma_f32_16x16x32_bf16 v[140:143], a[164:167], a[60:63], v[140:143]
  s_add_u32 m0, s70, 105472
  ds_read_b128 a[12:15], v242 offset:6144
  v_fmac_f32 v222, v225, v225
  v_mfma_f32_16x16x32_bf16 v[140:143], a[160:163], a[44:47], v[140:143]
  buffer_load_dwordx4 v245, s[16:19], s77 offen lds
  v_mfma_f32_16x16x32_bf16 v[144:147], a[168:171], a[32:35], v[144:147]
  s_sub_u32 s77, s77, 71552
  ds_read_b64_tr_b16 a[160:161], v30 offset:8192
  ds_read_b64_tr_b16 a[162:163], v30 offset:9216
  v_mfma_f32_16x16x32_bf16 v[144:147], a[172:175], a[48:51], v[144:147]
  s_cmp_eq_u32 s77, 1280
  s_cselect_b32 s77, 0, s77
  v_cvt_pk_bf16_f32 v223, v223, v223
  v_and_b32 v223, 0xffff0000, v223
  v_mfma_f32_16x16x32_bf16 v[148:151], a[172:175], a[52:55], v[148:151]
  s_add_u32 m0, s70, 65536
  ds_read_b64_tr_b16 a[164:165], v30 offset:12288
  ds_read_b64_tr_b16 a[166:167], v30 offset:13312
  v_mfma_f32_16x16x32_bf16 v[148:151], a[168:171], a[36:39], v[148:151]
  buffer_load_dwordx4 v244, s[16:19], s77 offen lds
  v_mfma_f32_16x16x32_bf16 v[152:155], a[168:171], a[40:43], v[152:155]
  s_add_u32 s77, s77, 10240
  ds_read_b128 a[16:19], v243 offset:0
  v_add_f32_dpp v222, v222, v222 row_ror:8 row_mask:0xf bank_mask:0xf
  v_mfma_f32_16x16x32_bf16 v[152:155], a[172:175], a[56:59], v[152:155]
  v_mfma_f32_16x16x32_bf16 v[156:159], a[172:175], a[60:63], v[156:159]
  ds_read_b128 a[20:23], v243 offset:2048
  v_add_f32_dpp v222, v222, v222 row_ror:4 row_mask:0xf bank_mask:0xf
  v_mfma_f32_16x16x32_bf16 v[156:159], a[168:171], a[44:47], v[156:159]
  v_mfma_f32_16x16x32_bf16 v[160:163], a[176:179], a[32:35], v[160:163]
  ds_read_b64_tr_b16 a[168:169], v30 offset:8200
  ds_read_b64_tr_b16 a[170:171], v30 offset:9224
  v_mfma_f32_16x16x32_bf16 v[160:163], a[180:183], a[48:51], v[160:163]
  v_add_f32_dpp v222, v222, v222 row_ror:2 row_mask:0xf bank_mask:0xf
  v_mfma_f32_16x16x32_bf16 v[164:167], a[180:183], a[52:55], v[164:167]
  s_add_u32 m0, s70, 66560
  ds_read_b64_tr_b16 a[172:173], v30 offset:12296
  ds_read_b64_tr_b16 a[174:175], v30 offset:13320
  v_mfma_f32_16x16x32_bf16 v[164:167], a[176:179], a[36:39], v[164:167]
  buffer_load_dwordx4 v245, s[16:19], s77 offen lds
  v_mfma_f32_16x16x32_bf16 v[168:171], a[176:179], a[40:43], v[168:171]
  s_add_u32 s77, s77, 10240
  ds_read_b128 a[24:27], v243 offset:4096
  v_add_f32_dpp v222, v222, v222 row_ror:1 row_mask:0xf bank_mask:0xf
  v_mfma_f32_16x16x32_bf16 v[168:171], a[180:183], a[56:59], v[168:171]
  v_mov_b32 v224, v222
  v_mfma_f32_16x16x32_bf16 v[172:175], a[180:183], a[60:63], v[172:175]
  s_add_u32 m0, s70, 67584
  ds_read_b128 a[28:31], v243 offset:6144
  v_mfma_f32_16x16x32_bf16 v[172:175], a[176:179], a[44:47], v[172:175]
  buffer_load_dwordx4 v244, s[16:19], s77 offen lds
  v_mfma_f32_16x16x32_bf16 v[176:179], a[184:187], a[32:35], v[176:179]
  s_add_u32 s77, s77, 10240
  ds_read_b64_tr_b16 a[176:177], v31 offset:8192
  ds_read_b64_tr_b16 a[178:179], v31 offset:9216
  v_mfma_f32_16x16x32_bf16 v[176:179], a[188:191], a[48:51], v[176:179]
  v_permlane16_swap_b32 v222, v224
  v_mfma_f32_16x16x32_bf16 v[180:183], a[188:191], a[52:55], v[180:183]
  s_add_u32 m0, s70, 68608
  ds_read_b64_tr_b16 a[180:181], v31 offset:12288
  ds_read_b64_tr_b16 a[182:183], v31 offset:13312
  v_mfma_f32_16x16x32_bf16 v[180:183], a[184:187], a[36:39], v[180:183]
  buffer_load_dwordx4 v245, s[16:19], s77 offen lds
  v_mfma_f32_16x16x32_bf16 v[184:187], a[184:187], a[40:43], v[184:187]
  s_add_u32 s77, s77, 10240
  v_add_f32 v222, v222, v224
  v_mul_f32 v222, 0x3acccccd, v222
  v_mfma_f32_16x16x32_bf16 v[184:187], a[188:191], a[56:59], v[184:187]
  v_cvt_pk_bf16_f32 v222, v222, v222
  v_and_b32 v222, 0xffff0000, v222
  v_mfma_f32_16x16x32_bf16 v[188:191], a[188:191], a[60:63], v[188:191]
  ds_read_b64_tr_b16 a[188:189], v31 offset:12296
  ds_read_b64_tr_b16 a[190:191], v31 offset:13320
  v_mfma_f32_16x16x32_bf16 v[188:191], a[184:187], a[44:47], v[188:191]
  s_waitcnt lgkmcnt(6)
  ds_read_b64_tr_b16 a[184:185], v31 offset:8200
  ds_read_b64_tr_b16 a[186:187], v31 offset:9224
  v_mfma_f32_16x16x32_bf16 v[64:67], a[128:131], a[0:3], v[64:67]
  s_add_u32 m0, s70, 69632
  v_add_f32 v222, 0x3727c5ac, v222
  v_cvt_pk_bf16_f32 v222, v222, v222
  v_mfma_f32_16x16x32_bf16 v[64:67], a[132:135], a[16:19], v[64:67]
  buffer_load_dwordx4 v244, s[16:19], s77 offen lds
  v_mfma_f32_16x16x32_bf16 v[68:71], a[132:135], a[20:23], v[68:71]
  s_add_u32 s77, s77, 10240
  v_and_b32 v222, 0xffff0000, v222
  v_mfma_f32_16x16x32_bf16 v[68:71], a[128:131], a[4:7], v[68:71]
  s_add_u32 m0, s70, 70656
  v_sqrt_f32 v222, v222
  v_mfma_f32_16x16x32_bf16 v[72:75], a[128:131], a[8:11], v[72:75]
  buffer_load_dwordx4 v245, s[16:19], s77 offen lds
  v_mfma_f32_16x16x32_bf16 v[72:75], a[132:135], a[24:27], v[72:75]
  s_add_u32 s77, s77, 10240
  v_add_f32 v192, v192, v223
  v_add_f32 v193, v193, v223
  v_mfma_f32_16x16x32_bf16 v[76:79], a[132:135], a[28:31], v[76:79]
  v_add_f32 v194, v194, v223
  v_add_f32 v195, v195, v223
  v_mfma_f32_16x16x32_bf16 v[76:79], a[128:131], a[12:15], v[76:79]
  s_waitcnt lgkmcnt(0)
  v_add_f32 v196, v196, v223
  v_add_f32 v197, v197, v223
  v_mfma_f32_16x16x32_bf16 a[64:67], a[128:131], a[248:251], a[64:67]
  s_waitcnt vmcnt(16)
  v_add_f32 v198, v198, v223
  v_add_f32 v199, v199, v223
  v_mfma_f32_16x16x32_bf16 a[64:67], a[132:135], a[248:251], a[64:67]
  s_barrier
  v_add_f32 v200, v200, v223
  v_add_f32 v201, v201, v223
  v_mfma_f32_16x16x32_bf16 v[80:83], a[136:139], a[0:3], v[80:83]
  s_add_u32 m0, s69, 8192
  ds_read_b64_tr_b16 a[128:129], v28 offset:16384
  ds_read_b64_tr_b16 a[130:131], v28 offset:17408
  v_mfma_f32_16x16x32_bf16 v[80:83], a[140:143], a[16:19], v[80:83]
  buffer_load_dwordx4 v33, s[12:15], s76 offen lds
  v_mfma_f32_16x16x32_bf16 v[84:87], a[140:143], a[20:23], v[84:87]
  s_add_u32 s76, s76, 32768
  ds_read_b64_tr_b16 a[132:133], v28 offset:20480
  ds_read_b64_tr_b16 a[134:135], v28 offset:21504
  v_mfma_f32_16x16x32_bf16 v[84:87], a[136:139], a[4:7], v[84:87]
  v_add_f32 v202, v202, v223
  v_add_f32 v203, v203, v223
  v_mfma_f32_16x16x32_bf16 v[88:91], a[136:139], a[8:11], v[88:91]
  s_add_u32 m0, s69, 9216
  v_add_f32 v204, v204, v223
  v_add_f32 v205, v205, v223
  v_mfma_f32_16x16x32_bf16 v[88:91], a[140:143], a[24:27], v[88:91]
  buffer_load_dwordx4 v33, s[12:15], s76 offen lds
  v_mfma_f32_16x16x32_bf16 v[92:95], a[140:143], a[28:31], v[92:95]
  s_add_u32 s76, s76, 229376
  v_add_f32 v206, v206, v223
  v_add_f32 v207, v207, v223
  v_mfma_f32_16x16x32_bf16 v[92:95], a[136:139], a[12:15], v[92:95]
  v_add_f32 v208, v208, v223
  v_add_f32 v209, v209, v223
  v_mfma_f32_16x16x32_bf16 a[68:71], a[136:139], a[248:251], a[68:71]
  s_add_u32 m0, s69, 12288
  v_add_f32 v210, v210, v223
  v_add_f32 v211, v211, v223
  v_mfma_f32_16x16x32_bf16 a[68:71], a[140:143], a[248:251], a[68:71]
  buffer_load_dwordx4 v33, s[12:15], s76 offen lds
  v_mfma_f32_16x16x32_bf16 v[96:99], a[144:147], a[0:3], v[96:99]
  s_add_u32 s76, s76, 32768
  ds_read_b64_tr_b16 a[136:137], v28 offset:16392
  ds_read_b64_tr_b16 a[138:139], v28 offset:17416
  v_mfma_f32_16x16x32_bf16 v[96:99], a[148:151], a[16:19], v[96:99]
  v_cvt_pk_bf16_f32 v222, v222, v222
  v_and_b32 v222, 0xffff0000, v222
  v_mfma_f32_16x16x32_bf16 v[100:103], a[148:151], a[20:23], v[100:103]
  ds_read_b64_tr_b16 a[140:141], v28 offset:20488
  ds_read_b64_tr_b16 a[142:143], v28 offset:21512
  v_mfma_f32_16x16x32_bf16 v[100:103], a[144:147], a[4:7], v[100:103]
  v_rcp_f32 v222, v222
  v_mfma_f32_16x16x32_bf16 v[104:107], a[144:147], a[8:11], v[104:107]
  v_cvt_pk_bf16_f32 v212, v192, v193
  v_cvt_pk_bf16_f32 v213, v194, v195
  v_mfma_f32_16x16x32_bf16 v[104:107], a[148:151], a[24:27], v[104:107]
  v_cvt_pk_bf16_f32 v214, v196, v197
  v_cvt_pk_bf16_f32 v215, v198, v199
  v_mfma_f32_16x16x32_bf16 v[108:111], a[148:151], a[28:31], v[108:111]
  s_add_u32 m0, s69, 13312
  v_cvt_pk_bf16_f32 v216, v200, v201
  v_cvt_pk_bf16_f32 v217, v202, v203
  v_mfma_f32_16x16x32_bf16 v[108:111], a[144:147], a[12:15], v[108:111]
  buffer_load_dwordx4 v33, s[12:15], s76 offen lds
  v_mfma_f32_16x16x32_bf16 v[112:115], a[152:155], a[0:3], v[112:115]
  s_add_u32 s76, s76, 229376
  ds_read_b64_tr_b16 a[144:145], v29 offset:16384
  ds_read_b64_tr_b16 a[146:147], v29 offset:17408
  v_mfma_f32_16x16x32_bf16 v[112:115], a[156:159], a[16:19], v[112:115]
  s_cmp_eq_u32 s76, 5242880
  s_cselect_b32 s76, 0, s76
  v_cvt_pk_bf16_f32 v218, v204, v205
  v_cvt_pk_bf16_f32 v219, v206, v207
  v_mfma_f32_16x16x32_bf16 v[116:119], a[156:159], a[20:23], v[116:119]
  s_add_u32 m0, s70, 71680
  ds_read_b64_tr_b16 a[148:149], v29 offset:20480
  ds_read_b64_tr_b16 a[150:151], v29 offset:21504
  v_mfma_f32_16x16x32_bf16 v[116:119], a[152:155], a[4:7], v[116:119]
  buffer_load_dwordx4 v244, s[16:19], s77 offen lds
  v_mfma_f32_16x16x32_bf16 v[120:123], a[152:155], a[8:11], v[120:123]
  s_waitcnt vmcnt(11)
  ds_read_b128 a[32:35], v240 offset:32768
  v_cvt_pk_bf16_f32 v220, v208, v209
  v_mfma_f32_16x16x32_bf16 v[120:123], a[156:159], a[24:27], v[120:123]
  s_add_u32 s77, s77, 10240
  v_cvt_pk_bf16_f32 v221, v210, v211
  v_lshlrev_b32 v192, 16, v212
  v_mfma_f32_16x16x32_bf16 v[124:127], a[156:159], a[28:31], v[124:127]
  s_add_u32 m0, s70, 72704
  ds_read_b128 a[36:39], v240 offset:34816
  v_and_b32 v193, 0xffff0000, v212
  v_mfma_f32_16x16x32_bf16 v[124:127], a[152:155], a[12:15], v[124:127]
  buffer_load_dwordx4 v245, s[16:19], s77 offen lds
  v_mfma_f32_16x16x32_bf16 v[128:131], a[160:163], a[0:3], v[128:131]
  s_sub_u32 s77, s77, 71552
  ds_read_b64_tr_b16 a[152:153], v29 offset:16392
  ds_read_b64_tr_b16 a[154:155], v29 offset:17416
  v_mfma_f32_16x16x32_bf16 v[128:131], a[164:167], a[16:19], v[128:131]
  s_cmp_eq_u32 s77, 1280
  s_cselect_b32 s77, 0, s77
  v_lshlrev_b32 v194, 16, v213
  v_and_b32 v195, 0xffff0000, v213
  v_mfma_f32_16x16x32_bf16 v[132:135], a[164:167], a[20:23], v[132:135]
  s_add_u32 m0, s70, 131072
  ds_read_b64_tr_b16 a[156:157], v29 offset:20488
  ds_read_b64_tr_b16 a[158:159], v29 offset:21512
  v_mfma_f32_16x16x32_bf16 v[132:135], a[160:163], a[4:7], v[132:135]
  buffer_load_dwordx4 v244, s[16:19], s77 offen lds
  v_mfma_f32_16x16x32_bf16 v[136:139], a[160:163], a[8:11], v[136:139]
  s_add_u32 s77, s77, 10240
  ds_read_b128 a[40:43], v240 offset:36864
  v_lshlrev_b32 v196, 16, v214
  v_mfma_f32_16x16x32_bf16 v[136:139], a[164:167], a[24:27], v[136:139]
  v_and_b32 v197, 0xffff0000, v214
  v_lshlrev_b32 v198, 16, v215
  v_mfma_f32_16x16x32_bf16 v[140:143], a[164:167], a[28:31], v[140:143]
  s_add_u32 m0, s70, 132096
  ds_read_b128 a[44:47], v240 offset:38912
  v_and_b32 v199, 0xffff0000, v215
  v_mfma_f32_16x16x32_bf16 v[140:143], a[160:163], a[12:15], v[140:143]
  buffer_load_dwordx4 v245, s[16:19], s77 offen lds
  v_mfma_f32_16x16x32_bf16 v[144:147], a[168:171], a[0:3], v[144:147]
  s_add_u32 s77, s77, 10240
  ds_read_b64_tr_b16 a[160:161], v30 offset:16384
  ds_read_b64_tr_b16 a[162:163], v30 offset:17408
  v_mfma_f32_16x16x32_bf16 v[144:147], a[172:175], a[16:19], v[144:147]
  v_lshlrev_b32 v200, 16, v216
  v_and_b32 v201, 0xffff0000, v216
  v_mfma_f32_16x16x32_bf16 v[148:151], a[172:175], a[20:23], v[148:151]
  s_add_u32 m0, s70, 133120
  ds_read_b64_tr_b16 a[164:165], v30 offset:20480
  ds_read_b64_tr_b16 a[166:167], v30 offset:21504
  v_mfma_f32_16x16x32_bf16 v[148:151], a[168:171], a[4:7], v[148:151]
  buffer_load_dwordx4 v244, s[16:19], s77 offen lds
  v_mfma_f32_16x16x32_bf16 v[152:155], a[168:171], a[8:11], v[152:155]
  s_add_u32 s77, s77, 10240
  ds_read_b128 a[48:51], v241 offset:32768
  v_lshlrev_b32 v202, 16, v217
  v_mfma_f32_16x16x32_bf16 v[152:155], a[172:175], a[24:27], v[152:155]
  v_and_b32 v203, 0xffff0000, v217
  v_lshlrev_b32 v204, 16, v218
  v_mfma_f32_16x16x32_bf16 v[156:159], a[172:175], a[28:31], v[156:159]
  ds_read_b128 a[52:55], v241 offset:34816
  v_and_b32 v205, 0xffff0000, v218
  v_mfma_f32_16x16x32_bf16 v[156:159], a[168:171], a[12:15], v[156:159]
  v_lshlrev_b32 v206, 16, v219
  v_and_b32 v207, 0xffff0000, v219
  v_mfma_f32_16x16x32_bf16 v[160:163], a[176:179], a[0:3], v[160:163]
  ds_read_b64_tr_b16 a[168:169], v30 offset:16392
  ds_read_b64_tr_b16 a[170:171], v30 offset:17416
  v_mfma_f32_16x16x32_bf16 v[160:163], a[180:183], a[16:19], v[160:163]
  v_lshlrev_b32 v208, 16, v220
  v_and_b32 v209, 0xffff0000, v220
  v_mfma_f32_16x16x32_bf16 v[164:167], a[180:183], a[20:23], v[164:167]
  s_add_u32 m0, s70, 134144
  ds_read_b64_tr_b16 a[172:173], v30 offset:20488
  ds_read_b64_tr_b16 a[174:175], v30 offset:21512
  v_mfma_f32_16x16x32_bf16 v[164:167], a[176:179], a[4:7], v[164:167]
  buffer_load_dwordx4 v245, s[16:19], s77 offen lds
  v_mfma_f32_16x16x32_bf16 v[168:171], a[176:179], a[8:11], v[168:171]
  s_add_u32 s77, s77, 10240
  ds_read_b128 a[56:59], v241 offset:36864
  v_lshlrev_b32 v210, 16, v221
  v_mfma_f32_16x16x32_bf16 v[168:171], a[180:183], a[24:27], v[168:171]
  v_and_b32 v211, 0xffff0000, v221
  v_mul_f32 v192, v192, v222
  v_mfma_f32_16x16x32_bf16 v[172:175], a[180:183], a[28:31], v[172:175]
  s_add_u32 m0, s70, 135168
  ds_read_b128 a[60:63], v241 offset:38912
  v_mul_f32 v193, v193, v222
  v_mfma_f32_16x16x32_bf16 v[172:175], a[176:179], a[12:15], v[172:175]
  buffer_load_dwordx4 v244, s[16:19], s77 offen lds
  v_mfma_f32_16x16x32_bf16 v[176:179], a[184:187], a[0:3], v[176:179]
  s_add_u32 s77, s77, 10240
  ds_read_b64_tr_b16 a[176:177], v31 offset:16384
  ds_read_b64_tr_b16 a[178:179], v31 offset:17408
  v_mfma_f32_16x16x32_bf16 v[176:179], a[188:191], a[16:19], v[176:179]
  v_mul_f32 v194, v194, v222
  v_mul_f32 v195, v195, v222
  v_mfma_f32_16x16x32_bf16 v[180:183], a[188:191], a[20:23], v[180:183]
  s_add_u32 m0, s70, 136192
  ds_read_b64_tr_b16 a[180:181], v31 offset:20480
  ds_read_b64_tr_b16 a[182:183], v31 offset:21504
  v_mfma_f32_16x16x32_bf16 v[180:183], a[184:187], a[4:7], v[180:183]
  buffer_load_dwordx4 v245, s[16:19], s77 offen lds
  v_mfma_f32_16x16x32_bf16 v[184:187], a[184:187], a[8:11], v[184:187]
  s_add_u32 s77, s77, 10240
  v_mul_f32 v196, v196, v222
  v_mul_f32 v197, v197, v222
  v_mfma_f32_16x16x32_bf16 v[184:187], a[188:191], a[24:27], v[184:187]
  v_mul_f32 v198, v198, v222
  v_mul_f32 v199, v199, v222
  v_mfma_f32_16x16x32_bf16 v[188:191], a[188:191], a[28:31], v[188:191]
  ds_read_b64_tr_b16 a[188:189], v31 offset:20488
  ds_read_b64_tr_b16 a[190:191], v31 offset:21512
  v_mfma_f32_16x16x32_bf16 v[188:191], a[184:187], a[12:15], v[188:191]
  s_waitcnt lgkmcnt(6)
  ds_read_b64_tr_b16 a[184:185], v31 offset:16392
  ds_read_b64_tr_b16 a[186:187], v31 offset:17416
  v_mfma_f32_16x16x32_bf16 v[64:67], a[128:131], a[32:35], v[64:67]
  s_add_u32 m0, s70, 137216
  v_mul_f32 v200, v200, v222
  v_mul_f32 v201, v201, v222
  v_mfma_f32_16x16x32_bf16 v[64:67], a[132:135], a[48:51], v[64:67]
  buffer_load_dwordx4 v244, s[16:19], s77 offen lds
  v_mfma_f32_16x16x32_bf16 v[68:71], a[132:135], a[52:55], v[68:71]
  s_add_u32 s77, s77, 10240
  v_mul_f32 v202, v202, v222
  v_mul_f32 v203, v203, v222
  v_mfma_f32_16x16x32_bf16 v[68:71], a[128:131], a[36:39], v[68:71]
  s_add_u32 m0, s70, 138240
  v_mul_f32 v204, v204, v222
  v_mul_f32 v205, v205, v222
  v_mfma_f32_16x16x32_bf16 v[72:75], a[128:131], a[40:43], v[72:75]
  buffer_load_dwordx4 v245, s[16:19], s77 offen lds
  v_mfma_f32_16x16x32_bf16 v[72:75], a[132:135], a[56:59], v[72:75]
  s_sub_u32 s77, s77, 71552
  v_mul_f32 v206, v206, v222
  v_mul_f32 v207, v207, v222
  v_mfma_f32_16x16x32_bf16 v[76:79], a[132:135], a[60:63], v[76:79]
  s_cmp_eq_u32 s77, 1280
  s_cselect_b32 s77, 0, s77
  v_mul_f32 v208, v208, v222
  v_mul_f32 v209, v209, v222
  v_mfma_f32_16x16x32_bf16 v[76:79], a[128:131], a[44:47], v[76:79]
  s_waitcnt lgkmcnt(0)
  v_mul_f32 v210, v210, v222
  v_mul_f32 v211, v211, v222
  v_mfma_f32_16x16x32_bf16 a[64:67], a[128:131], a[248:251], a[64:67]
  s_waitcnt vmcnt(24)
  v_cvt_pk_bf16_f32 v212, v192, v193
  v_cvt_pk_bf16_f32 v213, v194, v195
  v_mfma_f32_16x16x32_bf16 a[64:67], a[132:135], a[248:251], a[64:67]
  s_barrier
  v_cvt_pk_bf16_f32 v214, v196, v197
  v_cvt_pk_bf16_f32 v215, v198, v199
  v_mfma_f32_16x16x32_bf16 v[80:83], a[136:139], a[32:35], v[80:83]
  s_add_u32 m0, s69, 16384
  ds_read_b64_tr_b16 a[128:129], v28 offset:0
  ds_read_b64_tr_b16 a[130:131], v28 offset:1024
  v_mfma_f32_16x16x32_bf16 v[80:83], a[140:143], a[48:51], v[80:83]
  buffer_load_dwordx4 v33, s[12:15], s76 offen lds
  v_mfma_f32_16x16x32_bf16 v[84:87], a[140:143], a[52:55], v[84:87]
  s_add_u32 s76, s76, 32768
  ds_read_b64_tr_b16 a[132:133], v28 offset:4096
  ds_read_b64_tr_b16 a[134:135], v28 offset:5120
  v_mfma_f32_16x16x32_bf16 v[84:87], a[136:139], a[36:39], v[84:87]
  v_cvt_pk_bf16_f32 v216, v200, v201
  v_cvt_pk_bf16_f32 v217, v202, v203
  v_mfma_f32_16x16x32_bf16 v[88:91], a[136:139], a[40:43], v[88:91]
  s_add_u32 m0, s69, 17408
  v_cvt_pk_bf16_f32 v218, v204, v205
  v_cvt_pk_bf16_f32 v219, v206, v207
  v_mfma_f32_16x16x32_bf16 v[88:91], a[140:143], a[56:59], v[88:91]
  buffer_load_dwordx4 v33, s[12:15], s76 offen lds
  v_mfma_f32_16x16x32_bf16 v[92:95], a[140:143], a[60:63], v[92:95]
  s_add_u32 s76, s76, 229376
  v_cvt_pk_bf16_f32 v220, v208, v209
  v_cvt_pk_bf16_f32 v221, v210, v211
  v_mfma_f32_16x16x32_bf16 v[92:95], a[136:139], a[44:47], v[92:95]
  ds_write_b64 v253, v[212:213] offset:0
  ds_write_b64 v253, v[214:215] offset:256
  v_mfma_f32_16x16x32_bf16 a[68:71], a[136:139], a[248:251], a[68:71]
  s_add_u32 m0, s69, 20480
  ds_write_b64 v253, v[216:217] offset:512
  ds_write_b64 v253, v[218:219] offset:768
  v_mfma_f32_16x16x32_bf16 a[68:71], a[140:143], a[248:251], a[68:71]
  buffer_load_dwordx4 v33, s[12:15], s76 offen lds
  v_mfma_f32_16x16x32_bf16 v[96:99], a[144:147], a[32:35], v[96:99]
  s_add_u32 s76, s76, 32768
  ds_read_b64_tr_b16 a[136:137], v28 offset:8
  ds_read_b64_tr_b16 a[138:139], v28 offset:1032
  v_mfma_f32_16x16x32_bf16 v[96:99], a[148:151], a[48:51], v[96:99]
  ds_write_b64 v253, v[220:221] offset:1024
  v_mov_b32 v7, s28
  v_mfma_f32_16x16x32_bf16 v[100:103], a[148:151], a[52:55], v[100:103]
  ds_read_b64_tr_b16 a[140:141], v28 offset:4104
  ds_read_b64_tr_b16 a[142:143], v28 offset:5128
  v_mfma_f32_16x16x32_bf16 v[100:103], a[144:147], a[36:39], v[100:103]
  v_add_u32 v7, 0, v7
  v_and_b32 v7, 3, v7
  v_mfma_f32_16x16x32_bf16 v[104:107], a[144:147], a[40:43], v[104:107]
  v_lshl_add_u32 v7, v7, 2, v4
  v_xor_b32 v7, v7, v3
  v_mfma_f32_16x16x32_bf16 v[104:107], a[148:151], a[56:59], v[104:107]
  v_lshlrev_b32 v7, 4, v7
  v_lshl_add_u32 v10, v3, 8, v7
  v_mfma_f32_16x16x32_bf16 v[108:111], a[148:151], a[60:63], v[108:111]
  s_add_u32 m0, s69, 21504
  v_mov_b32 v7, s28
  v_add_u32 v7, 1, v7
  v_mfma_f32_16x16x32_bf16 v[108:111], a[144:147], a[44:47], v[108:111]
  buffer_load_dwordx4 v33, s[12:15], s76 offen lds
  v_mfma_f32_16x16x32_bf16 v[112:115], a[152:155], a[32:35], v[112:115]
  s_add_u32 s76, s76, 229376
  ds_read_b64_tr_b16 a[144:145], v29 offset:0
  ds_read_b64_tr_b16 a[146:147], v29 offset:1024
  v_mfma_f32_16x16x32_bf16 v[112:115], a[156:159], a[48:51], v[112:115]
  s_cmp_eq_u32 s76, 5242880
  s_cselect_b32 s76, 0, s76
  v_and_b32 v7, 3, v7
  v_lshl_add_u32 v7, v7, 2, v4
  v_mfma_f32_16x16x32_bf16 v[116:119], a[156:159], a[52:55], v[116:119]
  s_add_u32 m0, s70, 98304
  ds_read_b64_tr_b16 a[148:149], v29 offset:4096
  ds_read_b64_tr_b16 a[150:151], v29 offset:5120
  v_mfma_f32_16x16x32_bf16 v[116:119], a[152:155], a[36:39], v[116:119]
  buffer_load_dwordx4 v244, s[16:19], s77 offen lds
  v_mfma_f32_16x16x32_bf16 v[120:123], a[152:155], a[40:43], v[120:123]
  s_waitcnt vmcnt(13)
  ds_read_b128 a[0:3], v240 offset:0
  v_xor_b32 v7, v7, v3
  v_mfma_f32_16x16x32_bf16 v[120:123], a[156:159], a[56:59], v[120:123]
  s_add_u32 s77, s77, 10240
  v_lshlrev_b32 v7, 4, v7
  v_lshl_add_u32 v11, v3, 8, v7
  v_mfma_f32_16x16x32_bf16 v[124:127], a[156:159], a[60:63], v[124:127]
  s_add_u32 m0, s70, 99328
  ds_read_b128 a[4:7], v240 offset:2048
  v_mov_b32 v7, s28
  v_mfma_f32_16x16x32_bf16 v[124:127], a[152:155], a[44:47], v[124:127]
  buffer_load_dwordx4 v245, s[16:19], s77 offen lds
  v_mfma_f32_16x16x32_bf16 v[128:131], a[160:163], a[32:35], v[128:131]
  s_add_u32 s77, s77, 10240
  ds_read_b64_tr_b16 a[152:153], v29 offset:8
  ds_read_b64_tr_b16 a[154:155], v29 offset:1032
  v_mfma_f32_16x16x32_bf16 v[128:131], a[164:167], a[48:51], v[128:131]
  v_add_u32 v7, 2, v7
  v_and_b32 v7, 3, v7
  v_mfma_f32_16x16x32_bf16 v[132:135], a[164:167], a[52:55], v[132:135]
  s_add_u32 m0, s70, 100352
  ds_read_b64_tr_b16 a[156:157], v29 offset:4104
  ds_read_b64_tr_b16 a[158:159], v29 offset:5128
  v_mfma_f32_16x16x32_bf16 v[132:135], a[160:163], a[36:39], v[132:135]
  buffer_load_dwordx4 v244, s[16:19], s77 offen lds
  v_mfma_f32_16x16x32_bf16 v[136:139], a[160:163], a[40:43], v[136:139]
  s_add_u32 s77, s77, 10240
  ds_read_b128 a[8:11], v240 offset:4096
  v_lshl_add_u32 v7, v7, 2, v4
  v_mfma_f32_16x16x32_bf16 v[136:139], a[164:167], a[56:59], v[136:139]
  v_xor_b32 v7, v7, v3
  v_lshlrev_b32 v7, 4, v7
  v_mfma_f32_16x16x32_bf16 v[140:143], a[164:167], a[60:63], v[140:143]
  s_add_u32 m0, s70, 101376
  ds_read_b128 a[12:15], v240 offset:6144
  v_lshl_add_u32 v12, v3, 8, v7
  v_mfma_f32_16x16x32_bf16 v[140:143], a[160:163], a[44:47], v[140:143]
  buffer_load_dwordx4 v245, s[16:19], s77 offen lds
  v_mfma_f32_16x16x32_bf16 v[144:147], a[168:171], a[32:35], v[144:147]
  s_add_u32 s77, s77, 10240
  ds_read_b64_tr_b16 a[160:161], v30 offset:0
  ds_read_b64_tr_b16 a[162:163], v30 offset:1024
  v_mfma_f32_16x16x32_bf16 v[144:147], a[172:175], a[48:51], v[144:147]
  v_mov_b32 v7, s28
  v_add_u32 v7, 3, v7
  v_mfma_f32_16x16x32_bf16 v[148:151], a[172:175], a[52:55], v[148:151]
  s_add_u32 m0, s70, 102400
  ds_read_b64_tr_b16 a[164:165], v30 offset:4096
  ds_read_b64_tr_b16 a[166:167], v30 offset:5120
  v_mfma_f32_16x16x32_bf16 v[148:151], a[168:171], a[36:39], v[148:151]
  buffer_load_dwordx4 v244, s[16:19], s77 offen lds
  v_mfma_f32_16x16x32_bf16 v[152:155], a[168:171], a[40:43], v[152:155]
  s_add_u32 s77, s77, 10240
  ds_read_b128 a[16:19], v241 offset:0
  v_and_b32 v7, 3, v7
  v_mfma_f32_16x16x32_bf16 v[152:155], a[172:175], a[56:59], v[152:155]
  v_lshl_add_u32 v7, v7, 2, v4
  v_xor_b32 v7, v7, v3
  v_mfma_f32_16x16x32_bf16 v[156:159], a[172:175], a[60:63], v[156:159]
  ds_read_b128 a[20:23], v241 offset:2048
  v_lshlrev_b32 v7, 4, v7
  v_mfma_f32_16x16x32_bf16 v[156:159], a[168:171], a[44:47], v[156:159]
  v_lshl_add_u32 v13, v3, 8, v7
  v_lshrrev_b32 v62, 2, v2
  v_mfma_f32_16x16x32_bf16 v[160:163], a[176:179], a[32:35], v[160:163]
  ds_read_b64_tr_b16 a[168:169], v30 offset:8
  ds_read_b64_tr_b16 a[170:171], v30 offset:1032
  v_mfma_f32_16x16x32_bf16 v[160:163], a[180:183], a[48:51], v[160:163]
  v_lshlrev_b32 v63, 8, v62
  v_lshl_add_u32 v63, v6, 3, v63
  v_mfma_f32_16x16x32_bf16 v[164:167], a[180:183], a[52:55], v[164:167]
  s_add_u32 m0, s70, 103424
  ds_read_b64_tr_b16 a[172:173], v30 offset:4104
  ds_read_b64_tr_b16 a[174:175], v30 offset:5128
  v_mfma_f32_16x16x32_bf16 v[164:167], a[176:179], a[36:39], v[164:167]
  buffer_load_dwordx4 v245, s[16:19], s77 offen lds
  v_mfma_f32_16x16x32_bf16 v[168:171], a[176:179], a[40:43], v[168:171]
  s_add_u32 s77, s77, 10240
  ds_read_b128 a[24:27], v241 offset:4096
  v_add_u32 v63, 65536, v63
  v_mfma_f32_16x16x32_bf16 v[168:171], a[180:183], a[56:59], v[168:171]
  v_and_b32 v62, 7, v62
  v_xor_b32 v7, 0, v62
  v_mfma_f32_16x16x32_bf16 v[172:175], a[180:183], a[60:63], v[172:175]
  s_add_u32 m0, s70, 104448
  ds_read_b128 a[28:31], v241 offset:6144
  v_lshl_add_u32 v14, v7, 5, v63
  v_mfma_f32_16x16x32_bf16 v[172:175], a[176:179], a[44:47], v[172:175]
  buffer_load_dwordx4 v244, s[16:19], s77 offen lds
  v_mfma_f32_16x16x32_bf16 v[176:179], a[184:187], a[32:35], v[176:179]
  s_add_u32 s77, s77, 10240
  ds_read_b64_tr_b16 a[176:177], v31 offset:0
  ds_read_b64_tr_b16 a[178:179], v31 offset:1024
  v_mfma_f32_16x16x32_bf16 v[176:179], a[188:191], a[48:51], v[176:179]
  v_xor_b32 v7, 1, v62
  v_lshl_add_u32 v15, v7, 5, v63
  v_mfma_f32_16x16x32_bf16 v[180:183], a[188:191], a[52:55], v[180:183]
  s_add_u32 m0, s70, 105472
  ds_read_b64_tr_b16 a[180:181], v31 offset:4096
  ds_read_b64_tr_b16 a[182:183], v31 offset:5120
  v_mfma_f32_16x16x32_bf16 v[180:183], a[184:187], a[36:39], v[180:183]
  buffer_load_dwordx4 v245, s[16:19], s77 offen lds
  v_mfma_f32_16x16x32_bf16 v[184:187], a[184:187], a[40:43], v[184:187]
  s_sub_u32 s77, s77, 71552
  v_xor_b32 v7, 2, v62
  v_lshl_add_u32 v16, v7, 5, v63
  v_mfma_f32_16x16x32_bf16 v[184:187], a[188:191], a[56:59], v[184:187]
  s_cmp_eq_u32 s77, 1280
  s_cselect_b32 s77, 0, s77
  v_xor_b32 v7, 3, v62
  v_lshl_add_u32 v17, v7, 5, v63
  v_mfma_f32_16x16x32_bf16 v[188:191], a[188:191], a[60:63], v[188:191]
  ds_read_b64_tr_b16 a[188:189], v31 offset:4104
  ds_read_b64_tr_b16 a[190:191], v31 offset:5128
  v_mfma_f32_16x16x32_bf16 v[188:191], a[184:187], a[44:47], v[188:191]
  s_waitcnt lgkmcnt(6)
  ds_read_b64_tr_b16 a[184:185], v31 offset:8
  ds_read_b64_tr_b16 a[186:187], v31 offset:1032
  v_mfma_f32_16x16x32_bf16 v[64:67], a[128:131], a[0:3], v[64:67]
  s_add_u32 m0, s70, 65536
  v_xor_b32 v7, 4, v62
  v_lshl_add_u32 v18, v7, 5, v63
  v_mfma_f32_16x16x32_bf16 v[64:67], a[132:135], a[16:19], v[64:67]
  buffer_load_dwordx4 v244, s[16:19], s77 offen lds
  v_mfma_f32_16x16x32_bf16 v[68:71], a[132:135], a[20:23], v[68:71]
  s_add_u32 s77, s77, 10240
  v_xor_b32 v7, 5, v62
  v_lshl_add_u32 v19, v7, 5, v63
  v_mfma_f32_16x16x32_bf16 v[68:71], a[128:131], a[4:7], v[68:71]
  s_add_u32 m0, s70, 66560
  v_xor_b32 v7, 6, v62
  v_lshl_add_u32 v20, v7, 5, v63
  v_mfma_f32_16x16x32_bf16 v[72:75], a[128:131], a[8:11], v[72:75]
  buffer_load_dwordx4 v245, s[16:19], s77 offen lds
  v_mfma_f32_16x16x32_bf16 v[72:75], a[132:135], a[24:27], v[72:75]
  s_add_u32 s77, s77, 10240
  v_xor_b32 v7, 7, v62
  v_lshl_add_u32 v21, v7, 5, v63
  v_mfma_f32_16x16x32_bf16 v[76:79], a[132:135], a[28:31], v[76:79]
  v_lshlrev_b32 v63, 8, v4
  v_add_u32 v63, s32, v63
  v_mfma_f32_16x16x32_bf16 v[76:79], a[128:131], a[12:15], v[76:79]
  s_waitcnt lgkmcnt(0)
  v_mov_b32 v56, s28
  v_and_b32 v56, 1, v56
  v_mfma_f32_16x16x32_bf16 a[64:67], a[128:131], a[248:251], a[64:67]
  s_waitcnt vmcnt(24)
  v_lshlrev_b32 v56, 3, v56
  v_add_u32 v7, 0, v4
  v_mfma_f32_16x16x32_bf16 a[64:67], a[132:135], a[248:251], a[64:67]
  s_barrier
  v_add_u32 v62, v56, v7
  v_xor_b32 v62, v62, v3
  v_mfma_f32_16x16x32_bf16 v[80:83], a[136:139], a[0:3], v[80:83]
  s_add_u32 m0, s69, 0
  ds_read_b64_tr_b16 a[128:129], v28 offset:8192
  ds_read_b64_tr_b16 a[130:131], v28 offset:9216
  v_mfma_f32_16x16x32_bf16 v[80:83], a[140:143], a[16:19], v[80:83]
  buffer_load_dwordx4 v33, s[12:15], s76 offen lds
  v_mfma_f32_16x16x32_bf16 v[84:87], a[140:143], a[20:23], v[84:87]
  s_add_u32 s76, s76, 32768
  ds_read_b64_tr_b16 a[132:133], v28 offset:12288
  ds_read_b64_tr_b16 a[134:135], v28 offset:13312
  v_mfma_f32_16x16x32_bf16 v[84:87], a[136:139], a[4:7], v[84:87]
  ds_read_b64_tr_b16 a[72:73], v232 offset:0
  v_lshl_add_u32 v22, v62, 4, v63
  v_mfma_f32_16x16x32_bf16 v[88:91], a[136:139], a[8:11], v[88:91]
  ds_read_b64_tr_b16 a[74:75], v232 offset:5184
  v_lshlrev_b32 v7, 1, v7
  v_mfma_f32_16x16x32_bf16 v[88:91], a[140:143], a[24:27], v[88:91]
  v_xor_b32 v7, v7, v3
  v_lshl_add_u32 v24, v7, 4, v63
  v_mfma_f32_16x16x32_bf16 v[92:95], a[140:143], a[28:31], v[92:95]
  ds_read_b64_tr_b16 a[76:77], v232 offset:512
  v_add_u32 v7, 4, v4
  v_mfma_f32_16x16x32_bf16 v[92:95], a[136:139], a[12:15], v[92:95]
  ds_read_b64_tr_b16 a[78:79], v232 offset:5696
  v_add_u32 v62, v56, v7
  v_mfma_f32_16x16x32_bf16 a[68:71], a[136:139], a[248:251], a[68:71]
  s_add_u32 m0, s69, 1024
  ds_read_b64_tr_b16 a[80:81], v232 offset:1024
  v_xor_b32 v62, v62, v3
  v_mfma_f32_16x16x32_bf16 a[68:71], a[140:143], a[248:251], a[68:71]
  buffer_load_dwordx4 v33, s[12:15], s76 offen lds
  v_mfma_f32_16x16x32_bf16 v[96:99], a[144:147], a[0:3], v[96:99]
  s_add_u32 s76, s76, 229376
  ds_read_b64_tr_b16 a[136:137], v28 offset:8200
  ds_read_b64_tr_b16 a[138:139], v28 offset:9224
  v_mfma_f32_16x16x32_bf16 v[96:99], a[148:151], a[16:19], v[96:99]
  ds_read_b64_tr_b16 a[82:83], v232 offset:6208
  v_lshl_add_u32 v23, v62, 4, v63
  v_mfma_f32_16x16x32_bf16 v[100:103], a[148:151], a[20:23], v[100:103]
  s_add_u32 m0, s69, 4096
  ds_read_b64_tr_b16 a[140:141], v28 offset:12296
  ds_read_b64_tr_b16 a[142:143], v28 offset:13320
  v_mfma_f32_16x16x32_bf16 v[100:103], a[144:147], a[4:7], v[100:103]
  buffer_load_dwordx4 v33, s[12:15], s76 offen lds
  v_mfma_f32_16x16x32_bf16 v[104:107], a[144:147], a[8:11], v[104:107]
  s_add_u32 s76, s76, 32768
  v_lshlrev_b32 v7, 1, v7
  v_xor_b32 v7, v7, v3
  v_mfma_f32_16x16x32_bf16 v[104:107], a[148:151], a[24:27], v[104:107]
  v_lshl_add_u32 v25, v7, 4, v63
  v_lshrrev_b32 v7, 2, v2
  v_mfma_f32_16x16x32_bf16 v[108:111], a[148:151], a[28:31], v[108:111]
  s_add_u32 m0, s69, 5120
  v_lshlrev_b32 v7, 7, v7
  v_lshl_add_u32 v7, v6, 3, v7
  v_mfma_f32_16x16x32_bf16 v[108:111], a[144:147], a[12:15], v[108:111]
  buffer_load_dwordx4 v33, s[12:15], s76 offen lds
  v_mfma_f32_16x16x32_bf16 v[112:115], a[152:155], a[0:3], v[112:115]
  s_add_u32 s76, s76, 229376
  ds_read_b64_tr_b16 a[144:145], v29 offset:8192
  ds_read_b64_tr_b16 a[146:147], v29 offset:9216
  v_mfma_f32_16x16x32_bf16 v[112:115], a[156:159], a[16:19], v[112:115]
  s_cmp_eq_u32 s76, 5242880
  s_cselect_b32 s76, 0, s76
  v_add_u32 v7, s70, v7
  v_add_u32 v7, 131072, v7
  v_mfma_f32_16x16x32_bf16 v[116:119], a[156:159], a[20:23], v[116:119]
  ds_read_b64_tr_b16 a[148:149], v29 offset:12288
  ds_read_b64_tr_b16 a[150:151], v29 offset:13312
  v_mfma_f32_16x16x32_bf16 v[116:119], a[152:155], a[4:7], v[116:119]
  v_bfe_u32 v62, v2, 3, 2
  v_xor_b32 v63, 0, v62
  v_mfma_f32_16x16x32_bf16 v[120:123], a[152:155], a[8:11], v[120:123]
  s_waitcnt vmcnt(18)
  ds_read_b128 a[32:35], v242 offset:0
  v_lshl_add_u32 v58, v63, 5, v7
  v_mfma_f32_16x16x32_bf16 v[120:123], a[156:159], a[24:27], v[120:123]
  v_xor_b32 v63, 1, v62
  v_lshl_add_u32 v59, v63, 5, v7
  v_mfma_f32_16x16x32_bf16 v[124:127], a[156:159], a[28:31], v[124:127]
  s_add_u32 m0, s70, 67584
  ds_read_b128 a[36:39], v242 offset:2048
  v_xor_b32 v63, 2, v62
  v_mfma_f32_16x16x32_bf16 v[124:127], a[152:155], a[12:15], v[124:127]
  buffer_load_dwordx4 v244, s[16:19], s77 offen lds
  v_mfma_f32_16x16x32_bf16 v[128:131], a[160:163], a[0:3], v[128:131]
  s_add_u32 s77, s77, 10240
  ds_read_b64_tr_b16 a[152:153], v29 offset:8200
  ds_read_b64_tr_b16 a[154:155], v29 offset:9224
  v_mfma_f32_16x16x32_bf16 v[128:131], a[164:167], a[16:19], v[128:131]
  v_lshl_add_u32 v60, v63, 5, v7
  v_xor_b32 v63, 3, v62
  v_mfma_f32_16x16x32_bf16 v[132:135], a[164:167], a[20:23], v[132:135]
  s_add_u32 m0, s70, 68608
  ds_read_b64_tr_b16 a[156:157], v29 offset:12296
  ds_read_b64_tr_b16 a[158:159], v29 offset:13320
  v_mfma_f32_16x16x32_bf16 v[132:135], a[160:163], a[4:7], v[132:135]
  buffer_load_dwordx4 v245, s[16:19], s77 offen lds
  v_mfma_f32_16x16x32_bf16 v[136:139], a[160:163], a[8:11], v[136:139]
  s_add_u32 s77, s77, 10240
  ds_read_b128 a[40:43], v242 offset:4096
  v_lshl_add_u32 v61, v63, 5, v7
  v_mfma_f32_16x16x32_bf16 v[136:139], a[164:167], a[24:27], v[136:139]
  v_lshrrev_b32 v3, 3, v2
  v_bfe_u32 v7, v2, 1, 2
  v_mfma_f32_16x16x32_bf16 v[140:143], a[164:167], a[28:31], v[140:143]
  ds_read_b128 a[44:47], v242 offset:6144
  v_bfe_u32 v62, v2, 4, 2
  v_mfma_f32_16x16x32_bf16 v[140:143], a[160:163], a[12:15], v[140:143]
  v_xor_b32 v7, v7, v62
  v_and_b32 v62, 1, v2
  v_mfma_f32_16x16x32_bf16 v[144:147], a[168:171], a[0:3], v[144:147]
  ds_read_b64_tr_b16 a[160:161], v30 offset:8192
  ds_read_b64_tr_b16 a[162:163], v30 offset:9216
  v_mfma_f32_16x16x32_bf16 v[144:147], a[172:175], a[16:19], v[144:147]
  v_lshl_add_u32 v4, v7, 1, v62
  v_lshlrev_b32 v4, 4, v4
  v_mfma_f32_16x16x32_bf16 v[148:151], a[172:175], a[20:23], v[148:151]
  s_add_u32 m0, s70, 69632
  ds_read_b64_tr_b16 a[164:165], v30 offset:12288
  ds_read_b64_tr_b16 a[166:167], v30 offset:13312
  v_mfma_f32_16x16x32_bf16 v[148:151], a[168:171], a[4:7], v[148:151]
  buffer_load_dwordx4 v244, s[16:19], s77 offen lds
  v_mfma_f32_16x16x32_bf16 v[152:155], a[168:171], a[8:11], v[152:155]
  s_add_u32 s77, s77, 10240
  ds_read_b128 a[48:51], v243 offset:0
  v_mul_u32_u24 v32, 3456, v3
  v_mfma_f32_16x16x32_bf16 v[152:155], a[172:175], a[24:27], v[152:155]
  v_add_u32 v32, v32, v4
  v_lshrrev_b32 v7, 2, v2
  v_mfma_f32_16x16x32_bf16 v[156:159], a[172:175], a[28:31], v[156:159]
  s_add_u32 m0, s70, 70656
  ds_read_b128 a[52:55], v243 offset:2048
  v_lshlrev_b32 v7, 5, v7
  v_mfma_f32_16x16x32_bf16 v[156:159], a[168:171], a[12:15], v[156:159]
  buffer_load_dwordx4 v245, s[16:19], s77 offen lds
  v_mfma_f32_16x16x32_bf16 v[160:163], a[176:179], a[0:3], v[160:163]
  s_add_u32 s77, s77, 10240
  ds_read_b64_tr_b16 a[168:169], v30 offset:8200
  ds_read_b64_tr_b16 a[170:171], v30 offset:9224
  v_mfma_f32_16x16x32_bf16 v[160:163], a[180:183], a[16:19], v[160:163]
  v_lshl_add_u32 v7, v6, 3, v7
  v_add_u32 v1, s78, v7
  v_mfma_f32_16x16x32_bf16 v[164:167], a[180:183], a[20:23], v[164:167]
  s_add_u32 m0, s70, 71680
  ds_read_b64_tr_b16 a[172:173], v30 offset:12296
  ds_read_b64_tr_b16 a[174:175], v30 offset:13320
  v_mfma_f32_16x16x32_bf16 v[164:167], a[176:179], a[4:7], v[164:167]
  buffer_load_dwordx4 v244, s[16:19], s77 offen lds
  v_mfma_f32_16x16x32_bf16 v[168:171], a[176:179], a[8:11], v[168:171]
  s_add_u32 s77, s77, 10240
  ds_read_b128 a[56:59], v243 offset:4096
  v_lshrrev_b32 v7, 1, v2
  v_mfma_f32_16x16x32_bf16 v[168:171], a[180:183], a[24:27], v[168:171]
  v_mul_u32_u24 v7, 1280, v7
  v_and_b32 v62, 1, v2
  v_mfma_f32_16x16x32_bf16 v[172:175], a[180:183], a[28:31], v[172:175]
  ds_read_b128 a[60:63], v243 offset:6144
  v_lshl_add_u32 v57, v62, 4, v7
  v_mfma_f32_16x16x32_bf16 v[172:175], a[176:179], a[12:15], v[172:175]
  v_mov_b32 v34, 0
  v_mov_b32 v35, 0
  v_mfma_f32_16x16x32_bf16 v[176:179], a[184:187], a[0:3], v[176:179]
  ds_read_b64_tr_b16 a[176:177], v31 offset:8192
  ds_read_b64_tr_b16 a[178:179], v31 offset:9216
  v_mfma_f32_16x16x32_bf16 v[176:179], a[188:191], a[16:19], v[176:179]
  v_mov_b32 v36, 0
  v_mov_b32 v37, 0
  v_mfma_f32_16x16x32_bf16 v[180:183], a[188:191], a[20:23], v[180:183]
  s_add_u32 m0, s70, 72704
  ds_read_b64_tr_b16 a[180:181], v31 offset:12288
  ds_read_b64_tr_b16 a[182:183], v31 offset:13312
  v_mfma_f32_16x16x32_bf16 v[180:183], a[184:187], a[4:7], v[180:183]
  buffer_load_dwordx4 v245, s[16:19], s77 offen lds
  v_mfma_f32_16x16x32_bf16 v[184:187], a[184:187], a[8:11], v[184:187]
  s_sub_u32 s77, s77, 71552
  v_mov_b32 v7, s28
  v_lshl_add_u32 v38, v7, 10, v26
  v_mfma_f32_16x16x32_bf16 v[184:187], a[188:191], a[24:27], v[184:187]
  s_cmp_eq_u32 s77, 1280
  s_cselect_b32 s77, 0, s77
  v_mfma_f32_16x16x32_bf16 v[188:191], a[188:191], a[28:31], v[188:191]
  ds_read_b64_tr_b16 a[188:189], v31 offset:12296
  ds_read_b64_tr_b16 a[190:191], v31 offset:13320
  v_mfma_f32_16x16x32_bf16 v[188:191], a[184:187], a[12:15], v[188:191]
  s_waitcnt lgkmcnt(6)
  ds_read_b64_tr_b16 a[184:185], v31 offset:8200
  ds_read_b64_tr_b16 a[186:187], v31 offset:9224
  v_mfma_f32_16x16x32_bf16 v[64:67], a[128:131], a[32:35], v[64:67]
  s_add_u32 m0, s70, 131072
  v_mfma_f32_16x16x32_bf16 v[64:67], a[132:135], a[48:51], v[64:67]
  buffer_load_dwordx4 v244, s[16:19], s77 offen lds
  v_mfma_f32_16x16x32_bf16 v[68:71], a[132:135], a[52:55], v[68:71]
  s_add_u32 s77, s77, 10240
  v_mfma_f32_16x16x32_bf16 v[68:71], a[128:131], a[36:39], v[68:71]
  s_add_u32 m0, s70, 132096
  v_mfma_f32_16x16x32_bf16 v[72:75], a[128:131], a[40:43], v[72:75]
  buffer_load_dwordx4 v245, s[16:19], s77 offen lds
  v_mfma_f32_16x16x32_bf16 v[72:75], a[132:135], a[56:59], v[72:75]
  s_add_u32 s77, s77, 10240
  v_mfma_f32_16x16x32_bf16 v[76:79], a[132:135], a[60:63], v[76:79]
  v_mfma_f32_16x16x32_bf16 v[76:79], a[128:131], a[44:47], v[76:79]
  s_waitcnt lgkmcnt(0)
  v_mfma_f32_16x16x32_bf16 a[64:67], a[128:131], a[248:251], a[64:67]
  s_waitcnt vmcnt(22)
  v_mfma_f32_16x16x32_bf16 a[64:67], a[132:135], a[248:251], a[64:67]
  s_barrier
  v_mfma_f32_16x16x32_bf16 v[80:83], a[136:139], a[32:35], v[80:83]
  s_add_u32 m0, s69, 8192
  ds_read_b64_tr_b16 a[128:129], v28 offset:16384
  ds_read_b64_tr_b16 a[130:131], v28 offset:17408
  v_mfma_f32_16x16x32_bf16 v[80:83], a[140:143], a[48:51], v[80:83]
  buffer_load_dwordx4 v33, s[12:15], s76 offen lds
  v_mfma_f32_16x16x32_bf16 v[84:87], a[140:143], a[52:55], v[84:87]
  s_add_u32 s76, s76, 32768
  ds_read_b64_tr_b16 a[132:133], v28 offset:20480
  ds_read_b64_tr_b16 a[134:135], v28 offset:21504
  v_mfma_f32_16x16x32_bf16 v[84:87], a[136:139], a[36:39], v[84:87]
  v_mfma_f32_16x16x32_bf16 v[88:91], a[136:139], a[40:43], v[88:91]
  s_add_u32 m0, s69, 9216
  v_mfma_f32_16x16x32_bf16 v[88:91], a[140:143], a[56:59], v[88:91]
  buffer_load_dwordx4 v33, s[12:15], s76 offen lds
  v_mfma_f32_16x16x32_bf16 v[92:95], a[140:143], a[60:63], v[92:95]
  s_add_u32 s76, s76, 229376
  v_mfma_f32_16x16x32_bf16 v[92:95], a[136:139], a[44:47], v[92:95]
  v_mfma_f32_16x16x32_bf16 a[68:71], a[136:139], a[248:251], a[68:71]
  s_add_u32 m0, s69, 12288
  v_mfma_f32_16x16x32_bf16 a[68:71], a[140:143], a[248:251], a[68:71]
  buffer_load_dwordx4 v33, s[12:15], s76 offen lds
  v_mfma_f32_16x16x32_bf16 v[96:99], a[144:147], a[32:35], v[96:99]
  s_add_u32 s76, s76, 32768
  ds_read_b64_tr_b16 a[136:137], v28 offset:16392
  ds_read_b64_tr_b16 a[138:139], v28 offset:17416
  v_mfma_f32_16x16x32_bf16 v[96:99], a[148:151], a[48:51], v[96:99]
  v_mfma_f32_16x16x32_bf16 v[100:103], a[148:151], a[52:55], v[100:103]
  s_add_u32 m0, s69, 13312
  ds_read_b64_tr_b16 a[140:141], v28 offset:20488
  ds_read_b64_tr_b16 a[142:143], v28 offset:21512
  v_mfma_f32_16x16x32_bf16 v[100:103], a[144:147], a[36:39], v[100:103]
  buffer_load_dwordx4 v33, s[12:15], s76 offen lds
  v_mfma_f32_16x16x32_bf16 v[104:107], a[144:147], a[40:43], v[104:107]
  s_add_u32 s76, s76, 229376
  v_mfma_f32_16x16x32_bf16 v[104:107], a[148:151], a[56:59], v[104:107]
  s_cmp_eq_u32 s76, 5242880
  s_cselect_b32 s76, 0, s76
  v_mfma_f32_16x16x32_bf16 v[108:111], a[148:151], a[60:63], v[108:111]
  s_add_u32 m0, s70, 133120
  v_mfma_f32_16x16x32_bf16 v[108:111], a[144:147], a[44:47], v[108:111]
  buffer_load_dwordx4 v244, s[16:19], s77 offen lds
  v_mfma_f32_16x16x32_bf16 v[112:115], a[152:155], a[32:35], v[112:115]
  s_add_u32 s77, s77, 10240
  ds_read_b64_tr_b16 a[144:145], v29 offset:16384
  ds_read_b64_tr_b16 a[146:147], v29 offset:17408
  v_mfma_f32_16x16x32_bf16 v[112:115], a[156:159], a[48:51], v[112:115]
  v_mfma_f32_16x16x32_bf16 v[116:119], a[156:159], a[52:55], v[116:119]
  s_add_u32 m0, s70, 134144
  ds_read_b64_tr_b16 a[148:149], v29 offset:20480
  ds_read_b64_tr_b16 a[150:151], v29 offset:21504
  v_mfma_f32_16x16x32_bf16 v[116:119], a[152:155], a[36:39], v[116:119]
  buffer_load_dwordx4 v245, s[16:19], s77 offen lds
  v_mfma_f32_16x16x32_bf16 v[120:123], a[152:155], a[40:43], v[120:123]
  s_waitcnt vmcnt(20)
  ds_read_b128 a[0:3], v240 offset:32768
  v_mfma_f32_16x16x32_bf16 v[120:123], a[156:159], a[56:59], v[120:123]
  s_add_u32 s77, s77, 10240
  v_mfma_f32_16x16x32_bf16 v[124:127], a[156:159], a[60:63], v[124:127]
  ds_read_b128 a[4:7], v240 offset:34816
  v_mfma_f32_16x16x32_bf16 v[124:127], a[152:155], a[44:47], v[124:127]
  v_mfma_f32_16x16x32_bf16 v[128:131], a[160:163], a[32:35], v[128:131]
  ds_read_b64_tr_b16 a[152:153], v29 offset:16392
  ds_read_b64_tr_b16 a[154:155], v29 offset:17416
  v_mfma_f32_16x16x32_bf16 v[128:131], a[164:167], a[48:51], v[128:131]
  v_mfma_f32_16x16x32_bf16 v[132:135], a[164:167], a[52:55], v[132:135]
  s_add_u32 m0, s70, 135168
  ds_read_b64_tr_b16 a[156:157], v29 offset:20488
  ds_read_b64_tr_b16 a[158:159], v29 offset:21512
  v_mfma_f32_16x16x32_bf16 v[132:135], a[160:163], a[36:39], v[132:135]
  buffer_load_dwordx4 v244, s[16:19], s77 offen lds
  v_mfma_f32_16x16x32_bf16 v[136:139], a[160:163], a[40:43], v[136:139]
  s_add_u32 s77, s77, 10240
  ds_read_b128 a[8:11], v240 offset:36864
  v_mfma_f32_16x16x32_bf16 v[136:139], a[164:167], a[56:59], v[136:139]
  v_mfma_f32_16x16x32_bf16 v[140:143], a[164:167], a[60:63], v[140:143]
  s_add_u32 m0, s70, 136192
  ds_read_b128 a[12:15], v240 offset:38912
  v_mfma_f32_16x16x32_bf16 v[140:143], a[160:163], a[44:47], v[140:143]
  buffer_load_dwordx4 v245, s[16:19], s77 offen lds
  v_mfma_f32_16x16x32_bf16 v[144:147], a[168:171], a[32:35], v[144:147]
  s_add_u32 s77, s77, 10240
  ds_read_b64_tr_b16 a[160:161], v30 offset:16384
  ds_read_b64_tr_b16 a[162:163], v30 offset:17408
  v_mfma_f32_16x16x32_bf16 v[144:147], a[172:175], a[48:51], v[144:147]
  v_mfma_f32_16x16x32_bf16 v[148:151], a[172:175], a[52:55], v[148:151]
  s_add_u32 m0, s70, 137216
  ds_read_b64_tr_b16 a[164:165], v30 offset:20480
  ds_read_b64_tr_b16 a[166:167], v30 offset:21504
  v_mfma_f32_16x16x32_bf16 v[148:151], a[168:171], a[36:39], v[148:151]
  buffer_load_dwordx4 v244, s[16:19], s77 offen lds
  v_mfma_f32_16x16x32_bf16 v[152:155], a[168:171], a[40:43], v[152:155]
  s_add_u32 s77, s77, 10240
  ds_read_b128 a[16:19], v241 offset:32768
  v_mfma_f32_16x16x32_bf16 v[152:155], a[172:175], a[56:59], v[152:155]
  v_mfma_f32_16x16x32_bf16 v[156:159], a[172:175], a[60:63], v[156:159]
  s_add_u32 m0, s70, 138240
  ds_read_b128 a[20:23], v241 offset:34816
  v_mfma_f32_16x16x32_bf16 v[156:159], a[168:171], a[44:47], v[156:159]
  buffer_load_dwordx4 v245, s[16:19], s77 offen lds
  v_mfma_f32_16x16x32_bf16 v[160:163], a[176:179], a[32:35], v[160:163]
  s_sub_u32 s77, s77, 71552
  ds_read_b64_tr_b16 a[168:169], v30 offset:16392
  ds_read_b64_tr_b16 a[170:171], v30 offset:17416
  v_mfma_f32_16x16x32_bf16 v[160:163], a[180:183], a[48:51], v[160:163]
  s_cmp_eq_u32 s77, 1280
  s_cselect_b32 s77, 0, s77
  v_mfma_f32_16x16x32_bf16 v[164:167], a[180:183], a[52:55], v[164:167]
  ds_read_b64_tr_b16 a[172:173], v30 offset:20488
  ds_read_b64_tr_b16 a[174:175], v30 offset:21512
  v_mfma_f32_16x16x32_bf16 v[164:167], a[176:179], a[36:39], v[164:167]
  buffer_store_dwordx4 a[72:75], v233, s[20:23], s66 offen sc1
  v_mfma_f32_16x16x32_bf16 v[168:171], a[176:179], a[40:43], v[168:171]
  ds_read_b128 a[24:27], v241 offset:36864
  v_mfma_f32_16x16x32_bf16 v[168:171], a[180:183], a[56:59], v[168:171]
  v_mfma_f32_16x16x32_bf16 v[172:175], a[180:183], a[60:63], v[172:175]
  ds_read_b128 a[28:31], v241 offset:38912
  v_mfma_f32_16x16x32_bf16 v[172:175], a[176:179], a[44:47], v[172:175]
  buffer_store_dwordx4 a[76:79], v234, s[20:23], s66 offen sc1
  v_mfma_f32_16x16x32_bf16 v[176:179], a[184:187], a[32:35], v[176:179]
  ds_read_b64_tr_b16 a[176:177], v31 offset:16384
  ds_read_b64_tr_b16 a[178:179], v31 offset:17408
  v_mfma_f32_16x16x32_bf16 v[176:179], a[188:191], a[48:51], v[176:179]
  v_mfma_f32_16x16x32_bf16 v[180:183], a[188:191], a[52:55], v[180:183]
  ds_read_b64_tr_b16 a[180:181], v31 offset:20480
  ds_read_b64_tr_b16 a[182:183], v31 offset:21504
  v_mfma_f32_16x16x32_bf16 v[180:183], a[184:187], a[36:39], v[180:183]
  buffer_store_dwordx4 a[80:83], v235, s[20:23], s79 offen sc1
  v_mfma_f32_16x16x32_bf16 v[184:187], a[184:187], a[40:43], v[184:187]
  v_mfma_f32_16x16x32_bf16 v[184:187], a[188:191], a[56:59], v[184:187]
  v_mfma_f32_16x16x32_bf16 v[188:191], a[188:191], a[60:63], v[188:191]
  ds_read_b64_tr_b16 a[188:189], v31 offset:20488
  ds_read_b64_tr_b16 a[190:191], v31 offset:21512
  v_mfma_f32_16x16x32_bf16 v[188:191], a[184:187], a[44:47], v[188:191]
  s_waitcnt lgkmcnt(6)
  ds_read_b64_tr_b16 a[184:185], v31 offset:16392
  ds_read_b64_tr_b16 a[186:187], v31 offset:17416
  v_mfma_f32_16x16x32_bf16 v[64:67], a[128:131], a[0:3], v[64:67]
  s_add_u32 m0, s70, 98304
  v_mfma_f32_16x16x32_bf16 v[64:67], a[132:135], a[16:19], v[64:67]
  buffer_load_dwordx4 v244, s[16:19], s77 offen lds
  v_mfma_f32_16x16x32_bf16 v[68:71], a[132:135], a[20:23], v[68:71]
  s_add_u32 s77, s77, 10240
  v_mfma_f32_16x16x32_bf16 v[68:71], a[128:131], a[4:7], v[68:71]
  s_add_u32 m0, s70, 99328
  v_mfma_f32_16x16x32_bf16 v[72:75], a[128:131], a[8:11], v[72:75]
  buffer_load_dwordx4 v245, s[16:19], s77 offen lds
  v_mfma_f32_16x16x32_bf16 v[72:75], a[132:135], a[24:27], v[72:75]
  s_add_u32 s77, s77, 10240
  v_mfma_f32_16x16x32_bf16 v[76:79], a[132:135], a[28:31], v[76:79]
  v_mfma_f32_16x16x32_bf16 v[76:79], a[128:131], a[12:15], v[76:79]
  s_waitcnt lgkmcnt(0)
  v_mfma_f32_16x16x32_bf16 a[64:67], a[128:131], a[248:251], a[64:67]
  s_waitcnt vmcnt(23)
  v_mfma_f32_16x16x32_bf16 a[64:67], a[132:135], a[248:251], a[64:67]
  s_barrier
  v_mfma_f32_16x16x32_bf16 v[80:83], a[136:139], a[0:3], v[80:83]
  s_add_u32 m0, s69, 16384
  ds_read_b64_tr_b16 a[128:129], v28 offset:0
  ds_read_b64_tr_b16 a[130:131], v28 offset:1024
  v_mfma_f32_16x16x32_bf16 v[80:83], a[140:143], a[16:19], v[80:83]
  buffer_load_dwordx4 v33, s[12:15], s76 offen lds
  v_mfma_f32_16x16x32_bf16 v[84:87], a[140:143], a[20:23], v[84:87]
  s_add_u32 s76, s76, 32768
  ds_read_b64_tr_b16 a[132:133], v28 offset:4096
  ds_read_b64_tr_b16 a[134:135], v28 offset:5120
  v_mfma_f32_16x16x32_bf16 v[84:87], a[136:139], a[4:7], v[84:87]
  v_mfma_f32_16x16x32_bf16 v[88:91], a[136:139], a[8:11], v[88:91]
  s_add_u32 m0, s69, 17408
  v_mfma_f32_16x16x32_bf16 v[88:91], a[140:143], a[24:27], v[88:91]
  buffer_load_dwordx4 v33, s[12:15], s76 offen lds
  v_mfma_f32_16x16x32_bf16 v[92:95], a[140:143], a[28:31], v[92:95]
  s_add_u32 s76, s76, 229376
  v_mfma_f32_16x16x32_bf16 v[92:95], a[136:139], a[12:15], v[92:95]
  v_mfma_f32_16x16x32_bf16 a[68:71], a[136:139], a[248:251], a[68:71]
  v_mfma_f32_16x16x32_bf16 a[68:71], a[140:143], a[248:251], a[68:71]
  v_mfma_f32_16x16x32_bf16 v[96:99], a[144:147], a[0:3], v[96:99]
  ds_read_b64_tr_b16 a[136:137], v28 offset:8
  ds_read_b64_tr_b16 a[138:139], v28 offset:1032
  v_mfma_f32_16x16x32_bf16 v[96:99], a[148:151], a[16:19], v[96:99]
  v_mfma_f32_16x16x32_bf16 v[100:103], a[148:151], a[20:23], v[100:103]
  s_add_u32 m0, s69, 20480
  ds_read_b64_tr_b16 a[140:141], v28 offset:4104
  ds_read_b64_tr_b16 a[142:143], v28 offset:5128
  v_mfma_f32_16x16x32_bf16 v[100:103], a[144:147], a[4:7], v[100:103]
  buffer_load_dwordx4 v33, s[12:15], s76 offen lds
  v_mfma_f32_16x16x32_bf16 v[104:107], a[144:147], a[8:11], v[104:107]
  s_add_u32 s76, s76, 32768
  v_mfma_f32_16x16x32_bf16 v[104:107], a[148:151], a[24:27], v[104:107]
  v_mfma_f32_16x16x32_bf16 v[108:111], a[148:151], a[28:31], v[108:111]
  s_add_u32 m0, s69, 21504
  v_mfma_f32_16x16x32_bf16 v[108:111], a[144:147], a[12:15], v[108:111]
  buffer_load_dwordx4 v33, s[12:15], s76 offen lds
  v_mfma_f32_16x16x32_bf16 v[112:115], a[152:155], a[0:3], v[112:115]
  s_add_u32 s76, s76, 229376
  ds_read_b64_tr_b16 a[144:145], v29 offset:0
  ds_read_b64_tr_b16 a[146:147], v29 offset:1024
  v_mfma_f32_16x16x32_bf16 v[112:115], a[156:159], a[16:19], v[112:115]
  s_cmp_eq_u32 s76, 5242880
  s_cselect_b32 s76, 0, s76
  v_mfma_f32_16x16x32_bf16 v[116:119], a[156:159], a[20:23], v[116:119]
  s_add_u32 m0, s70, 100352
  ds_read_b64_tr_b16 a[148:149], v29 offset:4096
  ds_read_b64_tr_b16 a[150:151], v29 offset:5120
  v_mfma_f32_16x16x32_bf16 v[116:119], a[152:155], a[4:7], v[116:119]
  buffer_load_dwordx4 v244, s[16:19], s77 offen lds
  v_mfma_f32_16x16x32_bf16 v[120:123], a[152:155], a[8:11], v[120:123]
  s_waitcnt vmcnt(22)
  ds_read_b128 a[32:35], v240 offset:0
  v_mfma_f32_16x16x32_bf16 v[120:123], a[156:159], a[24:27], v[120:123]
  s_add_u32 s77, s77, 10240
  v_mfma_f32_16x16x32_bf16 v[124:127], a[156:159], a[28:31], v[124:127]
  ds_read_b128 a[36:39], v240 offset:2048
  v_mfma_f32_16x16x32_bf16 v[124:127], a[152:155], a[12:15], v[124:127]
  v_mfma_f32_16x16x32_bf16 v[128:131], a[160:163], a[0:3], v[128:131]
  ds_read_b64_tr_b16 a[152:153], v29 offset:8
  ds_read_b64_tr_b16 a[154:155], v29 offset:1032
  v_mfma_f32_16x16x32_bf16 v[128:131], a[164:167], a[16:19], v[128:131]
  v_mfma_f32_16x16x32_bf16 v[132:135], a[164:167], a[20:23], v[132:135]
  s_add_u32 m0, s70, 101376
  ds_read_b64_tr_b16 a[156:157], v29 offset:4104
  ds_read_b64_tr_b16 a[158:159], v29 offset:5128
  v_mfma_f32_16x16x32_bf16 v[132:135], a[160:163], a[4:7], v[132:135]
  buffer_load_dwordx4 v245, s[16:19], s77 offen lds
  v_mfma_f32_16x16x32_bf16 v[136:139], a[160:163], a[8:11], v[136:139]
  s_add_u32 s77, s77, 10240
  ds_read_b128 a[40:43], v240 offset:4096
  v_mfma_f32_16x16x32_bf16 v[136:139], a[164:167], a[24:27], v[136:139]
  v_mfma_f32_16x16x32_bf16 v[140:143], a[164:167], a[28:31], v[140:143]
  s_add_u32 m0, s70, 102400
  ds_read_b128 a[44:47], v240 offset:6144
  v_mfma_f32_16x16x32_bf16 v[140:143], a[160:163], a[12:15], v[140:143]
  buffer_load_dwordx4 v244, s[16:19], s77 offen lds
  v_mfma_f32_16x16x32_bf16 v[144:147], a[168:171], a[0:3], v[144:147]
  s_add_u32 s77, s77, 10240
  ds_read_b64_tr_b16 a[160:161], v30 offset:0
  ds_read_b64_tr_b16 a[162:163], v30 offset:1024
  v_mfma_f32_16x16x32_bf16 v[144:147], a[172:175], a[16:19], v[144:147]
  v_mfma_f32_16x16x32_bf16 v[148:151], a[172:175], a[20:23], v[148:151]
  s_add_u32 m0, s70, 103424
  ds_read_b64_tr_b16 a[164:165], v30 offset:4096
  ds_read_b64_tr_b16 a[166:167], v30 offset:5120
  v_mfma_f32_16x16x32_bf16 v[148:151], a[168:171], a[4:7], v[148:151]
  buffer_load_dwordx4 v245, s[16:19], s77 offen lds
  v_mfma_f32_16x16x32_bf16 v[152:155], a[168:171], a[8:11], v[152:155]
  s_add_u32 s77, s77, 10240
  ds_read_b128 a[48:51], v241 offset:0
  v_mfma_f32_16x16x32_bf16 v[152:155], a[172:175], a[24:27], v[152:155]
  v_mfma_f32_16x16x32_bf16 v[156:159], a[172:175], a[28:31], v[156:159]
  s_add_u32 m0, s70, 104448
  ds_read_b128 a[52:55], v241 offset:2048
  v_mfma_f32_16x16x32_bf16 v[156:159], a[168:171], a[12:15], v[156:159]
  buffer_load_dwordx4 v244, s[16:19], s77 offen lds
  v_mfma_f32_16x16x32_bf16 v[160:163], a[176:179], a[0:3], v[160:163]
  s_add_u32 s77, s77, 10240
  ds_read_b64_tr_b16 a[168:169], v30 offset:8
  ds_read_b64_tr_b16 a[170:171], v30 offset:1032
  v_mfma_f32_16x16x32_bf16 v[160:163], a[180:183], a[16:19], v[160:163]
  v_mfma_f32_16x16x32_bf16 v[164:167], a[180:183], a[20:23], v[164:167]
  ds_read_b64_tr_b16 a[172:173], v30 offset:4104
  ds_read_b64_tr_b16 a[174:175], v30 offset:5128
  v_mfma_f32_16x16x32_bf16 v[164:167], a[176:179], a[4:7], v[164:167]
  v_mfma_f32_16x16x32_bf16 v[168:171], a[176:179], a[8:11], v[168:171]
  ds_read_b128 a[56:59], v241 offset:4096
  v_mfma_f32_16x16x32_bf16 v[168:171], a[180:183], a[24:27], v[168:171]
  v_mfma_f32_16x16x32_bf16 v[172:175], a[180:183], a[28:31], v[172:175]
  s_add_u32 m0, s70, 105472
  ds_read_b128 a[60:63], v241 offset:6144
  v_mfma_f32_16x16x32_bf16 v[172:175], a[176:179], a[12:15], v[172:175]
  buffer_load_dwordx4 v245, s[16:19], s77 offen lds
  v_mfma_f32_16x16x32_bf16 v[176:179], a[184:187], a[0:3], v[176:179]
  s_sub_u32 s77, s77, 71552
  ds_read_b64_tr_b16 a[176:177], v31 offset:0
  ds_read_b64_tr_b16 a[178:179], v31 offset:1024
  v_mfma_f32_16x16x32_bf16 v[176:179], a[188:191], a[16:19], v[176:179]
  s_cmp_eq_u32 s77, 1280
  s_cselect_b32 s77, 0, s77
  v_mfma_f32_16x16x32_bf16 v[180:183], a[188:191], a[20:23], v[180:183]
  s_add_u32 s62, s100, L_CONV-L_PC
  s_addc_u32 s63, s101, 0
  ds_read_b64_tr_b16 a[180:181], v31 offset:4096
  ds_read_b64_tr_b16 a[182:183], v31 offset:5120
  v_mfma_f32_16x16x32_bf16 v[180:183], a[184:187], a[4:7], v[180:183]
  global_load_dword v7, v0, s[62:63]
  v_mfma_f32_16x16x32_bf16 v[184:187], a[184:187], a[8:11], v[184:187]
  v_mfma_f32_16x16x32_bf16 v[184:187], a[188:191], a[24:27], v[184:187]
  v_mfma_f32_16x16x32_bf16 v[188:191], a[188:191], a[28:31], v[188:191]
  ds_read_b64_tr_b16 a[188:189], v31 offset:4104
  ds_read_b64_tr_b16 a[190:191], v31 offset:5128
  v_mfma_f32_16x16x32_bf16 v[188:191], a[184:187], a[12:15], v[188:191]
  s_waitcnt lgkmcnt(6)
  ds_read_b64_tr_b16 a[184:185], v31 offset:8
  ds_read_b64_tr_b16 a[186:187], v31 offset:1032
  v_mfma_f32_16x16x32_bf16 v[64:67], a[128:131], a[32:35], v[64:67]
  v_mfma_f32_16x16x32_bf16 v[64:67], a[132:135], a[48:51], v[64:67]
  v_mfma_f32_16x16x32_bf16 v[68:71], a[132:135], a[52:55], v[68:71]
  v_mfma_f32_16x16x32_bf16 v[68:71], a[128:131], a[36:39], v[68:71]
  v_mfma_f32_16x16x32_bf16 v[72:75], a[128:131], a[40:43], v[72:75]
  v_mfma_f32_16x16x32_bf16 v[72:75], a[132:135], a[56:59], v[72:75]
  v_mfma_f32_16x16x32_bf16 v[76:79], a[132:135], a[60:63], v[76:79]
  v_mfma_f32_16x16x32_bf16 v[76:79], a[128:131], a[44:47], v[76:79]
  s_waitcnt lgkmcnt(0)
  v_mfma_f32_16x16x32_bf16 a[64:67], a[128:131], a[248:251], a[64:67]
  s_waitcnt vmcnt(13)
  v_mfma_f32_16x16x32_bf16 a[64:67], a[132:135], a[248:251], a[64:67]
  s_barrier
  s_cmp_lg_u32 s28, 0
  s_cbranch_scc1 SIG_1_1992
  s_bfe_u32 s71, s2, 0x20002
  s_lshl_b32 s71, s71, 10
  s_lshr_b32 vcc_lo, s2, 4
  s_lshl_b32 vcc_lo, vcc_lo, 6
  s_add_u32 s71, s71, vcc_lo
  s_and_b32 vcc_lo, s2, 3
  s_lshl_b32 vcc_lo, vcc_lo, 4
  s_add_u32 s71, s71, vcc_lo
  s_add_u32 s71, s71, 14712832
  v_mov_b32 v8, s31
  v_mov_b32 v9, 0
  s_mov_b64 exec, 1
  buffer_store_dword v8, v9, s[20:23], s71 offen sc1
  s_mov_b64 exec, -1
SIG_1_1992:
  v_mfma_f32_16x16x32_bf16 v[80:83], a[136:139], a[32:35], v[80:83]
  s_add_u32 m0, s32, 0
  ds_read_b64_tr_b16 a[128:129], v28 offset:8192
  ds_read_b64_tr_b16 a[130:131], v28 offset:9216
  v_mfma_f32_16x16x32_bf16 v[80:83], a[140:143], a[48:51], v[80:83]
  buffer_load_dwordx4 v22, s[4:7], s34 offen offset:0 lds
  v_mfma_f32_16x16x32_bf16 v[84:87], a[140:143], a[52:55], v[84:87]
  ds_read_b64_tr_b16 a[132:133], v28 offset:12288
  ds_read_b64_tr_b16 a[134:135], v28 offset:13312
  v_mfma_f32_16x16x32_bf16 v[84:87], a[136:139], a[36:39], v[84:87]
  v_mfma_f32_16x16x32_bf16 v[88:91], a[136:139], a[40:43], v[88:91]
  v_mfma_f32_16x16x32_bf16 v[88:91], a[140:143], a[56:59], v[88:91]
  buffer_load_dwordx4 v23, s[4:7], s34 offen offset:1024 lds
  v_mfma_f32_16x16x32_bf16 v[92:95], a[140:143], a[60:63], v[92:95]
  s_add_u32 s34, s34, 8192
  v_mfma_f32_16x16x32_bf16 v[92:95], a[136:139], a[44:47], v[92:95]
  s_and_b32 s34, s34, 0x7ffff
  v_mfma_f32_16x16x32_bf16 a[68:71], a[136:139], a[248:251], a[68:71]
  s_add_u32 m0, s32, 8192
  v_mfma_f32_16x16x32_bf16 a[68:71], a[140:143], a[248:251], a[68:71]
  buffer_load_dwordx4 v22, s[4:7], s34 offen offset:0 lds
  v_mfma_f32_16x16x32_bf16 v[96:99], a[144:147], a[32:35], v[96:99]
  ds_read_b64_tr_b16 a[136:137], v28 offset:8200
  ds_read_b64_tr_b16 a[138:139], v28 offset:9224
  v_mfma_f32_16x16x32_bf16 v[96:99], a[148:151], a[48:51], v[96:99]
  v_mfma_f32_16x16x32_bf16 v[100:103], a[148:151], a[52:55], v[100:103]
  ds_read_b64_tr_b16 a[140:141], v28 offset:12296
  ds_read_b64_tr_b16 a[142:143], v28 offset:13320
  v_mfma_f32_16x16x32_bf16 v[100:103], a[144:147], a[36:39], v[100:103]
  buffer_load_dwordx4 v23, s[4:7], s34 offen offset:1024 lds
  v_mfma_f32_16x16x32_bf16 v[104:107], a[144:147], a[40:43], v[104:107]
  s_add_u32 s34, s34, 8192
  v_mfma_f32_16x16x32_bf16 v[104:107], a[148:151], a[56:59], v[104:107]
  s_and_b32 s34, s34, 0x7ffff
  v_mfma_f32_16x16x32_bf16 v[108:111], a[148:151], a[60:63], v[108:111]
  s_add_u32 m0, s33, 0
  v_mfma_f32_16x16x32_bf16 v[108:111], a[144:147], a[44:47], v[108:111]
  buffer_load_dwordx4 v24, s[8:11], s35 offen offset:0 lds
  v_mfma_f32_16x16x32_bf16 v[112:115], a[152:155], a[32:35], v[112:115]
  ds_read_b64_tr_b16 a[144:145], v29 offset:8192
  ds_read_b64_tr_b16 a[146:147], v29 offset:9216
  v_mfma_f32_16x16x32_bf16 v[112:115], a[156:159], a[48:51], v[112:115]
  v_mfma_f32_16x16x32_bf16 v[116:119], a[156:159], a[52:55], v[116:119]
  ds_read_b64_tr_b16 a[148:149], v29 offset:12288
  ds_read_b64_tr_b16 a[150:151], v29 offset:13312
  v_mfma_f32_16x16x32_bf16 v[116:119], a[152:155], a[36:39], v[116:119]
  buffer_load_dwordx4 v25, s[8:11], s35 offen offset:1024 lds
  v_mfma_f32_16x16x32_bf16 v[120:123], a[152:155], a[40:43], v[120:123]
  s_waitcnt vmcnt(22)
  ds_read_b128 a[0:3], v242 offset:0
  v_mfma_f32_16x16x32_bf16 v[120:123], a[156:159], a[56:59], v[120:123]
  s_add_u32 s35, s35, 8192
  v_mfma_f32_16x16x32_bf16 v[124:127], a[156:159], a[60:63], v[124:127]
  s_mov_b32 s79, 15204352
  ds_read_b128 a[4:7], v242 offset:2048
  v_mfma_f32_16x16x32_bf16 v[124:127], a[152:155], a[44:47], v[124:127]
  s_and_b32 s35, s35, 0x7ffff
  buffer_load_dwordx4 v[40:43], v249, s[20:23], s79 offen offset:0 sc1
  v_mfma_f32_16x16x32_bf16 v[128:131], a[160:163], a[32:35], v[128:131]
  ds_read_b64_tr_b16 a[152:153], v29 offset:8200
  ds_read_b64_tr_b16 a[154:155], v29 offset:9224
  v_mfma_f32_16x16x32_bf16 v[128:131], a[164:167], a[48:51], v[128:131]
  v_mfma_f32_16x16x32_bf16 v[132:135], a[164:167], a[52:55], v[132:135]
  ds_read_b64_tr_b16 a[156:157], v29 offset:12296
  ds_read_b64_tr_b16 a[158:159], v29 offset:13320
  v_mfma_f32_16x16x32_bf16 v[132:135], a[160:163], a[36:39], v[132:135]
  buffer_load_dwordx4 v[44:47], v249, s[20:23], s79 offen offset:256 sc1
  v_mfma_f32_16x16x32_bf16 v[136:139], a[160:163], a[40:43], v[136:139]
  ds_read_b128 a[8:11], v242 offset:4096
  v_mfma_f32_16x16x32_bf16 v[136:139], a[164:167], a[56:59], v[136:139]
  v_mfma_f32_16x16x32_bf16 v[140:143], a[164:167], a[60:63], v[140:143]
  ds_read_b128 a[12:15], v242 offset:6144
  v_mfma_f32_16x16x32_bf16 v[140:143], a[160:163], a[44:47], v[140:143]
  buffer_load_dwordx4 v[48:51], v249, s[20:23], s79 offen offset:512 sc1
  v_mfma_f32_16x16x32_bf16 v[144:147], a[168:171], a[32:35], v[144:147]
  ds_read_b64_tr_b16 a[160:161], v30 offset:8192
  ds_read_b64_tr_b16 a[162:163], v30 offset:9216
  v_mfma_f32_16x16x32_bf16 v[144:147], a[172:175], a[48:51], v[144:147]
  v_mfma_f32_16x16x32_bf16 v[148:151], a[172:175], a[52:55], v[148:151]
  ds_read_b64_tr_b16 a[164:165], v30 offset:12288
  ds_read_b64_tr_b16 a[166:167], v30 offset:13312
  v_mfma_f32_16x16x32_bf16 v[148:151], a[168:171], a[36:39], v[148:151]
  buffer_load_dwordx4 v[52:55], v249, s[20:23], s79 offen offset:768 sc1
  v_mfma_f32_16x16x32_bf16 v[152:155], a[168:171], a[40:43], v[152:155]
  ds_read_b128 a[16:19], v243 offset:0
  v_mfma_f32_16x16x32_bf16 v[152:155], a[172:175], a[56:59], v[152:155]
  v_mfma_f32_16x16x32_bf16 v[156:159], a[172:175], a[60:63], v[156:159]
  ds_read_b128 a[20:23], v243 offset:2048
  v_mfma_f32_16x16x32_bf16 v[156:159], a[168:171], a[44:47], v[156:159]
  v_mfma_f32_16x16x32_bf16 v[160:163], a[176:179], a[32:35], v[160:163]
  ds_read_b64_tr_b16 a[168:169], v30 offset:8200
  ds_read_b64_tr_b16 a[170:171], v30 offset:9224
  v_mfma_f32_16x16x32_bf16 v[160:163], a[180:183], a[48:51], v[160:163]
  v_mfma_f32_16x16x32_bf16 v[164:167], a[180:183], a[52:55], v[164:167]
  ds_read_b64_tr_b16 a[172:173], v30 offset:12296
  ds_read_b64_tr_b16 a[174:175], v30 offset:13320
  v_mfma_f32_16x16x32_bf16 v[164:167], a[176:179], a[36:39], v[164:167]
  v_mfma_f32_16x16x32_bf16 v[168:171], a[176:179], a[40:43], v[168:171]
  ds_read_b128 a[24:27], v243 offset:4096
  v_mfma_f32_16x16x32_bf16 v[168:171], a[180:183], a[56:59], v[168:171]
  v_mfma_f32_16x16x32_bf16 v[172:175], a[180:183], a[60:63], v[172:175]
  ds_read_b128 a[28:31], v243 offset:6144
  v_mfma_f32_16x16x32_bf16 v[172:175], a[176:179], a[44:47], v[172:175]
  v_mfma_f32_16x16x32_bf16 v[176:179], a[184:187], a[32:35], v[176:179]
  ds_read_b64_tr_b16 a[176:177], v31 offset:8192
  ds_read_b64_tr_b16 a[178:179], v31 offset:9216
  v_mfma_f32_16x16x32_bf16 v[176:179], a[188:191], a[48:51], v[176:179]
  v_mfma_f32_16x16x32_bf16 v[180:183], a[188:191], a[52:55], v[180:183]
  ds_read_b64_tr_b16 a[180:181], v31 offset:12288
  ds_read_b64_tr_b16 a[182:183], v31 offset:13312
  v_mfma_f32_16x16x32_bf16 v[180:183], a[184:187], a[36:39], v[180:183]
  v_mfma_f32_16x16x32_bf16 v[184:187], a[184:187], a[40:43], v[184:187]
  v_mfma_f32_16x16x32_bf16 v[184:187], a[188:191], a[56:59], v[184:187]
  v_mfma_f32_16x16x32_bf16 v[188:191], a[188:191], a[60:63], v[188:191]
  ds_read_b64_tr_b16 a[188:189], v31 offset:12296
  ds_read_b64_tr_b16 a[190:191], v31 offset:13320
  v_mfma_f32_16x16x32_bf16 v[188:191], a[184:187], a[44:47], v[188:191]
  s_waitcnt lgkmcnt(6)
  ds_read_b64_tr_b16 a[184:185], v31 offset:8200
  ds_read_b64_tr_b16 a[186:187], v31 offset:9224
  v_mfma_f32_16x16x32_bf16 v[64:67], a[128:131], a[0:3], v[64:67]
  s_mov_b32 s12, s52
  v_mfma_f32_16x16x32_bf16 v[64:67], a[132:135], a[16:19], v[64:67]
  s_and_b32 s13, s53, 0xffff
  v_mfma_f32_16x16x32_bf16 v[68:71], a[132:135], a[20:23], v[68:71]
  s_cmp_lt_u32 s72, 216
  s_cselect_b32 s14, 7077888, 0
  v_mfma_f32_16x16x32_bf16 v[68:71], a[128:131], a[4:7], v[68:71]
  s_mul_i32 s38, s73, 327680
  v_mfma_f32_16x16x32_bf16 v[72:75], a[128:131], a[8:11], v[72:75]
  s_add_u32 s38, s38, 3145728
  v_mfma_f32_16x16x32_bf16 v[72:75], a[132:135], a[24:27], v[72:75]
  s_add_u32 s16, s64, s38
  s_addc_u32 s17, s65, 0
  v_mfma_f32_16x16x32_bf16 v[76:79], a[132:135], a[28:31], v[76:79]
  s_and_b32 s17, s17, 0xffff
  v_mfma_f32_16x16x32_bf16 v[76:79], a[128:131], a[12:15], v[76:79]
  s_waitcnt lgkmcnt(0)
  v_mfma_f32_16x16x32_bf16 a[64:67], a[128:131], a[248:251], a[64:67]
  s_waitcnt vmcnt(17)
  v_mfma_f32_16x16x32_bf16 a[64:67], a[132:135], a[248:251], a[64:67]
  s_barrier
  v_mfma_f32_16x16x32_bf16 v[80:83], a[136:139], a[0:3], v[80:83]
  s_add_u32 m0, s32, 16384
  ds_read_b64_tr_b16 a[128:129], v28 offset:16384
  ds_read_b64_tr_b16 a[130:131], v28 offset:17408
  v_mfma_f32_16x16x32_bf16 v[80:83], a[140:143], a[16:19], v[80:83]
  s_cmp_lt_u32 s72, 216
  s_cselect_b32 s18, 327680, 0
  buffer_load_dwordx4 v22, s[4:7], s34 offen offset:0 lds
  v_mfma_f32_16x16x32_bf16 v[84:87], a[140:143], a[20:23], v[84:87]
  s_lshr_b32 s38, s72, 3
  ds_read_b64_tr_b16 a[132:133], v28 offset:20480
  ds_read_b64_tr_b16 a[134:135], v28 offset:21504
  v_mfma_f32_16x16x32_bf16 v[84:87], a[136:139], a[4:7], v[84:87]
  s_lshl_b32 s38, s38, 7
  v_mfma_f32_16x16x32_bf16 v[88:91], a[136:139], a[8:11], v[88:91]
  s_mul_i32 s66, s28, 110592
  v_mfma_f32_16x16x32_bf16 v[88:91], a[140:143], a[24:27], v[88:91]
  s_add_u32 s66, s66, s38
  buffer_load_dwordx4 v23, s[4:7], s34 offen offset:1024 lds
  v_mfma_f32_16x16x32_bf16 v[92:95], a[140:143], a[28:31], v[92:95]
  s_add_u32 s34, s34, 8192
  v_mfma_f32_16x16x32_bf16 v[92:95], a[136:139], a[12:15], v[92:95]
  s_and_b32 s34, s34, 0x7ffff
  v_mfma_f32_16x16x32_bf16 a[68:71], a[136:139], a[248:251], a[68:71]
  s_add_u32 m0, s33, 8192
  v_mfma_f32_16x16x32_bf16 a[68:71], a[140:143], a[248:251], a[68:71]
  s_mul_i32 s67, s28, 5120
  buffer_load_dwordx4 v24, s[8:11], s35 offen offset:0 lds
  v_mfma_f32_16x16x32_bf16 v[96:99], a[144:147], a[0:3], v[96:99]
  s_mov_b32 s68, 27648
  ds_read_b64_tr_b16 a[136:137], v28 offset:16392
  ds_read_b64_tr_b16 a[138:139], v28 offset:17416
  v_mfma_f32_16x16x32_bf16 v[96:99], a[148:151], a[16:19], v[96:99]
  s_mov_b32 s70, 359424
  v_mfma_f32_16x16x32_bf16 v[100:103], a[148:151], a[20:23], v[100:103]
  s_lshl_b32 s69, s28, 13
  ds_read_b64_tr_b16 a[140:141], v28 offset:20488
  ds_read_b64_tr_b16 a[142:143], v28 offset:21512
  v_mfma_f32_16x16x32_bf16 v[100:103], a[144:147], a[4:7], v[100:103]
  s_add_u32 s69, s69, 131072
  buffer_load_dwordx4 v25, s[8:11], s35 offen offset:1024 lds
  v_mfma_f32_16x16x32_bf16 v[104:107], a[144:147], a[8:11], v[104:107]
  s_add_u32 s35, s35, 8192
  v_mfma_f32_16x16x32_bf16 v[104:107], a[148:151], a[24:27], v[104:107]
  s_and_b32 s35, s35, 0x7ffff
  v_mfma_f32_16x16x32_bf16 v[108:111], a[148:151], a[28:31], v[108:111]
  s_add_u32 m0, s33, 16384
  v_mfma_f32_16x16x32_bf16 v[108:111], a[144:147], a[12:15], v[108:111]
  buffer_load_dwordx4 v24, s[8:11], s35 offen offset:0 lds
  v_mfma_f32_16x16x32_bf16 v[112:115], a[152:155], a[0:3], v[112:115]
  ds_read_b64_tr_b16 a[144:145], v29 offset:16384
  ds_read_b64_tr_b16 a[146:147], v29 offset:17408
  v_mfma_f32_16x16x32_bf16 v[112:115], a[156:159], a[16:19], v[112:115]
  v_mfma_f32_16x16x32_bf16 v[116:119], a[156:159], a[20:23], v[116:119]
  ds_read_b64_tr_b16 a[148:149], v29 offset:20480
  ds_read_b64_tr_b16 a[150:151], v29 offset:21504
  v_mfma_f32_16x16x32_bf16 v[116:119], a[152:155], a[4:7], v[116:119]
  buffer_load_dwordx4 v25, s[8:11], s35 offen offset:1024 lds
  v_mfma_f32_16x16x32_bf16 v[120:123], a[152:155], a[8:11], v[120:123]
  s_waitcnt vmcnt(17)
  ds_read_b128 a[32:35], v240 offset:32768
  v_mfma_f32_16x16x32_bf16 v[120:123], a[156:159], a[24:27], v[120:123]
  s_add_u32 s35, s35, 8192
  v_mfma_f32_16x16x32_bf16 v[124:127], a[156:159], a[28:31], v[124:127]
  s_add_u32 m0, s69, 0
  ds_read_b128 a[36:39], v240 offset:34816
  v_mfma_f32_16x16x32_bf16 v[124:127], a[152:155], a[12:15], v[124:127]
  s_and_b32 s35, s35, 0x7ffff
  buffer_load_dwordx4 v32, s[12:15], s66 offen lds
  v_mfma_f32_16x16x32_bf16 v[128:131], a[160:163], a[0:3], v[128:131]
  s_add_u32 s66, s66, s68
  ds_read_b64_tr_b16 a[152:153], v29 offset:16392
  ds_read_b64_tr_b16 a[154:155], v29 offset:17416
  v_mfma_f32_16x16x32_bf16 v[128:131], a[164:167], a[16:19], v[128:131]
  v_mfma_f32_16x16x32_bf16 v[132:135], a[164:167], a[20:23], v[132:135]
  s_add_u32 m0, s69, 1024
  ds_read_b64_tr_b16 a[156:157], v29 offset:20488
  ds_read_b64_tr_b16 a[158:159], v29 offset:21512
  v_mfma_f32_16x16x32_bf16 v[132:135], a[160:163], a[4:7], v[132:135]
  buffer_load_dwordx4 v32, s[12:15], s66 offen lds
  v_mfma_f32_16x16x32_bf16 v[136:139], a[160:163], a[8:11], v[136:139]
  s_add_u32 s66, s66, s68
  ds_read_b128 a[40:43], v240 offset:36864
  v_mfma_f32_16x16x32_bf16 v[136:139], a[164:167], a[24:27], v[136:139]
  v_mfma_f32_16x16x32_bf16 v[140:143], a[164:167], a[28:31], v[140:143]
  s_add_u32 m0, s69, 2048
  ds_read_b128 a[44:47], v240 offset:38912
  v_mfma_f32_16x16x32_bf16 v[140:143], a[160:163], a[12:15], v[140:143]
  buffer_load_dwordx4 v32, s[12:15], s66 offen lds
  v_mfma_f32_16x16x32_bf16 v[144:147], a[168:171], a[0:3], v[144:147]
  s_add_u32 s66, s66, s68
  ds_read_b64_tr_b16 a[160:161], v30 offset:16384
  ds_read_b64_tr_b16 a[162:163], v30 offset:17408
  v_mfma_f32_16x16x32_bf16 v[144:147], a[172:175], a[16:19], v[144:147]
  v_mfma_f32_16x16x32_bf16 v[148:151], a[172:175], a[20:23], v[148:151]
  s_add_u32 m0, s69, 3072
  ds_read_b64_tr_b16 a[164:165], v30 offset:20480
  ds_read_b64_tr_b16 a[166:167], v30 offset:21504
  v_mfma_f32_16x16x32_bf16 v[148:151], a[168:171], a[4:7], v[148:151]
  buffer_load_dwordx4 v32, s[12:15], s66 offen lds
  v_mfma_f32_16x16x32_bf16 v[152:155], a[168:171], a[8:11], v[152:155]
  s_add_u32 s66, s66, s70
  ds_read_b128 a[48:51], v241 offset:32768
  v_mfma_f32_16x16x32_bf16 v[152:155], a[172:175], a[24:27], v[152:155]
  v_mfma_f32_16x16x32_bf16 v[156:159], a[172:175], a[28:31], v[156:159]
  ds_read_b128 a[52:55], v241 offset:34816
  v_mfma_f32_16x16x32_bf16 v[156:159], a[168:171], a[12:15], v[156:159]
  v_mfma_f32_16x16x32_bf16 v[160:163], a[176:179], a[0:3], v[160:163]
  ds_read_b64_tr_b16 a[168:169], v30 offset:16392
  ds_read_b64_tr_b16 a[170:171], v30 offset:17416
  v_mfma_f32_16x16x32_bf16 v[160:163], a[180:183], a[16:19], v[160:163]
  v_mfma_f32_16x16x32_bf16 v[164:167], a[180:183], a[20:23], v[164:167]
  ds_read_b64_tr_b16 a[172:173], v30 offset:20488
  ds_read_b64_tr_b16 a[174:175], v30 offset:21512
  v_mfma_f32_16x16x32_bf16 v[164:167], a[176:179], a[4:7], v[164:167]
  v_mfma_f32_16x16x32_bf16 v[168:171], a[176:179], a[8:11], v[168:171]
  ds_read_b128 a[56:59], v241 offset:36864
  v_mfma_f32_16x16x32_bf16 v[168:171], a[180:183], a[24:27], v[168:171]
  v_mfma_f32_16x16x32_bf16 v[172:175], a[180:183], a[28:31], v[172:175]
  ds_read_b128 a[60:63], v241 offset:38912
  v_mfma_f32_16x16x32_bf16 v[172:175], a[176:179], a[12:15], v[172:175]
  v_mfma_f32_16x16x32_bf16 v[176:179], a[184:187], a[0:3], v[176:179]
  ds_read_b64_tr_b16 a[176:177], v31 offset:16384
  ds_read_b64_tr_b16 a[178:179], v31 offset:17408
  v_mfma_f32_16x16x32_bf16 v[176:179], a[188:191], a[16:19], v[176:179]
  v_mfma_f32_16x16x32_bf16 v[180:183], a[188:191], a[20:23], v[180:183]
  ds_read_b64_tr_b16 a[180:181], v31 offset:20480
  ds_read_b64_tr_b16 a[182:183], v31 offset:21504
  v_mfma_f32_16x16x32_bf16 v[180:183], a[184:187], a[4:7], v[180:183]
  v_mfma_f32_16x16x32_bf16 v[184:187], a[184:187], a[8:11], v[184:187]
  v_mfma_f32_16x16x32_bf16 v[184:187], a[188:191], a[24:27], v[184:187]
  v_mfma_f32_16x16x32_bf16 v[188:191], a[188:191], a[28:31], v[188:191]
  ds_read_b64_tr_b16 a[188:189], v31 offset:20488
  ds_read_b64_tr_b16 a[190:191], v31 offset:21512
  v_mfma_f32_16x16x32_bf16 v[188:191], a[184:187], a[12:15], v[188:191]
  s_waitcnt lgkmcnt(6)
  ds_read_b64_tr_b16 a[184:185], v31 offset:16392
  ds_read_b64_tr_b16 a[186:187], v31 offset:17416
  v_mfma_f32_16x16x32_bf16 v[64:67], a[128:131], a[32:35], v[64:67]
  s_waitcnt vmcnt(10)
  v_mov_b32 v28, v58
  v_mov_b32 v29, v59
  v_mfma_f32_16x16x32_bf16 v[64:67], a[132:135], a[48:51], v[64:67]
  v_mov_b32 v30, v60
  v_mov_b32 v31, v61
  v_mfma_f32_16x16x32_bf16 v[68:71], a[132:135], a[52:55], v[68:71]
  v_mov_b32 v33, v57
  v_xor_b32 v7, s31, v41
  v_mfma_f32_16x16x32_bf16 v[68:71], a[128:131], a[36:39], v[68:71]
  v_xor_b32 v8, s31, v43
  v_or_b32 v7, v7, v8
  v_mfma_f32_16x16x32_bf16 v[72:75], a[128:131], a[40:43], v[72:75]
  v_xor_b32 v8, s31, v45
  v_or_b32 v7, v7, v8
  v_mfma_f32_16x16x32_bf16 v[72:75], a[132:135], a[56:59], v[72:75]
  v_xor_b32 v8, s31, v47
  v_or_b32 v7, v7, v8
  v_mfma_f32_16x16x32_bf16 v[76:79], a[132:135], a[60:63], v[76:79]
  v_xor_b32 v8, s31, v49
  v_or_b32 v7, v7, v8
  v_mfma_f32_16x16x32_bf16 v[76:79], a[128:131], a[44:47], v[76:79]
  s_waitcnt lgkmcnt(0)
  v_xor_b32 v8, s31, v51
  v_or_b32 v7, v7, v8
  v_mfma_f32_16x16x32_bf16 a[64:67], a[128:131], a[248:251], a[64:67]
  s_waitcnt vmcnt(63)
  v_xor_b32 v8, s31, v53
  v_or_b32 v7, v7, v8
  v_mfma_f32_16x16x32_bf16 a[64:67], a[132:135], a[248:251], a[64:67]
  s_barrier
  v_xor_b32 v8, s31, v55
  v_or_b32 v7, v7, v8
  v_mfma_f32_16x16x32_bf16 v[80:83], a[136:139], a[32:35], v[80:83]
  s_add_u32 m0, s32, 24576
  v_mfma_f32_16x16x32_bf16 v[80:83], a[140:143], a[48:51], v[80:83]
  buffer_load_dwordx4 v22, s[4:7], s34 offen offset:0 lds
  v_mfma_f32_16x16x32_bf16 v[84:87], a[140:143], a[52:55], v[84:87]
  v_mfma_f32_16x16x32_bf16 v[84:87], a[136:139], a[36:39], v[84:87]
  buffer_load_dwordx4 v23, s[4:7], s34 offen offset:1024 lds
  v_mfma_f32_16x16x32_bf16 v[88:91], a[136:139], a[40:43], v[88:91]
  s_add_u32 m0, s32, 32768
  v_mfma_f32_16x16x32_bf16 v[88:91], a[140:143], a[56:59], v[88:91]
  s_add_u32 s34, s34, 8192
  s_and_b32 s34, s34, 0x7ffff
  buffer_load_dwordx4 v22, s[4:7], s34 offen offset:0 lds
  v_mfma_f32_16x16x32_bf16 v[92:95], a[140:143], a[60:63], v[92:95]
  v_mfma_f32_16x16x32_bf16 v[92:95], a[136:139], a[44:47], v[92:95]
  buffer_load_dwordx4 v23, s[4:7], s34 offen offset:1024 lds
  v_mfma_f32_16x16x32_bf16 a[68:71], a[136:139], a[248:251], a[68:71]
  s_add_u32 m0, s32, 40960
  v_mfma_f32_16x16x32_bf16 a[68:71], a[140:143], a[248:251], a[68:71]
  s_add_u32 s34, s34, 8192
  s_and_b32 s34, s34, 0x7ffff
  buffer_load_dwordx4 v22, s[4:7], s34 offen offset:0 lds
  v_mfma_f32_16x16x32_bf16 v[96:99], a[144:147], a[32:35], v[96:99]
  v_mfma_f32_16x16x32_bf16 v[96:99], a[148:151], a[48:51], v[96:99]
  buffer_load_dwordx4 v23, s[4:7], s34 offen offset:1024 lds
  v_mfma_f32_16x16x32_bf16 v[100:103], a[148:151], a[52:55], v[100:103]
  s_add_u32 m0, s69, 4096
  v_mfma_f32_16x16x32_bf16 v[100:103], a[144:147], a[36:39], v[100:103]
  s_add_u32 s34, s34, 8192
  s_and_b32 s34, s34, 0x7ffff
  buffer_load_dwordx4 v32, s[12:15], s66 offen lds
  v_mfma_f32_16x16x32_bf16 v[104:107], a[144:147], a[40:43], v[104:107]
  s_add_u32 m0, s69, 5120
  v_mfma_f32_16x16x32_bf16 v[104:107], a[148:151], a[56:59], v[104:107]
  s_add_u32 s66, s66, s68
  buffer_load_dwordx4 v32, s[12:15], s66 offen lds
  v_mfma_f32_16x16x32_bf16 v[108:111], a[148:151], a[60:63], v[108:111]
  s_add_u32 s66, s66, s68
  ds_write_b128 v248, a[64:67] offset:0
  v_mfma_f32_16x16x32_bf16 v[108:111], a[144:147], a[44:47], v[108:111]
  ds_write_b128 v248, a[64:67] offset:512
  v_mfma_f32_16x16x32_bf16 v[112:115], a[152:155], a[32:35], v[112:115]
  ds_write_b128 v248, a[68:71] offset:64
  v_mfma_f32_16x16x32_bf16 v[112:115], a[156:159], a[48:51], v[112:115]
  ds_write_b128 v248, a[68:71] offset:576
  v_mfma_f32_16x16x32_bf16 v[116:119], a[156:159], a[52:55], v[116:119]
  s_add_u32 m0, s69, 6144
  v_mfma_f32_16x16x32_bf16 v[116:119], a[152:155], a[36:39], v[116:119]
  buffer_load_dwordx4 v32, s[12:15], s66 offen lds
  v_mfma_f32_16x16x32_bf16 v[120:123], a[152:155], a[40:43], v[120:123]
  s_add_u32 m0, s69, 7168
  v_mfma_f32_16x16x32_bf16 v[120:123], a[156:159], a[56:59], v[120:123]
  s_add_u32 s66, s66, s68
  buffer_load_dwordx4 v32, s[12:15], s66 offen lds
  v_mfma_f32_16x16x32_bf16 v[124:127], a[156:159], a[60:63], v[124:127]
  s_add_u32 s66, s66, s70
  v_mfma_f32_16x16x32_bf16 v[124:127], a[152:155], a[44:47], v[124:127]
  v_mfma_f32_16x16x32_bf16 v[128:131], a[160:163], a[32:35], v[128:131]
  v_mfma_f32_16x16x32_bf16 v[128:131], a[164:167], a[48:51], v[128:131]
  v_mfma_f32_16x16x32_bf16 v[132:135], a[164:167], a[52:55], v[132:135]
  v_mfma_f32_16x16x32_bf16 v[132:135], a[160:163], a[36:39], v[132:135]
  v_mfma_f32_16x16x32_bf16 v[136:139], a[160:163], a[40:43], v[136:139]
  s_waitcnt lgkmcnt(0)
  v_mfma_f32_16x16x32_bf16 v[136:139], a[164:167], a[56:59], v[136:139]
  s_waitcnt vmcnt(26)
  v_mfma_f32_16x16x32_bf16 v[140:143], a[164:167], a[60:63], v[140:143]
  s_barrier
  v_mfma_f32_16x16x32_bf16 v[140:143], a[160:163], a[44:47], v[140:143]
  v_mfma_f32_16x16x32_bf16 v[144:147], a[168:171], a[32:35], v[144:147]
  ds_read_b128 v[192:195], v248 offset:0
  v_mfma_f32_16x16x32_bf16 v[144:147], a[172:175], a[48:51], v[144:147]
  ds_read_b128 a[128:131], v10 offset:0
  v_mfma_f32_16x16x32_bf16 v[148:151], a[172:175], a[52:55], v[148:151]
  ds_read_b128 v[208:211], v248 offset:64
  v_mfma_f32_16x16x32_bf16 v[148:151], a[168:171], a[36:39], v[148:151]
  ds_read_b128 a[132:135], v11 offset:0
  v_mfma_f32_16x16x32_bf16 v[152:155], a[168:171], a[40:43], v[152:155]
  ds_read_b128 v[196:199], v248 offset:128
  v_mfma_f32_16x16x32_bf16 v[152:155], a[172:175], a[56:59], v[152:155]
  ds_read_b128 a[136:139], v12 offset:0
  v_mfma_f32_16x16x32_bf16 v[156:159], a[172:175], a[60:63], v[156:159]
  ds_read_b128 v[212:215], v248 offset:192
  v_mfma_f32_16x16x32_bf16 v[156:159], a[168:171], a[44:47], v[156:159]
  ds_read_b128 a[140:143], v13 offset:0
  v_mfma_f32_16x16x32_bf16 v[160:163], a[176:179], a[32:35], v[160:163]
  ds_read_b128 v[200:203], v248 offset:256
  v_mfma_f32_16x16x32_bf16 v[160:163], a[180:183], a[48:51], v[160:163]
  ds_read_b128 a[144:147], v10 offset:4096
  v_mfma_f32_16x16x32_bf16 v[164:167], a[180:183], a[52:55], v[164:167]
  ds_read_b128 v[216:219], v248 offset:320
  v_mfma_f32_16x16x32_bf16 v[164:167], a[176:179], a[36:39], v[164:167]
  ds_read_b128 a[148:151], v11 offset:4096
  v_mfma_f32_16x16x32_bf16 v[168:171], a[176:179], a[40:43], v[168:171]
  ds_read_b128 v[204:207], v248 offset:384
  v_mfma_f32_16x16x32_bf16 v[168:171], a[180:183], a[56:59], v[168:171]
  ds_read_b128 a[152:155], v12 offset:4096
  v_mfma_f32_16x16x32_bf16 v[172:175], a[180:183], a[60:63], v[172:175]
  ds_read_b128 v[220:223], v248 offset:448
  v_mfma_f32_16x16x32_bf16 v[172:175], a[176:179], a[44:47], v[172:175]
  ds_read_b128 a[156:159], v13 offset:4096
  v_mfma_f32_16x16x32_bf16 v[176:179], a[184:187], a[32:35], v[176:179]
  v_mfma_f32_16x16x32_bf16 v[176:179], a[188:191], a[48:51], v[176:179]
  s_mov_b32 s71, 14712832
  v_mfma_f32_16x16x32_bf16 v[180:183], a[188:191], a[52:55], v[180:183]
  buffer_load_dword v39, v38, s[20:23], s71 offen sc1
  v_mfma_f32_16x16x32_bf16 v[180:183], a[184:187], a[36:39], v[180:183]
  v_mfma_f32_16x16x32_bf16 v[184:187], a[184:187], a[40:43], v[184:187]
  v_mfma_f32_16x16x32_bf16 v[184:187], a[188:191], a[56:59], v[184:187]
  v_mfma_f32_16x16x32_bf16 v[188:191], a[188:191], a[60:63], v[188:191]
  v_mfma_f32_16x16x32_bf16 v[188:191], a[184:187], a[44:47], v[188:191]
L_CONV:
  s_mov_b32 s79, 0
POLL_S:
  v_cmp_ne_u32 vcc, 0, v7
  s_cbranch_vccz POLL_S_OK
  s_add_u32 s79, s79, 1
  s_cmp_gt_u32 s79, 1048576
  s_cbranch_scc1 POLL_S_OK
  s_mov_b32 s71, 15204352
  buffer_load_dwordx4 v[40:43], v249, s[20:23], s71 offen offset:0 sc1
  buffer_load_dwordx4 v[44:47], v249, s[20:23], s71 offen offset:256 sc1
  buffer_load_dwordx4 v[48:51], v249, s[20:23], s71 offen offset:512 sc1
  buffer_load_dwordx4 v[52:55], v249, s[20:23], s71 offen offset:768 sc1
  s_waitcnt vmcnt(0)
  v_xor_b32 v7, s31, v41
  v_xor_b32 v8, s31, v43
  v_or_b32 v7, v7, v8
  v_xor_b32 v8, s31, v45
  v_or_b32 v7, v7, v8
  v_xor_b32 v8, s31, v47
  v_or_b32 v7, v7, v8
  v_xor_b32 v8, s31, v49
  v_or_b32 v7, v7, v8
  v_xor_b32 v8, s31, v51
  v_or_b32 v7, v7, v8
  v_xor_b32 v8, s31, v53
  v_or_b32 v7, v7, v8
  v_xor_b32 v8, s31, v55
  v_or_b32 v7, v7, v8
  s_branch POLL_S
POLL_S_OK:
  s_waitcnt lgkmcnt(1)
  v_pk_fma_f32 v[64:65], v[192:193], v[40:41], v[64:65] op_sel_hi:[1,0,1]
  v_pk_fma_f32 v[66:67], v[194:195], v[40:41], v[66:67] op_sel_hi:[1,0,1]
  v_pk_fma_f32 v[80:81], v[208:209], v[40:41], v[80:81] op_sel_hi:[1,0,1]
  v_pk_fma_f32 v[82:83], v[210:211], v[40:41], v[82:83] op_sel_hi:[1,0,1]
  v_pk_fma_f32 v[68:69], v[192:193], v[44:45], v[68:69] op_sel_hi:[1,0,1]
  v_pk_fma_f32 v[70:71], v[194:195], v[44:45], v[70:71] op_sel_hi:[1,0,1]
  v_pk_fma_f32 v[84:85], v[208:209], v[44:45], v[84:85] op_sel_hi:[1,0,1]
  v_pk_fma_f32 v[86:87], v[210:211], v[44:45], v[86:87] op_sel_hi:[1,0,1]
  v_pk_fma_f32 v[72:73], v[192:193], v[48:49], v[72:73] op_sel_hi:[1,0,1]
  v_pk_fma_f32 v[74:75], v[194:195], v[48:49], v[74:75] op_sel_hi:[1,0,1]
  v_pk_fma_f32 v[88:89], v[208:209], v[48:49], v[88:89] op_sel_hi:[1,0,1]
  v_pk_fma_f32 v[90:91], v[210:211], v[48:49], v[90:91] op_sel_hi:[1,0,1]
  v_pk_fma_f32 v[76:77], v[192:193], v[52:53], v[76:77] op_sel_hi:[1,0,1]
  v_pk_fma_f32 v[78:79], v[194:195], v[52:53], v[78:79] op_sel_hi:[1,0,1]
  v_pk_fma_f32 v[92:93], v[208:209], v[52:53], v[92:93] op_sel_hi:[1,0,1]
  v_pk_fma_f32 v[94:95], v[210:211], v[52:53], v[94:95] op_sel_hi:[1,0,1]
  v_pk_mul_f32 v[64:65], v[64:65], v[42:43] op_sel_hi:[1,0]
  v_pk_mul_f32 v[66:67], v[66:67], v[42:43] op_sel_hi:[1,0]
  v_pk_mul_f32 v[80:81], v[80:81], v[42:43] op_sel_hi:[1,0]
  v_pk_mul_f32 v[82:83], v[82:83], v[42:43] op_sel_hi:[1,0]
  v_pk_mul_f32 v[68:69], v[68:69], v[46:47] op_sel_hi:[1,0]
  v_pk_mul_f32 v[70:71], v[70:71], v[46:47] op_sel_hi:[1,0]
  v_pk_mul_f32 v[84:85], v[84:85], v[46:47] op_sel_hi:[1,0]
  v_pk_mul_f32 v[86:87], v[86:87], v[46:47] op_sel_hi:[1,0]
  v_pk_mul_f32 v[72:73], v[72:73], v[50:51] op_sel_hi:[1,0]
  v_pk_mul_f32 v[74:75], v[74:75], v[50:51] op_sel_hi:[1,0]
  v_pk_mul_f32 v[88:89], v[88:89], v[50:51] op_sel_hi:[1,0]
  v_pk_mul_f32 v[90:91], v[90:91], v[50:51] op_sel_hi:[1,0]
  v_pk_mul_f32 v[76:77], v[76:77], v[54:55] op_sel_hi:[1,0]
  v_pk_mul_f32 v[78:79], v[78:79], v[54:55] op_sel_hi:[1,0]
  v_pk_mul_f32 v[92:93], v[92:93], v[54:55] op_sel_hi:[1,0]
  v_pk_mul_f32 v[94:95], v[94:95], v[54:55] op_sel_hi:[1,0]
  v_cvt_pk_bf16_f32 v192, v64, v65
  v_cvt_pk_bf16_f32 v193, v66, v67
  v_cvt_pk_bf16_f32 v194, v80, v81
  v_cvt_pk_bf16_f32 v195, v82, v83
  v_cvt_pk_bf16_f32 v208, v68, v69
  v_cvt_pk_bf16_f32 v209, v70, v71
  v_cvt_pk_bf16_f32 v210, v84, v85
  v_cvt_pk_bf16_f32 v211, v86, v87
  v_cvt_pk_bf16_f32 v224, v72, v73
  v_cvt_pk_bf16_f32 v225, v74, v75
  v_cvt_pk_bf16_f32 v226, v88, v89
  v_cvt_pk_bf16_f32 v227, v90, v91
  v_cvt_pk_bf16_f32 v240, v76, v77
  v_cvt_pk_bf16_f32 v241, v78, v79
  v_cvt_pk_bf16_f32 v242, v92, v93
  v_cvt_pk_bf16_f32 v243, v94, v95
  v_pk_fma_f32 v[96:97], v[196:197], v[40:41], v[96:97] op_sel_hi:[1,0,1]
  v_pk_fma_f32 v[98:99], v[198:199], v[40:41], v[98:99] op_sel_hi:[1,0,1]
  v_pk_fma_f32 v[112:113], v[212:213], v[40:41], v[112:113] op_sel_hi:[1,0,1]
  v_pk_fma_f32 v[114:115], v[214:215], v[40:41], v[114:115] op_sel_hi:[1,0,1]
  v_pk_fma_f32 v[100:101], v[196:197], v[44:45], v[100:101] op_sel_hi:[1,0,1]
  v_pk_fma_f32 v[102:103], v[198:199], v[44:45], v[102:103] op_sel_hi:[1,0,1]
  v_pk_fma_f32 v[116:117], v[212:213], v[44:45], v[116:117] op_sel_hi:[1,0,1]
  v_pk_fma_f32 v[118:119], v[214:215], v[44:45], v[118:119] op_sel_hi:[1,0,1]
  v_pk_fma_f32 v[104:105], v[196:197], v[48:49], v[104:105] op_sel_hi:[1,0,1]
  v_pk_fma_f32 v[106:107], v[198:199], v[48:49], v[106:107] op_sel_hi:[1,0,1]
  v_pk_fma_f32 v[120:121], v[212:213], v[48:49], v[120:121] op_sel_hi:[1,0,1]
  v_pk_fma_f32 v[122:123], v[214:215], v[48:49], v[122:123] op_sel_hi:[1,0,1]
  v_pk_fma_f32 v[108:109], v[196:197], v[52:53], v[108:109] op_sel_hi:[1,0,1]
  v_pk_fma_f32 v[110:111], v[198:199], v[52:53], v[110:111] op_sel_hi:[1,0,1]
  v_pk_fma_f32 v[124:125], v[212:213], v[52:53], v[124:125] op_sel_hi:[1,0,1]
  v_pk_fma_f32 v[126:127], v[214:215], v[52:53], v[126:127] op_sel_hi:[1,0,1]
  v_pk_mul_f32 v[96:97], v[96:97], v[42:43] op_sel_hi:[1,0]
  v_pk_mul_f32 v[98:99], v[98:99], v[42:43] op_sel_hi:[1,0]
  v_pk_mul_f32 v[112:113], v[112:113], v[42:43] op_sel_hi:[1,0]
  v_pk_mul_f32 v[114:115], v[114:115], v[42:43] op_sel_hi:[1,0]
  v_pk_mul_f32 v[100:101], v[100:101], v[46:47] op_sel_hi:[1,0]
  v_pk_mul_f32 v[102:103], v[102:103], v[46:47] op_sel_hi:[1,0]
  v_pk_mul_f32 v[116:117], v[116:117], v[46:47] op_sel_hi:[1,0]
  v_pk_mul_f32 v[118:119], v[118:119], v[46:47] op_sel_hi:[1,0]
  v_pk_mul_f32 v[104:105], v[104:105], v[50:51] op_sel_hi:[1,0]
  v_pk_mul_f32 v[106:107], v[106:107], v[50:51] op_sel_hi:[1,0]
  v_pk_mul_f32 v[120:121], v[120:121], v[50:51] op_sel_hi:[1,0]
  v_pk_mul_f32 v[122:123], v[122:123], v[50:51] op_sel_hi:[1,0]
  v_pk_mul_f32 v[108:109], v[108:109], v[54:55] op_sel_hi:[1,0]
  v_pk_mul_f32 v[110:111], v[110:111], v[54:55] op_sel_hi:[1,0]
  v_pk_mul_f32 v[124:125], v[124:125], v[54:55] op_sel_hi:[1,0]
  v_pk_mul_f32 v[126:127], v[126:127], v[54:55] op_sel_hi:[1,0]
  v_cvt_pk_bf16_f32 v196, v96, v97
  v_cvt_pk_bf16_f32 v197, v98, v99
  v_cvt_pk_bf16_f32 v198, v112, v113
  v_cvt_pk_bf16_f32 v199, v114, v115
  v_cvt_pk_bf16_f32 v212, v100, v101
  v_cvt_pk_bf16_f32 v213, v102, v103
  v_cvt_pk_bf16_f32 v214, v116, v117
  v_cvt_pk_bf16_f32 v215, v118, v119
  v_cvt_pk_bf16_f32 v228, v104, v105
  v_cvt_pk_bf16_f32 v229, v106, v107
  v_cvt_pk_bf16_f32 v230, v120, v121
  v_cvt_pk_bf16_f32 v231, v122, v123
  v_cvt_pk_bf16_f32 v244, v108, v109
  v_cvt_pk_bf16_f32 v245, v110, v111
  v_cvt_pk_bf16_f32 v246, v124, v125
  v_cvt_pk_bf16_f32 v247, v126, v127
  v_pk_fma_f32 v[128:129], v[200:201], v[40:41], v[128:129] op_sel_hi:[1,0,1]
  v_pk_fma_f32 v[130:131], v[202:203], v[40:41], v[130:131] op_sel_hi:[1,0,1]
  v_pk_fma_f32 v[144:145], v[216:217], v[40:41], v[144:145] op_sel_hi:[1,0,1]
  v_pk_fma_f32 v[146:147], v[218:219], v[40:41], v[146:147] op_sel_hi:[1,0,1]
  v_pk_fma_f32 v[132:133], v[200:201], v[44:45], v[132:133] op_sel_hi:[1,0,1]
  v_pk_fma_f32 v[134:135], v[202:203], v[44:45], v[134:135] op_sel_hi:[1,0,1]
  v_pk_fma_f32 v[148:149], v[216:217], v[44:45], v[148:149] op_sel_hi:[1,0,1]
  v_pk_fma_f32 v[150:151], v[218:219], v[44:45], v[150:151] op_sel_hi:[1,0,1]
  v_pk_fma_f32 v[136:137], v[200:201], v[48:49], v[136:137] op_sel_hi:[1,0,1]
  v_pk_fma_f32 v[138:139], v[202:203], v[48:49], v[138:139] op_sel_hi:[1,0,1]
  v_pk_fma_f32 v[152:153], v[216:217], v[48:49], v[152:153] op_sel_hi:[1,0,1]
  v_pk_fma_f32 v[154:155], v[218:219], v[48:49], v[154:155] op_sel_hi:[1,0,1]
  v_pk_fma_f32 v[140:141], v[200:201], v[52:53], v[140:141] op_sel_hi:[1,0,1]
  v_pk_fma_f32 v[142:143], v[202:203], v[52:53], v[142:143] op_sel_hi:[1,0,1]
  v_pk_fma_f32 v[156:157], v[216:217], v[52:53], v[156:157] op_sel_hi:[1,0,1]
  v_pk_fma_f32 v[158:159], v[218:219], v[52:53], v[158:159] op_sel_hi:[1,0,1]
  v_pk_mul_f32 v[128:129], v[128:129], v[42:43] op_sel_hi:[1,0]
  v_pk_mul_f32 v[130:131], v[130:131], v[42:43] op_sel_hi:[1,0]
  v_pk_mul_f32 v[144:145], v[144:145], v[42:43] op_sel_hi:[1,0]
  v_pk_mul_f32 v[146:147], v[146:147], v[42:43] op_sel_hi:[1,0]
  v_pk_mul_f32 v[132:133], v[132:133], v[46:47] op_sel_hi:[1,0]
  v_pk_mul_f32 v[134:135], v[134:135], v[46:47] op_sel_hi:[1,0]
  v_pk_mul_f32 v[148:149], v[148:149], v[46:47] op_sel_hi:[1,0]
  v_pk_mul_f32 v[150:151], v[150:151], v[46:47] op_sel_hi:[1,0]
  v_pk_mul_f32 v[136:137], v[136:137], v[50:51] op_sel_hi:[1,0]
  v_pk_mul_f32 v[138:139], v[138:139], v[50:51] op_sel_hi:[1,0]
  v_pk_mul_f32 v[152:153], v[152:153], v[50:51] op_sel_hi:[1,0]
  v_pk_mul_f32 v[154:155], v[154:155], v[50:51] op_sel_hi:[1,0]
  v_pk_mul_f32 v[140:141], v[140:141], v[54:55] op_sel_hi:[1,0]
  v_pk_mul_f32 v[142:143], v[142:143], v[54:55] op_sel_hi:[1,0]
  v_pk_mul_f32 v[156:157], v[156:157], v[54:55] op_sel_hi:[1,0]
  v_pk_mul_f32 v[158:159], v[158:159], v[54:55] op_sel_hi:[1,0]
  v_pk_fma_f32 v[160:161], v[204:205], v[40:41], v[160:161] op_sel_hi:[1,0,1]
  v_pk_fma_f32 v[162:163], v[206:207], v[40:41], v[162:163] op_sel_hi:[1,0,1]
  v_pk_fma_f32 v[176:177], v[220:221], v[40:41], v[176:177] op_sel_hi:[1,0,1]
  v_pk_fma_f32 v[178:179], v[222:223], v[40:41], v[178:179] op_sel_hi:[1,0,1]
  v_pk_fma_f32 v[164:165], v[204:205], v[44:45], v[164:165] op_sel_hi:[1,0,1]
  v_pk_fma_f32 v[166:167], v[206:207], v[44:45], v[166:167] op_sel_hi:[1,0,1]
  v_pk_fma_f32 v[180:181], v[220:221], v[44:45], v[180:181] op_sel_hi:[1,0,1]
  v_pk_fma_f32 v[182:183], v[222:223], v[44:45], v[182:183] op_sel_hi:[1,0,1]
  v_pk_fma_f32 v[168:169], v[204:205], v[48:49], v[168:169] op_sel_hi:[1,0,1]
  v_pk_fma_f32 v[170:171], v[206:207], v[48:49], v[170:171] op_sel_hi:[1,0,1]
  v_pk_fma_f32 v[184:185], v[220:221], v[48:49], v[184:185] op_sel_hi:[1,0,1]
  v_pk_fma_f32 v[186:187], v[222:223], v[48:49], v[186:187] op_sel_hi:[1,0,1]
  v_pk_fma_f32 v[172:173], v[204:205], v[52:53], v[172:173] op_sel_hi:[1,0,1]
  v_pk_fma_f32 v[174:175], v[206:207], v[52:53], v[174:175] op_sel_hi:[1,0,1]
  v_pk_fma_f32 v[188:189], v[220:221], v[52:53], v[188:189] op_sel_hi:[1,0,1]
  v_pk_fma_f32 v[190:191], v[222:223], v[52:53], v[190:191] op_sel_hi:[1,0,1]
  v_pk_mul_f32 v[160:161], v[160:161], v[42:43] op_sel_hi:[1,0]
  v_pk_mul_f32 v[162:163], v[162:163], v[42:43] op_sel_hi:[1,0]
  v_pk_mul_f32 v[176:177], v[176:177], v[42:43] op_sel_hi:[1,0]
  v_pk_mul_f32 v[178:179], v[178:179], v[42:43] op_sel_hi:[1,0]
  v_pk_mul_f32 v[164:165], v[164:165], v[46:47] op_sel_hi:[1,0]
  v_pk_mul_f32 v[166:167], v[166:167], v[46:47] op_sel_hi:[1,0]
  v_pk_mul_f32 v[180:181], v[180:181], v[46:47] op_sel_hi:[1,0]
  v_pk_mul_f32 v[182:183], v[182:183], v[46:47] op_sel_hi:[1,0]
  v_pk_mul_f32 v[168:169], v[168:169], v[50:51] op_sel_hi:[1,0]
  v_pk_mul_f32 v[170:171], v[170:171], v[50:51] op_sel_hi:[1,0]
  v_pk_mul_f32 v[184:185], v[184:185], v[50:51] op_sel_hi:[1,0]
  v_pk_mul_f32 v[186:187], v[186:187], v[50:51] op_sel_hi:[1,0]
  v_pk_mul_f32 v[172:173], v[172:173], v[54:55] op_sel_hi:[1,0]
  v_pk_mul_f32 v[174:175], v[174:175], v[54:55] op_sel_hi:[1,0]
  v_pk_mul_f32 v[188:189], v[188:189], v[54:55] op_sel_hi:[1,0]
  v_pk_mul_f32 v[190:191], v[190:191], v[54:55] op_sel_hi:[1,0]
  s_waitcnt lgkmcnt(0)
  v_mfma_f32_16x16x32_bf16 v[96:99], a[128:131], v[192:195], 0
  s_waitcnt vmcnt(0)
  v_cmp_ne_u32 vcc, s31, v39
  s_cbranch_vccz POLL_H_OK
  s_mov_b32 s71, 14712832
  s_mov_b32 s79, 0
POLL_H:
  buffer_load_dword v39, v38, s[20:23], s71 offen sc1
  s_add_u32 s79, s79, 1
  s_waitcnt vmcnt(0)
  v_cmp_ne_u32 vcc, s31, v39
  s_cmp_gt_u32 s79, 1048576
  s_cbranch_scc1 POLL_H_X
  s_cbranch_vccnz POLL_H
POLL_H_X:
POLL_H_OK:
  v_cvt_pk_bf16_f32 v200, v128, v129
  v_cvt_pk_bf16_f32 v201, v130, v131
  v_mfma_f32_16x16x32_bf16 v[100:103], a[128:131], v[208:211], 0
  v_cvt_pk_bf16_f32 v202, v144, v145
  v_cvt_pk_bf16_f32 v203, v146, v147
  v_mfma_f32_16x16x32_bf16 v[104:107], a[128:131], v[224:227], 0
  buffer_load_dwordx4 v[56:59], v26, s[16:19], s67 offen offset:0 sc1
  v_mfma_f32_16x16x32_bf16 v[108:111], a[128:131], v[240:243], 0
  v_cvt_pk_bf16_f32 v216, v132, v133
  v_cvt_pk_bf16_f32 v217, v134, v135
  v_mfma_f32_16x16x32_bf16 v[112:115], a[144:147], v[192:195], 0
  v_cvt_pk_bf16_f32 v218, v148, v149
  v_cvt_pk_bf16_f32 v219, v150, v151
  v_mfma_f32_16x16x32_bf16 v[116:119], a[144:147], v[208:211], 0
  buffer_load_dwordx4 v[60:63], v26, s[16:19], s67 offen offset:1024 sc1
  v_mfma_f32_16x16x32_bf16 v[120:123], a[144:147], v[224:227], 0
  v_cvt_pk_bf16_f32 v232, v136, v137
  v_cvt_pk_bf16_f32 v233, v138, v139
  v_mfma_f32_16x16x32_bf16 v[124:127], a[144:147], v[240:243], 0
  v_cvt_pk_bf16_f32 v234, v152, v153
  v_cvt_pk_bf16_f32 v235, v154, v155
  v_mfma_f32_16x16x32_bf16 v[96:99], a[132:135], v[196:199], v[96:99]
  buffer_load_dwordx4 v[64:67], v26, s[16:19], s67 offen offset:2048 sc1
  v_mfma_f32_16x16x32_bf16 v[100:103], a[132:135], v[212:215], v[100:103]
  v_cvt_pk_bf16_f32 v248, v140, v141
  v_cvt_pk_bf16_f32 v249, v142, v143
  v_mfma_f32_16x16x32_bf16 v[104:107], a[132:135], v[228:231], v[104:107]
  v_cvt_pk_bf16_f32 v250, v156, v157
  v_cvt_pk_bf16_f32 v251, v158, v159
  v_mfma_f32_16x16x32_bf16 v[108:111], a[132:135], v[244:247], v[108:111]
  buffer_load_dwordx4 v[68:71], v26, s[16:19], s67 offen offset:3072 sc1
  v_mfma_f32_16x16x32_bf16 v[112:115], a[148:151], v[196:199], v[112:115]
  v_cvt_pk_bf16_f32 v204, v160, v161
  v_cvt_pk_bf16_f32 v205, v162, v163
  v_mfma_f32_16x16x32_bf16 v[116:119], a[148:151], v[212:215], v[116:119]
  v_cvt_pk_bf16_f32 v206, v176, v177
  v_cvt_pk_bf16_f32 v207, v178, v179
  v_mfma_f32_16x16x32_bf16 v[120:123], a[148:151], v[228:231], v[120:123]
  v_cvt_pk_bf16_f32 v220, v164, v165
  v_cvt_pk_bf16_f32 v221, v166, v167
  v_mfma_f32_16x16x32_bf16 v[124:127], a[148:151], v[244:247], v[124:127]
  v_cvt_pk_bf16_f32 v222, v180, v181
  v_cvt_pk_bf16_f32 v223, v182, v183
  v_mfma_f32_16x16x32_bf16 v[96:99], a[136:139], v[200:203], v[96:99]
  v_cvt_pk_bf16_f32 v236, v168, v169
  v_cvt_pk_bf16_f32 v237, v170, v171
  v_mfma_f32_16x16x32_bf16 v[100:103], a[136:139], v[216:219], v[100:103]
  buffer_load_dwordx4 v[72:75], v27, s[16:19], s67 offen sc1
  v_mfma_f32_16x16x32_bf16 v[104:107], a[136:139], v[232:235], v[104:107]
  s_add_u32 s67, s67, 20480
  v_cvt_pk_bf16_f32 v238, v184, v185
  v_cvt_pk_bf16_f32 v239, v186, v187
  v_mfma_f32_16x16x32_bf16 v[108:111], a[136:139], v[248:251], v[108:111]
  v_cvt_pk_bf16_f32 v252, v172, v173
  v_cvt_pk_bf16_f32 v253, v174, v175
  v_mfma_f32_16x16x32_bf16 v[112:115], a[152:155], v[200:203], v[112:115]
  v_cvt_pk_bf16_f32 v254, v188, v189
  v_cvt_pk_bf16_f32 v255, v190, v191
  v_mfma_f32_16x16x32_bf16 v[116:119], a[152:155], v[216:219], v[116:119]
  buffer_load_dwordx4 v[76:79], v26, s[16:19], s67 offen offset:0 sc1
  v_mfma_f32_16x16x32_bf16 v[120:123], a[152:155], v[232:235], v[120:123]
  ds_read_b128 a[128:131], v10 offset:8192
  v_mfma_f32_16x16x32_bf16 v[124:127], a[152:155], v[248:251], v[124:127]
  buffer_load_dwordx4 v[80:83], v26, s[16:19], s67 offen offset:1024 sc1
  v_mfma_f32_16x16x32_bf16 v[96:99], a[140:143], v[204:207], v[96:99]
  ds_read_b128 a[132:135], v11 offset:8192
  v_mfma_f32_16x16x32_bf16 v[100:103], a[140:143], v[220:223], v[100:103]
  buffer_load_dwordx4 v[84:87], v26, s[16:19], s67 offen offset:2048 sc1
  v_mfma_f32_16x16x32_bf16 v[104:107], a[140:143], v[236:239], v[104:107]
  ds_read_b128 a[136:139], v12 offset:8192
  v_mfma_f32_16x16x32_bf16 v[108:111], a[140:143], v[252:255], v[108:111]
  buffer_load_dwordx4 v[88:91], v26, s[16:19], s67 offen offset:3072 sc1
  v_mfma_f32_16x16x32_bf16 v[112:115], a[156:159], v[204:207], v[112:115]
  ds_read_b128 a[144:147], v10 offset:12288
  v_mfma_f32_16x16x32_bf16 v[116:119], a[156:159], v[220:223], v[116:119]
  buffer_load_dwordx4 v[92:95], v27, s[16:19], s67 offen sc1
  v_mfma_f32_16x16x32_bf16 v[120:123], a[156:159], v[236:239], v[120:123]
  s_add_u32 s67, s67, 20480
  ds_read_b128 a[140:143], v13 offset:8192
  v_mfma_f32_16x16x32_bf16 v[124:127], a[156:159], v[252:255], v[124:127]
  s_cmp_lg_u32 s37, 0
  s_nop 3
  s_cbranch_scc1 ATT_EXACT
  v_max3_f32 v5, v96, v97, v98
  v_max3_f32 v6, v100, v101, v102
  v_max3_f32 v7, v104, v105, v106
  v_max3_f32 v8, v108, v109, v110
  v_max3_f32 v5, v5, v99, v112
  v_max3_f32 v5, v5, v113, v114
  v_max_f32 v5, v5, v115
  v_max3_f32 v6, v6, v103, v116
  v_max3_f32 v6, v6, v117, v118
  v_max_f32 v6, v6, v119
  v_max3_f32 v7, v7, v107, v120
  v_max3_f32 v7, v7, v121, v122
  v_max_f32 v7, v7, v123
  v_max3_f32 v8, v8, v111, v124
  v_max3_f32 v8, v8, v125, v126
  v_max_f32 v8, v8, v127
  v_mov_b32 v160, v5
  v_mov_b32 v161, v6
  v_mov_b32 v162, v7
  v_mov_b32 v163, v8
  s_nop 1
  v_permlane16_swap_b32 v5, v160
  v_permlane16_swap_b32 v6, v161
  v_permlane16_swap_b32 v7, v162
  v_permlane16_swap_b32 v8, v163
  s_nop 1
  v_max_f32 v5, v5, v160
  v_max_f32 v6, v6, v161
  v_max_f32 v7, v7, v162
  v_max_f32 v8, v8, v163
  v_mov_b32 v160, v5
  v_mov_b32 v161, v6
  v_mov_b32 v162, v7
  v_mov_b32 v163, v8
  s_nop 1
  v_permlane32_swap_b32 v5, v160
  v_permlane32_swap_b32 v6, v161
  v_permlane32_swap_b32 v7, v162
  v_permlane32_swap_b32 v8, v163
  s_nop 1
  v_max_f32 v5, v5, v160
  v_max_f32 v6, v6, v161
  v_max_f32 v7, v7, v162
  v_max_f32 v8, v8, v163
  v_sub_f32 v40, 0, v5
  v_sub_f32 v41, 0, v5
  v_sub_f32 v42, 0, v5
  v_sub_f32 v43, 0, v5
  v_sub_f32 v44, 0, v6
  v_sub_f32 v45, 0, v6
  v_sub_f32 v46, 0, v6
  v_sub_f32 v47, 0, v6
  v_sub_f32 v48, 0, v7
  v_sub_f32 v49, 0, v7
  v_sub_f32 v50, 0, v7
  v_sub_f32 v51, 0, v7
  v_sub_f32 v52, 0, v8
  v_sub_f32 v53, 0, v8
  v_sub_f32 v54, 0, v8
  v_sub_f32 v55, 0, v8
  v_pk_add_f32 v[96:97], v[96:97], v[40:41]
  v_pk_add_f32 v[98:99], v[98:99], v[40:41]
  v_pk_add_f32 v[112:113], v[112:113], v[40:41]
  v_pk_add_f32 v[114:115], v[114:115], v[40:41]
  v_pk_add_f32 v[100:101], v[100:101], v[44:45]
  v_pk_add_f32 v[102:103], v[102:103], v[44:45]
  v_pk_add_f32 v[116:117], v[116:117], v[44:45]
  v_pk_add_f32 v[118:119], v[118:119], v[44:45]
  v_pk_add_f32 v[104:105], v[104:105], v[48:49]
  v_pk_add_f32 v[106:107], v[106:107], v[48:49]
  v_pk_add_f32 v[120:121], v[120:121], v[48:49]
  v_pk_add_f32 v[122:123], v[122:123], v[48:49]
  v_pk_add_f32 v[108:109], v[108:109], v[52:53]
  v_pk_add_f32 v[110:111], v[110:111], v[52:53]
  v_pk_add_f32 v[124:125], v[124:125], v[52:53]
  v_pk_add_f32 v[126:127], v[126:127], v[52:53]
ATT_START:
  s_waitcnt lgkmcnt(0)
  v_mfma_f32_16x16x32_bf16 v[128:131], a[128:131], v[192:195], v[40:43]
  s_waitcnt vmcnt(19)
  v_exp_f32 v96, v96
  v_mfma_f32_16x16x32_bf16 v[128:131], a[132:135], v[196:199], v[128:131]
  s_barrier
  v_mfma_f32_16x16x32_bf16 v[128:131], a[136:139], v[200:203], v[128:131]
  ds_read_b128 a[148:151], v11 offset:12288
  v_add_f32 v34, v34, v96
  v_mfma_f32_16x16x32_bf16 v[128:131], a[140:143], v[204:207], v[128:131]
  v_exp_f32 v97, v97
  v_mfma_f32_16x16x32_bf16 v[132:135], a[140:143], v[220:223], v[44:47]
  ds_read_b128 a[152:155], v12 offset:12288
  v_add_f32 v34, v34, v97
  v_mfma_f32_16x16x32_bf16 v[132:135], a[136:139], v[216:219], v[132:135]
  s_mov_b32 s36, 7
  v_exp_f32 v98, v98
  v_mfma_f32_16x16x32_bf16 v[132:135], a[132:135], v[212:215], v[132:135]
  s_add_u32 s62, s100, L_M1EPI-L_PC
  s_addc_u32 s63, s101, 0
  ds_read_b128 a[156:159], v13 offset:12288
  v_cvt_pk_bf16_f32 v96, v96, v97
  v_mfma_f32_16x16x32_bf16 v[132:135], a[128:131], v[208:211], v[132:135]
  s_add_u32 m0, s32, 49152
  v_exp_f32 v99, v99
  v_mfma_f32_16x16x32_bf16 v[136:139], a[128:131], v[224:227], v[48:51]
  buffer_load_dwordx4 v22, s[4:7], s34 offen offset:0 lds
  v_mfma_f32_16x16x32_bf16 v[136:139], a[132:135], v[228:231], v[136:139]
  v_exp_f32 v112, v112
  v_mfma_f32_16x16x32_bf16 v[136:139], a[136:139], v[232:235], v[136:139]
  v_add_f32 v34, v34, v98
  v_add_f32 v34, v34, v99
  v_mfma_f32_16x16x32_bf16 v[136:139], a[140:143], v[236:239], v[136:139]
  v_exp_f32 v113, v113
  v_mfma_f32_16x16x32_bf16 v[140:143], a[140:143], v[252:255], v[52:55]
  v_cvt_pk_bf16_f32 v97, v98, v99
  v_add_f32 v34, v34, v112
  v_mfma_f32_16x16x32_bf16 v[140:143], a[136:139], v[248:251], v[140:143]
  v_exp_f32 v114, v114
  v_mfma_f32_16x16x32_bf16 v[140:143], a[132:135], v[244:247], v[140:143]
  v_add_f32 v34, v34, v113
  v_cvt_pk_bf16_f32 v98, v112, v113
  v_mfma_f32_16x16x32_bf16 v[140:143], a[128:131], v[240:243], v[140:143]
  s_waitcnt lgkmcnt(0)
  v_exp_f32 v115, v115
  v_mfma_f32_16x16x32_bf16 v[144:147], a[144:147], v[192:195], v[40:43]
  v_add_f32 v34, v34, v114
  v_add_f32 v34, v34, v115
  v_mfma_f32_16x16x32_bf16 v[144:147], a[148:151], v[196:199], v[144:147]
  v_exp_f32 v100, v100
  v_mfma_f32_16x16x32_bf16 v[144:147], a[152:155], v[200:203], v[144:147]
  v_cvt_pk_bf16_f32 v99, v114, v115
  v_add_f32 v35, v35, v100
  v_mfma_f32_16x16x32_bf16 v[144:147], a[156:159], v[204:207], v[144:147]
  v_exp_f32 v101, v101
  v_mfma_f32_16x16x32_bf16 v[148:151], a[156:159], v[220:223], v[44:47]
  buffer_load_dwordx4 v23, s[4:7], s34 offen offset:1024 lds
  v_mfma_f32_16x16x32_bf16 v[148:151], a[152:155], v[216:219], v[148:151]
  s_add_u32 s34, s34, 8192
  v_exp_f32 v102, v102
  v_mfma_f32_16x16x32_bf16 v[148:151], a[148:151], v[212:215], v[148:151]
  s_and_b32 s34, s34, 0x7ffff
  ds_read_b128 a[128:131], v10 offset:16384
  v_add_f32 v35, v35, v101
  v_mfma_f32_16x16x32_bf16 v[148:151], a[144:147], v[208:211], v[148:151]
  v_exp_f32 v103, v103
  v_mfma_f32_16x16x32_bf16 v[152:155], a[144:147], v[224:227], v[48:51]
  ds_read_b128 a[132:135], v11 offset:16384
  v_cvt_pk_bf16_f32 v100, v100, v101
  v_mfma_f32_16x16x32_bf16 v[152:155], a[148:151], v[228:231], v[152:155]
  v_exp_f32 v116, v116
  v_mfma_f32_16x16x32_bf16 v[152:155], a[152:155], v[232:235], v[152:155]
  ds_read_b128 a[136:139], v12 offset:16384
  v_add_f32 v35, v35, v102
  v_mfma_f32_16x16x32_bf16 v[152:155], a[156:159], v[236:239], v[152:155]
  v_exp_f32 v117, v117
  v_mfma_f32_16x16x32_bf16 v[156:159], a[156:159], v[252:255], v[52:55]
  ds_read_b128 a[140:143], v13 offset:16384
  v_add_f32 v35, v35, v103
  v_mfma_f32_16x16x32_bf16 v[156:159], a[152:155], v[248:251], v[156:159]
  v_exp_f32 v118, v118
  v_mfma_f32_16x16x32_bf16 v[156:159], a[148:151], v[244:247], v[156:159]
  v_cvt_pk_bf16_f32 v101, v102, v103
  v_add_f32 v35, v35, v116
  v_mfma_f32_16x16x32_bf16 v[156:159], a[144:147], v[240:243], v[156:159]
  s_add_u32 m0, s32, 57344
  v_exp_f32 v119, v119
  s_nop 0
  buffer_load_dwordx4 v22, s[4:7], s34 offen offset:0 lds
  s_nop 0
  v_exp_f32 v104, v104
  s_nop 0
  v_add_f32 v35, v35, v117
  v_cvt_pk_bf16_f32 v102, v116, v117
  s_nop 0
  v_exp_f32 v105, v105
  s_nop 0
  v_add_f32 v35, v35, v118
  v_add_f32 v35, v35, v119
  s_nop 0
  v_exp_f32 v106, v106
  s_nop 0
  ds_read_b128 a[144:147], v10 offset:20480
  v_cvt_pk_bf16_f32 v103, v118, v119
  s_nop 0
  v_exp_f32 v107, v107
  s_nop 0
  ds_read_b128 a[148:151], v11 offset:20480
  v_cvt_pk_bf16_f32 v104, v104, v105
  s_nop 0
  v_exp_f32 v120, v120
  s_nop 0
  ds_read_b128 a[152:155], v12 offset:20480
  v_cvt_pk_bf16_f32 v105, v106, v107
  s_waitcnt lgkmcnt(3)
  v_exp_f32 v121, v121
  v_mfma_f32_16x16x32_bf16 v[160:163], a[128:131], v[192:195], v[40:43]
  buffer_load_dwordx4 v23, s[4:7], s34 offen offset:1024 lds
  v_mfma_f32_16x16x32_bf16 v[160:163], a[132:135], v[196:199], v[160:163]
  s_add_u32 s34, s34, 8192
  v_exp_f32 v122, v122
  v_mfma_f32_16x16x32_bf16 v[160:163], a[136:139], v[200:203], v[160:163]
  s_and_b32 s34, s34, 0x7ffff
  ds_read_b128 a[156:159], v13 offset:20480
  v_cvt_pk_bf16_f32 v106, v120, v121
  v_mfma_f32_16x16x32_bf16 v[160:163], a[140:143], v[204:207], v[160:163]
  v_exp_f32 v123, v123
  v_mfma_f32_16x16x32_bf16 v[164:167], a[140:143], v[220:223], v[44:47]
  v_cvt_pk_bf16_f32 v107, v122, v123
  v_mfma_f32_16x16x32_bf16 v[164:167], a[136:139], v[216:219], v[164:167]
  v_exp_f32 v108, v108
  v_mfma_f32_16x16x32_bf16 v[164:167], a[132:135], v[212:215], v[164:167]
  v_mfma_f32_16x16x32_bf16 v[164:167], a[128:131], v[208:211], v[164:167]
  v_exp_f32 v109, v109
  v_mfma_f32_16x16x32_bf16 v[168:171], a[128:131], v[224:227], v[48:51]
  v_cvt_pk_bf16_f32 v108, v108, v109
  v_mfma_f32_16x16x32_bf16 v[168:171], a[132:135], v[228:231], v[168:171]
  v_exp_f32 v110, v110
  v_mfma_f32_16x16x32_bf16 v[168:171], a[136:139], v[232:235], v[168:171]
  v_mfma_f32_16x16x32_bf16 v[168:171], a[140:143], v[236:239], v[168:171]
  s_add_u32 m0, s33, 24576
  v_exp_f32 v111, v111
  v_mfma_f32_16x16x32_bf16 v[172:175], a[140:143], v[252:255], v[52:55]
  buffer_load_dwordx4 v24, s[8:11], s35 offen offset:0 lds
  v_mfma_f32_16x16x32_bf16 v[172:175], a[136:139], v[248:251], v[172:175]
  v_exp_f32 v124, v124
  v_mfma_f32_16x16x32_bf16 v[172:175], a[132:135], v[244:247], v[172:175]
  v_cvt_pk_bf16_f32 v109, v110, v111
  v_mfma_f32_16x16x32_bf16 v[172:175], a[128:131], v[240:243], v[172:175]
  s_waitcnt lgkmcnt(0)
  v_exp_f32 v125, v125
  v_mfma_f32_16x16x32_bf16 v[112:115], a[144:147], v[192:195], v[40:43]
  s_waitcnt vmcnt(10)
  ds_read_b64_tr_b16 a[128:129], v28 offset:0
  v_cvt_pk_bf16_f32 v110, v124, v125
  v_mfma_f32_16x16x32_bf16 v[112:115], a[148:151], v[196:199], v[112:115]
  v_exp_f32 v126, v126
  v_mfma_f32_16x16x32_bf16 v[112:115], a[152:155], v[200:203], v[112:115]
  ds_read_b64_tr_b16 a[130:131], v28 offset:2048
  v_mfma_f32_16x16x32_bf16 v[112:115], a[156:159], v[204:207], v[112:115]
  v_exp_f32 v127, v127
  v_mfma_f32_16x16x32_bf16 v[116:119], a[156:159], v[220:223], v[44:47]
  ds_read_b64_tr_b16 a[132:133], v29 offset:0
  v_cvt_pk_bf16_f32 v111, v126, v127
  v_mfma_f32_16x16x32_bf16 v[116:119], a[152:155], v[216:219], v[116:119]
  v_exp_f32 v128, v128
  v_mfma_f32_16x16x32_bf16 v[116:119], a[148:151], v[212:215], v[116:119]
  ds_read_b64_tr_b16 a[134:135], v29 offset:2048
  v_add_f32 v34, v34, v128
  v_mfma_f32_16x16x32_bf16 v[116:119], a[144:147], v[208:211], v[116:119]
  v_exp_f32 v129, v129
  v_mfma_f32_16x16x32_bf16 v[120:123], a[144:147], v[224:227], v[48:51]
  buffer_load_dwordx4 v25, s[8:11], s35 offen offset:1024 lds
  v_mfma_f32_16x16x32_bf16 v[120:123], a[148:151], v[228:231], v[120:123]
  s_add_u32 s35, s35, 8192
  v_exp_f32 v130, v130
  v_mfma_f32_16x16x32_bf16 v[120:123], a[152:155], v[232:235], v[120:123]
  s_and_b32 s35, s35, 0x7ffff
  ds_read_b64_tr_b16 a[136:137], v30 offset:0
  v_add_f32 v34, v34, v129
  v_mfma_f32_16x16x32_bf16 v[120:123], a[156:159], v[236:239], v[120:123]
  v_exp_f32 v131, v131
  v_mfma_f32_16x16x32_bf16 v[124:127], a[156:159], v[252:255], v[52:55]
  ds_read_b64_tr_b16 a[138:139], v30 offset:2048
  v_cvt_pk_bf16_f32 v128, v128, v129
  v_mfma_f32_16x16x32_bf16 v[124:127], a[152:155], v[248:251], v[124:127]
  v_exp_f32 v144, v144
  v_mfma_f32_16x16x32_bf16 v[124:127], a[148:151], v[244:247], v[124:127]
  ds_read_b64_tr_b16 a[140:141], v31 offset:0
  v_add_f32 v34, v34, v130
  v_mfma_f32_16x16x32_bf16 v[124:127], a[144:147], v[240:243], v[124:127]
  s_waitcnt lgkmcnt(5)
  v_exp_f32 v145, v145
  v_mfma_f32_16x16x32_bf16 a[160:163], a[128:131], v[56:59], 0
  ds_read_b64_tr_b16 a[142:143], v31 offset:2048
  v_add_f32 v34, v34, v131
  v_mfma_f32_16x16x32_bf16 a[164:167], a[128:131], v[60:63], 0
  ds_read_b64_tr_b16 a[144:145], v14 offset:0
  v_cvt_pk_bf16_f32 v129, v130, v131
  v_mfma_f32_16x16x32_bf16 a[168:171], a[128:131], v[64:67], 0
  s_add_u32 m0, s33, 32768
  v_exp_f32 v146, v146
  v_mfma_f32_16x16x32_bf16 a[172:175], a[128:131], v[68:71], 0
  buffer_load_dwordx4 v24, s[8:11], s35 offen offset:0 lds
  v_mfma_f32_16x16x32_bf16 a[176:179], a[128:131], v[72:75], 0
  s_waitcnt lgkmcnt(5)
  v_exp_f32 v147, v147
  v_mfma_f32_16x16x32_bf16 a[180:183], a[132:135], v[56:59], 0
  ds_read_b64_tr_b16 a[146:147], v14 offset:4096
  v_add_f32 v34, v34, v144
  v_mfma_f32_16x16x32_bf16 a[184:187], a[132:135], v[60:63], 0
  v_exp_f32 v132, v132
  v_mfma_f32_16x16x32_bf16 a[188:191], a[132:135], v[64:67], 0
  ds_read_b64_tr_b16 a[148:149], v15 offset:0
  v_add_f32 v34, v34, v145
  v_mfma_f32_16x16x32_bf16 a[192:195], a[132:135], v[68:71], 0
  v_exp_f32 v133, v133
  v_mfma_f32_16x16x32_bf16 a[196:199], a[132:135], v[72:75], 0
  s_waitcnt lgkmcnt(5)
  ds_read_b64_tr_b16 a[150:151], v15 offset:4096
  v_cvt_pk_bf16_f32 v130, v144, v145
  v_mfma_f32_16x16x32_bf16 a[200:203], a[136:139], v[56:59], 0
  v_exp_f32 v134, v134
  v_mfma_f32_16x16x32_bf16 a[204:207], a[136:139], v[60:63], 0
  ds_read_b64_tr_b16 a[152:153], v16 offset:0
  v_add_f32 v34, v34, v146
  v_mfma_f32_16x16x32_bf16 a[208:211], a[136:139], v[64:67], 0
  v_exp_f32 v135, v135
  v_mfma_f32_16x16x32_bf16 a[212:215], a[136:139], v[68:71], 0
  ds_read_b64_tr_b16 a[154:155], v16 offset:4096
  v_add_f32 v34, v34, v147
  v_mfma_f32_16x16x32_bf16 a[216:219], a[136:139], v[72:75], 0
  s_waitcnt lgkmcnt(6)
  v_exp_f32 v148, v148
  v_mfma_f32_16x16x32_bf16 a[220:223], a[140:143], v[56:59], 0
  buffer_load_dwordx4 v25, s[8:11], s35 offen offset:1024 lds
  v_mfma_f32_16x16x32_bf16 a[224:227], a[140:143], v[60:63], 0
  s_add_u32 s35, s35, 8192
  ds_read_b64_tr_b16 a[156:157], v17 offset:0
  ds_read_b64_tr_b16 a[138:139], v20 offset:4096
  v_mfma_f32_16x16x32_bf16 a[228:231], a[140:143], v[64:67], 0
  s_and_b32 s35, s35, 0x7ffff
  v_exp_f32 v149, v149
  v_mfma_f32_16x16x32_bf16 a[232:235], a[140:143], v[68:71], 0
  ds_read_b64_tr_b16 a[158:159], v17 offset:4096
  v_cvt_pk_bf16_f32 v131, v146, v147
  v_mfma_f32_16x16x32_bf16 a[236:239], a[140:143], v[72:75], 0
  s_waitcnt lgkmcnt(7)
  v_exp_f32 v150, v150
  v_mfma_f32_16x16x32_bf16 a[0:3], a[144:147], v[96:99], 0
  ds_read_b64_tr_b16 a[128:129], v18 offset:0
  ds_read_b64_tr_b16 a[142:143], v21 offset:4096
  v_mfma_f32_16x16x32_bf16 a[4:7], a[144:147], v[100:103], 0
  s_add_u32 m0, s69, 0
  v_exp_f32 v151, v151
  v_mfma_f32_16x16x32_bf16 a[8:11], a[144:147], v[104:107], 0
  s_waitcnt lgkmcnt(7)
  buffer_load_dwordx4 v32, s[12:15], s66 offen lds
  v_mfma_f32_16x16x32_bf16 a[12:15], a[144:147], v[108:111], 0
  s_add_u32 s66, s66, s68
  v_exp_f32 v136, v136
  v_mfma_f32_16x16x32_bf16 a[16:19], a[148:151], v[96:99], 0
  ds_read_b64_tr_b16 a[130:131], v18 offset:4096
  v_add_f32 v35, v35, v132
  v_mfma_f32_16x16x32_bf16 a[20:23], a[148:151], v[100:103], 0
  s_add_u32 m0, s69, 1024
  v_exp_f32 v137, v137
  v_mfma_f32_16x16x32_bf16 a[24:27], a[148:151], v[104:107], 0
  s_waitcnt lgkmcnt(6)
  buffer_load_dwordx4 v32, s[12:15], s66 offen lds
  v_mfma_f32_16x16x32_bf16 a[28:31], a[148:151], v[108:111], 0
  s_add_u32 s66, s66, s68
  v_exp_f32 v138, v138
  v_mfma_f32_16x16x32_bf16 a[32:35], a[152:155], v[96:99], 0
  s_add_u32 m0, s69, 2048
  ds_read_b64_tr_b16 a[132:133], v19 offset:0
  v_add_f32 v35, v35, v133
  v_mfma_f32_16x16x32_bf16 a[36:39], a[152:155], v[100:103], 0
  buffer_load_dwordx4 v32, s[12:15], s66 offen lds
  v_mfma_f32_16x16x32_bf16 a[40:43], a[152:155], v[104:107], 0
  s_add_u32 s66, s66, s68
  v_exp_f32 v139, v139
  v_mfma_f32_16x16x32_bf16 a[44:47], a[152:155], v[108:111], 0
  s_waitcnt lgkmcnt(4)
  ds_read_b64_tr_b16 a[134:135], v19 offset:4096
  v_cvt_pk_bf16_f32 v132, v132, v133
  v_mfma_f32_16x16x32_bf16 a[48:51], a[156:159], v[96:99], 0
  v_exp_f32 v152, v152
  v_mfma_f32_16x16x32_bf16 a[52:55], a[156:159], v[100:103], 0
  ds_read_b64_tr_b16 a[136:137], v20 offset:0
  v_add_f32 v35, v35, v134
  v_mfma_f32_16x16x32_bf16 a[56:59], a[156:159], v[104:107], 0
  s_add_u32 m0, s69, 3072
  v_exp_f32 v153, v153
  v_mfma_f32_16x16x32_bf16 a[60:63], a[156:159], v[108:111], 0
  s_waitcnt lgkmcnt(3)
  buffer_load_dwordx4 v32, s[12:15], s66 offen lds
  v_mfma_f32_16x16x32_bf16 a[64:67], a[128:131], v[96:99], 0
  s_add_u32 s66, s66, s70
  v_exp_f32 v154, v154
  v_mfma_f32_16x16x32_bf16 a[68:71], a[128:131], v[100:103], 0
  ds_read_b64_tr_b16 a[140:141], v21 offset:0
  v_add_f32 v35, v35, v135
  v_mfma_f32_16x16x32_bf16 a[72:75], a[128:131], v[104:107], 0
  v_exp_f32 v155, v155
  v_mfma_f32_16x16x32_bf16 a[76:79], a[128:131], v[108:111], 0
  s_waitcnt lgkmcnt(2)
  buffer_load_dwordx4 v[56:59], v26, s[16:19], s67 offen offset:0 sc1
  v_mfma_f32_16x16x32_bf16 a[80:83], a[132:135], v[96:99], 0
  v_exp_f32 v140, v140
  v_mfma_f32_16x16x32_bf16 a[84:87], a[132:135], v[100:103], 0
  ds_read_b128 a[144:147], v10 offset:24576
  v_cvt_pk_bf16_f32 v133, v134, v135
  v_mfma_f32_16x16x32_bf16 a[88:91], a[132:135], v[104:107], 0
  v_exp_f32 v141, v141
  v_mfma_f32_16x16x32_bf16 a[92:95], a[132:135], v[108:111], 0
  s_waitcnt lgkmcnt(2)
  buffer_load_dwordx4 v[60:63], v26, s[16:19], s67 offen offset:1024 sc1
  v_mfma_f32_16x16x32_bf16 a[96:99], a[136:139], v[96:99], 0
  ds_read_b128 a[148:151], v11 offset:24576
  v_add_f32 v35, v35, v148
  v_mfma_f32_16x16x32_bf16 a[100:103], a[136:139], v[100:103], 0
  v_exp_f32 v142, v142
  v_mfma_f32_16x16x32_bf16 a[104:107], a[136:139], v[104:107], 0
  ds_read_b128 a[152:155], v12 offset:24576
  v_add_f32 v35, v35, v149
  v_mfma_f32_16x16x32_bf16 a[108:111], a[136:139], v[108:111], 0
  s_waitcnt lgkmcnt(3)
  v_exp_f32 v143, v143
  v_mfma_f32_16x16x32_bf16 a[112:115], a[140:143], v[96:99], 0
  buffer_load_dwordx4 v[64:67], v26, s[16:19], s67 offen offset:2048 sc1
  v_mfma_f32_16x16x32_bf16 a[116:119], a[140:143], v[100:103], 0
  v_exp_f32 v156, v156
  v_mfma_f32_16x16x32_bf16 a[120:123], a[140:143], v[104:107], 0
  ds_read_b128 a[156:159], v13 offset:24576
  v_cvt_pk_bf16_f32 v134, v148, v149
  v_mfma_f32_16x16x32_bf16 a[124:127], a[140:143], v[108:111], 0
  v_exp_f32 v157, v157
  v_mfma_f32_16x16x32_bf16 a[240:243], a[248:251], v[104:107], 0
  buffer_load_dwordx4 v[68:71], v26, s[16:19], s67 offen offset:3072 sc1
  v_mfma_f32_16x16x32_bf16 a[244:247], a[248:251], v[108:111], 0
  v_exp_f32 v158, v158
  s_nop 0
  ds_read_b128 a[128:131], v10 offset:28672
  v_add_f32 v35, v35, v150
  s_nop 0
  v_exp_f32 v159, v159
  s_nop 0
  buffer_load_dwordx4 v[72:75], v27, s[16:19], s67 offen sc1
  s_add_u32 s67, s67, 20480
  v_add_f32 v35, v35, v151
  v_cvt_pk_bf16_f32 v135, v150, v151
  s_nop 0
  v_add_f32 v36, v36, v136
  v_add_f32 v36, v36, v137
  s_waitcnt lgkmcnt(1)
  v_cvt_pk_bf16_f32 v136, v136, v137
  v_add_f32 v36, v36, v138
  v_add_f32 v36, v36, v139
  v_cvt_pk_bf16_f32 v137, v138, v139
  v_add_f32 v36, v36, v152
  v_add_f32 v36, v36, v153
  v_cvt_pk_bf16_f32 v138, v152, v153
  v_add_f32 v36, v36, v154
  v_add_f32 v36, v36, v155
  v_cvt_pk_bf16_f32 v139, v154, v155
  v_cvt_pk_bf16_f32 v140, v140, v141
  v_cvt_pk_bf16_f32 v141, v142, v143
  v_cvt_pk_bf16_f32 v142, v156, v157
  v_cvt_pk_bf16_f32 v143, v158, v159
  s_branch LOOP_A1
.p2align 6
LOOP_A:
  v_mfma_f32_16x16x32_bf16 v[128:131], a[128:131], v[192:195], v[40:43]
  s_waitcnt vmcnt(28)
  v_exp_f32 v96, v96
  v_mfma_f32_16x16x32_bf16 v[128:131], a[132:135], v[196:199], v[128:131]
  s_barrier
  v_mfma_f32_16x16x32_bf16 v[128:131], a[136:139], v[200:203], v[128:131]
  ds_read_b128 a[148:151], v11 offset:12288
  ds_read_b128 a[156:159], v13 offset:12288
  v_mfma_f32_16x16x32_bf16 v[128:131], a[140:143], v[204:207], v[128:131]
  v_exp_f32 v97, v97
  v_mfma_f32_16x16x32_bf16 v[132:135], a[140:143], v[220:223], v[44:47]
  ds_read_b128 a[152:155], v12 offset:12288
  v_add_f32 v34, v34, v96
  v_mfma_f32_16x16x32_bf16 v[132:135], a[136:139], v[216:219], v[132:135]
  s_add_u32 m0, s32, 49152
  v_exp_f32 v98, v98
  v_mfma_f32_16x16x32_bf16 v[132:135], a[132:135], v[212:215], v[132:135]
  buffer_load_dwordx4 v22, s[4:7], s34 offen offset:0 lds
  v_mfma_f32_16x16x32_bf16 v[132:135], a[128:131], v[208:211], v[132:135]
  v_exp_f32 v99, v99
  v_mfma_f32_16x16x32_bf16 v[136:139], a[128:131], v[224:227], v[48:51]
  v_add_f32 v34, v34, v97
  v_cvt_pk_bf16_f32 v96, v96, v97
  v_mfma_f32_16x16x32_bf16 v[136:139], a[132:135], v[228:231], v[136:139]
  v_exp_f32 v112, v112
  v_mfma_f32_16x16x32_bf16 v[136:139], a[136:139], v[232:235], v[136:139]
  v_add_f32 v34, v34, v98
  v_add_f32 v34, v34, v99
  v_mfma_f32_16x16x32_bf16 v[136:139], a[140:143], v[236:239], v[136:139]
  v_cvt_pk_bf16_f32 v97, v98, v99
  v_add_f32 v34, v34, v112
  v_mfma_f32_16x16x32_bf16 v[140:143], a[140:143], v[252:255], v[52:55]
  s_waitcnt lgkmcnt(0)
  v_exp_f32 v113, v113
  v_mfma_f32_16x16x32_bf16 v[140:143], a[136:139], v[248:251], v[140:143]
  s_waitcnt vmcnt(18)
  buffer_load_dwordx4 v23, s[4:7], s34 offen offset:1024 lds
  v_mfma_f32_16x16x32_bf16 v[140:143], a[132:135], v[244:247], v[140:143]
  s_add_u32 s34, s34, 8192
  v_exp_f32 v114, v114
  v_mfma_f32_16x16x32_bf16 v[140:143], a[128:131], v[240:243], v[140:143]
  s_and_b32 s34, s34, 0x7ffff
  ds_read_b64_tr_b16 a[128:129], v28 offset:0
  v_add_f32 v34, v34, v113
  v_mfma_f32_16x16x32_bf16 v[144:147], a[144:147], v[192:195], v[40:43]
  v_exp_f32 v115, v115
  v_mfma_f32_16x16x32_bf16 v[144:147], a[148:151], v[196:199], v[144:147]
  ds_read_b64_tr_b16 a[130:131], v28 offset:2048
  v_cvt_pk_bf16_f32 v98, v112, v113
  v_mfma_f32_16x16x32_bf16 v[144:147], a[152:155], v[200:203], v[144:147]
  v_exp_f32 v100, v100
  v_mfma_f32_16x16x32_bf16 v[144:147], a[156:159], v[204:207], v[144:147]
  s_add_u32 m0, s32, 57344
  ds_read_b64_tr_b16 a[132:133], v29 offset:0
  v_add_f32 v34, v34, v114
  v_mfma_f32_16x16x32_bf16 v[148:151], a[156:159], v[220:223], v[44:47]
  buffer_load_dwordx4 v22, s[4:7], s34 offen offset:0 lds
  v_mfma_f32_16x16x32_bf16 v[148:151], a[152:155], v[216:219], v[148:151]
  v_exp_f32 v101, v101
  v_mfma_f32_16x16x32_bf16 v[148:151], a[148:151], v[212:215], v[148:151]
  ds_read_b64_tr_b16 a[134:135], v29 offset:2048
  v_add_f32 v34, v34, v115
  v_mfma_f32_16x16x32_bf16 v[148:151], a[144:147], v[208:211], v[148:151]
  v_exp_f32 v102, v102
  v_mfma_f32_16x16x32_bf16 v[152:155], a[144:147], v[224:227], v[48:51]
  ds_read_b64_tr_b16 a[136:137], v30 offset:0
  v_cvt_pk_bf16_f32 v99, v114, v115
  v_mfma_f32_16x16x32_bf16 v[152:155], a[148:151], v[228:231], v[152:155]
  v_exp_f32 v103, v103
  v_mfma_f32_16x16x32_bf16 v[152:155], a[152:155], v[232:235], v[152:155]
  ds_read_b64_tr_b16 a[138:139], v30 offset:2048
  v_add_f32 v35, v35, v100
  v_mfma_f32_16x16x32_bf16 v[152:155], a[156:159], v[236:239], v[152:155]
  v_exp_f32 v116, v116
  v_mfma_f32_16x16x32_bf16 v[156:159], a[156:159], v[252:255], v[52:55]
  buffer_load_dwordx4 v23, s[4:7], s34 offen offset:1024 lds
  v_mfma_f32_16x16x32_bf16 v[156:159], a[152:155], v[248:251], v[156:159]
  s_add_u32 s34, s34, 8192
  v_exp_f32 v117, v117
  v_mfma_f32_16x16x32_bf16 v[156:159], a[148:151], v[244:247], v[156:159]
  s_and_b32 s34, s34, 0x7ffff
  ds_read_b64_tr_b16 a[140:141], v31 offset:0
  v_add_f32 v35, v35, v101
  v_mfma_f32_16x16x32_bf16 v[156:159], a[144:147], v[240:243], v[156:159]
  s_waitcnt lgkmcnt(5)
  ds_read_b64_tr_b16 a[142:143], v31 offset:2048
  v_cvt_pk_bf16_f32 v100, v100, v101
  v_mfma_f32_16x16x32_bf16 a[160:163], a[128:131], v[56:59], a[160:163]
  v_exp_f32 v118, v118
  v_mfma_f32_16x16x32_bf16 a[164:167], a[128:131], v[60:63], a[164:167]
  ds_read_b128 a[144:147], v10 offset:16384
  v_add_f32 v35, v35, v102
  v_mfma_f32_16x16x32_bf16 a[168:171], a[128:131], v[64:67], a[168:171]
  s_add_u32 m0, s33, 24576
  v_exp_f32 v119, v119
  v_mfma_f32_16x16x32_bf16 a[172:175], a[128:131], v[68:71], a[172:175]
  buffer_load_dwordx4 v24, s[8:11], s35 offen offset:0 lds
  v_mfma_f32_16x16x32_bf16 a[176:179], a[128:131], v[72:75], a[176:179]
  s_waitcnt lgkmcnt(5)
  v_exp_f32 v104, v104
  v_mfma_f32_16x16x32_bf16 a[180:183], a[132:135], v[56:59], a[180:183]
  ds_read_b128 a[148:151], v11 offset:16384
  v_add_f32 v35, v35, v103
  v_mfma_f32_16x16x32_bf16 a[184:187], a[132:135], v[60:63], a[184:187]
  v_exp_f32 v105, v105
  v_mfma_f32_16x16x32_bf16 a[188:191], a[132:135], v[64:67], a[188:191]
  ds_read_b128 a[152:155], v12 offset:16384
  v_cvt_pk_bf16_f32 v101, v102, v103
  v_mfma_f32_16x16x32_bf16 a[192:195], a[132:135], v[68:71], a[192:195]
  ds_read_b128 a[156:159], v13 offset:16384
  v_add_f32 v35, v35, v116
  v_mfma_f32_16x16x32_bf16 a[196:199], a[132:135], v[72:75], a[196:199]
  s_waitcnt lgkmcnt(6)
  v_exp_f32 v106, v106
  v_mfma_f32_16x16x32_bf16 a[200:203], a[136:139], v[56:59], a[200:203]
  buffer_load_dwordx4 v25, s[8:11], s35 offen offset:1024 lds
  v_mfma_f32_16x16x32_bf16 a[204:207], a[136:139], v[60:63], a[204:207]
  s_add_u32 s35, s35, 8192
  v_exp_f32 v107, v107
  v_mfma_f32_16x16x32_bf16 a[208:211], a[136:139], v[64:67], a[208:211]
  s_and_b32 s35, s35, 0x7ffff
  v_add_f32 v35, v35, v117
  v_cvt_pk_bf16_f32 v102, v116, v117
  v_mfma_f32_16x16x32_bf16 a[212:215], a[136:139], v[68:71], a[212:215]
  v_exp_f32 v120, v120
  v_mfma_f32_16x16x32_bf16 a[216:219], a[136:139], v[72:75], a[216:219]
  s_waitcnt lgkmcnt(4)
  ds_read_b128 a[128:131], v10 offset:20480
  v_add_f32 v35, v35, v118
  v_mfma_f32_16x16x32_bf16 a[220:223], a[140:143], v[56:59], a[220:223]
  v_exp_f32 v121, v121
  v_mfma_f32_16x16x32_bf16 a[224:227], a[140:143], v[60:63], a[224:227]
  ds_read_b128 a[132:135], v11 offset:20480
  v_add_f32 v35, v35, v119
  v_mfma_f32_16x16x32_bf16 a[228:231], a[140:143], v[64:67], a[228:231]
  s_add_u32 m0, s33, 32768
  v_exp_f32 v122, v122
  v_mfma_f32_16x16x32_bf16 a[232:235], a[140:143], v[68:71], a[232:235]
  buffer_load_dwordx4 v24, s[8:11], s35 offen offset:0 lds
  v_mfma_f32_16x16x32_bf16 a[236:239], a[140:143], v[72:75], a[236:239]
  s_waitcnt lgkmcnt(2)
  ds_read_b128 a[136:139], v12 offset:20480
  v_cvt_pk_bf16_f32 v103, v118, v119
  v_mfma_f32_16x16x32_bf16 v[160:163], a[144:147], v[192:195], v[40:43]
  v_exp_f32 v123, v123
  v_mfma_f32_16x16x32_bf16 v[160:163], a[148:151], v[196:199], v[160:163]
  ds_read_b128 a[140:143], v13 offset:20480
  v_add_f32 v36, v36, v104
  v_mfma_f32_16x16x32_bf16 v[160:163], a[152:155], v[200:203], v[160:163]
  v_exp_f32 v108, v108
  v_mfma_f32_16x16x32_bf16 v[160:163], a[156:159], v[204:207], v[160:163]
  v_add_f32 v36, v36, v105
  v_cvt_pk_bf16_f32 v104, v104, v105
  v_mfma_f32_16x16x32_bf16 v[164:167], a[156:159], v[220:223], v[44:47]
  v_exp_f32 v109, v109
  v_mfma_f32_16x16x32_bf16 v[164:167], a[152:155], v[216:219], v[164:167]
  buffer_load_dwordx4 v25, s[8:11], s35 offen offset:1024 lds
  v_mfma_f32_16x16x32_bf16 v[164:167], a[148:151], v[212:215], v[164:167]
  s_add_u32 s35, s35, 8192
  v_exp_f32 v110, v110
  v_mfma_f32_16x16x32_bf16 v[164:167], a[144:147], v[208:211], v[164:167]
  s_and_b32 s35, s35, 0x7ffff
  v_add_f32 v36, v36, v106
  v_add_f32 v36, v36, v107
  v_mfma_f32_16x16x32_bf16 v[168:171], a[144:147], v[224:227], v[48:51]
  v_cvt_pk_bf16_f32 v105, v106, v107
  v_add_f32 v36, v36, v120
  v_mfma_f32_16x16x32_bf16 v[168:171], a[148:151], v[228:231], v[168:171]
  v_exp_f32 v111, v111
  v_mfma_f32_16x16x32_bf16 v[168:171], a[152:155], v[232:235], v[168:171]
  v_add_f32 v36, v36, v121
  v_cvt_pk_bf16_f32 v106, v120, v121
  v_mfma_f32_16x16x32_bf16 v[168:171], a[156:159], v[236:239], v[168:171]
  s_add_u32 m0, s69, 0
  v_exp_f32 v124, v124
  v_mfma_f32_16x16x32_bf16 v[172:175], a[156:159], v[252:255], v[52:55]
  buffer_load_dwordx4 v32, s[12:15], s66 offen lds
  v_mfma_f32_16x16x32_bf16 v[172:175], a[152:155], v[248:251], v[172:175]
  s_add_u32 s66, s66, s68
  v_exp_f32 v125, v125
  v_mfma_f32_16x16x32_bf16 v[172:175], a[148:151], v[244:247], v[172:175]
  ds_read_b64_tr_b16 a[148:149], v14 offset:0
  v_add_f32 v36, v36, v122
  v_mfma_f32_16x16x32_bf16 v[172:175], a[144:147], v[240:243], v[172:175]
  s_waitcnt lgkmcnt(1)
  v_exp_f32 v126, v126
  v_mfma_f32_16x16x32_bf16 v[112:115], a[128:131], v[192:195], v[40:43]
  ds_read_b64_tr_b16 a[144:145], v14 offset:57344
  v_add_f32 v36, v36, v123
  v_mfma_f32_16x16x32_bf16 v[112:115], a[132:135], v[196:199], v[112:115]
  v_exp_f32 v127, v127
  v_mfma_f32_16x16x32_bf16 v[112:115], a[136:139], v[200:203], v[112:115]
  ds_read_b64_tr_b16 a[146:147], v14 offset:61440
  v_cvt_pk_bf16_f32 v107, v122, v123
  v_mfma_f32_16x16x32_bf16 v[112:115], a[140:143], v[204:207], v[112:115]
  ds_read_b64_tr_b16 a[150:151], v14 offset:4096
  v_cvt_pk_bf16_f32 v108, v108, v109
  v_mfma_f32_16x16x32_bf16 v[116:119], a[140:143], v[220:223], v[44:47]
  v_exp_f32 v128, v128
  v_mfma_f32_16x16x32_bf16 v[116:119], a[136:139], v[216:219], v[116:119]
  ds_read_b64_tr_b16 a[152:153], v15 offset:57344
  v_cvt_pk_bf16_f32 v109, v110, v111
  v_mfma_f32_16x16x32_bf16 v[116:119], a[132:135], v[212:215], v[116:119]
  s_add_u32 m0, s69, 1024
  v_exp_f32 v129, v129
  v_mfma_f32_16x16x32_bf16 v[116:119], a[128:131], v[208:211], v[116:119]
  buffer_load_dwordx4 v32, s[12:15], s66 offen lds
  v_mfma_f32_16x16x32_bf16 v[120:123], a[128:131], v[224:227], v[48:51]
  s_add_u32 s66, s66, s68
  v_exp_f32 v130, v130
  v_mfma_f32_16x16x32_bf16 v[120:123], a[132:135], v[228:231], v[120:123]
  ds_read_b64_tr_b16 a[154:155], v15 offset:61440
  v_cvt_pk_bf16_f32 v110, v124, v125
  v_mfma_f32_16x16x32_bf16 v[120:123], a[136:139], v[232:235], v[120:123]
  ds_read_b64_tr_b16 a[156:157], v15 offset:0
  v_cvt_pk_bf16_f32 v111, v126, v127
  v_mfma_f32_16x16x32_bf16 v[120:123], a[140:143], v[236:239], v[120:123]
  v_exp_f32 v131, v131
  v_mfma_f32_16x16x32_bf16 v[124:127], a[140:143], v[252:255], v[52:55]
  ds_read_b64_tr_b16 a[158:159], v15 offset:4096
  v_add_f32 v34, v34, v128
  v_mfma_f32_16x16x32_bf16 v[124:127], a[136:139], v[248:251], v[124:127]
  v_exp_f32 v144, v144
  v_mfma_f32_16x16x32_bf16 v[124:127], a[132:135], v[244:247], v[124:127]
  ds_read_b64_tr_b16 a[132:133], v16 offset:0
  v_add_f32 v34, v34, v129
  v_mfma_f32_16x16x32_bf16 v[124:127], a[128:131], v[240:243], v[124:127]
  s_waitcnt lgkmcnt(5)
  ds_read_b64_tr_b16 a[128:129], v16 offset:57344
  v_cvt_pk_bf16_f32 v128, v128, v129
  v_mfma_f32_16x16x32_bf16 a[0:3], a[144:147], v[176:179], a[0:3]
  s_add_u32 m0, s69, 2048
  v_exp_f32 v145, v145
  v_mfma_f32_16x16x32_bf16 a[0:3], a[148:151], v[96:99], a[0:3]
  buffer_load_dwordx4 v32, s[12:15], s66 offen lds
  v_mfma_f32_16x16x32_bf16 a[4:7], a[148:151], v[100:103], a[4:7]
  s_add_u32 s66, s66, s68
  v_exp_f32 v146, v146
  v_mfma_f32_16x16x32_bf16 a[4:7], a[144:147], v[180:183], a[4:7]
  ds_read_b64_tr_b16 a[130:131], v16 offset:61440
  v_add_f32 v34, v34, v130
  v_mfma_f32_16x16x32_bf16 a[8:11], a[144:147], v[184:187], a[8:11]
  v_exp_f32 v147, v147
  v_mfma_f32_16x16x32_bf16 a[8:11], a[148:151], v[104:107], a[8:11]
  ds_read_b64_tr_b16 a[134:135], v16 offset:4096
  v_add_f32 v34, v34, v131
  v_mfma_f32_16x16x32_bf16 a[12:15], a[148:151], v[108:111], a[12:15]
  ds_read_b64_tr_b16 a[136:137], v17 offset:57344
  v_cvt_pk_bf16_f32 v129, v130, v131
  v_mfma_f32_16x16x32_bf16 a[12:15], a[144:147], v[188:191], a[12:15]
  s_waitcnt lgkmcnt(5)
  v_exp_f32 v132, v132
  v_mfma_f32_16x16x32_bf16 a[16:19], a[152:155], v[176:179], a[16:19]
  ds_read_b64_tr_b16 a[138:139], v17 offset:61440
  v_add_f32 v34, v34, v144
  v_mfma_f32_16x16x32_bf16 a[16:19], a[156:159], v[96:99], a[16:19]
  s_add_u32 m0, s69, 3072
  v_exp_f32 v133, v133
  v_mfma_f32_16x16x32_bf16 a[20:23], a[156:159], v[100:103], a[20:23]
  buffer_load_dwordx4 v32, s[12:15], s66 offen lds
  v_mfma_f32_16x16x32_bf16 a[20:23], a[152:155], v[180:183], a[20:23]
  s_add_u32 s66, s66, s70
  v_exp_f32 v134, v134
  v_mfma_f32_16x16x32_bf16 a[24:27], a[152:155], v[184:187], a[24:27]
  ds_read_b64_tr_b16 a[140:141], v17 offset:0
  v_add_f32 v34, v34, v145
  v_mfma_f32_16x16x32_bf16 a[24:27], a[156:159], v[104:107], a[24:27]
  ds_read_b64_tr_b16 a[142:143], v17 offset:4096
  v_cvt_pk_bf16_f32 v130, v144, v145
  v_mfma_f32_16x16x32_bf16 a[28:31], a[156:159], v[108:111], a[28:31]
  v_exp_f32 v135, v135
  v_mfma_f32_16x16x32_bf16 a[28:31], a[152:155], v[188:191], a[28:31]
  s_waitcnt lgkmcnt(4)
  ds_read_b64_tr_b16 a[144:145], v18 offset:57344
  v_add_f32 v34, v34, v146
  v_mfma_f32_16x16x32_bf16 a[32:35], a[128:131], v[176:179], a[32:35]
  v_exp_f32 v148, v148
  v_mfma_f32_16x16x32_bf16 a[32:35], a[132:135], v[96:99], a[32:35]
  ds_read_b64_tr_b16 a[146:147], v18 offset:61440
  v_add_f32 v34, v34, v147
  v_mfma_f32_16x16x32_bf16 a[36:39], a[132:135], v[100:103], a[36:39]
  ds_read_b64_tr_b16 a[148:149], v18 offset:0
  v_cvt_pk_bf16_f32 v131, v146, v147
  v_mfma_f32_16x16x32_bf16 a[36:39], a[128:131], v[180:183], a[36:39]
  v_exp_f32 v149, v149
  v_mfma_f32_16x16x32_bf16 a[40:43], a[128:131], v[184:187], a[40:43]
  buffer_load_dwordx4 v[56:59], v26, s[16:19], s67 offen offset:0 sc1
  v_mfma_f32_16x16x32_bf16 a[40:43], a[132:135], v[104:107], a[40:43]
  v_exp_f32 v150, v150
  v_mfma_f32_16x16x32_bf16 a[44:47], a[132:135], v[108:111], a[44:47]
  ds_read_b64_tr_b16 a[150:151], v18 offset:4096
  v_add_f32 v35, v35, v132
  v_mfma_f32_16x16x32_bf16 a[44:47], a[128:131], v[188:191], a[44:47]
  s_waitcnt lgkmcnt(4)
  v_exp_f32 v151, v151
  v_mfma_f32_16x16x32_bf16 a[48:51], a[136:139], v[176:179], a[48:51]
  ds_read_b64_tr_b16 a[152:153], v19 offset:57344
  v_add_f32 v35, v35, v133
  v_mfma_f32_16x16x32_bf16 a[48:51], a[140:143], v[96:99], a[48:51]
  ds_read_b64_tr_b16 a[154:155], v19 offset:61440
  v_cvt_pk_bf16_f32 v132, v132, v133
  v_mfma_f32_16x16x32_bf16 a[52:55], a[140:143], v[100:103], a[52:55]
  v_exp_f32 v136, v136
  v_mfma_f32_16x16x32_bf16 a[52:55], a[136:139], v[180:183], a[52:55]
  ds_read_b64_tr_b16 a[156:157], v19 offset:0
  v_add_f32 v35, v35, v134
  v_mfma_f32_16x16x32_bf16 a[56:59], a[136:139], v[184:187], a[56:59]
  v_exp_f32 v137, v137
  v_mfma_f32_16x16x32_bf16 a[56:59], a[140:143], v[104:107], a[56:59]
  ds_read_b64_tr_b16 a[158:159], v19 offset:4096
  v_add_f32 v35, v35, v135
  v_mfma_f32_16x16x32_bf16 a[60:63], a[140:143], v[108:111], a[60:63]
  v_exp_f32 v138, v138
  v_mfma_f32_16x16x32_bf16 a[60:63], a[136:139], v[188:191], a[60:63]
  s_waitcnt lgkmcnt(4)
  buffer_load_dwordx4 v[60:63], v26, s[16:19], s67 offen offset:1024 sc1
  v_mfma_f32_16x16x32_bf16 a[64:67], a[144:147], v[176:179], a[64:67]
  ds_read_b64_tr_b16 a[128:129], v20 offset:57344
  v_cvt_pk_bf16_f32 v133, v134, v135
  v_mfma_f32_16x16x32_bf16 a[64:67], a[148:151], v[96:99], a[64:67]
  v_exp_f32 v139, v139
  v_mfma_f32_16x16x32_bf16 a[68:71], a[148:151], v[100:103], a[68:71]
  ds_read_b64_tr_b16 a[130:131], v20 offset:61440
  v_add_f32 v35, v35, v148
  v_mfma_f32_16x16x32_bf16 a[68:71], a[144:147], v[180:183], a[68:71]
  v_exp_f32 v152, v152
  v_mfma_f32_16x16x32_bf16 a[72:75], a[144:147], v[184:187], a[72:75]
  ds_read_b64_tr_b16 a[132:133], v20 offset:0
  v_add_f32 v35, v35, v149
  v_mfma_f32_16x16x32_bf16 a[72:75], a[148:151], v[104:107], a[72:75]
  ds_read_b64_tr_b16 a[134:135], v20 offset:4096
  v_cvt_pk_bf16_f32 v134, v148, v149
  v_mfma_f32_16x16x32_bf16 a[76:79], a[148:151], v[108:111], a[76:79]
  v_exp_f32 v153, v153
  v_mfma_f32_16x16x32_bf16 a[76:79], a[144:147], v[188:191], a[76:79]
  s_waitcnt lgkmcnt(4)
  buffer_load_dwordx4 v[64:67], v26, s[16:19], s67 offen offset:2048 sc1
  v_mfma_f32_16x16x32_bf16 a[80:83], a[152:155], v[176:179], a[80:83]
  v_exp_f32 v154, v154
  v_mfma_f32_16x16x32_bf16 a[80:83], a[156:159], v[96:99], a[80:83]
  ds_read_b64_tr_b16 a[136:137], v21 offset:57344
  v_add_f32 v35, v35, v150
  v_mfma_f32_16x16x32_bf16 a[84:87], a[156:159], v[100:103], a[84:87]
  v_exp_f32 v155, v155
  v_mfma_f32_16x16x32_bf16 a[84:87], a[152:155], v[180:183], a[84:87]
  ds_read_b64_tr_b16 a[138:139], v21 offset:61440
  v_add_f32 v35, v35, v151
  v_mfma_f32_16x16x32_bf16 a[88:91], a[152:155], v[184:187], a[88:91]
  ds_read_b64_tr_b16 a[140:141], v21 offset:0
  v_cvt_pk_bf16_f32 v135, v150, v151
  v_mfma_f32_16x16x32_bf16 a[88:91], a[156:159], v[104:107], a[88:91]
  v_exp_f32 v140, v140
  v_mfma_f32_16x16x32_bf16 a[92:95], a[156:159], v[108:111], a[92:95]
  ds_read_b64_tr_b16 a[142:143], v21 offset:4096
  v_add_f32 v36, v36, v136
  v_mfma_f32_16x16x32_bf16 a[92:95], a[152:155], v[188:191], a[92:95]
  s_waitcnt lgkmcnt(4)
  v_exp_f32 v141, v141
  v_mfma_f32_16x16x32_bf16 a[96:99], a[128:131], v[176:179], a[96:99]
  ds_read_b128 a[144:147], v10 offset:24576
  v_add_f32 v36, v36, v137
  v_mfma_f32_16x16x32_bf16 a[96:99], a[132:135], v[96:99], a[96:99]
  v_exp_f32 v142, v142
  v_mfma_f32_16x16x32_bf16 a[100:103], a[132:135], v[100:103], a[100:103]
  buffer_load_dwordx4 v[68:71], v26, s[16:19], s67 offen offset:3072 sc1
  v_mfma_f32_16x16x32_bf16 a[100:103], a[128:131], v[180:183], a[100:103]
  ds_read_b128 a[148:151], v11 offset:24576
  v_cvt_pk_bf16_f32 v136, v136, v137
  v_mfma_f32_16x16x32_bf16 a[104:107], a[128:131], v[184:187], a[104:107]
  v_exp_f32 v143, v143
  v_mfma_f32_16x16x32_bf16 a[104:107], a[132:135], v[104:107], a[104:107]
  ds_read_b128 a[152:155], v12 offset:24576
  v_add_f32 v36, v36, v138
  v_mfma_f32_16x16x32_bf16 a[108:111], a[132:135], v[108:111], a[108:111]
  s_sub_u32 s36, s36, 1
  v_exp_f32 v156, v156
  v_mfma_f32_16x16x32_bf16 a[108:111], a[128:131], v[188:191], a[108:111]
  s_waitcnt lgkmcnt(3)
  ds_read_b128 a[156:159], v13 offset:24576
  v_add_f32 v36, v36, v139
  v_mfma_f32_16x16x32_bf16 a[112:115], a[136:139], v[176:179], a[112:115]
  v_cvt_pk_bf16_f32 v137, v138, v139
  v_add_f32 v36, v36, v152
  v_mfma_f32_16x16x32_bf16 a[112:115], a[140:143], v[96:99], a[112:115]
  v_exp_f32 v157, v157
  v_mfma_f32_16x16x32_bf16 a[116:119], a[140:143], v[100:103], a[116:119]
  v_add_f32 v36, v36, v153
  v_cvt_pk_bf16_f32 v138, v152, v153
  v_mfma_f32_16x16x32_bf16 a[116:119], a[136:139], v[180:183], a[116:119]
  v_exp_f32 v158, v158
  v_mfma_f32_16x16x32_bf16 a[120:123], a[136:139], v[184:187], a[120:123]
  buffer_load_dwordx4 v[72:75], v27, s[16:19], s67 offen sc1
  v_mfma_f32_16x16x32_bf16 a[120:123], a[140:143], v[104:107], a[120:123]
  s_add_u32 s67, s67, 20480
  v_exp_f32 v159, v159
  v_mfma_f32_16x16x32_bf16 a[124:127], a[140:143], v[108:111], a[124:127]
  ds_read_b128 a[128:131], v10 offset:28672
  v_add_f32 v36, v36, v154
  v_mfma_f32_16x16x32_bf16 a[124:127], a[136:139], v[188:191], a[124:127]
  v_add_f32 v36, v36, v155
  v_cvt_pk_bf16_f32 v139, v154, v155
  v_mfma_f32_16x16x32_bf16 a[244:247], a[248:251], v[188:191], a[244:247]
  v_cvt_pk_bf16_f32 v140, v140, v141
  v_cvt_pk_bf16_f32 v141, v142, v143
  v_mfma_f32_16x16x32_bf16 a[244:247], a[248:251], v[108:111], a[244:247]
  s_waitcnt lgkmcnt(1)
  v_cvt_pk_bf16_f32 v142, v156, v157
  v_cvt_pk_bf16_f32 v143, v158, v159
  s_cmp_eq_u32 s36, 0
  s_cbranch_scc1 LOOP_A_RET
LOOP_A1:
  v_mfma_f32_16x16x32_bf16 v[176:179], a[144:147], v[192:195], v[40:43]
  s_waitcnt vmcnt(26)
  v_exp_f32 v160, v160
  v_mfma_f32_16x16x32_bf16 v[176:179], a[148:151], v[196:199], v[176:179]
  s_barrier
  v_mfma_f32_16x16x32_bf16 v[176:179], a[152:155], v[200:203], v[176:179]
  ds_read_b128 a[132:135], v11 offset:28672
  ds_read_b128 a[140:143], v13 offset:28672
  v_mfma_f32_16x16x32_bf16 v[176:179], a[156:159], v[204:207], v[176:179]
  s_add_u32 m0, s78, 0
  v_exp_f32 v161, v161
  v_mfma_f32_16x16x32_bf16 v[180:183], a[156:159], v[220:223], v[44:47]
  buffer_load_dwordx4 v33, s[44:47], s42 offen lds
  v_mfma_f32_16x16x32_bf16 v[180:183], a[152:155], v[216:219], v[180:183]
  s_add_u32 s42, s42, 128
  v_exp_f32 v162, v162
  v_mfma_f32_16x16x32_bf16 v[180:183], a[148:151], v[212:215], v[180:183]
  ds_read_b128 a[136:139], v12 offset:28672
  v_add_f32 v34, v34, v160
  v_mfma_f32_16x16x32_bf16 v[180:183], a[144:147], v[208:211], v[180:183]
  s_add_u32 m0, s32, 0
  v_exp_f32 v163, v163
  v_mfma_f32_16x16x32_bf16 v[184:187], a[144:147], v[224:227], v[48:51]
  buffer_load_dwordx4 v22, s[4:7], s34 offen offset:0 lds
  v_mfma_f32_16x16x32_bf16 v[184:187], a[148:151], v[228:231], v[184:187]
  v_exp_f32 v112, v112
  v_mfma_f32_16x16x32_bf16 v[184:187], a[152:155], v[232:235], v[184:187]
  v_add_f32 v34, v34, v161
  v_cvt_pk_bf16_f32 v160, v160, v161
  v_mfma_f32_16x16x32_bf16 v[184:187], a[156:159], v[236:239], v[184:187]
  v_add_f32 v34, v34, v162
  v_add_f32 v34, v34, v163
  v_mfma_f32_16x16x32_bf16 v[188:191], a[156:159], v[252:255], v[52:55]
  v_exp_f32 v113, v113
  v_mfma_f32_16x16x32_bf16 v[188:191], a[152:155], v[248:251], v[188:191]
  v_cvt_pk_bf16_f32 v161, v162, v163
  v_add_f32 v34, v34, v112
  v_mfma_f32_16x16x32_bf16 v[188:191], a[148:151], v[244:247], v[188:191]
  s_waitcnt lgkmcnt(0)
  v_exp_f32 v114, v114
  v_mfma_f32_16x16x32_bf16 v[188:191], a[144:147], v[240:243], v[188:191]
  s_waitcnt vmcnt(19)
  buffer_load_dwordx4 v23, s[4:7], s34 offen offset:1024 lds
  v_mfma_f32_16x16x32_bf16 v[144:147], a[128:131], v[192:195], v[40:43]
  s_add_u32 s34, s34, 8192
  v_exp_f32 v115, v115
  v_mfma_f32_16x16x32_bf16 v[144:147], a[132:135], v[196:199], v[144:147]
  s_and_b32 s34, s34, 0x7ffff
  ds_read_b64_tr_b16 a[144:145], v28 offset:4096
  v_add_f32 v34, v34, v113
  v_mfma_f32_16x16x32_bf16 v[144:147], a[136:139], v[200:203], v[144:147]
  v_exp_f32 v164, v164
  v_mfma_f32_16x16x32_bf16 v[144:147], a[140:143], v[204:207], v[144:147]
  ds_read_b64_tr_b16 a[146:147], v28 offset:6144
  v_cvt_pk_bf16_f32 v162, v112, v113
  v_mfma_f32_16x16x32_bf16 v[148:151], a[140:143], v[220:223], v[44:47]
  s_mul_i32 s43, s50, 205
  ds_read_b64_tr_b16 a[148:149], v29 offset:4096
  v_add_f32 v34, v34, v114
  v_mfma_f32_16x16x32_bf16 v[148:151], a[136:139], v[216:219], v[148:151]
  s_add_u32 m0, s32, 8192
  v_exp_f32 v165, v165
  v_mfma_f32_16x16x32_bf16 v[148:151], a[132:135], v[212:215], v[148:151]
  s_lshr_b32 s43, s43, 10
  buffer_load_dwordx4 v22, s[4:7], s34 offen offset:0 lds
  v_mfma_f32_16x16x32_bf16 v[148:151], a[128:131], v[208:211], v[148:151]
  s_mul_i32 s43, s43, 635
  v_exp_f32 v166, v166
  v_mfma_f32_16x16x32_bf16 v[152:155], a[128:131], v[224:227], v[48:51]
  s_add_u32 s43, s43, s50
  ds_read_b64_tr_b16 a[150:151], v29 offset:6144
  v_add_f32 v34, v34, v115
  v_mfma_f32_16x16x32_bf16 v[152:155], a[132:135], v[228:231], v[152:155]
  s_add_u32 s43, s43, s51
  v_exp_f32 v167, v167
  v_mfma_f32_16x16x32_bf16 v[152:155], a[136:139], v[232:235], v[152:155]
  s_lshl_b32 s43, s43, 10
  ds_read_b64_tr_b16 a[152:153], v30 offset:4096
  v_cvt_pk_bf16_f32 v163, v114, v115
  v_mfma_f32_16x16x32_bf16 v[152:155], a[140:143], v[236:239], v[152:155]
  s_add_u32 s50, s50, 4
  v_exp_f32 v116, v116
  v_mfma_f32_16x16x32_bf16 v[156:159], a[140:143], v[252:255], v[52:55]
  ds_read_b64_tr_b16 a[154:155], v30 offset:6144
  ds_read_b128 a[140:143], v13 offset:32768
  v_mfma_f32_16x16x32_bf16 v[156:159], a[136:139], v[248:251], v[156:159]
  v_exp_f32 v117, v117
  v_mfma_f32_16x16x32_bf16 v[156:159], a[132:135], v[244:247], v[156:159]
  s_waitcnt lgkmcnt(5)
  buffer_load_dwordx4 v23, s[4:7], s34 offen offset:1024 lds
  v_mfma_f32_16x16x32_bf16 v[156:159], a[128:131], v[240:243], v[156:159]
  s_add_u32 s34, s34, 8192
  ds_read_b64_tr_b16 a[156:157], v31 offset:4096
  v_add_f32 v35, v35, v164
  v_mfma_f32_16x16x32_bf16 a[160:163], a[144:147], v[76:79], a[160:163]
  s_and_b32 s34, s34, 0x7ffff
  v_exp_f32 v118, v118
  v_mfma_f32_16x16x32_bf16 a[164:167], a[144:147], v[80:83], a[164:167]
  ds_read_b64_tr_b16 a[158:159], v31 offset:6144
  v_add_f32 v35, v35, v165
  v_mfma_f32_16x16x32_bf16 a[168:171], a[144:147], v[84:87], a[168:171]
  s_add_u32 m0, s33, 40960
  v_exp_f32 v119, v119
  v_mfma_f32_16x16x32_bf16 a[172:175], a[144:147], v[88:91], a[172:175]
  buffer_load_dwordx4 v24, s[8:11], s35 offen offset:0 lds
  v_mfma_f32_16x16x32_bf16 a[176:179], a[144:147], v[92:95], a[176:179]
  s_waitcnt lgkmcnt(5)
  v_exp_f32 v168, v168
  v_mfma_f32_16x16x32_bf16 a[180:183], a[148:151], v[76:79], a[180:183]
  ds_read_b128 a[128:131], v10 offset:32768
  v_cvt_pk_bf16_f32 v164, v164, v165
  v_mfma_f32_16x16x32_bf16 a[184:187], a[148:151], v[80:83], a[184:187]
  v_exp_f32 v169, v169
  v_mfma_f32_16x16x32_bf16 a[188:191], a[148:151], v[84:87], a[188:191]
  ds_read_b128 a[132:135], v11 offset:32768
  v_add_f32 v35, v35, v166
  v_mfma_f32_16x16x32_bf16 a[192:195], a[148:151], v[88:91], a[192:195]
  ds_read_b128 a[136:139], v12 offset:32768
  v_add_f32 v35, v35, v167
  v_mfma_f32_16x16x32_bf16 a[196:199], a[148:151], v[92:95], a[196:199]
  s_waitcnt lgkmcnt(6)
  v_exp_f32 v170, v170
  v_mfma_f32_16x16x32_bf16 a[200:203], a[152:155], v[76:79], a[200:203]
  buffer_load_dwordx4 v25, s[8:11], s35 offen offset:1024 lds
  v_mfma_f32_16x16x32_bf16 a[204:207], a[152:155], v[80:83], a[204:207]
  s_add_u32 s35, s35, 8192
  v_exp_f32 v171, v171
  v_mfma_f32_16x16x32_bf16 a[208:211], a[152:155], v[84:87], a[208:211]
  s_and_b32 s35, s35, 0x7ffff
  v_cvt_pk_bf16_f32 v165, v166, v167
  v_add_f32 v35, v35, v116
  v_mfma_f32_16x16x32_bf16 a[212:215], a[152:155], v[88:91], a[212:215]
  v_exp_f32 v120, v120
  v_mfma_f32_16x16x32_bf16 a[216:219], a[152:155], v[92:95], a[216:219]
  s_waitcnt lgkmcnt(3)
  ds_read_b128 a[144:147], v10 offset:36864
  v_add_f32 v35, v35, v117
  v_mfma_f32_16x16x32_bf16 a[220:223], a[156:159], v[76:79], a[220:223]
  v_exp_f32 v121, v121
  v_mfma_f32_16x16x32_bf16 a[224:227], a[156:159], v[80:83], a[224:227]
  ds_read_b128 a[148:151], v11 offset:36864
  v_cvt_pk_bf16_f32 v166, v116, v117
  v_mfma_f32_16x16x32_bf16 a[228:231], a[156:159], v[84:87], a[228:231]
  s_add_u32 m0, s33, 49152
  v_exp_f32 v122, v122
  v_mfma_f32_16x16x32_bf16 a[232:235], a[156:159], v[88:91], a[232:235]
  buffer_load_dwordx4 v24, s[8:11], s35 offen offset:0 lds
  v_mfma_f32_16x16x32_bf16 a[236:239], a[156:159], v[92:95], a[236:239]
  s_waitcnt lgkmcnt(2)
  ds_read_b128 a[152:155], v12 offset:36864
  v_add_f32 v35, v35, v118
  v_mfma_f32_16x16x32_bf16 v[96:99], a[128:131], v[192:195], v[40:43]
  v_exp_f32 v123, v123
  v_mfma_f32_16x16x32_bf16 v[96:99], a[132:135], v[196:199], v[96:99]
  ds_read_b128 a[156:159], v13 offset:36864
  v_add_f32 v35, v35, v119
  v_mfma_f32_16x16x32_bf16 v[96:99], a[136:139], v[200:203], v[96:99]
  v_exp_f32 v172, v172
  v_mfma_f32_16x16x32_bf16 v[96:99], a[140:143], v[204:207], v[96:99]
  v_cvt_pk_bf16_f32 v167, v118, v119
  v_add_f32 v36, v36, v168
  v_mfma_f32_16x16x32_bf16 v[100:103], a[140:143], v[220:223], v[44:47]
  v_exp_f32 v173, v173
  v_mfma_f32_16x16x32_bf16 v[100:103], a[136:139], v[216:219], v[100:103]
  buffer_load_dwordx4 v25, s[8:11], s35 offen offset:1024 lds
  v_mfma_f32_16x16x32_bf16 v[100:103], a[132:135], v[212:215], v[100:103]
  s_add_u32 s35, s35, 8192
  v_exp_f32 v174, v174
  v_mfma_f32_16x16x32_bf16 v[100:103], a[128:131], v[208:211], v[100:103]
  s_and_b32 s35, s35, 0x7ffff
  v_add_f32 v36, v36, v169
  v_cvt_pk_bf16_f32 v168, v168, v169
  v_mfma_f32_16x16x32_bf16 v[104:107], a[128:131], v[224:227], v[48:51]
  v_add_f32 v36, v36, v170
  v_add_f32 v36, v36, v171
  v_mfma_f32_16x16x32_bf16 v[104:107], a[132:135], v[228:231], v[104:107]
  v_exp_f32 v175, v175
  v_mfma_f32_16x16x32_bf16 v[104:107], a[136:139], v[232:235], v[104:107]
  v_cvt_pk_bf16_f32 v169, v170, v171
  v_add_f32 v36, v36, v120
  v_mfma_f32_16x16x32_bf16 v[104:107], a[140:143], v[236:239], v[104:107]
  s_add_u32 m0, s69, 4096
  v_exp_f32 v124, v124
  v_mfma_f32_16x16x32_bf16 v[108:111], a[140:143], v[252:255], v[52:55]
  buffer_load_dwordx4 v32, s[12:15], s66 offen lds
  v_mfma_f32_16x16x32_bf16 v[108:111], a[136:139], v[248:251], v[108:111]
  s_add_u32 s66, s66, s68
  v_exp_f32 v125, v125
  v_mfma_f32_16x16x32_bf16 v[108:111], a[132:135], v[244:247], v[108:111]
  ds_read_b64_tr_b16 a[132:133], v14 offset:16384
  v_add_f32 v36, v36, v121
  v_mfma_f32_16x16x32_bf16 v[108:111], a[128:131], v[240:243], v[108:111]
  s_waitcnt lgkmcnt(1)
  v_exp_f32 v126, v126
  v_mfma_f32_16x16x32_bf16 v[112:115], a[144:147], v[192:195], v[40:43]
  ds_read_b64_tr_b16 a[128:129], v14 offset:8192
  v_cvt_pk_bf16_f32 v170, v120, v121
  v_mfma_f32_16x16x32_bf16 v[112:115], a[148:151], v[196:199], v[112:115]
  v_exp_f32 v127, v127
  v_mfma_f32_16x16x32_bf16 v[112:115], a[152:155], v[200:203], v[112:115]
  ds_read_b64_tr_b16 a[130:131], v14 offset:12288
  v_add_f32 v36, v36, v122
  v_mfma_f32_16x16x32_bf16 v[112:115], a[156:159], v[204:207], v[112:115]
  ds_read_b64_tr_b16 a[134:135], v14 offset:20480
  v_add_f32 v36, v36, v123
  v_mfma_f32_16x16x32_bf16 v[116:119], a[156:159], v[220:223], v[44:47]
  v_exp_f32 v176, v176
  v_mfma_f32_16x16x32_bf16 v[116:119], a[152:155], v[216:219], v[116:119]
  ds_read_b64_tr_b16 a[136:137], v15 offset:8192
  v_cvt_pk_bf16_f32 v171, v122, v123
  v_mfma_f32_16x16x32_bf16 v[116:119], a[148:151], v[212:215], v[116:119]
  s_add_u32 m0, s69, 5120
  v_exp_f32 v177, v177
  v_mfma_f32_16x16x32_bf16 v[116:119], a[144:147], v[208:211], v[116:119]
  buffer_load_dwordx4 v32, s[12:15], s66 offen lds
  v_mfma_f32_16x16x32_bf16 v[120:123], a[144:147], v[224:227], v[48:51]
  s_add_u32 s66, s66, s68
  v_exp_f32 v178, v178
  v_mfma_f32_16x16x32_bf16 v[120:123], a[148:151], v[228:231], v[120:123]
  ds_read_b64_tr_b16 a[138:139], v15 offset:12288
  v_cvt_pk_bf16_f32 v172, v172, v173
  v_mfma_f32_16x16x32_bf16 v[120:123], a[152:155], v[232:235], v[120:123]
  ds_read_b64_tr_b16 a[140:141], v15 offset:16384
  v_cvt_pk_bf16_f32 v173, v174, v175
  v_mfma_f32_16x16x32_bf16 v[120:123], a[156:159], v[236:239], v[120:123]
  v_exp_f32 v179, v179
  v_cvt_pk_bf16_f32 v174, v124, v125
  v_cvt_pk_bf16_f32 v175, v126, v127
  v_mfma_f32_16x16x32_bf16 v[124:127], a[156:159], v[252:255], v[52:55]
  ds_read_b64_tr_b16 a[142:143], v15 offset:20480
  v_add_f32 v34, v34, v176
  v_mfma_f32_16x16x32_bf16 v[124:127], a[152:155], v[248:251], v[124:127]
  v_exp_f32 v144, v144
  v_mfma_f32_16x16x32_bf16 v[124:127], a[148:151], v[244:247], v[124:127]
  ds_read_b64_tr_b16 a[148:149], v16 offset:16384
  v_add_f32 v34, v34, v177
  v_mfma_f32_16x16x32_bf16 v[124:127], a[144:147], v[240:243], v[124:127]
  s_waitcnt lgkmcnt(5)
  ds_read_b64_tr_b16 a[144:145], v16 offset:8192
  v_cvt_pk_bf16_f32 v176, v176, v177
  v_mfma_f32_16x16x32_bf16 a[0:3], a[128:131], v[128:131], a[0:3]
  s_add_u32 m0, s69, 6144
  v_exp_f32 v145, v145
  v_mfma_f32_16x16x32_bf16 a[0:3], a[132:135], v[160:163], a[0:3]
  buffer_load_dwordx4 v32, s[12:15], s66 offen lds
  v_mfma_f32_16x16x32_bf16 a[4:7], a[132:135], v[164:167], a[4:7]
  s_add_u32 s66, s66, s68
  v_exp_f32 v146, v146
  v_mfma_f32_16x16x32_bf16 a[4:7], a[128:131], v[132:135], a[4:7]
  ds_read_b64_tr_b16 a[146:147], v16 offset:12288
  v_add_f32 v34, v34, v178
  v_mfma_f32_16x16x32_bf16 a[8:11], a[128:131], v[136:139], a[8:11]
  v_exp_f32 v147, v147
  v_mfma_f32_16x16x32_bf16 a[8:11], a[132:135], v[168:171], a[8:11]
  ds_read_b64_tr_b16 a[150:151], v16 offset:20480
  v_add_f32 v34, v34, v179
  v_mfma_f32_16x16x32_bf16 a[12:15], a[132:135], v[172:175], a[12:15]
  ds_read_b64_tr_b16 a[152:153], v17 offset:8192
  v_cvt_pk_bf16_f32 v177, v178, v179
  v_mfma_f32_16x16x32_bf16 a[12:15], a[128:131], v[140:143], a[12:15]
  s_waitcnt lgkmcnt(5)
  v_exp_f32 v180, v180
  v_mfma_f32_16x16x32_bf16 a[16:19], a[136:139], v[128:131], a[16:19]
  ds_read_b64_tr_b16 a[154:155], v17 offset:12288
  v_add_f32 v34, v34, v144
  v_mfma_f32_16x16x32_bf16 a[16:19], a[140:143], v[160:163], a[16:19]
  s_add_u32 m0, s69, 7168
  v_exp_f32 v181, v181
  v_mfma_f32_16x16x32_bf16 a[20:23], a[140:143], v[164:167], a[20:23]
  buffer_load_dwordx4 v32, s[12:15], s66 offen lds
  v_mfma_f32_16x16x32_bf16 a[20:23], a[136:139], v[132:135], a[20:23]
  s_add_u32 s66, s66, s70
  v_exp_f32 v182, v182
  v_mfma_f32_16x16x32_bf16 a[24:27], a[136:139], v[136:139], a[24:27]
  ds_read_b64_tr_b16 a[156:157], v17 offset:16384
  v_add_f32 v34, v34, v145
  v_mfma_f32_16x16x32_bf16 a[24:27], a[140:143], v[168:171], a[24:27]
  ds_read_b64_tr_b16 a[158:159], v17 offset:20480
  v_cvt_pk_bf16_f32 v178, v144, v145
  v_mfma_f32_16x16x32_bf16 a[28:31], a[140:143], v[172:175], a[28:31]
  v_exp_f32 v183, v183
  v_mfma_f32_16x16x32_bf16 a[28:31], a[136:139], v[140:143], a[28:31]
  s_waitcnt lgkmcnt(4)
  ds_read_b64_tr_b16 a[128:129], v18 offset:8192
  v_add_f32 v34, v34, v146
  v_mfma_f32_16x16x32_bf16 a[32:35], a[144:147], v[128:131], a[32:35]
  v_exp_f32 v148, v148
  v_mfma_f32_16x16x32_bf16 a[32:35], a[148:151], v[160:163], a[32:35]
  ds_read_b64_tr_b16 a[130:131], v18 offset:12288
  v_add_f32 v34, v34, v147
  v_mfma_f32_16x16x32_bf16 a[36:39], a[148:151], v[164:167], a[36:39]
  ds_read_b64_tr_b16 a[132:133], v18 offset:16384
  v_cvt_pk_bf16_f32 v179, v146, v147
  v_mfma_f32_16x16x32_bf16 a[36:39], a[144:147], v[132:135], a[36:39]
  v_exp_f32 v149, v149
  v_mfma_f32_16x16x32_bf16 a[40:43], a[144:147], v[136:139], a[40:43]
  buffer_load_dwordx4 v[76:79], v26, s[16:19], s67 offen offset:0 sc1
  v_mfma_f32_16x16x32_bf16 a[40:43], a[148:151], v[168:171], a[40:43]
  v_exp_f32 v150, v150
  v_mfma_f32_16x16x32_bf16 a[44:47], a[148:151], v[172:175], a[44:47]
  ds_read_b64_tr_b16 a[134:135], v18 offset:20480
  v_add_f32 v35, v35, v180
  v_mfma_f32_16x16x32_bf16 a[44:47], a[144:147], v[140:143], a[44:47]
  s_waitcnt lgkmcnt(4)
  v_exp_f32 v151, v151
  v_mfma_f32_16x16x32_bf16 a[48:51], a[152:155], v[128:131], a[48:51]
  ds_read_b64_tr_b16 a[136:137], v19 offset:8192
  v_add_f32 v35, v35, v181
  v_mfma_f32_16x16x32_bf16 a[48:51], a[156:159], v[160:163], a[48:51]
  ds_read_b64_tr_b16 a[138:139], v19 offset:12288
  v_cvt_pk_bf16_f32 v180, v180, v181
  v_mfma_f32_16x16x32_bf16 a[52:55], a[156:159], v[164:167], a[52:55]
  s_waitcnt vmcnt(13)
  v_exp_f32 v184, v184
  v_mfma_f32_16x16x32_bf16 a[52:55], a[152:155], v[132:135], a[52:55]
  ds_read_b64_tr_b16 a[140:141], v19 offset:16384
  ds_read_b64_tr_b16 a[252:253], v1 offset:0
  v_mfma_f32_16x16x32_bf16 a[56:59], a[152:155], v[136:139], a[56:59]
  v_exp_f32 v185, v185
  v_mfma_f32_16x16x32_bf16 a[56:59], a[156:159], v[168:171], a[56:59]
  ds_read_b64_tr_b16 a[142:143], v19 offset:20480
  ds_read_b64_tr_b16 a[254:255], v1 offset:512
  v_mfma_f32_16x16x32_bf16 a[60:63], a[156:159], v[172:175], a[60:63]
  v_exp_f32 v186, v186
  v_mfma_f32_16x16x32_bf16 a[60:63], a[152:155], v[140:143], a[60:63]
  s_waitcnt lgkmcnt(6)
  buffer_load_dwordx4 v[80:83], v26, s[16:19], s67 offen offset:1024 sc1
  v_mfma_f32_16x16x32_bf16 a[64:67], a[128:131], v[128:131], a[64:67]
  ds_read_b64_tr_b16 a[144:145], v20 offset:8192
  v_add_f32 v35, v35, v182
  v_mfma_f32_16x16x32_bf16 a[64:67], a[132:135], v[160:163], a[64:67]
  v_exp_f32 v187, v187
  v_mfma_f32_16x16x32_bf16 a[68:71], a[132:135], v[164:167], a[68:71]
  ds_read_b64_tr_b16 a[146:147], v20 offset:12288
  v_add_f32 v35, v35, v183
  v_mfma_f32_16x16x32_bf16 a[68:71], a[128:131], v[132:135], a[68:71]
  v_exp_f32 v152, v152
  v_mfma_f32_16x16x32_bf16 a[72:75], a[128:131], v[136:139], a[72:75]
  ds_read_b64_tr_b16 a[148:149], v20 offset:16384
  v_cvt_pk_bf16_f32 v181, v182, v183
  v_mfma_f32_16x16x32_bf16 a[72:75], a[132:135], v[168:171], a[72:75]
  ds_read_b64_tr_b16 a[150:151], v20 offset:20480
  v_add_f32 v35, v35, v148
  v_mfma_f32_16x16x32_bf16 a[76:79], a[132:135], v[172:175], a[76:79]
  v_exp_f32 v153, v153
  v_mfma_f32_16x16x32_bf16 a[76:79], a[128:131], v[140:143], a[76:79]
  s_waitcnt lgkmcnt(5)
  buffer_load_dwordx4 v[84:87], v26, s[16:19], s67 offen offset:2048 sc1
  v_mfma_f32_16x16x32_bf16 a[80:83], a[136:139], v[128:131], a[80:83]
  v_exp_f32 v154, v154
  v_mfma_f32_16x16x32_bf16 a[80:83], a[140:143], v[160:163], a[80:83]
  ds_read_b64_tr_b16 a[152:153], v21 offset:8192
  v_add_f32 v35, v35, v149
  v_mfma_f32_16x16x32_bf16 a[84:87], a[140:143], v[164:167], a[84:87]
  v_exp_f32 v155, v155
  v_mfma_f32_16x16x32_bf16 a[84:87], a[136:139], v[132:135], a[84:87]
  ds_read_b64_tr_b16 a[154:155], v21 offset:12288
  v_cvt_pk_bf16_f32 v182, v148, v149
  v_mfma_f32_16x16x32_bf16 a[88:91], a[136:139], v[136:139], a[88:91]
  ds_read_b64_tr_b16 a[156:157], v21 offset:16384
  v_add_f32 v35, v35, v150
  v_mfma_f32_16x16x32_bf16 a[88:91], a[140:143], v[168:171], a[88:91]
  v_exp_f32 v188, v188
  v_mfma_f32_16x16x32_bf16 a[92:95], a[140:143], v[172:175], a[92:95]
  ds_read_b64_tr_b16 a[158:159], v21 offset:20480
  v_add_f32 v35, v35, v151
  v_mfma_f32_16x16x32_bf16 a[92:95], a[136:139], v[140:143], a[92:95]
  s_waitcnt lgkmcnt(4)
  v_exp_f32 v189, v189
  v_mfma_f32_16x16x32_bf16 a[96:99], a[144:147], v[128:131], a[96:99]
  ds_read_b128 a[128:131], v10 offset:40960
  v_cvt_pk_bf16_f32 v183, v150, v151
  v_mfma_f32_16x16x32_bf16 a[96:99], a[148:151], v[160:163], a[96:99]
  v_exp_f32 v190, v190
  v_mfma_f32_16x16x32_bf16 a[100:103], a[148:151], v[164:167], a[100:103]
  buffer_load_dwordx4 v[88:91], v26, s[16:19], s67 offen offset:3072 sc1
  v_mfma_f32_16x16x32_bf16 a[100:103], a[144:147], v[132:135], a[100:103]
  ds_read_b128 a[132:135], v11 offset:40960
  v_add_f32 v36, v36, v184
  v_mfma_f32_16x16x32_bf16 a[104:107], a[144:147], v[136:139], a[104:107]
  v_exp_f32 v191, v191
  v_mfma_f32_16x16x32_bf16 a[104:107], a[148:151], v[168:171], a[104:107]
  ds_read_b128 a[136:139], v12 offset:40960
  v_add_f32 v36, v36, v185
  v_mfma_f32_16x16x32_bf16 a[108:111], a[148:151], v[172:175], a[108:111]
  v_exp_f32 v156, v156
  v_mfma_f32_16x16x32_bf16 a[108:111], a[144:147], v[140:143], a[108:111]
  s_waitcnt lgkmcnt(3)
  ds_read_b128 a[140:143], v13 offset:40960
  v_cvt_pk_bf16_f32 v184, v184, v185
  v_mfma_f32_16x16x32_bf16 a[112:115], a[152:155], v[128:131], a[112:115]
  v_add_f32 v36, v36, v186
  v_add_f32 v36, v36, v187
  v_mfma_f32_16x16x32_bf16 a[112:115], a[156:159], v[160:163], a[112:115]
  v_exp_f32 v157, v157
  v_mfma_f32_16x16x32_bf16 a[116:119], a[156:159], v[164:167], a[116:119]
  v_cvt_pk_bf16_f32 v185, v186, v187
  v_add_f32 v36, v36, v152
  v_mfma_f32_16x16x32_bf16 a[116:119], a[152:155], v[132:135], a[116:119]
  v_exp_f32 v158, v158
  v_mfma_f32_16x16x32_bf16 a[120:123], a[152:155], v[136:139], a[120:123]
  buffer_load_dwordx4 v[92:95], v27, s[16:19], s67 offen sc1
  v_mfma_f32_16x16x32_bf16 a[120:123], a[156:159], v[168:171], a[120:123]
  s_add_u32 s67, s67, 20480
  v_exp_f32 v159, v159
  v_mfma_f32_16x16x32_bf16 a[124:127], a[156:159], v[172:175], a[124:127]
  ds_read_b128 a[144:147], v10 offset:45056
  v_add_f32 v36, v36, v153
  v_mfma_f32_16x16x32_bf16 a[124:127], a[152:155], v[140:143], a[124:127]
  v_cvt_pk_bf16_f32 v186, v152, v153
  v_add_f32 v36, v36, v154
  v_mfma_f32_16x16x32_bf16 a[244:247], a[248:251], v[140:143], a[244:247]
  v_add_f32 v36, v36, v155
  v_cvt_pk_bf16_f32 v187, v154, v155
  v_mfma_f32_16x16x32_bf16 a[244:247], a[248:251], v[172:175], a[244:247]
  s_waitcnt lgkmcnt(1)
  v_cvt_pk_bf16_f32 v188, v188, v189
  v_cvt_pk_bf16_f32 v189, v190, v191
  v_cvt_pk_bf16_f32 v190, v156, v157
  v_cvt_pk_bf16_f32 v191, v158, v159
  v_mfma_f32_16x16x32_bf16 v[128:131], a[128:131], v[192:195], v[40:43]
  s_waitcnt vmcnt(27)
  v_exp_f32 v96, v96
  v_mfma_f32_16x16x32_bf16 v[128:131], a[132:135], v[196:199], v[128:131]
  s_barrier
  v_mfma_f32_16x16x32_bf16 v[128:131], a[136:139], v[200:203], v[128:131]
  ds_read_b128 a[148:151], v11 offset:45056
  ds_read_b128 a[156:159], v13 offset:45056
  v_mfma_f32_16x16x32_bf16 v[128:131], a[140:143], v[204:207], v[128:131]
  v_exp_f32 v97, v97
  v_mfma_f32_16x16x32_bf16 v[132:135], a[140:143], v[220:223], v[44:47]
  ds_read_b128 a[152:155], v12 offset:45056
  v_add_f32 v34, v34, v96
  v_mfma_f32_16x16x32_bf16 v[132:135], a[136:139], v[216:219], v[132:135]
  s_add_u32 m0, s32, 16384
  v_exp_f32 v98, v98
  v_mfma_f32_16x16x32_bf16 v[132:135], a[132:135], v[212:215], v[132:135]
  buffer_load_dwordx4 v22, s[4:7], s34 offen offset:0 lds
  v_mfma_f32_16x16x32_bf16 v[132:135], a[128:131], v[208:211], v[132:135]
  v_exp_f32 v99, v99
  v_mfma_f32_16x16x32_bf16 v[136:139], a[128:131], v[224:227], v[48:51]
  v_add_f32 v34, v34, v97
  v_cvt_pk_bf16_f32 v96, v96, v97
  v_mfma_f32_16x16x32_bf16 v[136:139], a[132:135], v[228:231], v[136:139]
  v_exp_f32 v112, v112
  v_mfma_f32_16x16x32_bf16 v[136:139], a[136:139], v[232:235], v[136:139]
  v_add_f32 v34, v34, v98
  v_add_f32 v34, v34, v99
  v_mfma_f32_16x16x32_bf16 v[136:139], a[140:143], v[236:239], v[136:139]
  v_cvt_pk_bf16_f32 v97, v98, v99
  v_add_f32 v34, v34, v112
  v_mfma_f32_16x16x32_bf16 v[140:143], a[140:143], v[252:255], v[52:55]
  s_waitcnt lgkmcnt(0)
  v_exp_f32 v113, v113
  v_mfma_f32_16x16x32_bf16 v[140:143], a[136:139], v[248:251], v[140:143]
  s_waitcnt vmcnt(19)
  buffer_load_dwordx4 v23, s[4:7], s34 offen offset:1024 lds
  v_mfma_f32_16x16x32_bf16 v[140:143], a[132:135], v[244:247], v[140:143]
  s_add_u32 s34, s34, 8192
  v_exp_f32 v114, v114
  v_mfma_f32_16x16x32_bf16 v[140:143], a[128:131], v[240:243], v[140:143]
  s_and_b32 s34, s34, 0x7ffff
  ds_read_b64_tr_b16 a[128:129], v28 offset:0
  v_add_f32 v34, v34, v113
  v_mfma_f32_16x16x32_bf16 v[144:147], a[144:147], v[192:195], v[40:43]
  v_exp_f32 v115, v115
  v_mfma_f32_16x16x32_bf16 v[144:147], a[148:151], v[196:199], v[144:147]
  ds_read_b64_tr_b16 a[130:131], v28 offset:2048
  v_cvt_pk_bf16_f32 v98, v112, v113
  v_mfma_f32_16x16x32_bf16 v[144:147], a[152:155], v[200:203], v[144:147]
  s_add_u32 m0, s32, 24576
  v_exp_f32 v100, v100
  v_mfma_f32_16x16x32_bf16 v[144:147], a[156:159], v[204:207], v[144:147]
  buffer_load_dwordx4 v22, s[4:7], s34 offen offset:0 lds
  v_mfma_f32_16x16x32_bf16 v[148:151], a[156:159], v[220:223], v[44:47]
  ds_read_b64_tr_b16 a[132:133], v29 offset:0
  v_add_f32 v34, v34, v114
  v_mfma_f32_16x16x32_bf16 v[148:151], a[152:155], v[216:219], v[148:151]
  v_exp_f32 v101, v101
  v_mfma_f32_16x16x32_bf16 v[148:151], a[148:151], v[212:215], v[148:151]
  ds_read_b64_tr_b16 a[134:135], v29 offset:2048
  v_add_f32 v34, v34, v115
  v_mfma_f32_16x16x32_bf16 v[148:151], a[144:147], v[208:211], v[148:151]
  v_exp_f32 v102, v102
  v_mfma_f32_16x16x32_bf16 v[152:155], a[144:147], v[224:227], v[48:51]
  ds_read_b64_tr_b16 a[136:137], v30 offset:0
  v_cvt_pk_bf16_f32 v99, v114, v115
  v_mfma_f32_16x16x32_bf16 v[152:155], a[148:151], v[228:231], v[152:155]
  v_exp_f32 v103, v103
  v_mfma_f32_16x16x32_bf16 v[152:155], a[152:155], v[232:235], v[152:155]
  buffer_load_dwordx4 v23, s[4:7], s34 offen offset:1024 lds
  v_mfma_f32_16x16x32_bf16 v[152:155], a[156:159], v[236:239], v[152:155]
  s_add_u32 s34, s34, 8192
  v_exp_f32 v116, v116
  v_mfma_f32_16x16x32_bf16 v[156:159], a[156:159], v[252:255], v[52:55]
  s_and_b32 s34, s34, 0x7ffff
  ds_read_b64_tr_b16 a[138:139], v30 offset:2048
  v_add_f32 v35, v35, v100
  v_mfma_f32_16x16x32_bf16 v[156:159], a[152:155], v[248:251], v[156:159]
  v_exp_f32 v117, v117
  v_mfma_f32_16x16x32_bf16 v[156:159], a[148:151], v[244:247], v[156:159]
  s_add_u32 m0, s33, 57344
  ds_read_b64_tr_b16 a[140:141], v31 offset:0
  v_add_f32 v35, v35, v101
  v_mfma_f32_16x16x32_bf16 v[156:159], a[144:147], v[240:243], v[156:159]
  s_waitcnt lgkmcnt(5)
  buffer_load_dwordx4 v24, s[8:11], s35 offen offset:0 lds
  v_mfma_f32_16x16x32_bf16 a[160:163], a[128:131], v[56:59], a[160:163]
  v_exp_f32 v118, v118
  v_mfma_f32_16x16x32_bf16 a[164:167], a[128:131], v[60:63], a[164:167]
  ds_read_b64_tr_b16 a[142:143], v31 offset:2048
  v_cvt_pk_bf16_f32 v100, v100, v101
  v_mfma_f32_16x16x32_bf16 a[168:171], a[128:131], v[64:67], a[168:171]
  v_exp_f32 v119, v119
  v_mfma_f32_16x16x32_bf16 a[172:175], a[128:131], v[68:71], a[172:175]
  ds_read_b128 a[144:147], v10 offset:49152
  v_add_f32 v35, v35, v102
  v_mfma_f32_16x16x32_bf16 a[176:179], a[128:131], v[72:75], a[176:179]
  s_waitcnt lgkmcnt(5)
  v_exp_f32 v104, v104
  v_mfma_f32_16x16x32_bf16 a[180:183], a[132:135], v[56:59], a[180:183]
  buffer_load_dwordx4 v25, s[8:11], s35 offen offset:1024 lds
  v_mfma_f32_16x16x32_bf16 a[184:187], a[132:135], v[60:63], a[184:187]
  s_add_u32 s35, s35, 8192
  v_exp_f32 v105, v105
  v_mfma_f32_16x16x32_bf16 a[188:191], a[132:135], v[64:67], a[188:191]
  s_and_b32 s35, s35, 0x7ffff
  ds_read_b128 a[148:151], v11 offset:49152
  v_add_f32 v35, v35, v103
  v_mfma_f32_16x16x32_bf16 a[192:195], a[132:135], v[68:71], a[192:195]
  ds_read_b128 a[152:155], v12 offset:49152
  v_cvt_pk_bf16_f32 v101, v102, v103
  v_mfma_f32_16x16x32_bf16 a[196:199], a[132:135], v[72:75], a[196:199]
  s_waitcnt lgkmcnt(5)
  v_exp_f32 v106, v106
  v_mfma_f32_16x16x32_bf16 a[200:203], a[136:139], v[56:59], a[200:203]
  ds_read_b128 a[156:159], v13 offset:49152
  v_add_f32 v35, v35, v116
  v_mfma_f32_16x16x32_bf16 a[204:207], a[136:139], v[60:63], a[204:207]
  s_add_u32 m0, s33, 0
  v_exp_f32 v107, v107
  v_mfma_f32_16x16x32_bf16 a[208:211], a[136:139], v[64:67], a[208:211]
  buffer_load_dwordx4 v24, s[8:11], s35 offen offset:0 lds
  v_mfma_f32_16x16x32_bf16 a[212:215], a[136:139], v[68:71], a[212:215]
  v_exp_f32 v120, v120
  v_mfma_f32_16x16x32_bf16 a[216:219], a[136:139], v[72:75], a[216:219]
  s_waitcnt lgkmcnt(4)
  ds_read_b128 a[128:131], v10 offset:53248
  v_add_f32 v35, v35, v117
  v_mfma_f32_16x16x32_bf16 a[220:223], a[140:143], v[56:59], a[220:223]
  v_exp_f32 v121, v121
  v_mfma_f32_16x16x32_bf16 a[224:227], a[140:143], v[60:63], a[224:227]
  ds_read_b128 a[132:135], v11 offset:53248
  v_cvt_pk_bf16_f32 v102, v116, v117
  v_mfma_f32_16x16x32_bf16 a[228:231], a[140:143], v[64:67], a[228:231]
  v_exp_f32 v122, v122
  v_mfma_f32_16x16x32_bf16 a[232:235], a[140:143], v[68:71], a[232:235]
  s_waitcnt lgkmcnt(2)
  buffer_load_dwordx4 v25, s[8:11], s35 offen offset:1024 lds
  v_mfma_f32_16x16x32_bf16 a[236:239], a[140:143], v[72:75], a[236:239]
  s_add_u32 s35, s35, 8192
  ds_read_b128 a[136:139], v12 offset:53248
  v_add_f32 v35, v35, v118
  v_mfma_f32_16x16x32_bf16 v[160:163], a[144:147], v[192:195], v[40:43]
  s_and_b32 s35, s35, 0x7ffff
  v_exp_f32 v123, v123
  v_mfma_f32_16x16x32_bf16 v[160:163], a[148:151], v[196:199], v[160:163]
  ds_read_b128 a[140:143], v13 offset:53248
  v_add_f32 v35, v35, v119
  v_mfma_f32_16x16x32_bf16 v[160:163], a[152:155], v[200:203], v[160:163]
  v_exp_f32 v108, v108
  v_mfma_f32_16x16x32_bf16 v[160:163], a[156:159], v[204:207], v[160:163]
  v_cvt_pk_bf16_f32 v103, v118, v119
  v_add_f32 v36, v36, v104
  v_mfma_f32_16x16x32_bf16 v[164:167], a[156:159], v[220:223], v[44:47]
  v_exp_f32 v109, v109
  v_mfma_f32_16x16x32_bf16 v[164:167], a[152:155], v[216:219], v[164:167]
  buffer_store_dwordx4 a[252:255], v26, s[20:23], s43 offen sc1
  v_mfma_f32_16x16x32_bf16 v[164:167], a[148:151], v[212:215], v[164:167]
  v_exp_f32 v110, v110
  v_mfma_f32_16x16x32_bf16 v[164:167], a[144:147], v[208:211], v[164:167]
  v_add_f32 v36, v36, v105
  v_cvt_pk_bf16_f32 v104, v104, v105
  v_mfma_f32_16x16x32_bf16 v[168:171], a[144:147], v[224:227], v[48:51]
  v_add_f32 v36, v36, v106
  v_add_f32 v36, v36, v107
  v_mfma_f32_16x16x32_bf16 v[168:171], a[148:151], v[228:231], v[168:171]
  v_exp_f32 v111, v111
  v_mfma_f32_16x16x32_bf16 v[168:171], a[152:155], v[232:235], v[168:171]
  v_cvt_pk_bf16_f32 v105, v106, v107
  v_add_f32 v36, v36, v120
  v_mfma_f32_16x16x32_bf16 v[168:171], a[156:159], v[236:239], v[168:171]
  s_add_u32 m0, s69, 0
  v_exp_f32 v124, v124
  v_mfma_f32_16x16x32_bf16 v[172:175], a[156:159], v[252:255], v[52:55]
  buffer_load_dwordx4 v32, s[12:15], s66 offen lds
  v_mfma_f32_16x16x32_bf16 v[172:175], a[152:155], v[248:251], v[172:175]
  s_add_u32 s66, s66, s68
  v_exp_f32 v125, v125
  v_mfma_f32_16x16x32_bf16 v[172:175], a[148:151], v[244:247], v[172:175]
  ds_read_b64_tr_b16 a[148:149], v14 offset:32768
  v_add_f32 v36, v36, v121
  v_mfma_f32_16x16x32_bf16 v[172:175], a[144:147], v[240:243], v[172:175]
  s_waitcnt lgkmcnt(1)
  v_exp_f32 v126, v126
  v_mfma_f32_16x16x32_bf16 v[112:115], a[128:131], v[192:195], v[40:43]
  ds_read_b64_tr_b16 a[144:145], v14 offset:24576
  v_cvt_pk_bf16_f32 v106, v120, v121
  v_mfma_f32_16x16x32_bf16 v[112:115], a[132:135], v[196:199], v[112:115]
  v_exp_f32 v127, v127
  v_mfma_f32_16x16x32_bf16 v[112:115], a[136:139], v[200:203], v[112:115]
  ds_read_b64_tr_b16 a[146:147], v14 offset:28672
  v_add_f32 v36, v36, v122
  v_mfma_f32_16x16x32_bf16 v[112:115], a[140:143], v[204:207], v[112:115]
  ds_read_b64_tr_b16 a[150:151], v14 offset:36864
  v_add_f32 v36, v36, v123
  v_mfma_f32_16x16x32_bf16 v[116:119], a[140:143], v[220:223], v[44:47]
  v_exp_f32 v128, v128
  v_mfma_f32_16x16x32_bf16 v[116:119], a[136:139], v[216:219], v[116:119]
  ds_read_b64_tr_b16 a[152:153], v15 offset:24576
  v_cvt_pk_bf16_f32 v107, v122, v123
  v_mfma_f32_16x16x32_bf16 v[116:119], a[132:135], v[212:215], v[116:119]
  s_add_u32 m0, s69, 1024
  v_exp_f32 v129, v129
  v_mfma_f32_16x16x32_bf16 v[116:119], a[128:131], v[208:211], v[116:119]
  buffer_load_dwordx4 v32, s[12:15], s66 offen lds
  v_mfma_f32_16x16x32_bf16 v[120:123], a[128:131], v[224:227], v[48:51]
  s_add_u32 s66, s66, s68
  v_exp_f32 v130, v130
  v_mfma_f32_16x16x32_bf16 v[120:123], a[132:135], v[228:231], v[120:123]
  ds_read_b64_tr_b16 a[154:155], v15 offset:28672
  v_cvt_pk_bf16_f32 v108, v108, v109
  v_mfma_f32_16x16x32_bf16 v[120:123], a[136:139], v[232:235], v[120:123]
  ds_read_b64_tr_b16 a[156:157], v15 offset:32768
  v_cvt_pk_bf16_f32 v109, v110, v111
  v_mfma_f32_16x16x32_bf16 v[120:123], a[140:143], v[236:239], v[120:123]
  v_exp_f32 v131, v131
  v_cvt_pk_bf16_f32 v110, v124, v125
  v_cvt_pk_bf16_f32 v111, v126, v127
  v_mfma_f32_16x16x32_bf16 v[124:127], a[140:143], v[252:255], v[52:55]
  ds_read_b64_tr_b16 a[158:159], v15 offset:36864
  v_add_f32 v34, v34, v128
  v_mfma_f32_16x16x32_bf16 v[124:127], a[136:139], v[248:251], v[124:127]
  v_exp_f32 v144, v144
  v_mfma_f32_16x16x32_bf16 v[124:127], a[132:135], v[244:247], v[124:127]
  ds_read_b64_tr_b16 a[132:133], v16 offset:32768
  v_add_f32 v34, v34, v129
  v_mfma_f32_16x16x32_bf16 v[124:127], a[128:131], v[240:243], v[124:127]
  s_waitcnt lgkmcnt(5)
  ds_read_b64_tr_b16 a[128:129], v16 offset:24576
  v_cvt_pk_bf16_f32 v128, v128, v129
  v_mfma_f32_16x16x32_bf16 a[0:3], a[144:147], v[176:179], a[0:3]
  s_add_u32 m0, s69, 2048
  v_exp_f32 v145, v145
  v_mfma_f32_16x16x32_bf16 a[0:3], a[148:151], v[96:99], a[0:3]
  buffer_load_dwordx4 v32, s[12:15], s66 offen lds
  v_mfma_f32_16x16x32_bf16 a[4:7], a[148:151], v[100:103], a[4:7]
  s_add_u32 s66, s66, s68
  v_exp_f32 v146, v146
  v_mfma_f32_16x16x32_bf16 a[4:7], a[144:147], v[180:183], a[4:7]
  ds_read_b64_tr_b16 a[130:131], v16 offset:28672
  v_add_f32 v34, v34, v130
  v_mfma_f32_16x16x32_bf16 a[8:11], a[144:147], v[184:187], a[8:11]
  v_exp_f32 v147, v147
  v_mfma_f32_16x16x32_bf16 a[8:11], a[148:151], v[104:107], a[8:11]
  ds_read_b64_tr_b16 a[134:135], v16 offset:36864
  v_add_f32 v34, v34, v131
  v_mfma_f32_16x16x32_bf16 a[12:15], a[148:151], v[108:111], a[12:15]
  ds_read_b64_tr_b16 a[136:137], v17 offset:24576
  v_cvt_pk_bf16_f32 v129, v130, v131
  v_mfma_f32_16x16x32_bf16 a[12:15], a[144:147], v[188:191], a[12:15]
  s_waitcnt lgkmcnt(5)
  v_exp_f32 v132, v132
  v_mfma_f32_16x16x32_bf16 a[16:19], a[152:155], v[176:179], a[16:19]
  ds_read_b64_tr_b16 a[138:139], v17 offset:28672
  v_add_f32 v34, v34, v144
  v_mfma_f32_16x16x32_bf16 a[16:19], a[156:159], v[96:99], a[16:19]
  s_add_u32 m0, s69, 3072
  v_exp_f32 v133, v133
  v_mfma_f32_16x16x32_bf16 a[20:23], a[156:159], v[100:103], a[20:23]
  buffer_load_dwordx4 v32, s[12:15], s66 offen lds
  v_mfma_f32_16x16x32_bf16 a[20:23], a[152:155], v[180:183], a[20:23]
  s_add_u32 s66, s66, s70
  v_exp_f32 v134, v134
  v_mfma_f32_16x16x32_bf16 a[24:27], a[152:155], v[184:187], a[24:27]
  ds_read_b64_tr_b16 a[140:141], v17 offset:32768
  v_add_f32 v34, v34, v145
  v_mfma_f32_16x16x32_bf16 a[24:27], a[156:159], v[104:107], a[24:27]
  ds_read_b64_tr_b16 a[142:143], v17 offset:36864
  v_cvt_pk_bf16_f32 v130, v144, v145
  v_mfma_f32_16x16x32_bf16 a[28:31], a[156:159], v[108:111], a[28:31]
  v_exp_f32 v135, v135
  v_mfma_f32_16x16x32_bf16 a[28:31], a[152:155], v[188:191], a[28:31]
  s_waitcnt lgkmcnt(4)
  ds_read_b64_tr_b16 a[144:145], v18 offset:24576
  v_add_f32 v34, v34, v146
  v_mfma_f32_16x16x32_bf16 a[32:35], a[128:131], v[176:179], a[32:35]
  v_exp_f32 v148, v148
  v_mfma_f32_16x16x32_bf16 a[32:35], a[132:135], v[96:99], a[32:35]
  ds_read_b64_tr_b16 a[146:147], v18 offset:28672
  v_add_f32 v34, v34, v147
  v_mfma_f32_16x16x32_bf16 a[36:39], a[132:135], v[100:103], a[36:39]
  ds_read_b64_tr_b16 a[148:149], v18 offset:32768
  v_cvt_pk_bf16_f32 v131, v146, v147
  v_mfma_f32_16x16x32_bf16 a[36:39], a[128:131], v[180:183], a[36:39]
  v_exp_f32 v149, v149
  v_mfma_f32_16x16x32_bf16 a[40:43], a[128:131], v[184:187], a[40:43]
  buffer_load_dwordx4 v[56:59], v26, s[16:19], s67 offen offset:0 sc1
  v_mfma_f32_16x16x32_bf16 a[40:43], a[132:135], v[104:107], a[40:43]
  v_exp_f32 v150, v150
  v_mfma_f32_16x16x32_bf16 a[44:47], a[132:135], v[108:111], a[44:47]
  ds_read_b64_tr_b16 a[150:151], v18 offset:36864
  v_add_f32 v35, v35, v132
  v_mfma_f32_16x16x32_bf16 a[44:47], a[128:131], v[188:191], a[44:47]
  s_waitcnt lgkmcnt(4)
  v_exp_f32 v151, v151
  v_mfma_f32_16x16x32_bf16 a[48:51], a[136:139], v[176:179], a[48:51]
  ds_read_b64_tr_b16 a[152:153], v19 offset:24576
  v_add_f32 v35, v35, v133
  v_mfma_f32_16x16x32_bf16 a[48:51], a[140:143], v[96:99], a[48:51]
  ds_read_b64_tr_b16 a[154:155], v19 offset:28672
  v_cvt_pk_bf16_f32 v132, v132, v133
  v_mfma_f32_16x16x32_bf16 a[52:55], a[140:143], v[100:103], a[52:55]
  v_exp_f32 v136, v136
  v_mfma_f32_16x16x32_bf16 a[52:55], a[136:139], v[180:183], a[52:55]
  ds_read_b64_tr_b16 a[156:157], v19 offset:32768
  v_add_f32 v35, v35, v134
  v_mfma_f32_16x16x32_bf16 a[56:59], a[136:139], v[184:187], a[56:59]
  v_exp_f32 v137, v137
  v_mfma_f32_16x16x32_bf16 a[56:59], a[140:143], v[104:107], a[56:59]
  ds_read_b64_tr_b16 a[158:159], v19 offset:36864
  v_add_f32 v35, v35, v135
  v_mfma_f32_16x16x32_bf16 a[60:63], a[140:143], v[108:111], a[60:63]
  v_exp_f32 v138, v138
  v_mfma_f32_16x16x32_bf16 a[60:63], a[136:139], v[188:191], a[60:63]
  s_waitcnt lgkmcnt(4)
  buffer_load_dwordx4 v[60:63], v26, s[16:19], s67 offen offset:1024 sc1
  v_mfma_f32_16x16x32_bf16 a[64:67], a[144:147], v[176:179], a[64:67]
  ds_read_b64_tr_b16 a[128:129], v20 offset:24576
  v_cvt_pk_bf16_f32 v133, v134, v135
  v_mfma_f32_16x16x32_bf16 a[64:67], a[148:151], v[96:99], a[64:67]
  v_exp_f32 v139, v139
  v_mfma_f32_16x16x32_bf16 a[68:71], a[148:151], v[100:103], a[68:71]
  ds_read_b64_tr_b16 a[130:131], v20 offset:28672
  v_add_f32 v35, v35, v148
  v_mfma_f32_16x16x32_bf16 a[68:71], a[144:147], v[180:183], a[68:71]
  v_exp_f32 v152, v152
  v_mfma_f32_16x16x32_bf16 a[72:75], a[144:147], v[184:187], a[72:75]
  ds_read_b64_tr_b16 a[132:133], v20 offset:32768
  v_add_f32 v35, v35, v149
  v_mfma_f32_16x16x32_bf16 a[72:75], a[148:151], v[104:107], a[72:75]
  ds_read_b64_tr_b16 a[134:135], v20 offset:36864
  v_cvt_pk_bf16_f32 v134, v148, v149
  v_mfma_f32_16x16x32_bf16 a[76:79], a[148:151], v[108:111], a[76:79]
  v_exp_f32 v153, v153
  v_mfma_f32_16x16x32_bf16 a[76:79], a[144:147], v[188:191], a[76:79]
  s_waitcnt lgkmcnt(4)
  buffer_load_dwordx4 v[64:67], v26, s[16:19], s67 offen offset:2048 sc1
  v_mfma_f32_16x16x32_bf16 a[80:83], a[152:155], v[176:179], a[80:83]
  v_exp_f32 v154, v154
  v_mfma_f32_16x16x32_bf16 a[80:83], a[156:159], v[96:99], a[80:83]
  ds_read_b64_tr_b16 a[136:137], v21 offset:24576
  v_add_f32 v35, v35, v150
  v_mfma_f32_16x16x32_bf16 a[84:87], a[156:159], v[100:103], a[84:87]
  v_exp_f32 v155, v155
  v_mfma_f32_16x16x32_bf16 a[84:87], a[152:155], v[180:183], a[84:87]
  ds_read_b64_tr_b16 a[138:139], v21 offset:28672
  v_add_f32 v35, v35, v151
  v_mfma_f32_16x16x32_bf16 a[88:91], a[152:155], v[184:187], a[88:91]
  ds_read_b64_tr_b16 a[140:141], v21 offset:32768
  v_cvt_pk_bf16_f32 v135, v150, v151
  v_mfma_f32_16x16x32_bf16 a[88:91], a[156:159], v[104:107], a[88:91]
  v_exp_f32 v140, v140
  v_mfma_f32_16x16x32_bf16 a[92:95], a[156:159], v[108:111], a[92:95]
  ds_read_b64_tr_b16 a[142:143], v21 offset:36864
  v_add_f32 v36, v36, v136
  v_mfma_f32_16x16x32_bf16 a[92:95], a[152:155], v[188:191], a[92:95]
  s_waitcnt lgkmcnt(4)
  v_exp_f32 v141, v141
  v_mfma_f32_16x16x32_bf16 a[96:99], a[128:131], v[176:179], a[96:99]
  ds_read_b128 a[144:147], v10 offset:57344
  v_add_f32 v36, v36, v137
  v_mfma_f32_16x16x32_bf16 a[96:99], a[132:135], v[96:99], a[96:99]
  v_exp_f32 v142, v142
  v_mfma_f32_16x16x32_bf16 a[100:103], a[132:135], v[100:103], a[100:103]
  buffer_load_dwordx4 v[68:71], v26, s[16:19], s67 offen offset:3072 sc1
  v_mfma_f32_16x16x32_bf16 a[100:103], a[128:131], v[180:183], a[100:103]
  ds_read_b128 a[148:151], v11 offset:57344
  v_cvt_pk_bf16_f32 v136, v136, v137
  v_mfma_f32_16x16x32_bf16 a[104:107], a[128:131], v[184:187], a[104:107]
  v_exp_f32 v143, v143
  v_mfma_f32_16x16x32_bf16 a[104:107], a[132:135], v[104:107], a[104:107]
  ds_read_b128 a[152:155], v12 offset:57344
  v_add_f32 v36, v36, v138
  v_mfma_f32_16x16x32_bf16 a[108:111], a[132:135], v[108:111], a[108:111]
  v_exp_f32 v156, v156
  v_mfma_f32_16x16x32_bf16 a[108:111], a[128:131], v[188:191], a[108:111]
  s_waitcnt lgkmcnt(3)
  ds_read_b128 a[156:159], v13 offset:57344
  v_add_f32 v36, v36, v139
  v_mfma_f32_16x16x32_bf16 a[112:115], a[136:139], v[176:179], a[112:115]
  v_cvt_pk_bf16_f32 v137, v138, v139
  v_add_f32 v36, v36, v152
  v_mfma_f32_16x16x32_bf16 a[112:115], a[140:143], v[96:99], a[112:115]
  v_exp_f32 v157, v157
  v_mfma_f32_16x16x32_bf16 a[116:119], a[140:143], v[100:103], a[116:119]
  v_add_f32 v36, v36, v153
  v_cvt_pk_bf16_f32 v138, v152, v153
  v_mfma_f32_16x16x32_bf16 a[116:119], a[136:139], v[180:183], a[116:119]
  v_exp_f32 v158, v158
  v_mfma_f32_16x16x32_bf16 a[120:123], a[136:139], v[184:187], a[120:123]
  buffer_load_dwordx4 v[72:75], v27, s[16:19], s67 offen sc1
  v_mfma_f32_16x16x32_bf16 a[120:123], a[140:143], v[104:107], a[120:123]
  s_add_u32 s67, s67, 20480
  v_exp_f32 v159, v159
  v_mfma_f32_16x16x32_bf16 a[124:127], a[140:143], v[108:111], a[124:127]
  ds_read_b128 a[128:131], v10 offset:61440
  v_add_f32 v36, v36, v154
  v_mfma_f32_16x16x32_bf16 a[124:127], a[136:139], v[188:191], a[124:127]
  v_add_f32 v36, v36, v155
  v_cvt_pk_bf16_f32 v139, v154, v155
  v_mfma_f32_16x16x32_bf16 a[244:247], a[248:251], v[188:191], a[244:247]
  v_cvt_pk_bf16_f32 v140, v140, v141
  v_cvt_pk_bf16_f32 v141, v142, v143
  v_mfma_f32_16x16x32_bf16 a[244:247], a[248:251], v[108:111], a[244:247]
  s_waitcnt lgkmcnt(1)
  v_cvt_pk_bf16_f32 v142, v156, v157
  v_cvt_pk_bf16_f32 v143, v158, v159
  v_mfma_f32_16x16x32_bf16 v[176:179], a[144:147], v[192:195], v[40:43]
  s_waitcnt vmcnt(27)
  v_exp_f32 v160, v160
  v_mfma_f32_16x16x32_bf16 v[176:179], a[148:151], v[196:199], v[176:179]
  s_barrier
  v_mfma_f32_16x16x32_bf16 v[176:179], a[152:155], v[200:203], v[176:179]
  ds_read_b128 a[132:135], v11 offset:61440
  ds_read_b128 a[140:143], v13 offset:61440
  v_mfma_f32_16x16x32_bf16 v[176:179], a[156:159], v[204:207], v[176:179]
  v_exp_f32 v161, v161
  v_mfma_f32_16x16x32_bf16 v[180:183], a[156:159], v[220:223], v[44:47]
  ds_read_b128 a[136:139], v12 offset:61440
  v_add_f32 v34, v34, v160
  v_mfma_f32_16x16x32_bf16 v[180:183], a[152:155], v[216:219], v[180:183]
  s_add_u32 m0, s32, 32768
  v_exp_f32 v162, v162
  v_mfma_f32_16x16x32_bf16 v[180:183], a[148:151], v[212:215], v[180:183]
  buffer_load_dwordx4 v22, s[4:7], s34 offen offset:0 lds
  v_mfma_f32_16x16x32_bf16 v[180:183], a[144:147], v[208:211], v[180:183]
  v_exp_f32 v163, v163
  v_mfma_f32_16x16x32_bf16 v[184:187], a[144:147], v[224:227], v[48:51]
  v_add_f32 v34, v34, v161
  v_cvt_pk_bf16_f32 v160, v160, v161
  v_mfma_f32_16x16x32_bf16 v[184:187], a[148:151], v[228:231], v[184:187]
  v_exp_f32 v112, v112
  v_mfma_f32_16x16x32_bf16 v[184:187], a[152:155], v[232:235], v[184:187]
  v_add_f32 v34, v34, v162
  v_add_f32 v34, v34, v163
  v_mfma_f32_16x16x32_bf16 v[184:187], a[156:159], v[236:239], v[184:187]
  v_cvt_pk_bf16_f32 v161, v162, v163
  v_add_f32 v34, v34, v112
  v_mfma_f32_16x16x32_bf16 v[188:191], a[156:159], v[252:255], v[52:55]
  s_waitcnt lgkmcnt(0)
  v_exp_f32 v113, v113
  v_mfma_f32_16x16x32_bf16 v[188:191], a[152:155], v[248:251], v[188:191]
  s_waitcnt vmcnt(19)
  buffer_load_dwordx4 v23, s[4:7], s34 offen offset:1024 lds
  v_mfma_f32_16x16x32_bf16 v[188:191], a[148:151], v[244:247], v[188:191]
  s_add_u32 s34, s34, 8192
  v_exp_f32 v114, v114
  v_mfma_f32_16x16x32_bf16 v[188:191], a[144:147], v[240:243], v[188:191]
  s_and_b32 s34, s34, 0x7ffff
  ds_read_b64_tr_b16 a[144:145], v28 offset:4096
  v_add_f32 v34, v34, v113
  v_mfma_f32_16x16x32_bf16 v[144:147], a[128:131], v[192:195], v[40:43]
  v_exp_f32 v115, v115
  v_mfma_f32_16x16x32_bf16 v[144:147], a[132:135], v[196:199], v[144:147]
  ds_read_b64_tr_b16 a[146:147], v28 offset:6144
  v_cvt_pk_bf16_f32 v162, v112, v113
  v_mfma_f32_16x16x32_bf16 v[144:147], a[136:139], v[200:203], v[144:147]
  s_add_u32 m0, s32, 40960
  v_exp_f32 v164, v164
  v_mfma_f32_16x16x32_bf16 v[144:147], a[140:143], v[204:207], v[144:147]
  buffer_load_dwordx4 v22, s[4:7], s34 offen offset:0 lds
  v_mfma_f32_16x16x32_bf16 v[148:151], a[140:143], v[220:223], v[44:47]
  ds_read_b64_tr_b16 a[148:149], v29 offset:4096
  v_add_f32 v34, v34, v114
  v_mfma_f32_16x16x32_bf16 v[148:151], a[136:139], v[216:219], v[148:151]
  v_exp_f32 v165, v165
  v_mfma_f32_16x16x32_bf16 v[148:151], a[132:135], v[212:215], v[148:151]
  ds_read_b64_tr_b16 a[150:151], v29 offset:6144
  v_add_f32 v34, v34, v115
  v_mfma_f32_16x16x32_bf16 v[148:151], a[128:131], v[208:211], v[148:151]
  v_exp_f32 v166, v166
  v_mfma_f32_16x16x32_bf16 v[152:155], a[128:131], v[224:227], v[48:51]
  ds_read_b64_tr_b16 a[152:153], v30 offset:4096
  v_cvt_pk_bf16_f32 v163, v114, v115
  v_mfma_f32_16x16x32_bf16 v[152:155], a[132:135], v[228:231], v[152:155]
  v_exp_f32 v167, v167
  v_mfma_f32_16x16x32_bf16 v[152:155], a[136:139], v[232:235], v[152:155]
  buffer_load_dwordx4 v23, s[4:7], s34 offen offset:1024 lds
  v_mfma_f32_16x16x32_bf16 v[152:155], a[140:143], v[236:239], v[152:155]
  s_add_u32 s34, s34, 8192
  v_exp_f32 v116, v116
  v_mfma_f32_16x16x32_bf16 v[156:159], a[140:143], v[252:255], v[52:55]
  s_and_b32 s34, s34, 0x7ffff
  ds_read_b64_tr_b16 a[154:155], v30 offset:6144
  v_add_f32 v35, v35, v164
  v_mfma_f32_16x16x32_bf16 v[156:159], a[136:139], v[248:251], v[156:159]
  v_exp_f32 v117, v117
  v_mfma_f32_16x16x32_bf16 v[156:159], a[132:135], v[244:247], v[156:159]
  s_add_u32 m0, s33, 8192
  ds_read_b64_tr_b16 a[156:157], v31 offset:4096
  v_add_f32 v35, v35, v165
  v_mfma_f32_16x16x32_bf16 v[156:159], a[128:131], v[240:243], v[156:159]
  s_waitcnt lgkmcnt(5)
  buffer_load_dwordx4 v24, s[8:11], s35 offen offset:0 lds
  v_mfma_f32_16x16x32_bf16 a[160:163], a[144:147], v[76:79], a[160:163]
  v_exp_f32 v118, v118
  v_mfma_f32_16x16x32_bf16 a[164:167], a[144:147], v[80:83], a[164:167]
  ds_read_b64_tr_b16 a[158:159], v31 offset:6144
  v_cvt_pk_bf16_f32 v164, v164, v165
  v_mfma_f32_16x16x32_bf16 a[168:171], a[144:147], v[84:87], a[168:171]
  v_exp_f32 v119, v119
  v_mfma_f32_16x16x32_bf16 a[172:175], a[144:147], v[88:91], a[172:175]
  ds_read_b128 a[128:131], v10 offset:0
  v_add_f32 v35, v35, v166
  v_mfma_f32_16x16x32_bf16 a[176:179], a[144:147], v[92:95], a[176:179]
  s_waitcnt lgkmcnt(5)
  v_exp_f32 v168, v168
  v_mfma_f32_16x16x32_bf16 a[180:183], a[148:151], v[76:79], a[180:183]
  buffer_load_dwordx4 v25, s[8:11], s35 offen offset:1024 lds
  v_mfma_f32_16x16x32_bf16 a[184:187], a[148:151], v[80:83], a[184:187]
  s_add_u32 s35, s35, 8192
  v_exp_f32 v169, v169
  v_mfma_f32_16x16x32_bf16 a[188:191], a[148:151], v[84:87], a[188:191]
  s_and_b32 s35, s35, 0x7ffff
  ds_read_b128 a[132:135], v11 offset:0
  v_add_f32 v35, v35, v167
  v_mfma_f32_16x16x32_bf16 a[192:195], a[148:151], v[88:91], a[192:195]
  ds_read_b128 a[136:139], v12 offset:0
  v_cvt_pk_bf16_f32 v165, v166, v167
  v_mfma_f32_16x16x32_bf16 a[196:199], a[148:151], v[92:95], a[196:199]
  s_waitcnt lgkmcnt(5)
  v_exp_f32 v170, v170
  v_mfma_f32_16x16x32_bf16 a[200:203], a[152:155], v[76:79], a[200:203]
  ds_read_b128 a[140:143], v13 offset:0
  v_add_f32 v35, v35, v116
  v_mfma_f32_16x16x32_bf16 a[204:207], a[152:155], v[80:83], a[204:207]
  s_add_u32 m0, s33, 16384
  v_exp_f32 v171, v171
  v_mfma_f32_16x16x32_bf16 a[208:211], a[152:155], v[84:87], a[208:211]
  buffer_load_dwordx4 v24, s[8:11], s35 offen offset:0 lds
  v_mfma_f32_16x16x32_bf16 a[212:215], a[152:155], v[88:91], a[212:215]
  v_exp_f32 v120, v120
  v_mfma_f32_16x16x32_bf16 a[216:219], a[152:155], v[92:95], a[216:219]
  s_waitcnt lgkmcnt(4)
  ds_read_b128 a[144:147], v10 offset:4096
  v_add_f32 v35, v35, v117
  v_mfma_f32_16x16x32_bf16 a[220:223], a[156:159], v[76:79], a[220:223]
  v_exp_f32 v121, v121
  v_mfma_f32_16x16x32_bf16 a[224:227], a[156:159], v[80:83], a[224:227]
  ds_read_b128 a[148:151], v11 offset:4096
  v_cvt_pk_bf16_f32 v166, v116, v117
  v_mfma_f32_16x16x32_bf16 a[228:231], a[156:159], v[84:87], a[228:231]
  v_exp_f32 v122, v122
  v_mfma_f32_16x16x32_bf16 a[232:235], a[156:159], v[88:91], a[232:235]
  s_waitcnt lgkmcnt(2)
  buffer_load_dwordx4 v25, s[8:11], s35 offen offset:1024 lds
  v_mfma_f32_16x16x32_bf16 a[236:239], a[156:159], v[92:95], a[236:239]
  s_add_u32 s35, s35, 8192
  ds_read_b128 a[152:155], v12 offset:4096
  v_add_f32 v35, v35, v118
  v_mfma_f32_16x16x32_bf16 v[96:99], a[128:131], v[192:195], v[40:43]
  s_and_b32 s35, s35, 0x7ffff
  v_exp_f32 v123, v123
  v_mfma_f32_16x16x32_bf16 v[96:99], a[132:135], v[196:199], v[96:99]
  ds_read_b128 a[156:159], v13 offset:4096
  v_add_f32 v35, v35, v119
  v_mfma_f32_16x16x32_bf16 v[96:99], a[136:139], v[200:203], v[96:99]
  v_exp_f32 v172, v172
  v_mfma_f32_16x16x32_bf16 v[96:99], a[140:143], v[204:207], v[96:99]
  v_cvt_pk_bf16_f32 v167, v118, v119
  v_add_f32 v36, v36, v168
  v_mfma_f32_16x16x32_bf16 v[100:103], a[140:143], v[220:223], v[44:47]
  v_exp_f32 v173, v173
  v_mfma_f32_16x16x32_bf16 v[100:103], a[136:139], v[216:219], v[100:103]
  global_load_dword v7, v0, s[62:63]
  v_mfma_f32_16x16x32_bf16 v[100:103], a[132:135], v[212:215], v[100:103]
  v_exp_f32 v174, v174
  v_mfma_f32_16x16x32_bf16 v[100:103], a[128:131], v[208:211], v[100:103]
  v_add_f32 v36, v36, v169
  v_cvt_pk_bf16_f32 v168, v168, v169
  v_mfma_f32_16x16x32_bf16 v[104:107], a[128:131], v[224:227], v[48:51]
  v_add_f32 v36, v36, v170
  v_add_f32 v36, v36, v171
  v_mfma_f32_16x16x32_bf16 v[104:107], a[132:135], v[228:231], v[104:107]
  v_exp_f32 v175, v175
  v_mfma_f32_16x16x32_bf16 v[104:107], a[136:139], v[232:235], v[104:107]
  v_cvt_pk_bf16_f32 v169, v170, v171
  v_add_f32 v36, v36, v120
  v_mfma_f32_16x16x32_bf16 v[104:107], a[140:143], v[236:239], v[104:107]
  s_add_u32 m0, s69, 4096
  v_exp_f32 v124, v124
  v_mfma_f32_16x16x32_bf16 v[108:111], a[140:143], v[252:255], v[52:55]
  buffer_load_dwordx4 v32, s[12:15], s66 offen lds
  v_mfma_f32_16x16x32_bf16 v[108:111], a[136:139], v[248:251], v[108:111]
  s_add_u32 s66, s66, s68
  v_exp_f32 v125, v125
  v_mfma_f32_16x16x32_bf16 v[108:111], a[132:135], v[244:247], v[108:111]
  ds_read_b64_tr_b16 a[132:133], v14 offset:49152
  v_add_f32 v36, v36, v121
  v_mfma_f32_16x16x32_bf16 v[108:111], a[128:131], v[240:243], v[108:111]
  s_waitcnt lgkmcnt(1)
  v_exp_f32 v126, v126
  v_mfma_f32_16x16x32_bf16 v[112:115], a[144:147], v[192:195], v[40:43]
  ds_read_b64_tr_b16 a[128:129], v14 offset:40960
  v_cvt_pk_bf16_f32 v170, v120, v121
  v_mfma_f32_16x16x32_bf16 v[112:115], a[148:151], v[196:199], v[112:115]
  v_exp_f32 v127, v127
  v_mfma_f32_16x16x32_bf16 v[112:115], a[152:155], v[200:203], v[112:115]
  ds_read_b64_tr_b16 a[130:131], v14 offset:45056
  v_add_f32 v36, v36, v122
  v_mfma_f32_16x16x32_bf16 v[112:115], a[156:159], v[204:207], v[112:115]
  ds_read_b64_tr_b16 a[134:135], v14 offset:53248
  v_add_f32 v36, v36, v123
  v_mfma_f32_16x16x32_bf16 v[116:119], a[156:159], v[220:223], v[44:47]
  v_exp_f32 v176, v176
  v_mfma_f32_16x16x32_bf16 v[116:119], a[152:155], v[216:219], v[116:119]
  ds_read_b64_tr_b16 a[136:137], v15 offset:40960
  v_cvt_pk_bf16_f32 v171, v122, v123
  v_mfma_f32_16x16x32_bf16 v[116:119], a[148:151], v[212:215], v[116:119]
  s_add_u32 m0, s69, 5120
  v_exp_f32 v177, v177
  v_mfma_f32_16x16x32_bf16 v[116:119], a[144:147], v[208:211], v[116:119]
  buffer_load_dwordx4 v32, s[12:15], s66 offen lds
  v_mfma_f32_16x16x32_bf16 v[120:123], a[144:147], v[224:227], v[48:51]
  s_add_u32 s66, s66, s68
  v_exp_f32 v178, v178
  v_mfma_f32_16x16x32_bf16 v[120:123], a[148:151], v[228:231], v[120:123]
  ds_read_b64_tr_b16 a[138:139], v15 offset:45056
  v_cvt_pk_bf16_f32 v172, v172, v173
  v_mfma_f32_16x16x32_bf16 v[120:123], a[152:155], v[232:235], v[120:123]
  ds_read_b64_tr_b16 a[140:141], v15 offset:49152
  v_cvt_pk_bf16_f32 v173, v174, v175
  v_mfma_f32_16x16x32_bf16 v[120:123], a[156:159], v[236:239], v[120:123]
  v_exp_f32 v179, v179
  v_cvt_pk_bf16_f32 v174, v124, v125
  v_cvt_pk_bf16_f32 v175, v126, v127
  v_mfma_f32_16x16x32_bf16 v[124:127], a[156:159], v[252:255], v[52:55]
  ds_read_b64_tr_b16 a[142:143], v15 offset:53248
  v_add_f32 v34, v34, v176
  v_mfma_f32_16x16x32_bf16 v[124:127], a[152:155], v[248:251], v[124:127]
  v_exp_f32 v144, v144
  v_mfma_f32_16x16x32_bf16 v[124:127], a[148:151], v[244:247], v[124:127]
  ds_read_b64_tr_b16 a[148:149], v16 offset:49152
  v_add_f32 v34, v34, v177
  v_mfma_f32_16x16x32_bf16 v[124:127], a[144:147], v[240:243], v[124:127]
  s_waitcnt lgkmcnt(5)
  ds_read_b64_tr_b16 a[144:145], v16 offset:40960
  v_cvt_pk_bf16_f32 v176, v176, v177
  v_mfma_f32_16x16x32_bf16 a[0:3], a[128:131], v[128:131], a[0:3]
  s_add_u32 m0, s69, 6144
  v_exp_f32 v145, v145
  v_mfma_f32_16x16x32_bf16 a[0:3], a[132:135], v[160:163], a[0:3]
  buffer_load_dwordx4 v32, s[12:15], s66 offen lds
  v_mfma_f32_16x16x32_bf16 a[4:7], a[132:135], v[164:167], a[4:7]
  s_add_u32 s66, s66, s68
  v_exp_f32 v146, v146
  v_mfma_f32_16x16x32_bf16 a[4:7], a[128:131], v[132:135], a[4:7]
  ds_read_b64_tr_b16 a[146:147], v16 offset:45056
  v_add_f32 v34, v34, v178
  v_mfma_f32_16x16x32_bf16 a[8:11], a[128:131], v[136:139], a[8:11]
  v_exp_f32 v147, v147
  v_mfma_f32_16x16x32_bf16 a[8:11], a[132:135], v[168:171], a[8:11]
  ds_read_b64_tr_b16 a[150:151], v16 offset:53248
  v_add_f32 v34, v34, v179
  v_mfma_f32_16x16x32_bf16 a[12:15], a[132:135], v[172:175], a[12:15]
  ds_read_b64_tr_b16 a[152:153], v17 offset:40960
  v_cvt_pk_bf16_f32 v177, v178, v179
  v_mfma_f32_16x16x32_bf16 a[12:15], a[128:131], v[140:143], a[12:15]
  s_waitcnt lgkmcnt(5)
  v_exp_f32 v180, v180
  v_mfma_f32_16x16x32_bf16 a[16:19], a[136:139], v[128:131], a[16:19]
  ds_read_b64_tr_b16 a[154:155], v17 offset:45056
  v_add_f32 v34, v34, v144
  v_mfma_f32_16x16x32_bf16 a[16:19], a[140:143], v[160:163], a[16:19]
  s_add_u32 m0, s69, 7168
  v_exp_f32 v181, v181
  v_mfma_f32_16x16x32_bf16 a[20:23], a[140:143], v[164:167], a[20:23]
  buffer_load_dwordx4 v32, s[12:15], s66 offen lds
  v_mfma_f32_16x16x32_bf16 a[20:23], a[136:139], v[132:135], a[20:23]
  s_add_u32 s66, s66, s70
  v_exp_f32 v182, v182
  v_mfma_f32_16x16x32_bf16 a[24:27], a[136:139], v[136:139], a[24:27]
  ds_read_b64_tr_b16 a[156:157], v17 offset:49152
  v_add_f32 v34, v34, v145
  v_mfma_f32_16x16x32_bf16 a[24:27], a[140:143], v[168:171], a[24:27]
  ds_read_b64_tr_b16 a[158:159], v17 offset:53248
  v_cvt_pk_bf16_f32 v178, v144, v145
  v_mfma_f32_16x16x32_bf16 a[28:31], a[140:143], v[172:175], a[28:31]
  v_exp_f32 v183, v183
  v_mfma_f32_16x16x32_bf16 a[28:31], a[136:139], v[140:143], a[28:31]
  s_waitcnt lgkmcnt(4)
  ds_read_b64_tr_b16 a[128:129], v18 offset:40960
  v_add_f32 v34, v34, v146
  v_mfma_f32_16x16x32_bf16 a[32:35], a[144:147], v[128:131], a[32:35]
  v_exp_f32 v148, v148
  v_mfma_f32_16x16x32_bf16 a[32:35], a[148:151], v[160:163], a[32:35]
  ds_read_b64_tr_b16 a[130:131], v18 offset:45056
  v_add_f32 v34, v34, v147
  v_mfma_f32_16x16x32_bf16 a[36:39], a[148:151], v[164:167], a[36:39]
  ds_read_b64_tr_b16 a[132:133], v18 offset:49152
  v_cvt_pk_bf16_f32 v179, v146, v147
  v_mfma_f32_16x16x32_bf16 a[36:39], a[144:147], v[132:135], a[36:39]
  v_exp_f32 v149, v149
  v_mfma_f32_16x16x32_bf16 a[40:43], a[144:147], v[136:139], a[40:43]
  buffer_load_dwordx4 v[76:79], v26, s[16:19], s67 offen offset:0 sc1
  v_mfma_f32_16x16x32_bf16 a[40:43], a[148:151], v[168:171], a[40:43]
  v_exp_f32 v150, v150
  v_mfma_f32_16x16x32_bf16 a[44:47], a[148:151], v[172:175], a[44:47]
  ds_read_b64_tr_b16 a[134:135], v18 offset:53248
  v_add_f32 v35, v35, v180
  v_mfma_f32_16x16x32_bf16 a[44:47], a[144:147], v[140:143], a[44:47]
  s_waitcnt lgkmcnt(4)
  v_exp_f32 v151, v151
  v_mfma_f32_16x16x32_bf16 a[48:51], a[152:155], v[128:131], a[48:51]
  ds_read_b64_tr_b16 a[136:137], v19 offset:40960
  v_add_f32 v35, v35, v181
  v_mfma_f32_16x16x32_bf16 a[48:51], a[156:159], v[160:163], a[48:51]
  ds_read_b64_tr_b16 a[138:139], v19 offset:45056
  v_cvt_pk_bf16_f32 v180, v180, v181
  v_mfma_f32_16x16x32_bf16 a[52:55], a[156:159], v[164:167], a[52:55]
  v_exp_f32 v184, v184
  v_mfma_f32_16x16x32_bf16 a[52:55], a[152:155], v[132:135], a[52:55]
  ds_read_b64_tr_b16 a[140:141], v19 offset:49152
  v_add_f32 v35, v35, v182
  v_mfma_f32_16x16x32_bf16 a[56:59], a[152:155], v[136:139], a[56:59]
  v_exp_f32 v185, v185
  v_mfma_f32_16x16x32_bf16 a[56:59], a[156:159], v[168:171], a[56:59]
  ds_read_b64_tr_b16 a[142:143], v19 offset:53248
  v_add_f32 v35, v35, v183
  v_mfma_f32_16x16x32_bf16 a[60:63], a[156:159], v[172:175], a[60:63]
  v_exp_f32 v186, v186
  v_mfma_f32_16x16x32_bf16 a[60:63], a[152:155], v[140:143], a[60:63]
  s_waitcnt lgkmcnt(4)
  buffer_load_dwordx4 v[80:83], v26, s[16:19], s67 offen offset:1024 sc1
  v_mfma_f32_16x16x32_bf16 a[64:67], a[128:131], v[128:131], a[64:67]
  ds_read_b64_tr_b16 a[144:145], v20 offset:40960
  v_cvt_pk_bf16_f32 v181, v182, v183
  v_mfma_f32_16x16x32_bf16 a[64:67], a[132:135], v[160:163], a[64:67]
  v_exp_f32 v187, v187
  v_mfma_f32_16x16x32_bf16 a[68:71], a[132:135], v[164:167], a[68:71]
  ds_read_b64_tr_b16 a[146:147], v20 offset:45056
  v_add_f32 v35, v35, v148
  v_mfma_f32_16x16x32_bf16 a[68:71], a[128:131], v[132:135], a[68:71]
  v_exp_f32 v152, v152
  v_mfma_f32_16x16x32_bf16 a[72:75], a[128:131], v[136:139], a[72:75]
  ds_read_b64_tr_b16 a[148:149], v20 offset:49152
  v_add_f32 v35, v35, v149
  v_mfma_f32_16x16x32_bf16 a[72:75], a[132:135], v[168:171], a[72:75]
  ds_read_b64_tr_b16 a[150:151], v20 offset:53248
  v_cvt_pk_bf16_f32 v182, v148, v149
  v_mfma_f32_16x16x32_bf16 a[76:79], a[132:135], v[172:175], a[76:79]
  v_exp_f32 v153, v153
  v_mfma_f32_16x16x32_bf16 a[76:79], a[128:131], v[140:143], a[76:79]
  s_waitcnt lgkmcnt(4)
  buffer_load_dwordx4 v[84:87], v26, s[16:19], s67 offen offset:2048 sc1
  v_mfma_f32_16x16x32_bf16 a[80:83], a[136:139], v[128:131], a[80:83]
  v_exp_f32 v154, v154
  v_mfma_f32_16x16x32_bf16 a[80:83], a[140:143], v[160:163], a[80:83]
  ds_read_b64_tr_b16 a[152:153], v21 offset:40960
  v_add_f32 v35, v35, v150
  v_mfma_f32_16x16x32_bf16 a[84:87], a[140:143], v[164:167], a[84:87]
  v_exp_f32 v155, v155
  v_mfma_f32_16x16x32_bf16 a[84:87], a[136:139], v[132:135], a[84:87]
  ds_read_b64_tr_b16 a[154:155], v21 offset:45056
  v_add_f32 v35, v35, v151
  v_mfma_f32_16x16x32_bf16 a[88:91], a[136:139], v[136:139], a[88:91]
  ds_read_b64_tr_b16 a[156:157], v21 offset:49152
  v_cvt_pk_bf16_f32 v183, v150, v151
  v_mfma_f32_16x16x32_bf16 a[88:91], a[140:143], v[168:171], a[88:91]
  v_exp_f32 v188, v188
  v_mfma_f32_16x16x32_bf16 a[92:95], a[140:143], v[172:175], a[92:95]
  ds_read_b64_tr_b16 a[158:159], v21 offset:53248
  v_add_f32 v36, v36, v184
  v_mfma_f32_16x16x32_bf16 a[92:95], a[136:139], v[140:143], a[92:95]
  s_waitcnt lgkmcnt(4)
  v_exp_f32 v189, v189
  v_mfma_f32_16x16x32_bf16 a[96:99], a[144:147], v[128:131], a[96:99]
  ds_read_b128 a[128:131], v10 offset:8192
  v_add_f32 v36, v36, v185
  v_mfma_f32_16x16x32_bf16 a[96:99], a[148:151], v[160:163], a[96:99]
  v_exp_f32 v190, v190
  v_mfma_f32_16x16x32_bf16 a[100:103], a[148:151], v[164:167], a[100:103]
  buffer_load_dwordx4 v[88:91], v26, s[16:19], s67 offen offset:3072 sc1
  v_mfma_f32_16x16x32_bf16 a[100:103], a[144:147], v[132:135], a[100:103]
  ds_read_b128 a[132:135], v11 offset:8192
  v_cvt_pk_bf16_f32 v184, v184, v185
  v_mfma_f32_16x16x32_bf16 a[104:107], a[144:147], v[136:139], a[104:107]
  v_exp_f32 v191, v191
  v_mfma_f32_16x16x32_bf16 a[104:107], a[148:151], v[168:171], a[104:107]
  ds_read_b128 a[136:139], v12 offset:8192
  v_add_f32 v36, v36, v186
  v_mfma_f32_16x16x32_bf16 a[108:111], a[148:151], v[172:175], a[108:111]
  s_sub_u32 s36, s36, 1
  v_exp_f32 v156, v156
  v_mfma_f32_16x16x32_bf16 a[108:111], a[144:147], v[140:143], a[108:111]
  s_waitcnt lgkmcnt(3)
  ds_read_b128 a[140:143], v13 offset:8192
  v_add_f32 v36, v36, v187
  v_mfma_f32_16x16x32_bf16 a[112:115], a[152:155], v[128:131], a[112:115]
  v_cvt_pk_bf16_f32 v185, v186, v187
  v_add_f32 v36, v36, v152
  v_mfma_f32_16x16x32_bf16 a[112:115], a[156:159], v[160:163], a[112:115]
  v_exp_f32 v157, v157
  v_mfma_f32_16x16x32_bf16 a[116:119], a[156:159], v[164:167], a[116:119]
  v_add_f32 v36, v36, v153
  v_cvt_pk_bf16_f32 v186, v152, v153
  v_mfma_f32_16x16x32_bf16 a[116:119], a[152:155], v[132:135], a[116:119]
  v_exp_f32 v158, v158
  v_mfma_f32_16x16x32_bf16 a[120:123], a[152:155], v[136:139], a[120:123]
  buffer_load_dwordx4 v[92:95], v27, s[16:19], s67 offen sc1
  v_mfma_f32_16x16x32_bf16 a[120:123], a[156:159], v[168:171], a[120:123]
  s_add_u32 s67, s67, 20480
  v_exp_f32 v159, v159
  v_mfma_f32_16x16x32_bf16 a[124:127], a[156:159], v[172:175], a[124:127]
  ds_read_b128 a[144:147], v10 offset:12288
  v_add_f32 v36, v36, v154
  v_mfma_f32_16x16x32_bf16 a[124:127], a[152:155], v[140:143], a[124:127]
  v_add_f32 v36, v36, v155
  v_cvt_pk_bf16_f32 v187, v154, v155
  v_mfma_f32_16x16x32_bf16 a[244:247], a[248:251], v[140:143], a[244:247]
  v_cvt_pk_bf16_f32 v188, v188, v189
  v_cvt_pk_bf16_f32 v189, v190, v191
  v_mfma_f32_16x16x32_bf16 a[244:247], a[248:251], v[172:175], a[244:247]
  s_waitcnt lgkmcnt(1)
  v_cvt_pk_bf16_f32 v190, v156, v157
  v_cvt_pk_bf16_f32 v191, v158, v159
  s_cmp_lg_u32 s36, 0
  s_cbranch_scc1 LOOP_A
L_M1EPI:
  s_mov_b32 s24, s54
  s_and_b32 s25, s55, 0xffff
  s_mov_b32 s26, 3456
  s_mov_b32 s27, 0x20000
  v_lshrrev_b32 v5, 4, v2
  v_lshlrev_b32 v5, 3, v5
  s_lshr_b32 s38, s72, 3
  s_lshl_b32 s38, s38, 7
  buffer_load_dwordx2 v[160:161], v5, s[24:27], s38 offen offset:0
  buffer_load_dwordx2 v[162:163], v5, s[24:27], s38 offen offset:32
  buffer_load_dwordx2 v[164:165], v5, s[24:27], s38 offen offset:64
  buffer_load_dwordx2 v[166:167], v5, s[24:27], s38 offen offset:96
  s_lshl_b32 s39, s28, 10
  v_add_u32 v6, s39, v26
  v_add_u32 v8, 114688, v6
  v_add_u32 v6, 49152, v6
  s_waitcnt vmcnt(4)
  s_barrier
  ds_write_b128 v8, a[160:163] offset:16384
  s_add_u32 s38, s28, 0
  s_cmp_ge_u32 s38, 5
  s_cselect_b32 s39, 5, 0
  s_add_u32 s38, s38, s39
  ds_write_b128 v8, a[164:167] offset:20480
  s_add_u32 s76, s38, 0
  s_cmp_ge_u32 s76, 8
  s_cselect_b32 s79, 14, 32
  s_cmp_ge_u32 s76, 16
  s_cselect_b32 s79, -4, s79
  ds_write_b128 v8, a[168:171] offset:24576
  s_add_u32 s76, s76, s79
  s_lshl_b32 s76, s76, 12
  s_add_u32 s77, s38, 5
  ds_write_b128 v8, a[172:175] offset:28672
  s_cmp_ge_u32 s77, 8
  s_cselect_b32 s79, 14, 32
  s_cmp_ge_u32 s77, 16
  s_cselect_b32 s79, -4, s79
  s_add_u32 s77, s77, s79
  ds_write_b128 v8, a[176:179] offset:32768
  s_lshl_b32 s77, s77, 12
  s_add_u32 s38, s28, 4
  s_cmp_ge_u32 s38, 5
  s_cselect_b32 s39, 5, 0
  ds_write_b128 v8, a[180:183] offset:36864
  s_add_u32 s38, s38, s39
  s_add_u32 s67, s38, 0
  s_cmp_ge_u32 s67, 8
  s_cselect_b32 s79, 14, 32
  ds_write_b128 v8, a[184:187] offset:40960
  s_cmp_ge_u32 s67, 16
  s_cselect_b32 s79, -4, s79
  s_add_u32 s67, s67, s79
  s_lshl_b32 s67, s67, 12
  ds_write_b128 v8, a[188:191] offset:45056
  s_add_u32 s70, s38, 5
  s_cmp_ge_u32 s70, 8
  s_cselect_b32 s79, 14, 32
  s_cmp_ge_u32 s70, 16
  s_cselect_b32 s79, -4, s79
  ds_write_b128 v6, a[192:195] offset:40960
  s_add_u32 s70, s70, s79
  s_lshl_b32 s70, s70, 12
  s_add_u32 s38, s28, 8
  ds_write_b128 v6, a[196:199] offset:45056
  s_cmp_ge_u32 s38, 5
  s_cselect_b32 s39, 5, 0
  s_add_u32 s38, s38, s39
  s_add_u32 s71, s38, 0
  ds_write_b128 v6, a[200:203] offset:49152
  s_cmp_ge_u32 s71, 8
  s_cselect_b32 s79, 14, 32
  s_cmp_ge_u32 s71, 16
  s_cselect_b32 s79, -4, s79
  s_add_u32 s71, s71, s79
  ds_write_b128 v6, a[204:207] offset:53248
  s_lshl_b32 s71, s71, 12
  s_add_u32 s3, s38, 5
  s_cmp_ge_u32 s3, 8
  s_cselect_b32 s79, 14, 32
  ds_write_b128 v6, a[208:211] offset:57344
  s_cmp_ge_u32 s3, 16
  s_cselect_b32 s79, -4, s79
  s_add_u32 s3, s3, s79
  s_lshl_b32 s3, s3, 12
  ds_write_b128 v6, a[212:215] offset:61440
  s_mov_b32 s68, 0xbdd2d3e8
  s_mov_b32 s69, 0xbdd2d3e8
  s_mul_i32 s66, s73, 54
  ds_write_b128 v8, a[216:219] offset:0
  s_lshr_b32 s79, s72, 3
  s_lshl_b32 s79, s79, 1
  s_add_u32 s66, s66, s79
  ds_write_b128 v8, a[220:223] offset:4096
  s_mul_i32 s66, s66, 5
  s_add_u32 s66, s66, s28
  s_lshl_b32 s66, s66, 10
  ds_write_b128 v6, a[224:227] offset:0
  s_add_u32 s66, s66, 6291456
  s_cmp_lt_u32 s72, 216
  s_cselect_b32 s66, s66, 0x8000000
  ds_write_b128 v6, a[228:231] offset:4096
  ds_write_b128 v6, a[232:235] offset:8192
  ds_write_b128 v6, a[236:239] offset:12288
  v_mov_b32 v8, 0xc0135761
  v_mov_b32 v9, 0xc0135761
  s_waitcnt lgkmcnt(0)
  s_barrier
  v_add_u32 v5, s76, v26
  v_add_u32 v6, s77, v26
  ds_read_b128 v[64:67], v5 offset:0
  ds_read_b128 v[68:71], v5 offset:1024
  ds_read_b128 v[72:75], v5 offset:2048
  ds_read_b128 v[76:79], v5 offset:3072
  ds_read_b128 v[80:83], v6 offset:0
  ds_read_b128 v[84:87], v6 offset:1024
  ds_read_b128 v[88:91], v6 offset:2048
  ds_read_b128 v[92:95], v6 offset:3072
  s_waitcnt vmcnt(0)
  v_lshlrev_b32 v168, 16, v160
  v_and_b32 v169, 0xffff0000, v160
  v_lshlrev_b32 v170, 16, v161
  v_and_b32 v171, 0xffff0000, v161
  v_lshlrev_b32 v172, 16, v162
  v_and_b32 v173, 0xffff0000, v162
  v_lshlrev_b32 v174, 16, v163
  v_and_b32 v175, 0xffff0000, v163
  s_waitcnt lgkmcnt(4)
  v_pk_add_f32 v[64:65], v[64:65], v[68:69]
  v_pk_add_f32 v[72:73], v[72:73], v[76:77]
  v_pk_add_f32 v[66:67], v[66:67], v[70:71]
  v_pk_add_f32 v[74:75], v[74:75], v[78:79]
  v_pk_add_f32 v[56:57], v[64:65], v[72:73]
  v_pk_add_f32 v[58:59], v[66:67], v[74:75]
  s_waitcnt lgkmcnt(0)
  v_pk_add_f32 v[80:81], v[80:81], v[84:85]
  v_pk_add_f32 v[88:89], v[88:89], v[92:93]
  v_pk_add_f32 v[82:83], v[82:83], v[86:87]
  v_pk_add_f32 v[90:91], v[90:91], v[94:95]
  v_pk_add_f32 v[60:61], v[80:81], v[88:89]
  v_pk_add_f32 v[62:63], v[82:83], v[90:91]
  v_add_u32 v5, s67, v26
  v_add_u32 v6, s70, v26
  ds_read_b128 v[64:67], v5 offset:0
  ds_read_b128 v[68:71], v5 offset:1024
  ds_read_b128 v[72:75], v5 offset:2048
  ds_read_b128 v[76:79], v5 offset:3072
  ds_read_b128 v[80:83], v6 offset:0
  ds_read_b128 v[84:87], v6 offset:1024
  ds_read_b128 v[88:91], v6 offset:2048
  ds_read_b128 v[92:95], v6 offset:3072
  v_cvt_pk_bf16_f32 v7, v56, v57
  v_lshlrev_b32 v56, 16, v7
  v_and_b32 v57, 0xffff0000, v7
  v_cvt_pk_bf16_f32 v7, v58, v59
  v_lshlrev_b32 v58, 16, v7
  v_and_b32 v59, 0xffff0000, v7
  v_cvt_pk_bf16_f32 v7, v60, v61
  v_lshlrev_b32 v60, 16, v7
  v_and_b32 v61, 0xffff0000, v7
  v_cvt_pk_bf16_f32 v7, v62, v63
  v_lshlrev_b32 v62, 16, v7
  v_and_b32 v63, 0xffff0000, v7
  v_pk_add_f32 v[56:57], v[56:57], v[168:169]
  v_pk_add_f32 v[58:59], v[58:59], v[170:171]
  v_pk_add_f32 v[60:61], v[60:61], v[172:173]
  v_pk_add_f32 v[62:63], v[62:63], v[174:175]
  v_cvt_pk_bf16_f32 v7, v56, v57
  v_lshlrev_b32 v56, 16, v7
  v_and_b32 v57, 0xffff0000, v7
  v_cvt_pk_bf16_f32 v7, v58, v59
  v_lshlrev_b32 v58, 16, v7
  v_and_b32 v59, 0xffff0000, v7
  v_cvt_pk_bf16_f32 v7, v60, v61
  v_lshlrev_b32 v60, 16, v7
  v_and_b32 v61, 0xffff0000, v7
  v_cvt_pk_bf16_f32 v7, v62, v63
  v_lshlrev_b32 v62, 16, v7
  v_and_b32 v63, 0xffff0000, v7
  v_pk_mul_f32 v[168:169], v[56:57], v[56:57]
  v_pk_mul_f32 v[170:171], v[58:59], v[58:59]
  v_pk_mul_f32 v[172:173], v[60:61], v[60:61]
  v_pk_mul_f32 v[174:175], v[62:63], v[62:63]
  v_pk_fma_f32 v[168:169], v[168:169], s[68:69], v[8:9]
  v_pk_fma_f32 v[170:171], v[170:171], s[68:69], v[8:9]
  v_pk_fma_f32 v[172:173], v[172:173], s[68:69], v[8:9]
  v_pk_fma_f32 v[174:175], v[174:175], s[68:69], v[8:9]
  v_pk_mul_f32 v[168:169], v[168:169], v[56:57]
  v_pk_mul_f32 v[170:171], v[170:171], v[58:59]
  v_pk_mul_f32 v[172:173], v[172:173], v[60:61]
  v_pk_mul_f32 v[174:175], v[174:175], v[62:63]
  v_exp_f32 v168, v168
  v_exp_f32 v169, v169
  v_exp_f32 v170, v170
  v_exp_f32 v171, v171
  v_exp_f32 v172, v172
  v_exp_f32 v173, v173
  v_exp_f32 v174, v174
  v_exp_f32 v175, v175
  v_pk_add_f32 v[168:169], v[168:169], 1.0 op_sel_hi:[1,0]
  v_pk_add_f32 v[170:171], v[170:171], 1.0 op_sel_hi:[1,0]
  v_pk_add_f32 v[172:173], v[172:173], 1.0 op_sel_hi:[1,0]
  v_pk_add_f32 v[174:175], v[174:175], 1.0 op_sel_hi:[1,0]
  v_rcp_f32 v168, v168
  v_rcp_f32 v169, v169
  v_rcp_f32 v170, v170
  v_rcp_f32 v171, v171
  v_rcp_f32 v172, v172
  v_rcp_f32 v173, v173
  v_rcp_f32 v174, v174
  v_rcp_f32 v175, v175
  v_pk_mul_f32 v[56:57], v[56:57], v[168:169]
  v_pk_mul_f32 v[58:59], v[58:59], v[170:171]
  v_pk_mul_f32 v[60:61], v[60:61], v[172:173]
  v_pk_mul_f32 v[62:63], v[62:63], v[174:175]
  v_cvt_pk_bf16_f32 v168, v56, v57
  v_cvt_pk_bf16_f32 v169, v58, v59
  v_cvt_pk_bf16_f32 v170, v60, v61
  v_cvt_pk_bf16_f32 v171, v62, v63
  buffer_store_dwordx4 v[168:171], v26, s[20:23], s66 offen sc1
  s_add_u32 s66, s66, 4096
  s_nop 0
  s_cmp_eq_u32 s28, 0
  s_cselect_b64 vcc, -1, 0
  v_cndmask_b32 v56, v164, v160, vcc
  v_cndmask_b32 v57, v165, v161, vcc
  v_cndmask_b32 v58, v166, v162, vcc
  v_cndmask_b32 v59, v167, v163, vcc
  v_lshlrev_b32 v168, 16, v56
  v_and_b32 v169, 0xffff0000, v56
  v_lshlrev_b32 v170, 16, v57
  v_and_b32 v171, 0xffff0000, v57
  v_lshlrev_b32 v172, 16, v58
  v_and_b32 v173, 0xffff0000, v58
  v_lshlrev_b32 v174, 16, v59
  v_and_b32 v175, 0xffff0000, v59
  s_waitcnt lgkmcnt(4)
  v_pk_add_f32 v[64:65], v[64:65], v[68:69]
  v_pk_add_f32 v[72:73], v[72:73], v[76:77]
  v_pk_add_f32 v[66:67], v[66:67], v[70:71]
  v_pk_add_f32 v[74:75], v[74:75], v[78:79]
  v_pk_add_f32 v[56:57], v[64:65], v[72:73]
  v_pk_add_f32 v[58:59], v[66:67], v[74:75]
  s_waitcnt lgkmcnt(0)
  v_pk_add_f32 v[80:81], v[80:81], v[84:85]
  v_pk_add_f32 v[88:89], v[88:89], v[92:93]
  v_pk_add_f32 v[82:83], v[82:83], v[86:87]
  v_pk_add_f32 v[90:91], v[90:91], v[94:95]
  v_pk_add_f32 v[60:61], v[80:81], v[88:89]
  v_pk_add_f32 v[62:63], v[82:83], v[90:91]
  v_add_u32 v5, s71, v26
  v_add_u32 v6, s3, v26
  ds_read_b128 v[64:67], v5 offset:0
  ds_read_b128 v[68:71], v5 offset:1024
  ds_read_b128 v[72:75], v5 offset:2048
  ds_read_b128 v[76:79], v5 offset:3072
  ds_read_b128 v[80:83], v6 offset:0
  ds_read_b128 v[84:87], v6 offset:1024
  ds_read_b128 v[88:91], v6 offset:2048
  ds_read_b128 v[92:95], v6 offset:3072
  v_cvt_pk_bf16_f32 v7, v56, v57
  v_lshlrev_b32 v56, 16, v7
  v_and_b32 v57, 0xffff0000, v7
  v_cvt_pk_bf16_f32 v7, v58, v59
  v_lshlrev_b32 v58, 16, v7
  v_and_b32 v59, 0xffff0000, v7
  v_cvt_pk_bf16_f32 v7, v60, v61
  v_lshlrev_b32 v60, 16, v7
  v_and_b32 v61, 0xffff0000, v7
  v_cvt_pk_bf16_f32 v7, v62, v63
  v_lshlrev_b32 v62, 16, v7
  v_and_b32 v63, 0xffff0000, v7
  v_pk_add_f32 v[56:57], v[56:57], v[168:169]
  v_pk_add_f32 v[58:59], v[58:59], v[170:171]
  v_pk_add_f32 v[60:61], v[60:61], v[172:173]
  v_pk_add_f32 v[62:63], v[62:63], v[174:175]
  v_cvt_pk_bf16_f32 v7, v56, v57
  v_lshlrev_b32 v56, 16, v7
  v_and_b32 v57, 0xffff0000, v7
  v_cvt_pk_bf16_f32 v7, v58, v59
  v_lshlrev_b32 v58, 16, v7
  v_and_b32 v59, 0xffff0000, v7
  v_cvt_pk_bf16_f32 v7, v60, v61
  v_lshlrev_b32 v60, 16, v7
  v_and_b32 v61, 0xffff0000, v7
  v_cvt_pk_bf16_f32 v7, v62, v63
  v_lshlrev_b32 v62, 16, v7
  v_and_b32 v63, 0xffff0000, v7
  v_pk_mul_f32 v[168:169], v[56:57], v[56:57]
  v_pk_mul_f32 v[170:171], v[58:59], v[58:59]
  v_pk_mul_f32 v[172:173], v[60:61], v[60:61]
  v_pk_mul_f32 v[174:175], v[62:63], v[62:63]
  v_pk_fma_f32 v[168:169], v[168:169], s[68:69], v[8:9]
  v_pk_fma_f32 v[170:171], v[170:171], s[68:69], v[8:9]
  v_pk_fma_f32 v[172:173], v[172:173], s[68:69], v[8:9]
  v_pk_fma_f32 v[174:175], v[174:175], s[68:69], v[8:9]
  v_pk_mul_f32 v[168:169], v[168:169], v[56:57]
  v_pk_mul_f32 v[170:171], v[170:171], v[58:59]
  v_pk_mul_f32 v[172:173], v[172:173], v[60:61]
  v_pk_mul_f32 v[174:175], v[174:175], v[62:63]
  v_exp_f32 v168, v168
  v_exp_f32 v169, v169
  v_exp_f32 v170, v170
  v_exp_f32 v171, v171
  v_exp_f32 v172, v172
  v_exp_f32 v173, v173
  v_exp_f32 v174, v174
  v_exp_f32 v175, v175
  v_pk_add_f32 v[168:169], v[168:169], 1.0 op_sel_hi:[1,0]
  v_pk_add_f32 v[170:171], v[170:171], 1.0 op_sel_hi:[1,0]
  v_pk_add_f32 v[172:173], v[172:173], 1.0 op_sel_hi:[1,0]
  v_pk_add_f32 v[174:175], v[174:175], 1.0 op_sel_hi:[1,0]
  v_rcp_f32 v168, v168
  v_rcp_f32 v169, v169
  v_rcp_f32 v170, v170
  v_rcp_f32 v171, v171
  v_rcp_f32 v172, v172
  v_rcp_f32 v173, v173
  v_rcp_f32 v174, v174
  v_rcp_f32 v175, v175
  v_pk_mul_f32 v[56:57], v[56:57], v[168:169]
  v_pk_mul_f32 v[58:59], v[58:59], v[170:171]
  v_pk_mul_f32 v[60:61], v[60:61], v[172:173]
  v_pk_mul_f32 v[62:63], v[62:63], v[174:175]
  v_cvt_pk_bf16_f32 v168, v56, v57
  v_cvt_pk_bf16_f32 v169, v58, v59
  v_cvt_pk_bf16_f32 v170, v60, v61
  v_cvt_pk_bf16_f32 v171, v62, v63
  buffer_store_dwordx4 v[168:171], v26, s[20:23], s66 offen sc1
  s_add_u32 s66, s66, 4096
  s_nop 0
  s_cmp_ge_u32 s28, 2
  s_cbranch_scc1 M1_DONE
  v_lshlrev_b32 v168, 16, v164
  v_and_b32 v169, 0xffff0000, v164
  v_lshlrev_b32 v170, 16, v165
  v_and_b32 v171, 0xffff0000, v165
  v_lshlrev_b32 v172, 16, v166
  v_and_b32 v173, 0xffff0000, v166
  v_lshlrev_b32 v174, 16, v167
  v_and_b32 v175, 0xffff0000, v167
  s_waitcnt lgkmcnt(4)
  v_pk_add_f32 v[64:65], v[64:65], v[68:69]
  v_pk_add_f32 v[72:73], v[72:73], v[76:77]
  v_pk_add_f32 v[66:67], v[66:67], v[70:71]
  v_pk_add_f32 v[74:75], v[74:75], v[78:79]
  v_pk_add_f32 v[56:57], v[64:65], v[72:73]
  v_pk_add_f32 v[58:59], v[66:67], v[74:75]
  s_waitcnt lgkmcnt(0)
  v_pk_add_f32 v[80:81], v[80:81], v[84:85]
  v_pk_add_f32 v[88:89], v[88:89], v[92:93]
  v_pk_add_f32 v[82:83], v[82:83], v[86:87]
  v_pk_add_f32 v[90:91], v[90:91], v[94:95]
  v_pk_add_f32 v[60:61], v[80:81], v[88:89]
  v_pk_add_f32 v[62:63], v[82:83], v[90:91]
  v_cvt_pk_bf16_f32 v7, v56, v57
  v_lshlrev_b32 v56, 16, v7
  v_and_b32 v57, 0xffff0000, v7
  v_cvt_pk_bf16_f32 v7, v58, v59
  v_lshlrev_b32 v58, 16, v7
  v_and_b32 v59, 0xffff0000, v7
  v_cvt_pk_bf16_f32 v7, v60, v61
  v_lshlrev_b32 v60, 16, v7
  v_and_b32 v61, 0xffff0000, v7
  v_cvt_pk_bf16_f32 v7, v62, v63
  v_lshlrev_b32 v62, 16, v7
  v_and_b32 v63, 0xffff0000, v7
  v_pk_add_f32 v[56:57], v[56:57], v[168:169]
  v_pk_add_f32 v[58:59], v[58:59], v[170:171]
  v_pk_add_f32 v[60:61], v[60:61], v[172:173]
  v_pk_add_f32 v[62:63], v[62:63], v[174:175]
  v_cvt_pk_bf16_f32 v7, v56, v57
  v_lshlrev_b32 v56, 16, v7
  v_and_b32 v57, 0xffff0000, v7
  v_cvt_pk_bf16_f32 v7, v58, v59
  v_lshlrev_b32 v58, 16, v7
  v_and_b32 v59, 0xffff0000, v7
  v_cvt_pk_bf16_f32 v7, v60, v61
  v_lshlrev_b32 v60, 16, v7
  v_and_b32 v61, 0xffff0000, v7
  v_cvt_pk_bf16_f32 v7, v62, v63
  v_lshlrev_b32 v62, 16, v7
  v_and_b32 v63, 0xffff0000, v7
  v_pk_mul_f32 v[168:169], v[56:57], v[56:57]
  v_pk_mul_f32 v[170:171], v[58:59], v[58:59]
  v_pk_mul_f32 v[172:173], v[60:61], v[60:61]
  v_pk_mul_f32 v[174:175], v[62:63], v[62:63]
  v_pk_fma_f32 v[168:169], v[168:169], s[68:69], v[8:9]
  v_pk_fma_f32 v[170:171], v[170:171], s[68:69], v[8:9]
  v_pk_fma_f32 v[172:173], v[172:173], s[68:69], v[8:9]
  v_pk_fma_f32 v[174:175], v[174:175], s[68:69], v[8:9]
  v_pk_mul_f32 v[168:169], v[168:169], v[56:57]
  v_pk_mul_f32 v[170:171], v[170:171], v[58:59]
  v_pk_mul_f32 v[172:173], v[172:173], v[60:61]
  v_pk_mul_f32 v[174:175], v[174:175], v[62:63]
  v_exp_f32 v168, v168
  v_exp_f32 v169, v169
  v_exp_f32 v170, v170
  v_exp_f32 v171, v171
  v_exp_f32 v172, v172
  v_exp_f32 v173, v173
  v_exp_f32 v174, v174
  v_exp_f32 v175, v175
  v_pk_add_f32 v[168:169], v[168:169], 1.0 op_sel_hi:[1,0]
  v_pk_add_f32 v[170:171], v[170:171], 1.0 op_sel_hi:[1,0]
  v_pk_add_f32 v[172:173], v[172:173], 1.0 op_sel_hi:[1,0]
  v_pk_add_f32 v[174:175], v[174:175], 1.0 op_sel_hi:[1,0]
  v_rcp_f32 v168, v168
  v_rcp_f32 v169, v169
  v_rcp_f32 v170, v170
  v_rcp_f32 v171, v171
  v_rcp_f32 v172, v172
  v_rcp_f32 v173, v173
  v_rcp_f32 v174, v174
  v_rcp_f32 v175, v175
  v_pk_mul_f32 v[56:57], v[56:57], v[168:169]
  v_pk_mul_f32 v[58:59], v[58:59], v[170:171]
  v_pk_mul_f32 v[60:61], v[60:61], v[172:173]
  v_pk_mul_f32 v[62:63], v[62:63], v[174:175]
  v_cvt_pk_bf16_f32 v168, v56, v57
  v_cvt_pk_bf16_f32 v169, v58, v59
  v_cvt_pk_bf16_f32 v170, v60, v61
  v_cvt_pk_bf16_f32 v171, v62, v63
  buffer_store_dwordx4 v[168:171], v26, s[20:23], s66 offen sc1
  s_add_u32 s66, s66, 4096
  s_nop 0
M1_DONE:
  s_waitcnt lgkmcnt(0)
  s_lshl_b32 s69, s28, 13
  s_add_u32 s69, s69, 131072
  v_lshl_add_u32 v32, v3, 12, v4
  v_min_u32 v38, 26, v2
  s_lshl_b32 s38, s75, 5
  v_add_u32 v38, s38, v38
  v_lshlrev_b32 v38, 4, v38
  v_and_b32 v6, 31, v2
  s_lshl_b32 s38, s28, 1
  s_lshr_b32 s39, s75, 2
  s_add_u32 s38, s38, s39
  s_lshl_b32 s38, s38, 5
  v_add_u32 v6, s38, v6
  v_lshlrev_b32 v6, 4, v6
  v_mfma_f32_16x16x32_bf16 v[128:131], a[128:131], v[192:195], v[40:43]
  s_waitcnt vmcnt(63)
  v_exp_f32 v96, v96
  v_mfma_f32_16x16x32_bf16 v[128:131], a[132:135], v[196:199], v[128:131]
  s_barrier
  v_mfma_f32_16x16x32_bf16 v[128:131], a[136:139], v[200:203], v[128:131]
  v_exp_f32 v97, v97
  v_mfma_f32_16x16x32_bf16 v[128:131], a[140:143], v[204:207], v[128:131]
  ds_read_b128 a[148:151], v11 offset:12288
  v_add_f32 v34, v34, v96
  v_mfma_f32_16x16x32_bf16 v[132:135], a[140:143], v[220:223], v[44:47]
  v_exp_f32 v98, v98
  v_mfma_f32_16x16x32_bf16 v[132:135], a[136:139], v[216:219], v[132:135]
  ds_read_b128 a[152:155], v12 offset:12288
  v_add_f32 v34, v34, v97
  v_mfma_f32_16x16x32_bf16 v[132:135], a[132:135], v[212:215], v[132:135]
  v_exp_f32 v99, v99
  v_mfma_f32_16x16x32_bf16 v[132:135], a[128:131], v[208:211], v[132:135]
  ds_read_b128 a[156:159], v13 offset:12288
  v_cvt_pk_bf16_f32 v96, v96, v97
  v_mfma_f32_16x16x32_bf16 v[136:139], a[128:131], v[224:227], v[48:51]
  v_exp_f32 v112, v112
  v_mfma_f32_16x16x32_bf16 v[136:139], a[132:135], v[228:231], v[136:139]
  v_exp_f32 v113, v113
  v_mfma_f32_16x16x32_bf16 v[136:139], a[136:139], v[232:235], v[136:139]
  v_add_f32 v34, v34, v98
  v_add_f32 v34, v34, v99
  v_mfma_f32_16x16x32_bf16 v[136:139], a[140:143], v[236:239], v[136:139]
  s_add_u32 m0, s32, 49152
  v_exp_f32 v114, v114
  v_mfma_f32_16x16x32_bf16 v[140:143], a[140:143], v[252:255], v[52:55]
  buffer_load_dwordx4 v22, s[4:7], s34 offen offset:0 lds
  v_mfma_f32_16x16x32_bf16 v[140:143], a[136:139], v[248:251], v[140:143]
  v_exp_f32 v115, v115
  v_mfma_f32_16x16x32_bf16 v[140:143], a[132:135], v[244:247], v[140:143]
  ds_read_b128 a[132:135], v11 offset:16384
  v_cvt_pk_bf16_f32 v97, v98, v99
  v_mfma_f32_16x16x32_bf16 v[140:143], a[128:131], v[240:243], v[140:143]
  s_waitcnt lgkmcnt(1)
  v_exp_f32 v100, v100
  v_mfma_f32_16x16x32_bf16 v[144:147], a[144:147], v[192:195], v[40:43]
  v_exp_f32 v101, v101
  v_mfma_f32_16x16x32_bf16 v[144:147], a[148:151], v[196:199], v[144:147]
  ds_read_b128 a[128:131], v10 offset:16384
  v_add_f32 v34, v34, v112
  v_mfma_f32_16x16x32_bf16 v[144:147], a[152:155], v[200:203], v[144:147]
  v_exp_f32 v102, v102
  v_mfma_f32_16x16x32_bf16 v[144:147], a[156:159], v[204:207], v[144:147]
  ds_read_b128 a[136:139], v12 offset:16384
  v_add_f32 v34, v34, v113
  v_mfma_f32_16x16x32_bf16 v[148:151], a[156:159], v[220:223], v[44:47]
  v_exp_f32 v103, v103
  v_mfma_f32_16x16x32_bf16 v[148:151], a[152:155], v[216:219], v[148:151]
  ds_read_b128 a[140:143], v13 offset:16384
  v_cvt_pk_bf16_f32 v98, v112, v113
  v_mfma_f32_16x16x32_bf16 v[148:151], a[148:151], v[212:215], v[148:151]
  v_exp_f32 v116, v116
  v_mfma_f32_16x16x32_bf16 v[148:151], a[144:147], v[208:211], v[148:151]
  v_add_f32 v34, v34, v114
  v_add_f32 v34, v34, v115
  v_mfma_f32_16x16x32_bf16 v[152:155], a[144:147], v[224:227], v[48:51]
  v_exp_f32 v117, v117
  v_mfma_f32_16x16x32_bf16 v[152:155], a[148:151], v[228:231], v[152:155]
  v_exp_f32 v118, v118
  v_mfma_f32_16x16x32_bf16 v[152:155], a[152:155], v[232:235], v[152:155]
  v_cvt_pk_bf16_f32 v99, v114, v115
  v_add_f32 v35, v35, v100
  v_mfma_f32_16x16x32_bf16 v[152:155], a[156:159], v[236:239], v[152:155]
  v_exp_f32 v119, v119
  v_mfma_f32_16x16x32_bf16 v[156:159], a[156:159], v[252:255], v[52:55]
  ds_read_b128 a[156:159], v13 offset:20480
  v_add_f32 v35, v35, v101
  v_mfma_f32_16x16x32_bf16 v[156:159], a[152:155], v[248:251], v[156:159]
  v_exp_f32 v104, v104
  v_mfma_f32_16x16x32_bf16 v[156:159], a[148:151], v[244:247], v[156:159]
  s_waitcnt lgkmcnt(1)
  buffer_load_dwordx4 v23, s[4:7], s34 offen offset:1024 lds
  v_mfma_f32_16x16x32_bf16 v[156:159], a[144:147], v[240:243], v[156:159]
  s_add_u32 s34, s34, 8192
  v_exp_f32 v105, v105
  v_mfma_f32_16x16x32_bf16 v[160:163], a[128:131], v[192:195], v[40:43]
  s_and_b32 s34, s34, 0x7ffff
  v_exp_f32 v106, v106
  v_mfma_f32_16x16x32_bf16 v[160:163], a[132:135], v[196:199], v[160:163]
  ds_read_b128 a[144:147], v10 offset:20480
  v_cvt_pk_bf16_f32 v100, v100, v101
  v_mfma_f32_16x16x32_bf16 v[160:163], a[136:139], v[200:203], v[160:163]
  v_exp_f32 v107, v107
  v_mfma_f32_16x16x32_bf16 v[160:163], a[140:143], v[204:207], v[160:163]
  ds_read_b128 a[148:151], v11 offset:20480
  v_add_f32 v35, v35, v102
  v_mfma_f32_16x16x32_bf16 v[164:167], a[140:143], v[220:223], v[44:47]
  v_exp_f32 v120, v120
  v_mfma_f32_16x16x32_bf16 v[164:167], a[136:139], v[216:219], v[164:167]
  ds_read_b128 a[152:155], v12 offset:20480
  v_add_f32 v35, v35, v103
  v_mfma_f32_16x16x32_bf16 v[164:167], a[132:135], v[212:215], v[164:167]
  v_exp_f32 v121, v121
  v_mfma_f32_16x16x32_bf16 v[164:167], a[128:131], v[208:211], v[164:167]
  v_cvt_pk_bf16_f32 v101, v102, v103
  v_add_f32 v35, v35, v116
  v_mfma_f32_16x16x32_bf16 v[168:171], a[128:131], v[224:227], v[48:51]
  v_exp_f32 v122, v122
  v_mfma_f32_16x16x32_bf16 v[168:171], a[132:135], v[228:231], v[168:171]
  v_exp_f32 v123, v123
  v_mfma_f32_16x16x32_bf16 v[168:171], a[136:139], v[232:235], v[168:171]
  v_add_f32 v35, v35, v117
  v_cvt_pk_bf16_f32 v102, v116, v117
  v_mfma_f32_16x16x32_bf16 v[168:171], a[140:143], v[236:239], v[168:171]
  v_exp_f32 v108, v108
  v_mfma_f32_16x16x32_bf16 v[172:175], a[140:143], v[252:255], v[52:55]
  v_add_f32 v35, v35, v118
  v_add_f32 v35, v35, v119
  v_mfma_f32_16x16x32_bf16 v[172:175], a[136:139], v[248:251], v[172:175]
  v_exp_f32 v109, v109
  v_mfma_f32_16x16x32_bf16 v[172:175], a[132:135], v[244:247], v[172:175]
  ds_read_b64_tr_b16 a[132:133], v14 offset:0
  v_cvt_pk_bf16_f32 v103, v118, v119
  v_mfma_f32_16x16x32_bf16 v[172:175], a[128:131], v[240:243], v[172:175]
  s_waitcnt lgkmcnt(1)
  v_exp_f32 v110, v110
  v_mfma_f32_16x16x32_bf16 v[112:115], a[144:147], v[192:195], v[40:43]
  s_add_u32 m0, s32, 57344
  v_exp_f32 v111, v111
  v_mfma_f32_16x16x32_bf16 v[112:115], a[148:151], v[196:199], v[112:115]
  buffer_load_dwordx4 v22, s[4:7], s34 offen offset:0 lds
  v_mfma_f32_16x16x32_bf16 v[112:115], a[152:155], v[200:203], v[112:115]
  v_exp_f32 v124, v124
  v_mfma_f32_16x16x32_bf16 v[112:115], a[156:159], v[204:207], v[112:115]
  ds_read_b64_tr_b16 a[128:129], v14 offset:57344
  v_cvt_pk_bf16_f32 v104, v104, v105
  v_mfma_f32_16x16x32_bf16 v[116:119], a[156:159], v[220:223], v[44:47]
  v_exp_f32 v125, v125
  v_mfma_f32_16x16x32_bf16 v[116:119], a[152:155], v[216:219], v[116:119]
  ds_read_b64_tr_b16 a[130:131], v14 offset:61440
  v_cvt_pk_bf16_f32 v105, v106, v107
  v_mfma_f32_16x16x32_bf16 v[116:119], a[148:151], v[212:215], v[116:119]
  v_exp_f32 v126, v126
  v_mfma_f32_16x16x32_bf16 v[116:119], a[144:147], v[208:211], v[116:119]
  ds_read_b64_tr_b16 a[134:135], v14 offset:4096
  v_cvt_pk_bf16_f32 v106, v120, v121
  v_cvt_pk_bf16_f32 v107, v122, v123
  v_mfma_f32_16x16x32_bf16 v[120:123], a[144:147], v[224:227], v[48:51]
  v_exp_f32 v127, v127
  v_mfma_f32_16x16x32_bf16 v[120:123], a[148:151], v[228:231], v[120:123]
  ds_read_b64_tr_b16 a[136:137], v15 offset:57344
  v_cvt_pk_bf16_f32 v108, v108, v109
  v_mfma_f32_16x16x32_bf16 v[120:123], a[152:155], v[232:235], v[120:123]
  v_exp_f32 v128, v128
  v_mfma_f32_16x16x32_bf16 v[120:123], a[156:159], v[236:239], v[120:123]
  ds_read_b64_tr_b16 a[138:139], v15 offset:61440
  v_cvt_pk_bf16_f32 v109, v110, v111
  v_cvt_pk_bf16_f32 v110, v124, v125
  v_cvt_pk_bf16_f32 v111, v126, v127
  v_mfma_f32_16x16x32_bf16 v[124:127], a[156:159], v[252:255], v[52:55]
  v_exp_f32 v129, v129
  v_mfma_f32_16x16x32_bf16 v[124:127], a[152:155], v[248:251], v[124:127]
  ds_read_b64_tr_b16 a[140:141], v15 offset:0
  v_add_f32 v34, v34, v128
  v_mfma_f32_16x16x32_bf16 v[124:127], a[148:151], v[244:247], v[124:127]
  v_exp_f32 v130, v130
  v_mfma_f32_16x16x32_bf16 v[124:127], a[144:147], v[240:243], v[124:127]
  s_waitcnt lgkmcnt(3)
  ds_read_b64_tr_b16 a[142:143], v15 offset:4096
  ds_read_b64_tr_b16 a[150:151], v16 offset:4096
  v_mfma_f32_16x16x32_bf16 a[0:3], a[128:131], v[176:179], a[0:3]
  s_waitcnt vmcnt(3)
  v_exp_f32 v131, v131
  v_mfma_f32_16x16x32_bf16 a[0:3], a[132:135], v[96:99], a[0:3]
  s_barrier
  s_cmp_lg_u32 s28, 0
  s_cbranch_scc1 SIG_2_3785
  s_and_b32 s71, s72, 7
  s_lshl_b32 s71, s71, 9
  s_lshr_b32 vcc_lo, s72, 3
  s_lshl_b32 vcc_lo, vcc_lo, 4
  s_add_u32 s71, s71, vcc_lo
  s_add_u32 s71, s71, 14745600
  v_mov_b32 v8, s31
  v_mov_b32 v9, 0
  s_mov_b64 exec, 1
  buffer_store_dword v8, v9, s[20:23], s71 offen sc1
  s_mov_b64 exec, -1
SIG_2_3785:
  buffer_load_dwordx4 v23, s[4:7], s34 offen offset:1024 lds
  v_mfma_f32_16x16x32_bf16 a[4:7], a[132:135], v[100:103], a[4:7]
  s_add_u32 s34, s34, 8192
  v_exp_f32 v144, v144
  v_mfma_f32_16x16x32_bf16 a[4:7], a[128:131], v[180:183], a[4:7]
  s_and_b32 s34, s34, 0x7ffff
  ds_read_b64_tr_b16 a[144:145], v16 offset:57344
  v_add_f32 v34, v34, v129
  v_mfma_f32_16x16x32_bf16 a[8:11], a[128:131], v[184:187], a[8:11]
  ds_read_b64_tr_b16 a[146:147], v16 offset:61440
  v_cvt_pk_bf16_f32 v128, v128, v129
  v_mfma_f32_16x16x32_bf16 a[8:11], a[132:135], v[104:107], a[8:11]
  v_exp_f32 v145, v145
  v_mfma_f32_16x16x32_bf16 a[12:15], a[132:135], v[108:111], a[12:15]
  s_mov_b32 s12, s56
  ds_read_b64_tr_b16 a[148:149], v16 offset:0
  v_add_f32 v34, v34, v130
  v_mfma_f32_16x16x32_bf16 a[12:15], a[128:131], v[188:191], a[12:15]
  s_waitcnt lgkmcnt(4)
  v_exp_f32 v146, v146
  v_mfma_f32_16x16x32_bf16 a[16:19], a[136:139], v[176:179], a[16:19]
  s_and_b32 s13, s57, 0xffff
  ds_read_b64_tr_b16 a[156:157], v17 offset:57344
  v_add_f32 v34, v34, v131
  v_mfma_f32_16x16x32_bf16 a[16:19], a[140:143], v[96:99], a[16:19]
  s_mov_b32 s14, 7077888
  v_exp_f32 v147, v147
  v_mfma_f32_16x16x32_bf16 a[20:23], a[140:143], v[100:103], a[20:23]
  s_mul_i32 s38, s75, 276480
  ds_read_b64_tr_b16 a[158:159], v17 offset:61440
  v_cvt_pk_bf16_f32 v129, v130, v131
  v_mfma_f32_16x16x32_bf16 a[20:23], a[136:139], v[180:183], a[20:23]
  s_add_u32 s38, s38, 6291456
  v_exp_f32 v132, v132
  v_mfma_f32_16x16x32_bf16 a[24:27], a[136:139], v[184:187], a[24:27]
  s_add_u32 s16, s64, s38
  s_addc_u32 s17, s65, 0
  ds_read_b64_tr_b16 a[128:129], v17 offset:0
  v_add_f32 v34, v34, v144
  v_mfma_f32_16x16x32_bf16 a[24:27], a[140:143], v[104:107], a[24:27]
  s_and_b32 s17, s17, 0xffff
  ds_read_b64_tr_b16 a[130:131], v17 offset:4096
  v_add_f32 v34, v34, v145
  v_mfma_f32_16x16x32_bf16 a[28:31], a[140:143], v[108:111], a[28:31]
  s_add_u32 m0, s33, 24576
  v_exp_f32 v133, v133
  v_mfma_f32_16x16x32_bf16 a[28:31], a[136:139], v[188:191], a[28:31]
  s_waitcnt lgkmcnt(4)
  buffer_load_dwordx4 v24, s[8:11], s35 offen offset:0 lds
  v_mfma_f32_16x16x32_bf16 a[32:35], a[144:147], v[176:179], a[32:35]
  s_mov_b32 s18, 276480
  v_exp_f32 v134, v134
  v_mfma_f32_16x16x32_bf16 a[32:35], a[148:151], v[96:99], a[32:35]
  s_lshl_b32 s66, s28, 17
  ds_read_b64_tr_b16 a[132:133], v18 offset:57344
  v_cvt_pk_bf16_f32 v130, v144, v145
  v_mfma_f32_16x16x32_bf16 a[36:39], a[148:151], v[100:103], a[36:39]
  s_lshl_b32 s38, s74, 7
  v_exp_f32 v135, v135
  v_mfma_f32_16x16x32_bf16 a[36:39], a[144:147], v[180:183], a[36:39]
  s_add_u32 s66, s66, s38
  ds_read_b64_tr_b16 a[134:135], v18 offset:61440
  v_add_f32 v34, v34, v146
  v_mfma_f32_16x16x32_bf16 a[40:43], a[144:147], v[184:187], a[40:43]
  s_mul_i32 s67, s28, 5120
  v_exp_f32 v148, v148
  v_mfma_f32_16x16x32_bf16 a[40:43], a[148:151], v[104:107], a[40:43]
  s_mov_b32 s68, 32768
  ds_read_b64_tr_b16 a[136:137], v18 offset:0
  v_add_f32 v34, v34, v147
  v_mfma_f32_16x16x32_bf16 a[44:47], a[148:151], v[108:111], a[44:47]
  s_mov_b32 s70, 425984
  v_exp_f32 v149, v149
  v_mfma_f32_16x16x32_bf16 a[44:47], a[144:147], v[188:191], a[44:47]
  s_waitcnt lgkmcnt(3)
  ds_read_b64_tr_b16 a[138:139], v18 offset:4096
  ds_read_b64_tr_b16 a[146:147], v19 offset:4096
  v_mfma_f32_16x16x32_bf16 a[48:51], a[156:159], v[176:179], a[48:51]
  ds_read_b64_tr_b16 a[140:141], v19 offset:57344
  v_cvt_pk_bf16_f32 v131, v146, v147
  v_mfma_f32_16x16x32_bf16 a[48:51], a[128:131], v[96:99], a[48:51]
  v_exp_f32 v150, v150
  v_mfma_f32_16x16x32_bf16 a[52:55], a[128:131], v[100:103], a[52:55]
  ds_read_b64_tr_b16 a[142:143], v19 offset:61440
  v_add_f32 v35, v35, v132
  v_mfma_f32_16x16x32_bf16 a[52:55], a[156:159], v[180:183], a[52:55]
  v_exp_f32 v151, v151
  v_mfma_f32_16x16x32_bf16 a[56:59], a[156:159], v[184:187], a[56:59]
  ds_read_b64_tr_b16 a[144:145], v19 offset:0
  v_add_f32 v35, v35, v133
  v_mfma_f32_16x16x32_bf16 a[56:59], a[128:131], v[104:107], a[56:59]
  v_exp_f32 v136, v136
  v_mfma_f32_16x16x32_bf16 a[60:63], a[128:131], v[108:111], a[60:63]
  s_waitcnt lgkmcnt(4)
  buffer_load_dwordx4 v25, s[8:11], s35 offen offset:1024 lds
  v_mfma_f32_16x16x32_bf16 a[60:63], a[156:159], v[188:191], a[60:63]
  s_add_u32 s35, s35, 8192
  v_exp_f32 v137, v137
  v_mfma_f32_16x16x32_bf16 a[64:67], a[132:135], v[176:179], a[64:67]
  s_and_b32 s35, s35, 0x7ffff
  ds_read_b64_tr_b16 a[148:149], v20 offset:57344
  v_cvt_pk_bf16_f32 v132, v132, v133
  v_mfma_f32_16x16x32_bf16 a[64:67], a[136:139], v[96:99], a[64:67]
  ds_read_b64_tr_b16 a[150:151], v20 offset:61440
  v_add_f32 v35, v35, v134
  v_mfma_f32_16x16x32_bf16 a[68:71], a[136:139], v[100:103], a[68:71]
  v_exp_f32 v138, v138
  v_mfma_f32_16x16x32_bf16 a[68:71], a[132:135], v[180:183], a[68:71]
  ds_read_b64_tr_b16 a[152:153], v20 offset:0
  v_add_f32 v35, v35, v135
  v_mfma_f32_16x16x32_bf16 a[72:75], a[132:135], v[184:187], a[72:75]
  v_exp_f32 v139, v139
  v_mfma_f32_16x16x32_bf16 a[72:75], a[136:139], v[104:107], a[72:75]
  ds_read_b64_tr_b16 a[154:155], v20 offset:4096
  v_cvt_pk_bf16_f32 v133, v134, v135
  v_mfma_f32_16x16x32_bf16 a[76:79], a[136:139], v[108:111], a[76:79]
  v_exp_f32 v152, v152
  v_mfma_f32_16x16x32_bf16 a[76:79], a[132:135], v[188:191], a[76:79]
  s_waitcnt lgkmcnt(4)
  ds_read_b64_tr_b16 a[156:157], v21 offset:57344
  v_add_f32 v35, v35, v148
  v_mfma_f32_16x16x32_bf16 a[80:83], a[140:143], v[176:179], a[80:83]
  v_exp_f32 v153, v153
  v_mfma_f32_16x16x32_bf16 a[80:83], a[144:147], v[96:99], a[80:83]
  ds_read_b64_tr_b16 a[158:159], v21 offset:61440
  v_add_f32 v35, v35, v149
  v_mfma_f32_16x16x32_bf16 a[84:87], a[144:147], v[100:103], a[84:87]
  v_exp_f32 v154, v154
  v_mfma_f32_16x16x32_bf16 a[84:87], a[140:143], v[180:183], a[84:87]
  s_add_u32 m0, s33, 32768
  ds_read_b64_tr_b16 a[128:129], v21 offset:0
  v_cvt_pk_bf16_f32 v134, v148, v149
  v_mfma_f32_16x16x32_bf16 a[88:91], a[140:143], v[184:187], a[88:91]
  buffer_load_dwordx4 v24, s[8:11], s35 offen offset:0 lds
  v_mfma_f32_16x16x32_bf16 a[88:91], a[144:147], v[104:107], a[88:91]
  v_exp_f32 v155, v155
  v_mfma_f32_16x16x32_bf16 a[92:95], a[144:147], v[108:111], a[92:95]
  ds_read_b64_tr_b16 a[130:131], v21 offset:4096
  v_add_f32 v35, v35, v150
  v_mfma_f32_16x16x32_bf16 a[92:95], a[140:143], v[188:191], a[92:95]
  s_waitcnt lgkmcnt(4)
  v_exp_f32 v140, v140
  v_mfma_f32_16x16x32_bf16 a[96:99], a[148:151], v[176:179], a[96:99]
  ds_read_b128 a[132:135], v10 offset:24576
  v_add_f32 v35, v35, v151
  v_mfma_f32_16x16x32_bf16 a[96:99], a[152:155], v[96:99], a[96:99]
  v_exp_f32 v141, v141
  v_mfma_f32_16x16x32_bf16 a[100:103], a[152:155], v[100:103], a[100:103]
  ds_read_b128 a[136:139], v11 offset:24576
  v_cvt_pk_bf16_f32 v135, v150, v151
  v_mfma_f32_16x16x32_bf16 a[100:103], a[148:151], v[180:183], a[100:103]
  v_exp_f32 v142, v142
  v_mfma_f32_16x16x32_bf16 a[104:107], a[148:151], v[184:187], a[104:107]
  ds_read_b128 a[140:143], v12 offset:24576
  v_cvt_pk_bf16_f32 v136, v136, v137
  v_mfma_f32_16x16x32_bf16 a[104:107], a[152:155], v[104:107], a[104:107]
  ds_read_b128 a[144:147], v13 offset:24576
  v_cvt_pk_bf16_f32 v137, v138, v139
  v_mfma_f32_16x16x32_bf16 a[108:111], a[152:155], v[108:111], a[108:111]
  v_exp_f32 v143, v143
  v_mfma_f32_16x16x32_bf16 a[108:111], a[148:151], v[188:191], a[108:111]
  s_waitcnt lgkmcnt(4)
  v_cvt_pk_bf16_f32 v138, v152, v153
  v_cvt_pk_bf16_f32 v139, v154, v155
  v_mfma_f32_16x16x32_bf16 a[112:115], a[156:159], v[176:179], a[112:115]
  v_exp_f32 v156, v156
  v_mfma_f32_16x16x32_bf16 a[112:115], a[128:131], v[96:99], a[112:115]
  v_cvt_pk_bf16_f32 v140, v140, v141
  v_cvt_pk_bf16_f32 v141, v142, v143
  v_mfma_f32_16x16x32_bf16 a[116:119], a[128:131], v[100:103], a[116:119]
  v_exp_f32 v157, v157
  v_mfma_f32_16x16x32_bf16 a[116:119], a[156:159], v[180:183], a[116:119]
  buffer_load_dwordx4 v25, s[8:11], s35 offen offset:1024 lds
  v_mfma_f32_16x16x32_bf16 a[120:123], a[156:159], v[184:187], a[120:123]
  s_add_u32 s35, s35, 8192
  v_exp_f32 v158, v158
  v_mfma_f32_16x16x32_bf16 a[120:123], a[128:131], v[104:107], a[120:123]
  s_and_b32 s35, s35, 0x7ffff
  ds_read_b128 a[148:151], v10 offset:28672
  v_cvt_pk_bf16_f32 v142, v156, v157
  v_mfma_f32_16x16x32_bf16 a[124:127], a[128:131], v[108:111], a[124:127]
  v_exp_f32 v159, v159
  v_mfma_f32_16x16x32_bf16 a[124:127], a[156:159], v[188:191], a[124:127]
  v_cvt_pk_bf16_f32 v143, v158, v159
  v_mfma_f32_16x16x32_bf16 a[240:243], a[248:251], v[104:107], a[240:243]
  v_mfma_f32_16x16x32_bf16 a[244:247], a[248:251], v[188:191], a[244:247]
  v_mfma_f32_16x16x32_bf16 a[244:247], a[248:251], v[108:111], a[244:247]
  s_waitcnt lgkmcnt(1)
  v_mfma_f32_16x16x32_bf16 v[176:179], a[132:135], v[192:195], v[40:43]
  s_waitcnt vmcnt(63)
  v_exp_f32 v160, v160
  v_mfma_f32_16x16x32_bf16 v[176:179], a[136:139], v[196:199], v[176:179]
  s_barrier
  v_mfma_f32_16x16x32_bf16 v[176:179], a[140:143], v[200:203], v[176:179]
  v_exp_f32 v161, v161
  v_mfma_f32_16x16x32_bf16 v[176:179], a[144:147], v[204:207], v[176:179]
  ds_read_b128 a[152:155], v11 offset:28672
  ds_read_b128 a[128:131], v13 offset:28672
  v_mfma_f32_16x16x32_bf16 v[180:183], a[144:147], v[220:223], v[44:47]
  s_add_u32 m0, s78, 0
  v_exp_f32 v162, v162
  v_mfma_f32_16x16x32_bf16 v[180:183], a[140:143], v[216:219], v[180:183]
  buffer_load_dwordx4 v33, s[44:47], s42 offen lds
  v_mfma_f32_16x16x32_bf16 v[180:183], a[136:139], v[212:215], v[180:183]
  s_add_u32 s42, s42, 128
  v_exp_f32 v163, v163
  v_mfma_f32_16x16x32_bf16 v[180:183], a[132:135], v[208:211], v[180:183]
  ds_read_b128 a[156:159], v12 offset:28672
  v_add_f32 v34, v34, v160
  v_mfma_f32_16x16x32_bf16 v[184:187], a[132:135], v[224:227], v[48:51]
  v_exp_f32 v112, v112
  v_mfma_f32_16x16x32_bf16 v[184:187], a[136:139], v[228:231], v[184:187]
  s_add_u32 m0, s32, 0
  v_exp_f32 v113, v113
  v_mfma_f32_16x16x32_bf16 v[184:187], a[140:143], v[232:235], v[184:187]
  buffer_load_dwordx4 v22, s[4:7], s34 offen offset:0 lds
  v_mfma_f32_16x16x32_bf16 v[184:187], a[144:147], v[236:239], v[184:187]
  v_exp_f32 v114, v114
  v_mfma_f32_16x16x32_bf16 v[188:191], a[144:147], v[252:255], v[52:55]
  ds_read_b128 a[144:147], v13 offset:32768
  v_add_f32 v34, v34, v161
  v_mfma_f32_16x16x32_bf16 v[188:191], a[140:143], v[248:251], v[188:191]
  v_exp_f32 v115, v115
  v_mfma_f32_16x16x32_bf16 v[188:191], a[136:139], v[244:247], v[188:191]
  ds_read_b128 a[136:139], v11 offset:32768
  v_cvt_pk_bf16_f32 v160, v160, v161
  v_mfma_f32_16x16x32_bf16 v[188:191], a[132:135], v[240:243], v[188:191]
  s_waitcnt lgkmcnt(2)
  v_exp_f32 v164, v164
  v_mfma_f32_16x16x32_bf16 v[144:147], a[148:151], v[192:195], v[40:43]
  v_exp_f32 v165, v165
  v_mfma_f32_16x16x32_bf16 v[144:147], a[152:155], v[196:199], v[144:147]
  ds_read_b128 a[132:135], v10 offset:32768
  v_add_f32 v34, v34, v162
  v_mfma_f32_16x16x32_bf16 v[144:147], a[156:159], v[200:203], v[144:147]
  v_exp_f32 v166, v166
  v_mfma_f32_16x16x32_bf16 v[144:147], a[128:131], v[204:207], v[144:147]
  buffer_load_dwordx4 v23, s[4:7], s34 offen offset:1024 lds
  v_mfma_f32_16x16x32_bf16 v[148:151], a[128:131], v[220:223], v[44:47]
  s_add_u32 s34, s34, 8192
  v_exp_f32 v167, v167
  v_mfma_f32_16x16x32_bf16 v[148:151], a[156:159], v[216:219], v[148:151]
  s_and_b32 s34, s34, 0x7ffff
  ds_read_b128 a[140:143], v12 offset:32768
  v_add_f32 v34, v34, v163
  v_mfma_f32_16x16x32_bf16 v[148:151], a[152:155], v[212:215], v[148:151]
  s_mul_i32 s43, s50, 205
  v_exp_f32 v116, v116
  v_mfma_f32_16x16x32_bf16 v[148:151], a[148:151], v[208:211], v[148:151]
  s_lshr_b32 s43, s43, 10
  v_cvt_pk_bf16_f32 v161, v162, v163
  v_add_f32 v34, v34, v112
  v_mfma_f32_16x16x32_bf16 v[152:155], a[148:151], v[224:227], v[48:51]
  s_mul_i32 s43, s43, 635
  v_exp_f32 v117, v117
  v_mfma_f32_16x16x32_bf16 v[152:155], a[152:155], v[228:231], v[152:155]
  s_add_u32 m0, s32, 8192
  v_exp_f32 v118, v118
  v_mfma_f32_16x16x32_bf16 v[152:155], a[156:159], v[232:235], v[152:155]
  s_add_u32 s43, s43, s50
  buffer_load_dwordx4 v22, s[4:7], s34 offen offset:0 lds
  v_mfma_f32_16x16x32_bf16 v[152:155], a[128:131], v[236:239], v[152:155]
  s_add_u32 s43, s43, s51
  v_exp_f32 v119, v119
  v_mfma_f32_16x16x32_bf16 v[156:159], a[128:131], v[252:255], v[52:55]
  s_lshl_b32 s43, s43, 10
  ds_read_b128 a[128:131], v13 offset:36864
  v_add_f32 v34, v34, v113
  v_mfma_f32_16x16x32_bf16 v[156:159], a[156:159], v[248:251], v[156:159]
  s_add_u32 s50, s50, 4
  v_exp_f32 v168, v168
  v_mfma_f32_16x16x32_bf16 v[156:159], a[152:155], v[244:247], v[156:159]
  ds_read_b128 a[152:155], v11 offset:36864
  v_cvt_pk_bf16_f32 v162, v112, v113
  v_mfma_f32_16x16x32_bf16 v[156:159], a[148:151], v[240:243], v[156:159]
  s_waitcnt lgkmcnt(2)
  v_exp_f32 v169, v169
  v_mfma_f32_16x16x32_bf16 v[96:99], a[132:135], v[192:195], v[40:43]
  v_exp_f32 v170, v170
  v_mfma_f32_16x16x32_bf16 v[96:99], a[136:139], v[196:199], v[96:99]
  buffer_load_dwordx4 v23, s[4:7], s34 offen offset:1024 lds
  v_mfma_f32_16x16x32_bf16 v[96:99], a[140:143], v[200:203], v[96:99]
  s_add_u32 s34, s34, 8192
  v_exp_f32 v171, v171
  v_mfma_f32_16x16x32_bf16 v[96:99], a[144:147], v[204:207], v[96:99]
  s_and_b32 s34, s34, 0x7ffff
  ds_read_b128 a[148:151], v10 offset:36864
  v_add_f32 v34, v34, v114
  v_mfma_f32_16x16x32_bf16 v[100:103], a[144:147], v[220:223], v[44:47]
  v_exp_f32 v120, v120
  v_mfma_f32_16x16x32_bf16 v[100:103], a[140:143], v[216:219], v[100:103]
  ds_read_b128 a[156:159], v12 offset:36864
  v_add_f32 v34, v34, v115
  v_mfma_f32_16x16x32_bf16 v[100:103], a[136:139], v[212:215], v[100:103]
  v_exp_f32 v121, v121
  v_mfma_f32_16x16x32_bf16 v[100:103], a[132:135], v[208:211], v[100:103]
  v_cvt_pk_bf16_f32 v163, v114, v115
  v_add_f32 v35, v35, v164
  v_mfma_f32_16x16x32_bf16 v[104:107], a[132:135], v[224:227], v[48:51]
  v_exp_f32 v122, v122
  v_mfma_f32_16x16x32_bf16 v[104:107], a[136:139], v[228:231], v[104:107]
  s_add_u32 m0, s33, 40960
  v_exp_f32 v123, v123
  v_mfma_f32_16x16x32_bf16 v[104:107], a[140:143], v[232:235], v[104:107]
  buffer_load_dwordx4 v24, s[8:11], s35 offen offset:0 lds
  v_mfma_f32_16x16x32_bf16 v[104:107], a[144:147], v[236:239], v[104:107]
  v_exp_f32 v172, v172
  v_mfma_f32_16x16x32_bf16 v[108:111], a[144:147], v[252:255], v[52:55]
  ds_read_b64_tr_b16 a[146:147], v15 offset:20480
  v_add_f32 v35, v35, v165
  v_mfma_f32_16x16x32_bf16 v[108:111], a[140:143], v[248:251], v[108:111]
  v_exp_f32 v173, v173
  v_mfma_f32_16x16x32_bf16 v[108:111], a[136:139], v[244:247], v[108:111]
  ds_read_b64_tr_b16 a[136:137], v14 offset:16384
  ds_read_b64_tr_b16 a[138:139], v14 offset:20480
  v_mfma_f32_16x16x32_bf16 v[108:111], a[132:135], v[240:243], v[108:111]
  s_waitcnt lgkmcnt(3)
  v_exp_f32 v174, v174
  v_mfma_f32_16x16x32_bf16 v[112:115], a[148:151], v[192:195], v[40:43]
  v_exp_f32 v175, v175
  v_mfma_f32_16x16x32_bf16 v[112:115], a[152:155], v[196:199], v[112:115]
  buffer_load_dwordx4 v25, s[8:11], s35 offen offset:1024 lds
  v_mfma_f32_16x16x32_bf16 v[112:115], a[156:159], v[200:203], v[112:115]
  s_add_u32 s35, s35, 8192
  v_exp_f32 v124, v124
  v_mfma_f32_16x16x32_bf16 v[112:115], a[128:131], v[204:207], v[112:115]
  s_and_b32 s35, s35, 0x7ffff
  ds_read_b64_tr_b16 a[132:133], v14 offset:8192
  v_cvt_pk_bf16_f32 v164, v164, v165
  v_add_f32 v35, v35, v166
  v_add_f32 v35, v35, v167
  v_cvt_pk_bf16_f32 v165, v166, v167
  v_add_f32 v35, v35, v116
  v_add_f32 v35, v35, v117
  v_cvt_pk_bf16_f32 v166, v116, v117
  v_add_f32 v35, v35, v118
  v_add_f32 v35, v35, v119
  v_cvt_pk_bf16_f32 v167, v118, v119
  v_mfma_f32_16x16x32_bf16 v[116:119], a[128:131], v[220:223], v[44:47]
  v_exp_f32 v125, v125
  v_mfma_f32_16x16x32_bf16 v[116:119], a[156:159], v[216:219], v[116:119]
  ds_read_b64_tr_b16 a[134:135], v14 offset:12288
  v_cvt_pk_bf16_f32 v168, v168, v169
  v_mfma_f32_16x16x32_bf16 v[116:119], a[152:155], v[212:215], v[116:119]
  s_add_u32 m0, s33, 49152
  v_exp_f32 v126, v126
  v_mfma_f32_16x16x32_bf16 v[116:119], a[148:151], v[208:211], v[116:119]
  buffer_load_dwordx4 v24, s[8:11], s35 offen offset:0 lds
  v_cvt_pk_bf16_f32 v169, v170, v171
  v_cvt_pk_bf16_f32 v170, v120, v121
  v_cvt_pk_bf16_f32 v171, v122, v123
  v_mfma_f32_16x16x32_bf16 v[120:123], a[148:151], v[224:227], v[48:51]
  v_exp_f32 v127, v127
  v_mfma_f32_16x16x32_bf16 v[120:123], a[152:155], v[228:231], v[120:123]
  ds_read_b64_tr_b16 a[140:141], v15 offset:8192
  v_cvt_pk_bf16_f32 v172, v172, v173
  v_mfma_f32_16x16x32_bf16 v[120:123], a[156:159], v[232:235], v[120:123]
  v_exp_f32 v176, v176
  v_mfma_f32_16x16x32_bf16 v[120:123], a[128:131], v[236:239], v[120:123]
  ds_read_b64_tr_b16 a[142:143], v15 offset:12288
  v_cvt_pk_bf16_f32 v173, v174, v175
  v_cvt_pk_bf16_f32 v174, v124, v125
  v_cvt_pk_bf16_f32 v175, v126, v127
  v_mfma_f32_16x16x32_bf16 v[124:127], a[128:131], v[252:255], v[52:55]
  v_exp_f32 v177, v177
  v_mfma_f32_16x16x32_bf16 v[124:127], a[156:159], v[248:251], v[124:127]
  ds_read_b64_tr_b16 a[144:145], v15 offset:16384
  ds_read_b64_tr_b16 a[158:159], v20 offset:20480
  v_mfma_f32_16x16x32_bf16 v[124:127], a[152:155], v[244:247], v[124:127]
  v_exp_f32 v178, v178
  v_mfma_f32_16x16x32_bf16 v[124:127], a[148:151], v[240:243], v[124:127]
  s_waitcnt lgkmcnt(4)
  buffer_load_dwordx4 v25, s[8:11], s35 offen offset:1024 lds
  v_mfma_f32_16x16x32_bf16 a[0:3], a[132:135], v[128:131], a[0:3]
  s_add_u32 s35, s35, 8192
  v_exp_f32 v179, v179
  v_mfma_f32_16x16x32_bf16 a[0:3], a[136:139], v[160:163], a[0:3]
  s_and_b32 s35, s35, 0x7ffff
  ds_read_b64_tr_b16 a[148:149], v16 offset:8192
  ds_read_b64_tr_b16 a[154:155], v16 offset:20480
  v_mfma_f32_16x16x32_bf16 a[4:7], a[136:139], v[164:167], a[4:7]
  ds_read_b64_tr_b16 a[150:151], v16 offset:12288
  v_add_f32 v34, v34, v176
  v_mfma_f32_16x16x32_bf16 a[4:7], a[132:135], v[132:135], a[4:7]
  v_exp_f32 v144, v144
  v_mfma_f32_16x16x32_bf16 a[8:11], a[132:135], v[136:139], a[8:11]
  ds_read_b64_tr_b16 a[152:153], v16 offset:16384
  v_add_f32 v34, v34, v177
  v_mfma_f32_16x16x32_bf16 a[8:11], a[136:139], v[168:171], a[8:11]
  s_add_u32 m0, s69, 4096
  v_exp_f32 v145, v145
  v_mfma_f32_16x16x32_bf16 a[12:15], a[136:139], v[172:175], a[12:15]
  s_waitcnt lgkmcnt(5)
  buffer_load_dwordx4 v32, s[12:15], s66 offen lds
  v_mfma_f32_16x16x32_bf16 a[12:15], a[132:135], v[140:143], a[12:15]
  s_add_u32 s66, s66, s68
  v_exp_f32 v146, v146
  v_mfma_f32_16x16x32_bf16 a[16:19], a[140:143], v[128:131], a[16:19]
  ds_read_b64_tr_b16 a[128:129], v17 offset:8192
  v_cvt_pk_bf16_f32 v176, v176, v177
  v_mfma_f32_16x16x32_bf16 a[16:19], a[144:147], v[160:163], a[16:19]
  v_exp_f32 v147, v147
  v_mfma_f32_16x16x32_bf16 a[20:23], a[144:147], v[164:167], a[20:23]
  ds_read_b64_tr_b16 a[130:131], v17 offset:12288
  v_add_f32 v34, v34, v178
  v_mfma_f32_16x16x32_bf16 a[20:23], a[140:143], v[132:135], a[20:23]
  ds_read_b64_tr_b16 a[132:133], v17 offset:16384
  v_add_f32 v34, v34, v179
  v_mfma_f32_16x16x32_bf16 a[24:27], a[140:143], v[136:139], a[24:27]
  s_add_u32 m0, s69, 5120
  v_exp_f32 v180, v180
  v_mfma_f32_16x16x32_bf16 a[24:27], a[144:147], v[168:171], a[24:27]
  buffer_load_dwordx4 v32, s[12:15], s66 offen lds
  v_mfma_f32_16x16x32_bf16 a[28:31], a[144:147], v[172:175], a[28:31]
  s_add_u32 s66, s66, s68
  v_exp_f32 v181, v181
  v_mfma_f32_16x16x32_bf16 a[28:31], a[140:143], v[140:143], a[28:31]
  s_waitcnt lgkmcnt(3)
  ds_read_b64_tr_b16 a[134:135], v17 offset:20480
  ds_read_b64_tr_b16 a[142:143], v18 offset:20480
  v_mfma_f32_16x16x32_bf16 a[32:35], a[148:151], v[128:131], a[32:35]
  v_exp_f32 v182, v182
  v_mfma_f32_16x16x32_bf16 a[32:35], a[152:155], v[160:163], a[32:35]
  ds_read_b64_tr_b16 a[136:137], v18 offset:8192
  v_cvt_pk_bf16_f32 v177, v178, v179
  v_mfma_f32_16x16x32_bf16 a[36:39], a[152:155], v[164:167], a[36:39]
  v_exp_f32 v183, v183
  v_mfma_f32_16x16x32_bf16 a[36:39], a[148:151], v[132:135], a[36:39]
  ds_read_b64_tr_b16 a[138:139], v18 offset:12288
  v_add_f32 v34, v34, v144
  v_mfma_f32_16x16x32_bf16 a[40:43], a[148:151], v[136:139], a[40:43]
  ds_read_b64_tr_b16 a[140:141], v18 offset:16384
  v_add_f32 v34, v34, v145
  v_mfma_f32_16x16x32_bf16 a[40:43], a[152:155], v[168:171], a[40:43]
  s_add_u32 m0, s69, 6144
  v_exp_f32 v148, v148
  v_mfma_f32_16x16x32_bf16 a[44:47], a[152:155], v[172:175], a[44:47]
  s_waitcnt lgkmcnt(4)
  buffer_load_dwordx4 v32, s[12:15], s66 offen lds
  v_mfma_f32_16x16x32_bf16 a[44:47], a[148:151], v[140:143], a[44:47]
  s_add_u32 s66, s66, s68
  v_exp_f32 v149, v149
  v_mfma_f32_16x16x32_bf16 a[48:51], a[128:131], v[128:131], a[48:51]
  ds_read_b64_tr_b16 a[144:145], v19 offset:8192
  v_cvt_pk_bf16_f32 v178, v144, v145
  v_mfma_f32_16x16x32_bf16 a[48:51], a[132:135], v[160:163], a[48:51]
  v_exp_f32 v150, v150
  v_mfma_f32_16x16x32_bf16 a[52:55], a[132:135], v[164:167], a[52:55]
  ds_read_b64_tr_b16 a[146:147], v19 offset:12288
  v_add_f32 v34, v34, v146
  v_mfma_f32_16x16x32_bf16 a[52:55], a[128:131], v[132:135], a[52:55]
  s_waitcnt vmcnt(11)
  v_exp_f32 v151, v151
  v_mfma_f32_16x16x32_bf16 a[56:59], a[128:131], v[136:139], a[56:59]
  s_add_u32 m0, s69, 7168
  ds_read_b64_tr_b16 a[148:149], v19 offset:16384
  ds_read_b64_tr_b16 a[252:253], v1 offset:0
  v_mfma_f32_16x16x32_bf16 a[56:59], a[132:135], v[168:171], a[56:59]
  buffer_load_dwordx4 v32, s[12:15], s66 offen lds
  v_mfma_f32_16x16x32_bf16 a[60:63], a[132:135], v[172:175], a[60:63]
  s_add_u32 s66, s66, s70
  v_exp_f32 v184, v184
  v_mfma_f32_16x16x32_bf16 a[60:63], a[128:131], v[140:143], a[60:63]
  s_waitcnt lgkmcnt(4)
  ds_read_b64_tr_b16 a[150:151], v19 offset:20480
  ds_read_b64_tr_b16 a[254:255], v1 offset:512
  v_mfma_f32_16x16x32_bf16 a[64:67], a[136:139], v[128:131], a[64:67]
  v_exp_f32 v185, v185
  v_mfma_f32_16x16x32_bf16 a[64:67], a[140:143], v[160:163], a[64:67]
  ds_read_b64_tr_b16 a[152:153], v20 offset:8192
  v_add_f32 v34, v34, v147
  v_mfma_f32_16x16x32_bf16 a[68:71], a[140:143], v[164:167], a[68:71]
  v_exp_f32 v186, v186
  v_mfma_f32_16x16x32_bf16 a[68:71], a[136:139], v[132:135], a[68:71]
  ds_read_b64_tr_b16 a[154:155], v20 offset:12288
  v_cvt_pk_bf16_f32 v179, v146, v147
  v_mfma_f32_16x16x32_bf16 a[72:75], a[136:139], v[136:139], a[72:75]
  v_exp_f32 v187, v187
  v_mfma_f32_16x16x32_bf16 a[72:75], a[140:143], v[168:171], a[72:75]
  s_add_u32 m0, s69, 0
  ds_read_b64_tr_b16 a[156:157], v20 offset:16384
  v_add_f32 v35, v35, v180
  v_mfma_f32_16x16x32_bf16 a[76:79], a[140:143], v[172:175], a[76:79]
  s_waitcnt lgkmcnt(4)
  buffer_load_dwordx4 v32, s[12:15], s66 offen lds
  v_mfma_f32_16x16x32_bf16 a[76:79], a[136:139], v[140:143], a[76:79]
  s_add_u32 s66, s66, s68
  v_exp_f32 v152, v152
  v_mfma_f32_16x16x32_bf16 a[80:83], a[144:147], v[128:131], a[80:83]
  ds_read_b64_tr_b16 a[128:129], v21 offset:8192
  v_add_f32 v35, v35, v181
  v_mfma_f32_16x16x32_bf16 a[80:83], a[148:151], v[160:163], a[80:83]
  v_exp_f32 v153, v153
  v_mfma_f32_16x16x32_bf16 a[84:87], a[148:151], v[164:167], a[84:87]
  ds_read_b64_tr_b16 a[130:131], v21 offset:12288
  v_cvt_pk_bf16_f32 v180, v180, v181
  v_mfma_f32_16x16x32_bf16 a[84:87], a[144:147], v[132:135], a[84:87]
  v_exp_f32 v154, v154
  v_mfma_f32_16x16x32_bf16 a[88:91], a[144:147], v[136:139], a[88:91]
  ds_read_b64_tr_b16 a[132:133], v21 offset:16384
  v_add_f32 v35, v35, v182
  v_mfma_f32_16x16x32_bf16 a[88:91], a[148:151], v[168:171], a[88:91]
  s_add_u32 m0, s69, 1024
  v_exp_f32 v155, v155
  v_mfma_f32_16x16x32_bf16 a[92:95], a[148:151], v[172:175], a[92:95]
  s_waitcnt lgkmcnt(3)
  buffer_load_dwordx4 v32, s[12:15], s66 offen lds
  v_mfma_f32_16x16x32_bf16 a[92:95], a[144:147], v[140:143], a[92:95]
  s_add_u32 s66, s66, s68
  ds_read_b64_tr_b16 a[134:135], v21 offset:20480
  v_add_f32 v35, v35, v183
  v_mfma_f32_16x16x32_bf16 a[96:99], a[152:155], v[128:131], a[96:99]
  v_exp_f32 v188, v188
  v_mfma_f32_16x16x32_bf16 a[96:99], a[156:159], v[160:163], a[96:99]
  ds_read_b128 a[136:139], v10 offset:40960
  v_cvt_pk_bf16_f32 v181, v182, v183
  v_mfma_f32_16x16x32_bf16 a[100:103], a[156:159], v[164:167], a[100:103]
  v_exp_f32 v189, v189
  v_mfma_f32_16x16x32_bf16 a[100:103], a[152:155], v[132:135], a[100:103]
  ds_read_b128 a[140:143], v11 offset:40960
  v_add_f32 v35, v35, v148
  v_mfma_f32_16x16x32_bf16 a[104:107], a[152:155], v[136:139], a[104:107]
  v_exp_f32 v190, v190
  v_mfma_f32_16x16x32_bf16 a[104:107], a[156:159], v[168:171], a[104:107]
  ds_read_b128 a[144:147], v12 offset:40960
  v_add_f32 v35, v35, v149
  v_mfma_f32_16x16x32_bf16 a[108:111], a[156:159], v[172:175], a[108:111]
  s_add_u32 m0, s69, 2048
  v_exp_f32 v191, v191
  v_mfma_f32_16x16x32_bf16 a[108:111], a[152:155], v[140:143], a[108:111]
  s_waitcnt lgkmcnt(3)
  buffer_load_dwordx4 v32, s[12:15], s66 offen lds
  v_mfma_f32_16x16x32_bf16 a[112:115], a[128:131], v[128:131], a[112:115]
  s_add_u32 s66, s66, s68
  ds_read_b128 a[148:151], v13 offset:40960
  v_cvt_pk_bf16_f32 v182, v148, v149
  v_mfma_f32_16x16x32_bf16 a[112:115], a[132:135], v[160:163], a[112:115]
  v_exp_f32 v156, v156
  v_mfma_f32_16x16x32_bf16 a[116:119], a[132:135], v[164:167], a[116:119]
  v_add_f32 v35, v35, v150
  v_add_f32 v35, v35, v151
  v_mfma_f32_16x16x32_bf16 a[116:119], a[128:131], v[132:135], a[116:119]
  v_exp_f32 v157, v157
  v_mfma_f32_16x16x32_bf16 a[120:123], a[128:131], v[136:139], a[120:123]
  v_cvt_pk_bf16_f32 v183, v150, v151
  v_cvt_pk_bf16_f32 v184, v184, v185
  v_mfma_f32_16x16x32_bf16 a[120:123], a[132:135], v[168:171], a[120:123]
  s_add_u32 m0, s69, 3072
  v_exp_f32 v158, v158
  v_mfma_f32_16x16x32_bf16 a[124:127], a[132:135], v[172:175], a[124:127]
  buffer_load_dwordx4 v32, s[12:15], s66 offen lds
  v_mfma_f32_16x16x32_bf16 a[124:127], a[128:131], v[140:143], a[124:127]
  s_add_u32 s66, s66, s70
  v_exp_f32 v159, v159
  v_mfma_f32_16x16x32_bf16 a[240:243], a[248:251], v[136:139], a[240:243]
  ds_read_b128 a[152:155], v10 offset:45056
  v_cvt_pk_bf16_f32 v185, v186, v187
  v_mfma_f32_16x16x32_bf16 a[240:243], a[248:251], v[168:171], a[240:243]
  v_cvt_pk_bf16_f32 v186, v152, v153
  v_cvt_pk_bf16_f32 v187, v154, v155
  v_mfma_f32_16x16x32_bf16 a[244:247], a[248:251], v[140:143], a[244:247]
  v_cvt_pk_bf16_f32 v188, v188, v189
  v_cvt_pk_bf16_f32 v189, v190, v191
  v_mfma_f32_16x16x32_bf16 a[244:247], a[248:251], v[172:175], a[244:247]
  s_waitcnt lgkmcnt(1)
  v_cvt_pk_bf16_f32 v190, v156, v157
  v_cvt_pk_bf16_f32 v191, v158, v159
  v_mfma_f32_16x16x32_bf16 v[128:131], a[136:139], v[192:195], v[40:43]
  s_waitcnt vmcnt(17)
  v_exp_f32 v96, v96
  v_mfma_f32_16x16x32_bf16 v[128:131], a[140:143], v[196:199], v[128:131]
  s_barrier
  v_mfma_f32_16x16x32_bf16 v[128:131], a[144:147], v[200:203], v[128:131]
  v_exp_f32 v97, v97
  v_mfma_f32_16x16x32_bf16 v[128:131], a[148:151], v[204:207], v[128:131]
  ds_read_b128 a[156:159], v11 offset:45056
  v_add_f32 v34, v34, v96
  v_mfma_f32_16x16x32_bf16 v[132:135], a[148:151], v[220:223], v[44:47]
  v_exp_f32 v98, v98
  v_mfma_f32_16x16x32_bf16 v[132:135], a[144:147], v[216:219], v[132:135]
  ds_read_b128 a[128:131], v12 offset:45056
  v_add_f32 v34, v34, v97
  v_mfma_f32_16x16x32_bf16 v[132:135], a[140:143], v[212:215], v[132:135]
  v_exp_f32 v99, v99
  v_mfma_f32_16x16x32_bf16 v[132:135], a[136:139], v[208:211], v[132:135]
  ds_read_b128 a[132:135], v13 offset:45056
  v_cvt_pk_bf16_f32 v96, v96, v97
  v_mfma_f32_16x16x32_bf16 v[136:139], a[136:139], v[224:227], v[48:51]
  v_exp_f32 v112, v112
  v_mfma_f32_16x16x32_bf16 v[136:139], a[140:143], v[228:231], v[136:139]
  v_exp_f32 v113, v113
  v_mfma_f32_16x16x32_bf16 v[136:139], a[144:147], v[232:235], v[136:139]
  v_add_f32 v34, v34, v98
  v_add_f32 v34, v34, v99
  v_mfma_f32_16x16x32_bf16 v[136:139], a[148:151], v[236:239], v[136:139]
  v_exp_f32 v114, v114
  v_mfma_f32_16x16x32_bf16 v[140:143], a[148:151], v[252:255], v[52:55]
  ds_read_b128 a[148:151], v13 offset:49152
  v_cvt_pk_bf16_f32 v97, v98, v99
  v_mfma_f32_16x16x32_bf16 v[140:143], a[144:147], v[248:251], v[140:143]
  s_mov_b32 s71, 14745600
  v_exp_f32 v115, v115
  v_mfma_f32_16x16x32_bf16 v[140:143], a[140:143], v[244:247], v[140:143]
  buffer_load_dword v39, v38, s[20:23], s71 offen sc1
  v_mfma_f32_16x16x32_bf16 v[140:143], a[136:139], v[240:243], v[140:143]
  s_waitcnt lgkmcnt(1)
  v_exp_f32 v100, v100
  v_mfma_f32_16x16x32_bf16 v[144:147], a[152:155], v[192:195], v[40:43]
  v_exp_f32 v101, v101
  v_mfma_f32_16x16x32_bf16 v[144:147], a[156:159], v[196:199], v[144:147]
  ds_read_b128 a[136:139], v10 offset:49152
  ds_read_b128 a[144:147], v12 offset:49152
  v_mfma_f32_16x16x32_bf16 v[144:147], a[128:131], v[200:203], v[144:147]
  s_add_u32 m0, s32, 16384
  v_exp_f32 v102, v102
  v_mfma_f32_16x16x32_bf16 v[144:147], a[132:135], v[204:207], v[144:147]
  buffer_load_dwordx4 v22, s[4:7], s34 offen offset:0 lds
  v_mfma_f32_16x16x32_bf16 v[148:151], a[132:135], v[220:223], v[44:47]
  v_exp_f32 v103, v103
  v_mfma_f32_16x16x32_bf16 v[148:151], a[128:131], v[216:219], v[148:151]
  ds_read_b128 a[140:143], v11 offset:49152
  v_add_f32 v34, v34, v112
  v_mfma_f32_16x16x32_bf16 v[148:151], a[156:159], v[212:215], v[148:151]
  v_exp_f32 v116, v116
  v_mfma_f32_16x16x32_bf16 v[148:151], a[152:155], v[208:211], v[148:151]
  buffer_load_dwordx4 v23, s[4:7], s34 offen offset:1024 lds
  v_mfma_f32_16x16x32_bf16 v[152:155], a[152:155], v[224:227], v[48:51]
  s_add_u32 s34, s34, 8192
  v_exp_f32 v117, v117
  v_mfma_f32_16x16x32_bf16 v[152:155], a[156:159], v[228:231], v[152:155]
  s_and_b32 s34, s34, 0x7ffff
  v_exp_f32 v118, v118
  v_mfma_f32_16x16x32_bf16 v[152:155], a[128:131], v[232:235], v[152:155]
  v_add_f32 v34, v34, v113
  v_cvt_pk_bf16_f32 v98, v112, v113
  v_mfma_f32_16x16x32_bf16 v[152:155], a[132:135], v[236:239], v[152:155]
  s_add_u32 m0, s32, 24576
  v_exp_f32 v119, v119
  v_mfma_f32_16x16x32_bf16 v[156:159], a[132:135], v[252:255], v[52:55]
  buffer_load_dwordx4 v22, s[4:7], s34 offen offset:0 lds
  v_mfma_f32_16x16x32_bf16 v[156:159], a[128:131], v[248:251], v[156:159]
  v_exp_f32 v104, v104
  v_mfma_f32_16x16x32_bf16 v[156:159], a[156:159], v[244:247], v[156:159]
  ds_read_b128 a[156:159], v11 offset:53248
  ds_read_b128 a[132:135], v13 offset:53248
  v_mfma_f32_16x16x32_bf16 v[156:159], a[152:155], v[240:243], v[156:159]
  s_waitcnt lgkmcnt(2)
  v_exp_f32 v105, v105
  v_mfma_f32_16x16x32_bf16 v[160:163], a[136:139], v[192:195], v[40:43]
  v_exp_f32 v106, v106
  v_mfma_f32_16x16x32_bf16 v[160:163], a[140:143], v[196:199], v[160:163]
  ds_read_b128 a[152:155], v10 offset:53248
  v_add_f32 v34, v34, v114
  v_mfma_f32_16x16x32_bf16 v[160:163], a[144:147], v[200:203], v[160:163]
  v_exp_f32 v107, v107
  v_mfma_f32_16x16x32_bf16 v[160:163], a[148:151], v[204:207], v[160:163]
  buffer_load_dwordx4 v23, s[4:7], s34 offen offset:1024 lds
  v_mfma_f32_16x16x32_bf16 v[164:167], a[148:151], v[220:223], v[44:47]
  s_add_u32 s34, s34, 8192
  v_exp_f32 v120, v120
  v_mfma_f32_16x16x32_bf16 v[164:167], a[144:147], v[216:219], v[164:167]
  s_and_b32 s34, s34, 0x7ffff
  ds_read_b128 a[128:131], v12 offset:53248
  v_add_f32 v34, v34, v115
  v_mfma_f32_16x16x32_bf16 v[164:167], a[140:143], v[212:215], v[164:167]
  s_add_u32 m0, s33, 57344
  v_exp_f32 v121, v121
  v_mfma_f32_16x16x32_bf16 v[164:167], a[136:139], v[208:211], v[164:167]
  buffer_load_dwordx4 v24, s[8:11], s35 offen offset:0 lds
  v_mfma_f32_16x16x32_bf16 v[168:171], a[136:139], v[224:227], v[48:51]
  v_exp_f32 v122, v122
  v_mfma_f32_16x16x32_bf16 v[168:171], a[140:143], v[228:231], v[168:171]
  v_exp_f32 v123, v123
  v_mfma_f32_16x16x32_bf16 v[168:171], a[144:147], v[232:235], v[168:171]
  v_cvt_pk_bf16_f32 v99, v114, v115
  v_add_f32 v35, v35, v100
  v_mfma_f32_16x16x32_bf16 v[168:171], a[148:151], v[236:239], v[168:171]
  v_exp_f32 v108, v108
  v_mfma_f32_16x16x32_bf16 v[172:175], a[148:151], v[252:255], v[52:55]
  buffer_load_dwordx4 v25, s[8:11], s35 offen offset:1024 lds
  v_mfma_f32_16x16x32_bf16 v[172:175], a[144:147], v[248:251], v[172:175]
  s_add_u32 s35, s35, 8192
  v_exp_f32 v109, v109
  v_mfma_f32_16x16x32_bf16 v[172:175], a[140:143], v[244:247], v[172:175]
  s_and_b32 s35, s35, 0x7ffff
  ds_read_b64_tr_b16 a[140:141], v14 offset:32768
  ds_read_b64_tr_b16 a[142:143], v14 offset:36864
  v_mfma_f32_16x16x32_bf16 v[172:175], a[136:139], v[240:243], v[172:175]
  s_waitcnt lgkmcnt(2)
  v_exp_f32 v110, v110
  v_mfma_f32_16x16x32_bf16 v[112:115], a[152:155], v[192:195], v[40:43]
  v_exp_f32 v111, v111
  v_mfma_f32_16x16x32_bf16 v[112:115], a[156:159], v[196:199], v[112:115]
  ds_read_b64_tr_b16 a[136:137], v14 offset:24576
  ds_read_b64_tr_b16 a[150:151], v15 offset:36864
  v_mfma_f32_16x16x32_bf16 v[112:115], a[128:131], v[200:203], v[112:115]
  s_add_u32 m0, s33, 0
  v_exp_f32 v124, v124
  v_mfma_f32_16x16x32_bf16 v[112:115], a[132:135], v[204:207], v[112:115]
  buffer_load_dwordx4 v24, s[8:11], s35 offen offset:0 lds
  v_add_f32 v35, v35, v101
  v_cvt_pk_bf16_f32 v100, v100, v101
  v_add_f32 v35, v35, v102
  v_add_f32 v35, v35, v103
  v_cvt_pk_bf16_f32 v101, v102, v103
  v_add_f32 v35, v35, v116
  v_add_f32 v35, v35, v117
  v_cvt_pk_bf16_f32 v102, v116, v117
  v_add_f32 v35, v35, v118
  v_add_f32 v35, v35, v119
  v_cvt_pk_bf16_f32 v103, v118, v119
  v_mfma_f32_16x16x32_bf16 v[116:119], a[132:135], v[220:223], v[44:47]
  v_exp_f32 v125, v125
  v_mfma_f32_16x16x32_bf16 v[116:119], a[128:131], v[216:219], v[116:119]
  ds_read_b64_tr_b16 a[138:139], v14 offset:28672
  v_cvt_pk_bf16_f32 v104, v104, v105
  v_mfma_f32_16x16x32_bf16 v[116:119], a[156:159], v[212:215], v[116:119]
  v_exp_f32 v126, v126
  v_mfma_f32_16x16x32_bf16 v[116:119], a[152:155], v[208:211], v[116:119]
  buffer_load_dwordx4 v25, s[8:11], s35 offen offset:1024 lds
  v_cvt_pk_bf16_f32 v105, v106, v107
  v_cvt_pk_bf16_f32 v106, v120, v121
  v_cvt_pk_bf16_f32 v107, v122, v123
  v_mfma_f32_16x16x32_bf16 v[120:123], a[152:155], v[224:227], v[48:51]
  s_add_u32 s35, s35, 8192
  v_exp_f32 v127, v127
  v_mfma_f32_16x16x32_bf16 v[120:123], a[156:159], v[228:231], v[120:123]
  s_and_b32 s35, s35, 0x7ffff
  ds_read_b64_tr_b16 a[144:145], v15 offset:24576
  v_cvt_pk_bf16_f32 v108, v108, v109
  v_mfma_f32_16x16x32_bf16 v[120:123], a[128:131], v[232:235], v[120:123]
  v_exp_f32 v128, v128
  v_mfma_f32_16x16x32_bf16 v[120:123], a[132:135], v[236:239], v[120:123]
  buffer_store_dwordx4 a[252:255], v26, s[20:23], s43 offen sc1
  v_cvt_pk_bf16_f32 v109, v110, v111
  v_cvt_pk_bf16_f32 v110, v124, v125
  v_cvt_pk_bf16_f32 v111, v126, v127
  v_mfma_f32_16x16x32_bf16 v[124:127], a[132:135], v[252:255], v[52:55]
  s_waitcnt vmcnt(9)
  v_cmp_ne_u32 vcc, s31, v39
  s_cbranch_vccz POLL_U_OK
  s_mov_b32 s71, 14745600
  s_mov_b32 s79, 0
POLL_U:
  buffer_load_dword v39, v38, s[20:23], s71 offen sc1
  s_add_u32 s79, s79, 1
  s_waitcnt vmcnt(0)
  v_cmp_ne_u32 vcc, s31, v39
  s_cmp_gt_u32 s79, 1048576
  s_cbranch_scc1 POLL_U_X
  s_cbranch_vccnz POLL_U
POLL_U_X:
POLL_U_OK:
  v_exp_f32 v129, v129
  v_mfma_f32_16x16x32_bf16 v[124:127], a[128:131], v[248:251], v[124:127]
  ds_read_b64_tr_b16 a[146:147], v15 offset:28672
  ds_read_b64_tr_b16 a[130:131], v20 offset:36864
  v_mfma_f32_16x16x32_bf16 v[124:127], a[156:159], v[244:247], v[124:127]
  v_exp_f32 v130, v130
  v_mfma_f32_16x16x32_bf16 v[124:127], a[152:155], v[240:243], v[124:127]
  s_waitcnt lgkmcnt(3)
  ds_read_b64_tr_b16 a[148:149], v15 offset:32768
  ds_read_b64_tr_b16 a[158:159], v16 offset:36864
  v_mfma_f32_16x16x32_bf16 a[0:3], a[136:139], v[176:179], a[0:3]
  v_exp_f32 v131, v131
  v_mfma_f32_16x16x32_bf16 a[0:3], a[140:143], v[96:99], a[0:3]
  buffer_load_dwordx4 v[76:79], v26, s[16:19], s67 offen offset:0 sc1
  v_mfma_f32_16x16x32_bf16 a[4:7], a[140:143], v[100:103], a[4:7]
  ds_read_b64_tr_b16 a[152:153], v16 offset:24576
  v_add_f32 v34, v34, v128
  v_mfma_f32_16x16x32_bf16 a[4:7], a[136:139], v[180:183], a[4:7]
  v_exp_f32 v144, v144
  v_mfma_f32_16x16x32_bf16 a[8:11], a[136:139], v[184:187], a[8:11]
  ds_read_b64_tr_b16 a[154:155], v16 offset:28672
  v_add_f32 v34, v34, v129
  v_mfma_f32_16x16x32_bf16 a[8:11], a[140:143], v[104:107], a[8:11]
  v_exp_f32 v145, v145
  v_mfma_f32_16x16x32_bf16 a[12:15], a[140:143], v[108:111], a[12:15]
  ds_read_b64_tr_b16 a[156:157], v16 offset:32768
  v_cvt_pk_bf16_f32 v128, v128, v129
  v_mfma_f32_16x16x32_bf16 a[12:15], a[136:139], v[188:191], a[12:15]
  s_waitcnt lgkmcnt(4)
  v_exp_f32 v146, v146
  v_mfma_f32_16x16x32_bf16 a[16:19], a[144:147], v[176:179], a[16:19]
  buffer_load_dwordx4 v[80:83], v26, s[16:19], s67 offen offset:1024 sc1
  v_mfma_f32_16x16x32_bf16 a[16:19], a[148:151], v[96:99], a[16:19]
  v_exp_f32 v147, v147
  v_mfma_f32_16x16x32_bf16 a[20:23], a[148:151], v[100:103], a[20:23]
  ds_read_b64_tr_b16 a[132:133], v17 offset:24576
  ds_read_b64_tr_b16 a[138:139], v17 offset:36864
  v_mfma_f32_16x16x32_bf16 a[20:23], a[144:147], v[180:183], a[20:23]
  ds_read_b64_tr_b16 a[134:135], v17 offset:28672
  v_add_f32 v34, v34, v130
  v_mfma_f32_16x16x32_bf16 a[24:27], a[144:147], v[184:187], a[24:27]
  v_exp_f32 v132, v132
  v_mfma_f32_16x16x32_bf16 a[24:27], a[148:151], v[104:107], a[24:27]
  ds_read_b64_tr_b16 a[136:137], v17 offset:32768
  v_add_f32 v34, v34, v131
  v_mfma_f32_16x16x32_bf16 a[28:31], a[148:151], v[108:111], a[28:31]
  v_exp_f32 v133, v133
  v_mfma_f32_16x16x32_bf16 a[28:31], a[144:147], v[188:191], a[28:31]
  s_waitcnt lgkmcnt(4)
  buffer_load_dwordx4 v[84:87], v26, s[16:19], s67 offen offset:2048 sc1
  v_mfma_f32_16x16x32_bf16 a[32:35], a[152:155], v[176:179], a[32:35]
  v_exp_f32 v134, v134
  v_mfma_f32_16x16x32_bf16 a[32:35], a[156:159], v[96:99], a[32:35]
  ds_read_b64_tr_b16 a[140:141], v18 offset:24576
  ds_read_b64_tr_b16 a[146:147], v18 offset:36864
  v_mfma_f32_16x16x32_bf16 a[36:39], a[156:159], v[100:103], a[36:39]
  v_exp_f32 v135, v135
  v_mfma_f32_16x16x32_bf16 a[36:39], a[152:155], v[180:183], a[36:39]
  ds_read_b64_tr_b16 a[142:143], v18 offset:28672
  v_cvt_pk_bf16_f32 v129, v130, v131
  v_mfma_f32_16x16x32_bf16 a[40:43], a[152:155], v[184:187], a[40:43]
  ds_read_b64_tr_b16 a[144:145], v18 offset:32768
  v_add_f32 v34, v34, v144
  v_mfma_f32_16x16x32_bf16 a[40:43], a[156:159], v[104:107], a[40:43]
  v_exp_f32 v148, v148
  v_mfma_f32_16x16x32_bf16 a[44:47], a[156:159], v[108:111], a[44:47]
  buffer_load_dwordx4 v[88:91], v26, s[16:19], s67 offen offset:3072 sc1
  v_mfma_f32_16x16x32_bf16 a[44:47], a[152:155], v[188:191], a[44:47]
  s_waitcnt lgkmcnt(4)
  v_exp_f32 v149, v149
  v_mfma_f32_16x16x32_bf16 a[48:51], a[132:135], v[176:179], a[48:51]
  ds_read_b64_tr_b16 a[148:149], v19 offset:24576
  v_add_f32 v34, v34, v145
  v_mfma_f32_16x16x32_bf16 a[48:51], a[136:139], v[96:99], a[48:51]
  v_exp_f32 v150, v150
  v_mfma_f32_16x16x32_bf16 a[52:55], a[136:139], v[100:103], a[52:55]
  ds_read_b64_tr_b16 a[150:151], v19 offset:28672
  v_cvt_pk_bf16_f32 v130, v144, v145
  v_mfma_f32_16x16x32_bf16 a[52:55], a[132:135], v[180:183], a[52:55]
  v_exp_f32 v151, v151
  v_mfma_f32_16x16x32_bf16 a[56:59], a[132:135], v[184:187], a[56:59]
  ds_read_b64_tr_b16 a[152:153], v19 offset:32768
  v_add_f32 v34, v34, v146
  v_mfma_f32_16x16x32_bf16 a[56:59], a[136:139], v[104:107], a[56:59]
  buffer_load_dwordx4 v[92:95], v27, s[16:19], s67 offen sc1
  v_mfma_f32_16x16x32_bf16 a[60:63], a[136:139], v[108:111], a[60:63]
  s_add_u32 s67, s67, 20480
  v_exp_f32 v136, v136
  v_mfma_f32_16x16x32_bf16 a[60:63], a[132:135], v[188:191], a[60:63]
  s_waitcnt lgkmcnt(3)
  ds_read_b64_tr_b16 a[154:155], v19 offset:36864
  v_add_f32 v34, v34, v147
  v_mfma_f32_16x16x32_bf16 a[64:67], a[140:143], v[176:179], a[64:67]
  v_exp_f32 v137, v137
  v_mfma_f32_16x16x32_bf16 a[64:67], a[144:147], v[96:99], a[64:67]
  ds_read_b64_tr_b16 a[156:157], v20 offset:24576
  v_cvt_pk_bf16_f32 v131, v146, v147
  v_mfma_f32_16x16x32_bf16 a[68:71], a[144:147], v[100:103], a[68:71]
  v_exp_f32 v138, v138
  v_mfma_f32_16x16x32_bf16 a[68:71], a[140:143], v[180:183], a[68:71]
  buffer_load_dwordx4 v[56:59], v26, s[16:19], s67 offen offset:0 sc1
  v_mfma_f32_16x16x32_bf16 a[72:75], a[140:143], v[184:187], a[72:75]
  v_exp_f32 v139, v139
  v_mfma_f32_16x16x32_bf16 a[72:75], a[144:147], v[104:107], a[72:75]
  ds_read_b64_tr_b16 a[158:159], v20 offset:28672
  v_add_f32 v35, v35, v132
  v_mfma_f32_16x16x32_bf16 a[76:79], a[144:147], v[108:111], a[76:79]
  ds_read_b64_tr_b16 a[128:129], v20 offset:32768
  v_add_f32 v35, v35, v133
  v_mfma_f32_16x16x32_bf16 a[76:79], a[140:143], v[188:191], a[76:79]
  s_waitcnt lgkmcnt(3)
  v_exp_f32 v152, v152
  v_mfma_f32_16x16x32_bf16 a[80:83], a[148:151], v[176:179], a[80:83]
  ds_read_b64_tr_b16 a[132:133], v21 offset:24576
  v_cvt_pk_bf16_f32 v132, v132, v133
  v_mfma_f32_16x16x32_bf16 a[80:83], a[152:155], v[96:99], a[80:83]
  v_exp_f32 v153, v153
  v_mfma_f32_16x16x32_bf16 a[84:87], a[152:155], v[100:103], a[84:87]
  buffer_load_dwordx4 v[60:63], v26, s[16:19], s67 offen offset:1024 sc1
  v_mfma_f32_16x16x32_bf16 a[84:87], a[148:151], v[180:183], a[84:87]
  v_exp_f32 v154, v154
  v_mfma_f32_16x16x32_bf16 a[88:91], a[148:151], v[184:187], a[88:91]
  ds_read_b64_tr_b16 a[134:135], v21 offset:28672
  v_add_f32 v35, v35, v134
  v_mfma_f32_16x16x32_bf16 a[88:91], a[152:155], v[104:107], a[88:91]
  v_exp_f32 v155, v155
  v_mfma_f32_16x16x32_bf16 a[92:95], a[152:155], v[108:111], a[92:95]
  ds_read_b64_tr_b16 a[136:137], v21 offset:32768
  v_add_f32 v35, v35, v135
  v_mfma_f32_16x16x32_bf16 a[92:95], a[148:151], v[188:191], a[92:95]
  s_waitcnt lgkmcnt(3)
  ds_read_b64_tr_b16 a[138:139], v21 offset:36864
  v_cvt_pk_bf16_f32 v133, v134, v135
  v_mfma_f32_16x16x32_bf16 a[96:99], a[156:159], v[176:179], a[96:99]
  v_exp_f32 v140, v140
  v_mfma_f32_16x16x32_bf16 a[96:99], a[128:131], v[96:99], a[96:99]
  buffer_load_dwordx4 v[64:67], v26, s[16:19], s67 offen offset:2048 sc1
  v_mfma_f32_16x16x32_bf16 a[100:103], a[128:131], v[100:103], a[100:103]
  v_exp_f32 v141, v141
  v_mfma_f32_16x16x32_bf16 a[100:103], a[156:159], v[180:183], a[100:103]
  ds_read_b128 a[140:143], v10 offset:57344
  v_add_f32 v35, v35, v148
  v_mfma_f32_16x16x32_bf16 a[104:107], a[156:159], v[184:187], a[104:107]
  v_exp_f32 v142, v142
  v_mfma_f32_16x16x32_bf16 a[104:107], a[128:131], v[104:107], a[104:107]
  ds_read_b128 a[144:147], v11 offset:57344
  v_add_f32 v35, v35, v149
  v_mfma_f32_16x16x32_bf16 a[108:111], a[128:131], v[108:111], a[108:111]
  v_exp_f32 v143, v143
  v_mfma_f32_16x16x32_bf16 a[108:111], a[156:159], v[188:191], a[108:111]
  s_waitcnt lgkmcnt(2)
  ds_read_b128 a[148:151], v12 offset:57344
  v_cvt_pk_bf16_f32 v134, v148, v149
  v_mfma_f32_16x16x32_bf16 a[112:115], a[132:135], v[176:179], a[112:115]
  buffer_load_dwordx4 v[68:71], v26, s[16:19], s67 offen offset:3072 sc1
  v_mfma_f32_16x16x32_bf16 a[112:115], a[136:139], v[96:99], a[112:115]
  v_exp_f32 v156, v156
  v_mfma_f32_16x16x32_bf16 a[116:119], a[136:139], v[100:103], a[116:119]
  ds_read_b128 a[152:155], v13 offset:57344
  v_add_f32 v35, v35, v150
  v_mfma_f32_16x16x32_bf16 a[116:119], a[132:135], v[180:183], a[116:119]
  v_exp_f32 v157, v157
  v_mfma_f32_16x16x32_bf16 a[120:123], a[132:135], v[184:187], a[120:123]
  v_add_f32 v35, v35, v151
  v_cvt_pk_bf16_f32 v135, v150, v151
  v_mfma_f32_16x16x32_bf16 a[120:123], a[136:139], v[104:107], a[120:123]
  v_exp_f32 v158, v158
  v_mfma_f32_16x16x32_bf16 a[124:127], a[136:139], v[108:111], a[124:127]
  ds_read_b128 a[156:159], v10 offset:61440
  v_cvt_pk_bf16_f32 v136, v136, v137
  v_mfma_f32_16x16x32_bf16 a[124:127], a[132:135], v[188:191], a[124:127]
  v_exp_f32 v159, v159
  v_mfma_f32_16x16x32_bf16 a[240:243], a[248:251], v[184:187], a[240:243]
  buffer_load_dwordx4 v[72:75], v27, s[16:19], s67 offen sc1
  v_mfma_f32_16x16x32_bf16 a[240:243], a[248:251], v[104:107], a[240:243]
  s_add_u32 s67, s67, 20480
  v_cvt_pk_bf16_f32 v137, v138, v139
  v_cvt_pk_bf16_f32 v138, v152, v153
  v_mfma_f32_16x16x32_bf16 a[244:247], a[248:251], v[188:191], a[244:247]
  v_cvt_pk_bf16_f32 v139, v154, v155
  v_cvt_pk_bf16_f32 v140, v140, v141
  v_mfma_f32_16x16x32_bf16 a[244:247], a[248:251], v[108:111], a[244:247]
  s_waitcnt lgkmcnt(1)
  v_cvt_pk_bf16_f32 v141, v142, v143
  v_cvt_pk_bf16_f32 v142, v156, v157
  v_cvt_pk_bf16_f32 v143, v158, v159
  v_mfma_f32_16x16x32_bf16 v[176:179], a[140:143], v[192:195], v[40:43]
  s_waitcnt vmcnt(10)
  s_waitcnt vmcnt(28)
  v_exp_f32 v160, v160
  v_mfma_f32_16x16x32_bf16 v[176:179], a[144:147], v[196:199], v[176:179]
  s_barrier
  s_cmp_lg_u32 s28, 0
  s_cbranch_scc1 SIG_4_4744
  s_and_b32 s71, s2, 7
  s_lshl_b32 s71, s71, 9
  s_lshr_b32 vcc_lo, s2, 3
  s_lshl_b32 vcc_lo, vcc_lo, 4
  s_add_u32 s71, s71, vcc_lo
  s_add_u32 s71, s71, 14811136
  v_mov_b32 v8, s31
  v_mov_b32 v9, 0
  s_mov_b64 exec, 1
  buffer_store_dword v8, v9, s[20:23], s71 offen sc1
  s_mov_b64 exec, -1
SIG_4_4744:
  v_mfma_f32_16x16x32_bf16 v[176:179], a[148:151], v[200:203], v[176:179]
  v_exp_f32 v161, v161
  v_mfma_f32_16x16x32_bf16 v[176:179], a[152:155], v[204:207], v[176:179]
  ds_read_b128 a[128:131], v11 offset:61440
  ds_read_b128 a[136:139], v13 offset:61440
  v_mfma_f32_16x16x32_bf16 v[180:183], a[152:155], v[220:223], v[44:47]
  s_mov_b32 s42, 0x8000000
  v_exp_f32 v162, v162
  v_mfma_f32_16x16x32_bf16 v[180:183], a[148:151], v[216:219], v[180:183]
  s_mov_b32 s36, 5
  ds_read_b128 a[132:135], v12 offset:61440
  v_add_f32 v34, v34, v160
  v_mfma_f32_16x16x32_bf16 v[180:183], a[144:147], v[212:215], v[180:183]
  s_add_u32 m0, s32, 32768
  v_exp_f32 v163, v163
  v_mov_b32 v38, v6
  v_mfma_f32_16x16x32_bf16 v[180:183], a[140:143], v[208:211], v[180:183]
  s_add_u32 s62, s100, L_CODE_END-32768-L_PC
  s_addc_u32 s63, s101, 0
  buffer_load_dwordx4 v22, s[4:7], s34 offen offset:0 lds
  v_mfma_f32_16x16x32_bf16 v[184:187], a[140:143], v[224:227], v[48:51]
  s_mov_b32 s51, 0x20000
  v_exp_f32 v112, v112
  v_mfma_f32_16x16x32_bf16 v[184:187], a[144:147], v[228:231], v[184:187]
  v_exp_f32 v113, v113
  v_mfma_f32_16x16x32_bf16 v[184:187], a[148:151], v[232:235], v[184:187]
  v_add_f32 v34, v34, v161
  v_cvt_pk_bf16_f32 v160, v160, v161
  v_mfma_f32_16x16x32_bf16 v[184:187], a[152:155], v[236:239], v[184:187]
  v_exp_f32 v114, v114
  v_mfma_f32_16x16x32_bf16 v[188:191], a[152:155], v[252:255], v[52:55]
  ds_read_b128 a[152:155], v13 offset:0
  v_add_f32 v34, v34, v162
  v_mfma_f32_16x16x32_bf16 v[188:191], a[148:151], v[248:251], v[188:191]
  v_exp_f32 v115, v115
  v_mfma_f32_16x16x32_bf16 v[188:191], a[144:147], v[244:247], v[188:191]
  ds_read_b128 a[144:147], v11 offset:0
  v_add_f32 v34, v34, v163
  v_mfma_f32_16x16x32_bf16 v[188:191], a[140:143], v[240:243], v[188:191]
  s_waitcnt lgkmcnt(2)
  v_exp_f32 v164, v164
  v_mfma_f32_16x16x32_bf16 v[144:147], a[156:159], v[192:195], v[40:43]
  v_exp_f32 v165, v165
  v_mfma_f32_16x16x32_bf16 v[144:147], a[128:131], v[196:199], v[144:147]
  ds_read_b128 a[140:143], v10 offset:0
  v_cvt_pk_bf16_f32 v161, v162, v163
  v_mfma_f32_16x16x32_bf16 v[144:147], a[132:135], v[200:203], v[144:147]
  v_exp_f32 v166, v166
  v_mfma_f32_16x16x32_bf16 v[144:147], a[136:139], v[204:207], v[144:147]
  buffer_load_dwordx4 v23, s[4:7], s34 offen offset:1024 lds
  v_mfma_f32_16x16x32_bf16 v[148:151], a[136:139], v[220:223], v[44:47]
  s_add_u32 s34, s34, 8192
  v_exp_f32 v167, v167
  v_mfma_f32_16x16x32_bf16 v[148:151], a[132:135], v[216:219], v[148:151]
  s_and_b32 s34, s34, 0x7ffff
  ds_read_b128 a[148:151], v12 offset:0
  v_add_f32 v34, v34, v112
  v_mfma_f32_16x16x32_bf16 v[148:151], a[128:131], v[212:215], v[148:151]
  v_exp_f32 v116, v116
  v_mfma_f32_16x16x32_bf16 v[148:151], a[156:159], v[208:211], v[148:151]
  v_add_f32 v34, v34, v113
  v_cvt_pk_bf16_f32 v162, v112, v113
  v_mfma_f32_16x16x32_bf16 v[152:155], a[156:159], v[224:227], v[48:51]
  v_exp_f32 v117, v117
  v_mfma_f32_16x16x32_bf16 v[152:155], a[128:131], v[228:231], v[152:155]
  v_exp_f32 v118, v118
  v_mfma_f32_16x16x32_bf16 v[152:155], a[132:135], v[232:235], v[152:155]
  v_add_f32 v34, v34, v114
  v_add_f32 v34, v34, v115
  v_mfma_f32_16x16x32_bf16 v[152:155], a[136:139], v[236:239], v[152:155]
  v_exp_f32 v119, v119
  v_mfma_f32_16x16x32_bf16 v[156:159], a[136:139], v[252:255], v[52:55]
  ds_read_b128 a[136:139], v13 offset:4096
  v_cvt_pk_bf16_f32 v163, v114, v115
  v_mfma_f32_16x16x32_bf16 v[156:159], a[132:135], v[248:251], v[156:159]
  v_exp_f32 v168, v168
  v_mfma_f32_16x16x32_bf16 v[156:159], a[128:131], v[244:247], v[156:159]
  ds_read_b128 a[128:131], v11 offset:4096
  v_add_f32 v35, v35, v164
  v_mfma_f32_16x16x32_bf16 v[156:159], a[156:159], v[240:243], v[156:159]
  s_waitcnt lgkmcnt(2)
  v_exp_f32 v169, v169
  v_mfma_f32_16x16x32_bf16 v[96:99], a[140:143], v[192:195], v[40:43]
  s_add_u32 m0, s32, 40960
  v_exp_f32 v170, v170
  v_mfma_f32_16x16x32_bf16 v[96:99], a[144:147], v[196:199], v[96:99]
  buffer_load_dwordx4 v22, s[4:7], s34 offen offset:0 lds
  v_mfma_f32_16x16x32_bf16 v[96:99], a[148:151], v[200:203], v[96:99]
  v_exp_f32 v171, v171
  v_mfma_f32_16x16x32_bf16 v[96:99], a[152:155], v[204:207], v[96:99]
  ds_read_b128 a[156:159], v10 offset:4096
  v_add_f32 v35, v35, v165
  v_mfma_f32_16x16x32_bf16 v[100:103], a[152:155], v[220:223], v[44:47]
  v_exp_f32 v120, v120
  v_mfma_f32_16x16x32_bf16 v[100:103], a[148:151], v[216:219], v[100:103]
  ds_read_b128 a[132:135], v12 offset:4096
  v_cvt_pk_bf16_f32 v164, v164, v165
  v_mfma_f32_16x16x32_bf16 v[100:103], a[144:147], v[212:215], v[100:103]
  v_exp_f32 v121, v121
  v_mfma_f32_16x16x32_bf16 v[100:103], a[140:143], v[208:211], v[100:103]
  v_add_f32 v35, v35, v166
  v_add_f32 v35, v35, v167
  v_mfma_f32_16x16x32_bf16 v[104:107], a[140:143], v[224:227], v[48:51]
  v_exp_f32 v122, v122
  v_mfma_f32_16x16x32_bf16 v[104:107], a[144:147], v[228:231], v[104:107]
  v_exp_f32 v123, v123
  v_mfma_f32_16x16x32_bf16 v[104:107], a[148:151], v[232:235], v[104:107]
  v_cvt_pk_bf16_f32 v165, v166, v167
  v_add_f32 v35, v35, v116
  v_mfma_f32_16x16x32_bf16 v[104:107], a[152:155], v[236:239], v[104:107]
  v_exp_f32 v172, v172
  v_mfma_f32_16x16x32_bf16 v[108:111], a[152:155], v[252:255], v[52:55]
  buffer_load_dwordx4 v23, s[4:7], s34 offen offset:1024 lds
  v_mfma_f32_16x16x32_bf16 v[108:111], a[148:151], v[248:251], v[108:111]
  s_add_u32 s34, s34, 8192
  v_exp_f32 v173, v173
  v_mfma_f32_16x16x32_bf16 v[108:111], a[144:147], v[244:247], v[108:111]
  s_and_b32 s34, s34, 0x7ffff
  v_add_f32 v35, v35, v117
  v_cvt_pk_bf16_f32 v166, v116, v117
  v_mfma_f32_16x16x32_bf16 v[108:111], a[140:143], v[240:243], v[108:111]
  s_waitcnt lgkmcnt(0)
  v_exp_f32 v174, v174
  v_mfma_f32_16x16x32_bf16 v[112:115], a[156:159], v[192:195], v[40:43]
  v_exp_f32 v175, v175
  v_mfma_f32_16x16x32_bf16 v[112:115], a[128:131], v[196:199], v[112:115]
  s_waitcnt vmcnt(9)
  ds_read_b64_tr_b16 a[140:141], v28 offset:4096
  v_add_f32 v35, v35, v118
  v_mfma_f32_16x16x32_bf16 v[112:115], a[132:135], v[200:203], v[112:115]
  v_exp_f32 v124, v124
  v_mfma_f32_16x16x32_bf16 v[112:115], a[136:139], v[204:207], v[112:115]
  ds_read_b64_tr_b16 a[142:143], v28 offset:6144
  v_add_f32 v35, v35, v119
  v_cvt_pk_bf16_f32 v167, v118, v119
  v_mfma_f32_16x16x32_bf16 v[116:119], a[136:139], v[220:223], v[44:47]
  v_exp_f32 v125, v125
  v_mfma_f32_16x16x32_bf16 v[116:119], a[132:135], v[216:219], v[116:119]
  ds_read_b64_tr_b16 a[144:145], v29 offset:4096
  v_add_f32 v36, v36, v168
  v_mfma_f32_16x16x32_bf16 v[116:119], a[128:131], v[212:215], v[116:119]
  s_add_u32 m0, s33, 8192
  v_exp_f32 v126, v126
  v_mfma_f32_16x16x32_bf16 v[116:119], a[156:159], v[208:211], v[116:119]
  buffer_load_dwordx4 v24, s[8:11], s35 offen offset:0 lds
  v_add_f32 v36, v36, v169
  v_cvt_pk_bf16_f32 v168, v168, v169
  v_add_f32 v36, v36, v170
  v_add_f32 v36, v36, v171
  v_cvt_pk_bf16_f32 v169, v170, v171
  v_add_f32 v36, v36, v120
  v_add_f32 v36, v36, v121
  v_cvt_pk_bf16_f32 v170, v120, v121
  v_add_f32 v36, v36, v122
  v_add_f32 v36, v36, v123
  v_cvt_pk_bf16_f32 v171, v122, v123
  v_mfma_f32_16x16x32_bf16 v[120:123], a[156:159], v[224:227], v[48:51]
  v_exp_f32 v127, v127
  v_mfma_f32_16x16x32_bf16 v[120:123], a[128:131], v[228:231], v[120:123]
  ds_read_b64_tr_b16 a[146:147], v29 offset:6144
  v_cvt_pk_bf16_f32 v172, v172, v173
  v_mfma_f32_16x16x32_bf16 v[120:123], a[132:135], v[232:235], v[120:123]
  v_exp_f32 v176, v176
  v_mfma_f32_16x16x32_bf16 v[120:123], a[136:139], v[236:239], v[120:123]
  ds_read_b64_tr_b16 a[148:149], v30 offset:4096
  v_cvt_pk_bf16_f32 v173, v174, v175
  v_cvt_pk_bf16_f32 v174, v124, v125
  v_cvt_pk_bf16_f32 v175, v126, v127
  v_mfma_f32_16x16x32_bf16 v[124:127], a[136:139], v[252:255], v[52:55]
  ds_read_b64_tr_b16 a[150:151], v30 offset:6144
  v_add_f32 v34, v34, v176
  v_mfma_f32_16x16x32_bf16 v[124:127], a[132:135], v[248:251], v[124:127]
  v_exp_f32 v177, v177
  v_mfma_f32_16x16x32_bf16 v[124:127], a[128:131], v[244:247], v[124:127]
  ds_read_b64_tr_b16 a[152:153], v31 offset:4096
  v_add_f32 v34, v34, v177
  v_mfma_f32_16x16x32_bf16 v[124:127], a[156:159], v[240:243], v[124:127]
  s_waitcnt lgkmcnt(5)
  buffer_load_dwordx4 v25, s[8:11], s35 offen offset:1024 lds
  v_mfma_f32_16x16x32_bf16 a[160:163], a[140:143], v[76:79], 0
  s_add_u32 s35, s35, 8192
  v_exp_f32 v178, v178
  v_mfma_f32_16x16x32_bf16 a[164:167], a[140:143], v[80:83], 0
  s_and_b32 s35, s35, 0x7ffff
  ds_read_b64_tr_b16 a[154:155], v31 offset:6144
  v_cvt_pk_bf16_f32 v176, v176, v177
  v_mfma_f32_16x16x32_bf16 a[168:171], a[140:143], v[84:87], 0
  v_exp_f32 v179, v179
  v_mfma_f32_16x16x32_bf16 a[172:175], a[140:143], v[88:91], 0
  ds_read_b64_tr_b16 a[156:157], v14 offset:40960
  v_add_f32 v34, v34, v178
  v_mfma_f32_16x16x32_bf16 a[176:179], a[140:143], v[92:95], 0
  s_waitcnt lgkmcnt(5)
  ds_read_b64_tr_b16 a[158:159], v14 offset:45056
  v_add_f32 v34, v34, v179
  v_mfma_f32_16x16x32_bf16 a[180:183], a[144:147], v[76:79], 0
  v_exp_f32 v144, v144
  v_mfma_f32_16x16x32_bf16 a[184:187], a[144:147], v[80:83], 0
  ds_read_b64_tr_b16 a[128:129], v14 offset:49152
  v_cvt_pk_bf16_f32 v177, v178, v179
  v_mfma_f32_16x16x32_bf16 a[188:191], a[144:147], v[84:87], 0
  ds_read_b64_tr_b16 a[130:131], v14 offset:53248
  v_add_f32 v34, v34, v144
  v_mfma_f32_16x16x32_bf16 a[192:195], a[144:147], v[88:91], 0
  s_add_u32 m0, s33, 16384
  v_exp_f32 v145, v145
  v_mfma_f32_16x16x32_bf16 a[196:199], a[144:147], v[92:95], 0
  s_waitcnt lgkmcnt(6)
  buffer_load_dwordx4 v24, s[8:11], s35 offen offset:0 lds
  v_mfma_f32_16x16x32_bf16 a[200:203], a[148:151], v[76:79], 0
  ds_read_b64_tr_b16 a[132:133], v15 offset:40960
  v_add_f32 v34, v34, v145
  v_mfma_f32_16x16x32_bf16 a[204:207], a[148:151], v[80:83], 0
  v_exp_f32 v146, v146
  v_mfma_f32_16x16x32_bf16 a[208:211], a[148:151], v[84:87], 0
  ds_read_b64_tr_b16 a[134:135], v15 offset:45056
  v_cvt_pk_bf16_f32 v178, v144, v145
  v_mfma_f32_16x16x32_bf16 a[212:215], a[148:151], v[88:91], 0
  ds_read_b64_tr_b16 a[136:137], v15 offset:49152
  v_add_f32 v34, v34, v146
  v_mfma_f32_16x16x32_bf16 a[216:219], a[148:151], v[92:95], 0
  s_waitcnt lgkmcnt(7)
  v_exp_f32 v147, v147
  v_mfma_f32_16x16x32_bf16 a[220:223], a[152:155], v[76:79], 0
  ds_read_b64_tr_b16 a[138:139], v15 offset:53248
  v_add_f32 v34, v34, v147
  v_mfma_f32_16x16x32_bf16 a[224:227], a[152:155], v[80:83], 0
  buffer_load_dwordx4 v25, s[8:11], s35 offen offset:1024 lds
  v_mfma_f32_16x16x32_bf16 a[228:231], a[152:155], v[84:87], 0
  s_add_u32 s35, s35, 8192
  v_exp_f32 v180, v180
  v_mfma_f32_16x16x32_bf16 a[232:235], a[152:155], v[88:91], 0
  s_and_b32 s35, s35, 0x7ffff
  ds_read_b64_tr_b16 a[140:141], v16 offset:40960
  v_cvt_pk_bf16_f32 v179, v146, v147
  v_mfma_f32_16x16x32_bf16 a[236:239], a[152:155], v[92:95], 0
  s_waitcnt lgkmcnt(5)
  ds_read_b64_tr_b16 a[142:143], v16 offset:45056
  v_add_f32 v35, v35, v180
  v_mfma_f32_16x16x32_bf16 a[0:3], a[156:159], v[128:131], a[0:3]
  v_exp_f32 v181, v181
  v_mfma_f32_16x16x32_bf16 a[0:3], a[128:131], v[160:163], a[0:3]
  ds_read_b64_tr_b16 a[144:145], v16 offset:49152
  v_add_f32 v35, v35, v181
  v_mfma_f32_16x16x32_bf16 a[4:7], a[128:131], v[164:167], a[4:7]
  v_exp_f32 v182, v182
  v_mfma_f32_16x16x32_bf16 a[4:7], a[156:159], v[132:135], a[4:7]
  s_add_u32 m0, s69, 4096
  ds_read_b64_tr_b16 a[146:147], v16 offset:53248
  v_cvt_pk_bf16_f32 v180, v180, v181
  v_mfma_f32_16x16x32_bf16 a[8:11], a[156:159], v[136:139], a[8:11]
  buffer_load_dwordx4 v32, s[12:15], s66 offen lds
  v_mfma_f32_16x16x32_bf16 a[8:11], a[128:131], v[168:171], a[8:11]
  s_add_u32 s66, s66, s68
  v_exp_f32 v183, v183
  v_mfma_f32_16x16x32_bf16 a[12:15], a[128:131], v[172:175], a[12:15]
  ds_read_b64_tr_b16 a[152:153], v17 offset:40960
  v_add_f32 v35, v35, v182
  v_mfma_f32_16x16x32_bf16 a[12:15], a[156:159], v[140:143], a[12:15]
  s_waitcnt lgkmcnt(5)
  ds_read_b64_tr_b16 a[154:155], v17 offset:45056
  v_add_f32 v35, v35, v183
  v_mfma_f32_16x16x32_bf16 a[16:19], a[132:135], v[128:131], a[16:19]
  v_exp_f32 v148, v148
  v_mfma_f32_16x16x32_bf16 a[16:19], a[136:139], v[160:163], a[16:19]
  ds_read_b64_tr_b16 a[156:157], v17 offset:49152
  v_cvt_pk_bf16_f32 v181, v182, v183
  v_mfma_f32_16x16x32_bf16 a[20:23], a[136:139], v[164:167], a[20:23]
  ds_read_b64_tr_b16 a[158:159], v17 offset:53248
  v_add_f32 v35, v35, v148
  v_mfma_f32_16x16x32_bf16 a[20:23], a[132:135], v[132:135], a[20:23]
  s_add_u32 m0, s69, 5120
  v_exp_f32 v149, v149
  v_mfma_f32_16x16x32_bf16 a[24:27], a[132:135], v[136:139], a[24:27]
  buffer_load_dwordx4 v32, s[12:15], s66 offen lds
  v_mfma_f32_16x16x32_bf16 a[24:27], a[136:139], v[168:171], a[24:27]
  s_add_u32 s66, s66, s68
  ds_read_b64_tr_b16 a[128:129], v18 offset:40960
  v_add_f32 v35, v35, v149
  v_mfma_f32_16x16x32_bf16 a[28:31], a[136:139], v[172:175], a[28:31]
  v_exp_f32 v150, v150
  v_mfma_f32_16x16x32_bf16 a[28:31], a[132:135], v[140:143], a[28:31]
  s_waitcnt lgkmcnt(5)
  ds_read_b64_tr_b16 a[130:131], v18 offset:45056
  v_cvt_pk_bf16_f32 v182, v148, v149
  v_mfma_f32_16x16x32_bf16 a[32:35], a[140:143], v[128:131], a[32:35]
  ds_read_b64_tr_b16 a[132:133], v18 offset:49152
  v_add_f32 v35, v35, v150
  v_mfma_f32_16x16x32_bf16 a[32:35], a[144:147], v[160:163], a[32:35]
  s_add_u32 m0, s69, 6144
  v_exp_f32 v151, v151
  v_mfma_f32_16x16x32_bf16 a[36:39], a[144:147], v[164:167], a[36:39]
  buffer_load_dwordx4 v32, s[12:15], s66 offen lds
  v_mfma_f32_16x16x32_bf16 a[36:39], a[140:143], v[132:135], a[36:39]
  s_add_u32 s66, s66, s68
  v_exp_f32 v184, v184
  v_mfma_f32_16x16x32_bf16 a[40:43], a[140:143], v[136:139], a[40:43]
  ds_read_b64_tr_b16 a[134:135], v18 offset:53248
  v_add_f32 v35, v35, v151
  v_mfma_f32_16x16x32_bf16 a[40:43], a[144:147], v[168:171], a[40:43]
  ds_read_b64_tr_b16 a[136:137], v19 offset:40960
  v_cvt_pk_bf16_f32 v183, v150, v151
  v_mfma_f32_16x16x32_bf16 a[44:47], a[144:147], v[172:175], a[44:47]
  v_exp_f32 v185, v185
  v_mfma_f32_16x16x32_bf16 a[44:47], a[140:143], v[140:143], a[44:47]
  s_waitcnt lgkmcnt(5)
  ds_read_b64_tr_b16 a[138:139], v19 offset:45056
  v_add_f32 v36, v36, v184
  v_mfma_f32_16x16x32_bf16 a[48:51], a[152:155], v[128:131], a[48:51]
  ds_read_b64_tr_b16 a[140:141], v19 offset:49152
  v_add_f32 v36, v36, v185
  v_mfma_f32_16x16x32_bf16 a[48:51], a[156:159], v[160:163], a[48:51]
  s_add_u32 m0, s69, 7168
  v_exp_f32 v186, v186
  v_mfma_f32_16x16x32_bf16 a[52:55], a[156:159], v[164:167], a[52:55]
  buffer_load_dwordx4 v32, s[12:15], s66 offen lds
  v_mfma_f32_16x16x32_bf16 a[52:55], a[152:155], v[132:135], a[52:55]
  s_add_u32 s66, s66, s70
  ds_read_b64_tr_b16 a[142:143], v19 offset:53248
  v_cvt_pk_bf16_f32 v184, v184, v185
  v_mfma_f32_16x16x32_bf16 a[56:59], a[152:155], v[136:139], a[56:59]
  v_exp_f32 v187, v187
  v_mfma_f32_16x16x32_bf16 a[56:59], a[156:159], v[168:171], a[56:59]
  ds_read_b64_tr_b16 a[144:145], v20 offset:40960
  v_add_f32 v36, v36, v186
  v_mfma_f32_16x16x32_bf16 a[60:63], a[156:159], v[172:175], a[60:63]
  ds_read_b64_tr_b16 a[146:147], v20 offset:45056
  v_add_f32 v36, v36, v187
  v_mfma_f32_16x16x32_bf16 a[60:63], a[152:155], v[140:143], a[60:63]
  s_waitcnt lgkmcnt(6)
  v_exp_f32 v152, v152
  v_mfma_f32_16x16x32_bf16 a[64:67], a[128:131], v[128:131], a[64:67]
  ds_read_b64_tr_b16 a[148:149], v20 offset:49152
  v_cvt_pk_bf16_f32 v185, v186, v187
  v_mfma_f32_16x16x32_bf16 a[64:67], a[132:135], v[160:163], a[64:67]
  buffer_load_dwordx4 v[76:79], v26, s[16:19], s67 offen offset:0 sc1
  v_mfma_f32_16x16x32_bf16 a[68:71], a[132:135], v[164:167], a[68:71]
  v_exp_f32 v153, v153
  v_mfma_f32_16x16x32_bf16 a[68:71], a[128:131], v[132:135], a[68:71]
  ds_read_b64_tr_b16 a[150:151], v20 offset:53248
  v_add_f32 v36, v36, v152
  v_mfma_f32_16x16x32_bf16 a[72:75], a[128:131], v[136:139], a[72:75]
  v_exp_f32 v154, v154
  v_mfma_f32_16x16x32_bf16 a[72:75], a[132:135], v[168:171], a[72:75]
  ds_read_b64_tr_b16 a[152:153], v21 offset:40960
  v_add_f32 v36, v36, v153
  v_mfma_f32_16x16x32_bf16 a[76:79], a[132:135], v[172:175], a[76:79]
  ds_read_b64_tr_b16 a[154:155], v21 offset:45056
  v_cvt_pk_bf16_f32 v186, v152, v153
  v_mfma_f32_16x16x32_bf16 a[76:79], a[128:131], v[140:143], a[76:79]
  s_waitcnt lgkmcnt(6)
  v_exp_f32 v155, v155
  v_mfma_f32_16x16x32_bf16 a[80:83], a[136:139], v[128:131], a[80:83]
  buffer_load_dwordx4 v[80:83], v26, s[16:19], s67 offen offset:1024 sc1
  v_mfma_f32_16x16x32_bf16 a[80:83], a[140:143], v[160:163], a[80:83]
  ds_read_b64_tr_b16 a[156:157], v21 offset:49152
  v_add_f32 v36, v36, v154
  v_mfma_f32_16x16x32_bf16 a[84:87], a[140:143], v[164:167], a[84:87]
  v_exp_f32 v188, v188
  v_mfma_f32_16x16x32_bf16 a[84:87], a[136:139], v[132:135], a[84:87]
  ds_read_b64_tr_b16 a[158:159], v21 offset:53248
  v_add_f32 v36, v36, v155
  v_mfma_f32_16x16x32_bf16 a[88:91], a[136:139], v[136:139], a[88:91]
  v_cvt_pk_bf16_f32 v187, v154, v155
  v_mfma_f32_16x16x32_bf16 a[88:91], a[140:143], v[168:171], a[88:91]
  v_exp_f32 v189, v189
  v_mfma_f32_16x16x32_bf16 a[92:95], a[140:143], v[172:175], a[92:95]
  ds_read_b128 a[128:131], v10 offset:8192
  v_cvt_pk_bf16_f32 v188, v188, v189
  v_mfma_f32_16x16x32_bf16 a[92:95], a[136:139], v[140:143], a[92:95]
  s_waitcnt lgkmcnt(5)
  buffer_load_dwordx4 v[84:87], v26, s[16:19], s67 offen offset:2048 sc1
  v_mfma_f32_16x16x32_bf16 a[96:99], a[144:147], v[128:131], a[96:99]
  v_exp_f32 v190, v190
  v_mfma_f32_16x16x32_bf16 a[96:99], a[148:151], v[160:163], a[96:99]
  ds_read_b128 a[132:135], v11 offset:8192
  v_mfma_f32_16x16x32_bf16 a[100:103], a[148:151], v[164:167], a[100:103]
  ds_read_b128 a[136:139], v12 offset:8192
  v_mfma_f32_16x16x32_bf16 a[100:103], a[144:147], v[132:135], a[100:103]
  v_exp_f32 v191, v191
  v_mfma_f32_16x16x32_bf16 a[104:107], a[144:147], v[136:139], a[104:107]
  ds_read_b128 a[140:143], v13 offset:8192
  v_cvt_pk_bf16_f32 v189, v190, v191
  v_mfma_f32_16x16x32_bf16 a[104:107], a[148:151], v[168:171], a[104:107]
  v_mfma_f32_16x16x32_bf16 a[108:111], a[148:151], v[172:175], a[108:111]
  v_exp_f32 v156, v156
  v_mfma_f32_16x16x32_bf16 a[108:111], a[144:147], v[140:143], a[108:111]
  s_waitcnt lgkmcnt(4)
  buffer_load_dwordx4 v[88:91], v26, s[16:19], s67 offen offset:3072 sc1
  v_mfma_f32_16x16x32_bf16 a[112:115], a[152:155], v[128:131], a[112:115]
  v_exp_f32 v157, v157
  v_mfma_f32_16x16x32_bf16 a[112:115], a[156:159], v[160:163], a[112:115]
  v_cvt_pk_bf16_f32 v190, v156, v157
  v_mfma_f32_16x16x32_bf16 a[116:119], a[156:159], v[164:167], a[116:119]
  v_mfma_f32_16x16x32_bf16 a[116:119], a[152:155], v[132:135], a[116:119]
  v_exp_f32 v158, v158
  v_mfma_f32_16x16x32_bf16 a[120:123], a[152:155], v[136:139], a[120:123]
  v_mfma_f32_16x16x32_bf16 a[120:123], a[156:159], v[168:171], a[120:123]
  buffer_load_dwordx4 v[92:95], v27, s[16:19], s67 offen sc1
  v_mfma_f32_16x16x32_bf16 a[124:127], a[156:159], v[172:175], a[124:127]
  s_add_u32 s67, s67, 20480
  v_exp_f32 v159, v159
  v_mfma_f32_16x16x32_bf16 a[124:127], a[152:155], v[140:143], a[124:127]
  ds_read_b128 a[144:147], v10 offset:12288
  v_cvt_pk_bf16_f32 v191, v158, v159
  v_mfma_f32_16x16x32_bf16 a[240:243], a[248:251], v[136:139], a[240:243]
  v_mfma_f32_16x16x32_bf16 a[244:247], a[248:251], v[140:143], a[244:247]
  v_mfma_f32_16x16x32_bf16 a[244:247], a[248:251], v[172:175], a[244:247]
  s_waitcnt lgkmcnt(1)
  s_branch LOOP_A
LOOP_A_RET:
  v_mfma_f32_16x16x32_bf16 v[176:179], a[144:147], v[192:195], v[40:43]
  s_waitcnt vmcnt(27)
  v_exp_f32 v160, v160
  v_mfma_f32_16x16x32_bf16 v[176:179], a[148:151], v[196:199], v[176:179]
  s_barrier
  v_mfma_f32_16x16x32_bf16 v[176:179], a[152:155], v[200:203], v[176:179]
  ds_read_b128 a[132:135], v11 offset:28672
  ds_read_b128 a[140:143], v13 offset:28672
  v_mfma_f32_16x16x32_bf16 v[176:179], a[156:159], v[204:207], v[176:179]
  s_mov_b32 s71, 14811136
  v_exp_f32 v161, v161
  v_mfma_f32_16x16x32_bf16 v[180:183], a[156:159], v[220:223], v[44:47]
  s_mul_i32 s38, s75, 655360
  buffer_load_dword v39, v38, s[20:23], s71 offen sc1
  v_mfma_f32_16x16x32_bf16 v[180:183], a[152:155], v[216:219], v[180:183]
  s_add_u32 s38, s38, 9437184
  v_exp_f32 v162, v162
  v_mfma_f32_16x16x32_bf16 v[180:183], a[148:151], v[212:215], v[180:183]
  s_add_u32 s44, s64, s38
  s_addc_u32 s45, s65, 0
  ds_read_b128 a[136:139], v12 offset:28672
  v_add_f32 v34, v34, v160
  v_mfma_f32_16x16x32_bf16 v[180:183], a[144:147], v[208:211], v[180:183]
  s_and_b32 s45, s45, 0xffff
  v_exp_f32 v163, v163
  v_mfma_f32_16x16x32_bf16 v[184:187], a[144:147], v[224:227], v[48:51]
  s_mov_b32 s46, 655360
  v_add_f32 v34, v34, v161
  v_cvt_pk_bf16_f32 v160, v160, v161
  v_mfma_f32_16x16x32_bf16 v[184:187], a[148:151], v[228:231], v[184:187]
  s_and_b32 s76, s74, 1
  v_exp_f32 v112, v112
  v_mfma_f32_16x16x32_bf16 v[184:187], a[152:155], v[232:235], v[184:187]
  s_add_u32 m0, s33, 40960
  v_add_f32 v34, v34, v162
  v_add_f32 v34, v34, v163
  v_mfma_f32_16x16x32_bf16 v[184:187], a[156:159], v[236:239], v[184:187]
  s_mul_i32 s77, s28, 5120
  buffer_load_dwordx4 v24, s[8:11], s35 offen offset:0 lds
  v_mfma_f32_16x16x32_bf16 v[188:191], a[156:159], v[252:255], v[52:55]
  s_mul_i32 s38, s76, 327680
  v_exp_f32 v113, v113
  v_mfma_f32_16x16x32_bf16 v[188:191], a[152:155], v[248:251], v[188:191]
  s_add_u32 s77, s77, s38
  v_cvt_pk_bf16_f32 v161, v162, v163
  v_add_f32 v34, v34, v112
  v_mfma_f32_16x16x32_bf16 v[188:191], a[148:151], v[244:247], v[188:191]
  s_waitcnt lgkmcnt(0)
  v_exp_f32 v114, v114
  v_mfma_f32_16x16x32_bf16 v[188:191], a[144:147], v[240:243], v[188:191]
  s_waitcnt vmcnt(19)
  ds_read_b64_tr_b16 a[144:145], v28 offset:4096
  v_add_f32 v34, v34, v113
  v_mfma_f32_16x16x32_bf16 v[144:147], a[128:131], v[192:195], v[40:43]
  v_exp_f32 v115, v115
  v_mfma_f32_16x16x32_bf16 v[144:147], a[132:135], v[196:199], v[144:147]
  ds_read_b64_tr_b16 a[146:147], v28 offset:6144
  v_cvt_pk_bf16_f32 v162, v112, v113
  v_mfma_f32_16x16x32_bf16 v[144:147], a[136:139], v[200:203], v[144:147]
  v_exp_f32 v164, v164
  v_mfma_f32_16x16x32_bf16 v[144:147], a[140:143], v[204:207], v[144:147]
  ds_read_b64_tr_b16 a[148:149], v29 offset:4096
  v_add_f32 v34, v34, v114
  v_mfma_f32_16x16x32_bf16 v[148:151], a[140:143], v[220:223], v[44:47]
  ds_read_b64_tr_b16 a[150:151], v29 offset:6144
  v_add_f32 v34, v34, v115
  v_mfma_f32_16x16x32_bf16 v[148:151], a[136:139], v[216:219], v[148:151]
  v_exp_f32 v165, v165
  v_mfma_f32_16x16x32_bf16 v[148:151], a[132:135], v[212:215], v[148:151]
  buffer_load_dwordx4 v25, s[8:11], s35 offen offset:1024 lds
  v_mfma_f32_16x16x32_bf16 v[148:151], a[128:131], v[208:211], v[148:151]
  s_add_u32 s35, s35, 8192
  v_exp_f32 v166, v166
  v_mfma_f32_16x16x32_bf16 v[152:155], a[128:131], v[224:227], v[48:51]
  s_and_b32 s35, s35, 0x7ffff
  ds_read_b64_tr_b16 a[152:153], v30 offset:4096
  v_cvt_pk_bf16_f32 v163, v114, v115
  v_mfma_f32_16x16x32_bf16 v[152:155], a[132:135], v[228:231], v[152:155]
  v_exp_f32 v167, v167
  v_mfma_f32_16x16x32_bf16 v[152:155], a[136:139], v[232:235], v[152:155]
  ds_read_b64_tr_b16 a[154:155], v30 offset:6144
  v_add_f32 v35, v35, v164
  v_mfma_f32_16x16x32_bf16 v[152:155], a[140:143], v[236:239], v[152:155]
  v_exp_f32 v116, v116
  v_mfma_f32_16x16x32_bf16 v[156:159], a[140:143], v[252:255], v[52:55]
  ds_read_b64_tr_b16 a[156:157], v31 offset:4096
  v_add_f32 v35, v35, v165
  v_mfma_f32_16x16x32_bf16 v[156:159], a[136:139], v[248:251], v[156:159]
  v_exp_f32 v117, v117
  v_mfma_f32_16x16x32_bf16 v[156:159], a[132:135], v[244:247], v[156:159]
  ds_read_b64_tr_b16 a[158:159], v31 offset:6144
  v_cvt_pk_bf16_f32 v164, v164, v165
  v_mfma_f32_16x16x32_bf16 v[156:159], a[128:131], v[240:243], v[156:159]
  s_waitcnt lgkmcnt(6)
  ds_read_b128 a[128:131], v10 offset:32768
  v_add_f32 v35, v35, v166
  v_mfma_f32_16x16x32_bf16 a[160:163], a[144:147], v[76:79], a[160:163]
  v_exp_f32 v118, v118
  v_mfma_f32_16x16x32_bf16 a[164:167], a[144:147], v[80:83], a[164:167]
  ds_read_b128 a[132:135], v11 offset:32768
  v_add_f32 v35, v35, v167
  v_mfma_f32_16x16x32_bf16 a[168:171], a[144:147], v[84:87], a[168:171]
  s_add_u32 m0, s33, 49152
  v_exp_f32 v119, v119
  v_mfma_f32_16x16x32_bf16 a[172:175], a[144:147], v[88:91], a[172:175]
  buffer_load_dwordx4 v24, s[8:11], s35 offen offset:0 lds
  v_mfma_f32_16x16x32_bf16 a[176:179], a[144:147], v[92:95], a[176:179]
  s_waitcnt lgkmcnt(6)
  v_exp_f32 v168, v168
  v_mfma_f32_16x16x32_bf16 a[180:183], a[148:151], v[76:79], a[180:183]
  ds_read_b128 a[136:139], v12 offset:32768
  v_cvt_pk_bf16_f32 v165, v166, v167
  v_mfma_f32_16x16x32_bf16 a[184:187], a[148:151], v[80:83], a[184:187]
  v_exp_f32 v169, v169
  v_mfma_f32_16x16x32_bf16 a[188:191], a[148:151], v[84:87], a[188:191]
  ds_read_b128 a[140:143], v13 offset:32768
  v_add_f32 v35, v35, v116
  v_mfma_f32_16x16x32_bf16 a[192:195], a[148:151], v[88:91], a[192:195]
  v_add_f32 v35, v35, v117
  v_cvt_pk_bf16_f32 v166, v116, v117
  v_mfma_f32_16x16x32_bf16 a[196:199], a[148:151], v[92:95], a[196:199]
  s_waitcnt lgkmcnt(6)
  v_exp_f32 v170, v170
  v_mfma_f32_16x16x32_bf16 a[200:203], a[152:155], v[76:79], a[200:203]
  v_add_f32 v35, v35, v118
  v_add_f32 v35, v35, v119
  v_mfma_f32_16x16x32_bf16 a[204:207], a[152:155], v[80:83], a[204:207]
  v_exp_f32 v171, v171
  v_mfma_f32_16x16x32_bf16 a[208:211], a[152:155], v[84:87], a[208:211]
  s_waitcnt vmcnt(3)
  v_cmp_ne_u32 vcc, s31, v39
  s_cbranch_vccz POLL_R_OK
  s_mov_b32 s71, 14811136
  s_mov_b32 s79, 0
POLL_R:
  buffer_load_dword v39, v38, s[20:23], s71 offen sc1
  s_add_u32 s79, s79, 1
  s_waitcnt vmcnt(0)
  v_cmp_ne_u32 vcc, s31, v39
  s_cmp_gt_u32 s79, 1048576
  s_cbranch_scc1 POLL_R_X
  s_cbranch_vccnz POLL_R
POLL_R_X:
POLL_R_OK:
  v_cvt_pk_bf16_f32 v167, v118, v119
  v_add_f32 v36, v36, v168
  v_mfma_f32_16x16x32_bf16 a[212:215], a[152:155], v[88:91], a[212:215]
  v_exp_f32 v120, v120
  v_mfma_f32_16x16x32_bf16 a[216:219], a[152:155], v[92:95], a[216:219]
  s_waitcnt lgkmcnt(4)
  buffer_load_dwordx4 v25, s[8:11], s35 offen offset:1024 lds
  v_mfma_f32_16x16x32_bf16 a[220:223], a[156:159], v[76:79], a[220:223]
  s_add_u32 s35, s35, 8192
  v_exp_f32 v121, v121
  v_mfma_f32_16x16x32_bf16 a[224:227], a[156:159], v[80:83], a[224:227]
  s_and_b32 s35, s35, 0x7ffff
  ds_read_b128 a[144:147], v10 offset:36864
  v_add_f32 v36, v36, v169
  v_mfma_f32_16x16x32_bf16 a[228:231], a[156:159], v[84:87], a[228:231]
  v_exp_f32 v122, v122
  v_mfma_f32_16x16x32_bf16 a[232:235], a[156:159], v[88:91], a[232:235]
  ds_read_b128 a[148:151], v11 offset:36864
  v_cvt_pk_bf16_f32 v168, v168, v169
  v_mfma_f32_16x16x32_bf16 a[236:239], a[156:159], v[92:95], a[236:239]
  s_waitcnt lgkmcnt(2)
  ds_read_b128 a[152:155], v12 offset:36864
  v_add_f32 v36, v36, v170
  v_mfma_f32_16x16x32_bf16 v[96:99], a[128:131], v[192:195], v[40:43]
  v_exp_f32 v123, v123
  v_mfma_f32_16x16x32_bf16 v[96:99], a[132:135], v[196:199], v[96:99]
  ds_read_b128 a[156:159], v13 offset:36864
  v_add_f32 v36, v36, v171
  v_mfma_f32_16x16x32_bf16 v[96:99], a[136:139], v[200:203], v[96:99]
  s_add_u32 m0, s69, 4096
  v_exp_f32 v172, v172
  v_mfma_f32_16x16x32_bf16 v[96:99], a[140:143], v[204:207], v[96:99]
  buffer_load_dwordx4 v32, s[12:15], s66 offen lds
  v_mfma_f32_16x16x32_bf16 v[100:103], a[140:143], v[220:223], v[44:47]
  s_add_u32 s66, s66, s68
  v_exp_f32 v173, v173
  v_mfma_f32_16x16x32_bf16 v[100:103], a[136:139], v[216:219], v[100:103]
  v_cvt_pk_bf16_f32 v169, v170, v171
  v_add_f32 v36, v36, v120
  v_mfma_f32_16x16x32_bf16 v[100:103], a[132:135], v[212:215], v[100:103]
  v_exp_f32 v174, v174
  v_mfma_f32_16x16x32_bf16 v[100:103], a[128:131], v[208:211], v[100:103]
  s_add_u32 m0, s69, 5120
  v_add_f32 v36, v36, v121
  v_cvt_pk_bf16_f32 v170, v120, v121
  v_mfma_f32_16x16x32_bf16 v[104:107], a[128:131], v[224:227], v[48:51]
  buffer_load_dwordx4 v32, s[12:15], s66 offen lds
  v_mfma_f32_16x16x32_bf16 v[104:107], a[132:135], v[228:231], v[104:107]
  s_add_u32 s66, s66, s68
  v_exp_f32 v175, v175
  v_mfma_f32_16x16x32_bf16 v[104:107], a[136:139], v[232:235], v[104:107]
  v_add_f32 v36, v36, v122
  v_add_f32 v36, v36, v123
  v_mfma_f32_16x16x32_bf16 v[104:107], a[140:143], v[236:239], v[104:107]
  v_exp_f32 v124, v124
  v_mfma_f32_16x16x32_bf16 v[108:111], a[140:143], v[252:255], v[52:55]
  ds_read_b64_tr_b16 a[142:143], v15 offset:20480
  v_cvt_pk_bf16_f32 v171, v122, v123
  v_mfma_f32_16x16x32_bf16 v[108:111], a[136:139], v[248:251], v[108:111]
  v_exp_f32 v125, v125
  v_mfma_f32_16x16x32_bf16 v[108:111], a[132:135], v[244:247], v[108:111]
  s_waitcnt lgkmcnt(1)
  ds_read_b64_tr_b16 a[132:133], v14 offset:16384
  v_cvt_pk_bf16_f32 v172, v172, v173
  v_mfma_f32_16x16x32_bf16 v[108:111], a[128:131], v[240:243], v[108:111]
  s_add_u32 m0, s69, 6144
  v_exp_f32 v126, v126
  v_mfma_f32_16x16x32_bf16 v[112:115], a[144:147], v[192:195], v[40:43]
  buffer_load_dwordx4 v32, s[12:15], s66 offen lds
  v_mfma_f32_16x16x32_bf16 v[112:115], a[148:151], v[196:199], v[112:115]
  s_add_u32 s66, s66, s68
  v_exp_f32 v127, v127
  v_mfma_f32_16x16x32_bf16 v[112:115], a[152:155], v[200:203], v[112:115]
  ds_read_b64_tr_b16 a[128:129], v14 offset:8192
  v_cvt_pk_bf16_f32 v173, v174, v175
  v_mfma_f32_16x16x32_bf16 v[112:115], a[156:159], v[204:207], v[112:115]
  ds_read_b64_tr_b16 a[130:131], v14 offset:12288
  v_cvt_pk_bf16_f32 v174, v124, v125
  v_mfma_f32_16x16x32_bf16 v[116:119], a[156:159], v[220:223], v[44:47]
  s_add_u32 m0, s69, 7168
  v_exp_f32 v176, v176
  v_mfma_f32_16x16x32_bf16 v[116:119], a[152:155], v[216:219], v[116:119]
  buffer_load_dwordx4 v32, s[12:15], s66 offen lds
  v_mfma_f32_16x16x32_bf16 v[116:119], a[148:151], v[212:215], v[116:119]
  s_add_u32 s66, s66, s70
  v_exp_f32 v177, v177
  v_mfma_f32_16x16x32_bf16 v[116:119], a[144:147], v[208:211], v[116:119]
  ds_read_b64_tr_b16 a[134:135], v14 offset:20480
  v_cvt_pk_bf16_f32 v175, v126, v127
  v_mfma_f32_16x16x32_bf16 v[120:123], a[144:147], v[224:227], v[48:51]
  v_exp_f32 v178, v178
  v_mfma_f32_16x16x32_bf16 v[120:123], a[148:151], v[228:231], v[120:123]
  ds_read_b64_tr_b16 a[136:137], v15 offset:8192
  v_add_f32 v34, v34, v176
  v_mfma_f32_16x16x32_bf16 v[120:123], a[152:155], v[232:235], v[120:123]
  buffer_load_dwordx4 v[76:79], v26, s[16:19], s67 offen offset:0 sc1
  v_mfma_f32_16x16x32_bf16 v[120:123], a[156:159], v[236:239], v[120:123]
  v_exp_f32 v179, v179
  v_mfma_f32_16x16x32_bf16 v[124:127], a[156:159], v[252:255], v[52:55]
  ds_read_b64_tr_b16 a[138:139], v15 offset:12288
  v_add_f32 v34, v34, v177
  v_mfma_f32_16x16x32_bf16 v[124:127], a[152:155], v[248:251], v[124:127]
  v_exp_f32 v144, v144
  v_mfma_f32_16x16x32_bf16 v[124:127], a[148:151], v[244:247], v[124:127]
  ds_read_b64_tr_b16 a[140:141], v15 offset:16384
  ds_read_b64_tr_b16 a[150:151], v16 offset:20480
  v_mfma_f32_16x16x32_bf16 v[124:127], a[144:147], v[240:243], v[124:127]
  s_waitcnt lgkmcnt(4)
  buffer_load_dwordx4 v[80:83], v26, s[16:19], s67 offen offset:1024 sc1
  v_mfma_f32_16x16x32_bf16 a[0:3], a[128:131], v[128:131], a[0:3]
  v_exp_f32 v145, v145
  v_mfma_f32_16x16x32_bf16 a[0:3], a[132:135], v[160:163], a[0:3]
  ds_read_b64_tr_b16 a[144:145], v16 offset:8192
  v_cvt_pk_bf16_f32 v176, v176, v177
  v_mfma_f32_16x16x32_bf16 a[4:7], a[132:135], v[164:167], a[4:7]
  v_exp_f32 v146, v146
  v_mfma_f32_16x16x32_bf16 a[4:7], a[128:131], v[132:135], a[4:7]
  ds_read_b64_tr_b16 a[146:147], v16 offset:12288
  v_add_f32 v34, v34, v178
  v_mfma_f32_16x16x32_bf16 a[8:11], a[128:131], v[136:139], a[8:11]
  v_exp_f32 v147, v147
  v_mfma_f32_16x16x32_bf16 a[8:11], a[132:135], v[168:171], a[8:11]
  buffer_load_dwordx4 v[84:87], v26, s[16:19], s67 offen offset:2048 sc1
  v_mfma_f32_16x16x32_bf16 a[12:15], a[132:135], v[172:175], a[12:15]
  ds_read_b64_tr_b16 a[148:149], v16 offset:16384
  ds_read_b64_tr_b16 a[132:133], v18 offset:16384
  v_mfma_f32_16x16x32_bf16 a[12:15], a[128:131], v[140:143], a[12:15]
  s_waitcnt lgkmcnt(5)
  v_exp_f32 v180, v180
  v_mfma_f32_16x16x32_bf16 a[16:19], a[136:139], v[128:131], a[16:19]
  ds_read_b64_tr_b16 a[152:153], v17 offset:8192
  ds_read_b64_tr_b16 a[134:135], v18 offset:20480
  v_mfma_f32_16x16x32_bf16 a[16:19], a[140:143], v[160:163], a[16:19]
  v_exp_f32 v181, v181
  v_mfma_f32_16x16x32_bf16 a[20:23], a[140:143], v[164:167], a[20:23]
  ds_read_b64_tr_b16 a[154:155], v17 offset:12288
  v_add_f32 v34, v34, v179
  v_mfma_f32_16x16x32_bf16 a[20:23], a[136:139], v[132:135], a[20:23]
  v_exp_f32 v182, v182
  v_mfma_f32_16x16x32_bf16 a[24:27], a[136:139], v[136:139], a[24:27]
  buffer_load_dwordx4 v[88:91], v26, s[16:19], s67 offen offset:3072 sc1
  v_mfma_f32_16x16x32_bf16 a[24:27], a[140:143], v[168:171], a[24:27]
  ds_read_b64_tr_b16 a[156:157], v17 offset:16384
  v_cvt_pk_bf16_f32 v177, v178, v179
  v_mfma_f32_16x16x32_bf16 a[28:31], a[140:143], v[172:175], a[28:31]
  v_exp_f32 v183, v183
  v_mfma_f32_16x16x32_bf16 a[28:31], a[136:139], v[140:143], a[28:31]
  s_waitcnt lgkmcnt(5)
  ds_read_b64_tr_b16 a[158:159], v17 offset:20480
  v_add_f32 v34, v34, v144
  v_mfma_f32_16x16x32_bf16 a[32:35], a[144:147], v[128:131], a[32:35]
  v_exp_f32 v148, v148
  v_mfma_f32_16x16x32_bf16 a[32:35], a[148:151], v[160:163], a[32:35]
  buffer_load_dwordx4 v[92:95], v27, s[16:19], s67 offen sc1
  v_mfma_f32_16x16x32_bf16 a[36:39], a[148:151], v[164:167], a[36:39]
  s_add_u32 s67, s67, 20480
  ds_read_b64_tr_b16 a[128:129], v18 offset:8192
  v_add_f32 v34, v34, v145
  v_mfma_f32_16x16x32_bf16 a[36:39], a[144:147], v[132:135], a[36:39]
  v_exp_f32 v149, v149
  v_mfma_f32_16x16x32_bf16 a[40:43], a[144:147], v[136:139], a[40:43]
  s_add_u32 m0, s78, 4294901760
  ds_read_b64_tr_b16 a[130:131], v18 offset:12288
  v_cvt_pk_bf16_f32 v178, v144, v145
  v_mfma_f32_16x16x32_bf16 a[40:43], a[148:151], v[168:171], a[40:43]
  s_add_u32 s42, s77, 266240
  v_exp_f32 v150, v150
  v_mfma_f32_16x16x32_bf16 a[44:47], a[148:151], v[172:175], a[44:47]
  s_waitcnt lgkmcnt(2)
  buffer_load_dwordx4 v26, s[44:47], s42 offen sc1 lds
  v_mfma_f32_16x16x32_bf16 a[44:47], a[144:147], v[140:143], a[44:47]
  s_add_u32 s42, s42, 1024
  v_exp_f32 v151, v151
  v_mfma_f32_16x16x32_bf16 a[48:51], a[152:155], v[128:131], a[48:51]
  ds_read_b64_tr_b16 a[136:137], v19 offset:8192
  v_add_f32 v34, v34, v146
  v_mfma_f32_16x16x32_bf16 a[48:51], a[156:159], v[160:163], a[48:51]
  ds_read_b64_tr_b16 a[138:139], v19 offset:12288
  v_add_f32 v34, v34, v147
  v_mfma_f32_16x16x32_bf16 a[52:55], a[156:159], v[164:167], a[52:55]
  v_exp_f32 v184, v184
  v_mfma_f32_16x16x32_bf16 a[52:55], a[152:155], v[132:135], a[52:55]
  ds_read_b64_tr_b16 a[140:141], v19 offset:16384
  v_cvt_pk_bf16_f32 v179, v146, v147
  v_mfma_f32_16x16x32_bf16 a[56:59], a[152:155], v[136:139], a[56:59]
  s_add_u32 m0, s78, 4294905856
  v_exp_f32 v185, v185
  v_mfma_f32_16x16x32_bf16 a[56:59], a[156:159], v[168:171], a[56:59]
  buffer_load_dwordx4 v26, s[44:47], s42 offen sc1 lds
  v_mfma_f32_16x16x32_bf16 a[60:63], a[156:159], v[172:175], a[60:63]
  s_add_u32 s42, s42, 1024
  v_exp_f32 v186, v186
  v_mfma_f32_16x16x32_bf16 a[60:63], a[152:155], v[140:143], a[60:63]
  s_waitcnt lgkmcnt(3)
  ds_read_b64_tr_b16 a[142:143], v19 offset:20480
  ds_read_b64_tr_b16 a[158:159], v21 offset:20480
  v_mfma_f32_16x16x32_bf16 a[64:67], a[128:131], v[128:131], a[64:67]
  ds_read_b64_tr_b16 a[144:145], v20 offset:8192
  v_add_f32 v35, v35, v180
  v_mfma_f32_16x16x32_bf16 a[64:67], a[132:135], v[160:163], a[64:67]
  v_exp_f32 v187, v187
  v_mfma_f32_16x16x32_bf16 a[68:71], a[132:135], v[164:167], a[68:71]
  ds_read_b64_tr_b16 a[146:147], v20 offset:12288
  v_add_f32 v35, v35, v181
  v_mfma_f32_16x16x32_bf16 a[68:71], a[128:131], v[132:135], a[68:71]
  s_add_u32 m0, s78, 4294909952
  v_exp_f32 v152, v152
  v_mfma_f32_16x16x32_bf16 a[72:75], a[128:131], v[136:139], a[72:75]
  buffer_load_dwordx4 v26, s[44:47], s42 offen sc1 lds
  v_mfma_f32_16x16x32_bf16 a[72:75], a[132:135], v[168:171], a[72:75]
  s_add_u32 s42, s42, 1024
  ds_read_b64_tr_b16 a[148:149], v20 offset:16384
  v_cvt_pk_bf16_f32 v180, v180, v181
  v_mfma_f32_16x16x32_bf16 a[76:79], a[132:135], v[172:175], a[76:79]
  v_exp_f32 v153, v153
  v_mfma_f32_16x16x32_bf16 a[76:79], a[128:131], v[140:143], a[76:79]
  s_waitcnt lgkmcnt(4)
  ds_read_b64_tr_b16 a[150:151], v20 offset:20480
  v_add_f32 v35, v35, v182
  v_mfma_f32_16x16x32_bf16 a[80:83], a[136:139], v[128:131], a[80:83]
  v_exp_f32 v154, v154
  v_mfma_f32_16x16x32_bf16 a[80:83], a[140:143], v[160:163], a[80:83]
  ds_read_b64_tr_b16 a[152:153], v21 offset:8192
  v_add_f32 v35, v35, v183
  v_mfma_f32_16x16x32_bf16 a[84:87], a[140:143], v[164:167], a[84:87]
  s_add_u32 m0, s78, 4294914048
  v_exp_f32 v155, v155
  v_mfma_f32_16x16x32_bf16 a[84:87], a[136:139], v[132:135], a[84:87]
  buffer_load_dwordx4 v26, s[44:47], s42 offen sc1 lds
  v_mfma_f32_16x16x32_bf16 a[88:91], a[136:139], v[136:139], a[88:91]
  s_add_u32 s42, s42, 1024
  ds_read_b64_tr_b16 a[154:155], v21 offset:12288
  v_cvt_pk_bf16_f32 v181, v182, v183
  v_mfma_f32_16x16x32_bf16 a[88:91], a[140:143], v[168:171], a[88:91]
  v_exp_f32 v188, v188
  v_mfma_f32_16x16x32_bf16 a[92:95], a[140:143], v[172:175], a[92:95]
  s_waitcnt lgkmcnt(2)
  ds_read_b64_tr_b16 a[156:157], v21 offset:16384
  v_add_f32 v35, v35, v148
  v_mfma_f32_16x16x32_bf16 a[92:95], a[136:139], v[140:143], a[92:95]
  s_add_u32 m0, s78, 4294918144
  v_exp_f32 v189, v189
  v_mfma_f32_16x16x32_bf16 a[96:99], a[144:147], v[128:131], a[96:99]
  buffer_load_dwordx4 v26, s[44:47], s42 offen sc1 lds
  v_mfma_f32_16x16x32_bf16 a[96:99], a[148:151], v[160:163], a[96:99]
  v_exp_f32 v190, v190
  v_mfma_f32_16x16x32_bf16 a[100:103], a[148:151], v[164:167], a[100:103]
  ds_read_b128 a[128:131], v10 offset:40960
  v_add_f32 v35, v35, v149
  v_mfma_f32_16x16x32_bf16 a[100:103], a[144:147], v[132:135], a[100:103]
  ds_read_b128 a[132:135], v11 offset:40960
  v_cvt_pk_bf16_f32 v182, v148, v149
  v_mfma_f32_16x16x32_bf16 a[104:107], a[144:147], v[136:139], a[104:107]
  v_exp_f32 v191, v191
  v_mfma_f32_16x16x32_bf16 a[104:107], a[148:151], v[168:171], a[104:107]
  s_add_u32 m0, s78, 4294922240
  ds_read_b128 a[136:139], v12 offset:40960
  v_add_f32 v35, v35, v150
  v_mfma_f32_16x16x32_bf16 a[108:111], a[148:151], v[172:175], a[108:111]
  s_add_u32 s42, s77, 286720
  v_exp_f32 v156, v156
  v_mfma_f32_16x16x32_bf16 a[108:111], a[144:147], v[140:143], a[108:111]
  s_waitcnt lgkmcnt(3)
  buffer_load_dwordx4 v26, s[44:47], s42 offen sc1 lds
  v_mfma_f32_16x16x32_bf16 a[112:115], a[152:155], v[128:131], a[112:115]
  s_add_u32 s42, s42, 1024
  ds_read_b128 a[140:143], v13 offset:40960
  v_add_f32 v35, v35, v151
  v_mfma_f32_16x16x32_bf16 a[112:115], a[156:159], v[160:163], a[112:115]
  v_exp_f32 v157, v157
  v_mfma_f32_16x16x32_bf16 a[116:119], a[156:159], v[164:167], a[116:119]
  v_cvt_pk_bf16_f32 v183, v150, v151
  v_add_f32 v36, v36, v184
  v_mfma_f32_16x16x32_bf16 a[116:119], a[152:155], v[132:135], a[116:119]
  v_exp_f32 v158, v158
  v_mfma_f32_16x16x32_bf16 a[120:123], a[152:155], v[136:139], a[120:123]
  ds_read_b128 a[144:147], v10 offset:45056
  v_add_f32 v36, v36, v185
  v_mfma_f32_16x16x32_bf16 a[120:123], a[156:159], v[168:171], a[120:123]
  s_add_u32 m0, s78, 0
  v_exp_f32 v159, v159
  v_mfma_f32_16x16x32_bf16 a[124:127], a[156:159], v[172:175], a[124:127]
  buffer_load_dwordx4 v26, s[44:47], s42 offen sc1 lds
  v_mfma_f32_16x16x32_bf16 a[124:127], a[152:155], v[140:143], a[124:127]
  s_add_u32 s42, s42, 1024
  v_cvt_pk_bf16_f32 v184, v184, v185
  v_add_f32 v36, v36, v186
  v_mfma_f32_16x16x32_bf16 a[244:247], a[248:251], v[140:143], a[244:247]
  v_add_f32 v36, v36, v187
  v_cvt_pk_bf16_f32 v185, v186, v187
  v_mfma_f32_16x16x32_bf16 a[244:247], a[248:251], v[172:175], a[244:247]
  s_waitcnt lgkmcnt(1)
  v_add_f32 v36, v36, v152
  v_add_f32 v36, v36, v153
  v_cvt_pk_bf16_f32 v186, v152, v153
  v_add_f32 v36, v36, v154
  v_add_f32 v36, v36, v155
  v_cvt_pk_bf16_f32 v187, v154, v155
  v_cvt_pk_bf16_f32 v188, v188, v189
  v_cvt_pk_bf16_f32 v189, v190, v191
  v_cvt_pk_bf16_f32 v190, v156, v157
  v_cvt_pk_bf16_f32 v191, v158, v159
  v_mfma_f32_16x16x32_bf16 v[128:131], a[128:131], v[192:195], v[40:43]
  s_waitcnt vmcnt(30)
  v_exp_f32 v96, v96
  v_mfma_f32_16x16x32_bf16 v[128:131], a[132:135], v[196:199], v[128:131]
  s_barrier
  v_mfma_f32_16x16x32_bf16 v[128:131], a[136:139], v[200:203], v[128:131]
  ds_read_b128 a[148:151], v11 offset:45056
  ds_read_b128 a[156:159], v13 offset:45056
  v_mfma_f32_16x16x32_bf16 v[128:131], a[140:143], v[204:207], v[128:131]
  v_exp_f32 v97, v97
  v_mfma_f32_16x16x32_bf16 v[132:135], a[140:143], v[220:223], v[44:47]
  s_mov_b32 s24, s40
  ds_read_b128 a[152:155], v12 offset:45056
  v_add_f32 v34, v34, v96
  v_mfma_f32_16x16x32_bf16 v[132:135], a[136:139], v[216:219], v[132:135]
  s_add_u32 m0, s33, 57344
  v_exp_f32 v98, v98
  v_mfma_f32_16x16x32_bf16 v[132:135], a[132:135], v[212:215], v[132:135]
  s_and_b32 s25, s41, 0xffff
  buffer_load_dwordx4 v24, s[8:11], s35 offen offset:0 lds
  v_mfma_f32_16x16x32_bf16 v[132:135], a[128:131], v[208:211], v[132:135]
  s_mov_b32 s26, 2621440
  v_exp_f32 v99, v99
  v_mfma_f32_16x16x32_bf16 v[136:139], a[128:131], v[224:227], v[48:51]
  s_lshl_b32 s38, s74, 2
  v_add_f32 v34, v34, v97
  v_cvt_pk_bf16_f32 v96, v96, v97
  v_mfma_f32_16x16x32_bf16 v[136:139], a[132:135], v[228:231], v[136:139]
  s_add_u32 s38, s38, s28
  v_exp_f32 v112, v112
  v_mfma_f32_16x16x32_bf16 v[136:139], a[136:139], v[232:235], v[136:139]
  s_mul_i32 s38, s38, 20480
  v_add_f32 v34, v34, v98
  v_add_f32 v34, v34, v99
  v_mfma_f32_16x16x32_bf16 v[136:139], a[140:143], v[236:239], v[136:139]
  s_mul_i32 s34, s75, 160
  v_cvt_pk_bf16_f32 v97, v98, v99
  v_add_f32 v34, v34, v112
  v_mfma_f32_16x16x32_bf16 v[140:143], a[140:143], v[252:255], v[52:55]
  s_waitcnt lgkmcnt(0)
  v_exp_f32 v113, v113
  v_mfma_f32_16x16x32_bf16 v[140:143], a[136:139], v[248:251], v[140:143]
  s_waitcnt vmcnt(22)
  buffer_load_dwordx4 v25, s[8:11], s35 offen offset:1024 lds
  v_mfma_f32_16x16x32_bf16 v[140:143], a[132:135], v[244:247], v[140:143]
  s_add_u32 s35, s35, 8192
  v_exp_f32 v114, v114
  v_mfma_f32_16x16x32_bf16 v[140:143], a[128:131], v[240:243], v[140:143]
  s_and_b32 s35, s35, 0x7ffff
  ds_read_b64_tr_b16 a[128:129], v28 offset:0
  v_add_f32 v34, v34, v113
  v_mfma_f32_16x16x32_bf16 v[144:147], a[144:147], v[192:195], v[40:43]
  v_exp_f32 v115, v115
  v_mfma_f32_16x16x32_bf16 v[144:147], a[148:151], v[196:199], v[144:147]
  ds_read_b64_tr_b16 a[130:131], v28 offset:2048
  v_cvt_pk_bf16_f32 v98, v112, v113
  v_mfma_f32_16x16x32_bf16 v[144:147], a[152:155], v[200:203], v[144:147]
  s_add_u32 m0, s78, 4096
  v_exp_f32 v100, v100
  v_mfma_f32_16x16x32_bf16 v[144:147], a[156:159], v[204:207], v[144:147]
  buffer_load_dwordx4 v26, s[44:47], s42 offen sc1 lds
  v_mfma_f32_16x16x32_bf16 v[148:151], a[156:159], v[220:223], v[44:47]
  s_add_u32 s42, s42, 1024
  ds_read_b64_tr_b16 a[132:133], v29 offset:0
  v_add_f32 v34, v34, v114
  v_mfma_f32_16x16x32_bf16 v[148:151], a[152:155], v[216:219], v[148:151]
  v_exp_f32 v101, v101
  v_mfma_f32_16x16x32_bf16 v[148:151], a[148:151], v[212:215], v[148:151]
  ds_read_b64_tr_b16 a[134:135], v29 offset:2048
  v_add_f32 v34, v34, v115
  v_mfma_f32_16x16x32_bf16 v[148:151], a[144:147], v[208:211], v[148:151]
  v_exp_f32 v102, v102
  v_mfma_f32_16x16x32_bf16 v[152:155], a[144:147], v[224:227], v[48:51]
  ds_read_b64_tr_b16 a[136:137], v30 offset:0
  v_cvt_pk_bf16_f32 v99, v114, v115
  v_mfma_f32_16x16x32_bf16 v[152:155], a[148:151], v[228:231], v[152:155]
  s_add_u32 m0, s78, 4294926336
  v_exp_f32 v103, v103
  v_mfma_f32_16x16x32_bf16 v[152:155], a[152:155], v[232:235], v[152:155]
  buffer_load_dwordx4 v26, s[44:47], s42 offen sc1 lds
  v_mfma_f32_16x16x32_bf16 v[152:155], a[156:159], v[236:239], v[152:155]
  s_add_u32 s42, s42, 1024
  v_exp_f32 v116, v116
  v_mfma_f32_16x16x32_bf16 v[156:159], a[156:159], v[252:255], v[52:55]
  ds_read_b64_tr_b16 a[138:139], v30 offset:2048
  v_add_f32 v35, v35, v100
  v_mfma_f32_16x16x32_bf16 v[156:159], a[152:155], v[248:251], v[156:159]
  v_exp_f32 v117, v117
  v_mfma_f32_16x16x32_bf16 v[156:159], a[148:151], v[244:247], v[156:159]
  s_add_u32 m0, s78, 4294930432
  ds_read_b64_tr_b16 a[140:141], v31 offset:0
  v_add_f32 v35, v35, v101
  v_mfma_f32_16x16x32_bf16 v[156:159], a[144:147], v[240:243], v[156:159]
  s_waitcnt lgkmcnt(5)
  buffer_load_dwordx4 v26, s[44:47], s42 offen sc1 lds
  v_mfma_f32_16x16x32_bf16 a[160:163], a[128:131], v[56:59], a[160:163]
  v_exp_f32 v118, v118
  v_mfma_f32_16x16x32_bf16 a[164:167], a[128:131], v[60:63], a[164:167]
  ds_read_b64_tr_b16 a[142:143], v31 offset:2048
  v_cvt_pk_bf16_f32 v100, v100, v101
  v_mfma_f32_16x16x32_bf16 a[168:171], a[128:131], v[64:67], a[168:171]
  s_waitcnt lgkmcnt(4)
  v_exp_f32 v119, v119
  v_mfma_f32_16x16x32_bf16 a[172:175], a[128:131], v[68:71], a[172:175]
  s_add_u32 m0, s78, 4294934528
  ds_read_b128 a[144:147], v10 offset:49152
  v_add_f32 v35, v35, v102
  v_mfma_f32_16x16x32_bf16 a[176:179], a[128:131], v[72:75], a[176:179]
  s_add_u32 s42, s77, 307200
  v_exp_f32 v104, v104
  v_mfma_f32_16x16x32_bf16 a[180:183], a[132:135], v[56:59], a[180:183]
  buffer_load_dwordx4 v26, s[44:47], s42 offen sc1 lds
  v_mfma_f32_16x16x32_bf16 a[184:187], a[132:135], v[60:63], a[184:187]
  s_add_u32 s42, s42, 1024
  v_exp_f32 v105, v105
  v_mfma_f32_16x16x32_bf16 a[188:191], a[132:135], v[64:67], a[188:191]
  ds_read_b128 a[148:151], v11 offset:49152
  v_add_f32 v35, v35, v103
  v_mfma_f32_16x16x32_bf16 a[192:195], a[132:135], v[68:71], a[192:195]
  ds_read_b128 a[152:155], v12 offset:49152
  v_cvt_pk_bf16_f32 v101, v102, v103
  v_mfma_f32_16x16x32_bf16 a[196:199], a[132:135], v[72:75], a[196:199]
  s_waitcnt lgkmcnt(5)
  v_exp_f32 v106, v106
  v_mfma_f32_16x16x32_bf16 a[200:203], a[136:139], v[56:59], a[200:203]
  ds_read_b128 a[156:159], v13 offset:49152
  v_add_f32 v35, v35, v116
  v_mfma_f32_16x16x32_bf16 a[204:207], a[136:139], v[60:63], a[204:207]
  s_add_u32 m0, s78, 4294938624
  v_exp_f32 v107, v107
  v_mfma_f32_16x16x32_bf16 a[208:211], a[136:139], v[64:67], a[208:211]
  buffer_load_dwordx4 v26, s[44:47], s42 offen sc1 lds
  v_mfma_f32_16x16x32_bf16 a[212:215], a[136:139], v[68:71], a[212:215]
  s_add_u32 s42, s42, 1024
  v_exp_f32 v120, v120
  v_mfma_f32_16x16x32_bf16 a[216:219], a[136:139], v[72:75], a[216:219]
  s_waitcnt lgkmcnt(4)
  ds_read_b128 a[128:131], v10 offset:53248
  v_add_f32 v35, v35, v117
  v_mfma_f32_16x16x32_bf16 a[220:223], a[140:143], v[56:59], a[220:223]
  v_exp_f32 v121, v121
  v_mfma_f32_16x16x32_bf16 a[224:227], a[140:143], v[60:63], a[224:227]
  ds_read_b128 a[132:135], v11 offset:53248
  v_cvt_pk_bf16_f32 v102, v116, v117
  v_mfma_f32_16x16x32_bf16 a[228:231], a[140:143], v[64:67], a[228:231]
  s_add_u32 m0, s78, 8192
  v_exp_f32 v122, v122
  v_mfma_f32_16x16x32_bf16 a[232:235], a[140:143], v[68:71], a[232:235]
  s_waitcnt lgkmcnt(2)
  buffer_load_dwordx4 v26, s[44:47], s42 offen sc1 lds
  v_mfma_f32_16x16x32_bf16 a[236:239], a[140:143], v[72:75], a[236:239]
  s_add_u32 s42, s42, 1024
  ds_read_b128 a[136:139], v12 offset:53248
  v_add_f32 v35, v35, v118
  v_mfma_f32_16x16x32_bf16 v[160:163], a[144:147], v[192:195], v[40:43]
  v_exp_f32 v123, v123
  v_mfma_f32_16x16x32_bf16 v[160:163], a[148:151], v[196:199], v[160:163]
  ds_read_b128 a[140:143], v13 offset:53248
  v_add_f32 v35, v35, v119
  v_mfma_f32_16x16x32_bf16 v[160:163], a[152:155], v[200:203], v[160:163]
  v_exp_f32 v108, v108
  v_mfma_f32_16x16x32_bf16 v[160:163], a[156:159], v[204:207], v[160:163]
  v_cvt_pk_bf16_f32 v103, v118, v119
  v_add_f32 v36, v36, v104
  v_mfma_f32_16x16x32_bf16 v[164:167], a[156:159], v[220:223], v[44:47]
  s_add_u32 m0, s78, 12288
  v_exp_f32 v109, v109
  v_mfma_f32_16x16x32_bf16 v[164:167], a[152:155], v[216:219], v[164:167]
  buffer_load_dwordx4 v26, s[44:47], s42 offen sc1 lds
  v_mfma_f32_16x16x32_bf16 v[164:167], a[148:151], v[212:215], v[164:167]
  s_add_u32 s42, s42, 1024
  v_exp_f32 v110, v110
  v_mfma_f32_16x16x32_bf16 v[164:167], a[144:147], v[208:211], v[164:167]
  v_add_f32 v36, v36, v105
  v_cvt_pk_bf16_f32 v104, v104, v105
  v_mfma_f32_16x16x32_bf16 v[168:171], a[144:147], v[224:227], v[48:51]
  v_add_f32 v36, v36, v106
  v_add_f32 v36, v36, v107
  v_mfma_f32_16x16x32_bf16 v[168:171], a[148:151], v[228:231], v[168:171]
  v_exp_f32 v111, v111
  v_mfma_f32_16x16x32_bf16 v[168:171], a[152:155], v[232:235], v[168:171]
  v_cvt_pk_bf16_f32 v105, v106, v107
  v_add_f32 v36, v36, v120
  v_mfma_f32_16x16x32_bf16 v[168:171], a[156:159], v[236:239], v[168:171]
  s_add_u32 m0, s69, 0
  v_exp_f32 v124, v124
  v_mfma_f32_16x16x32_bf16 v[172:175], a[156:159], v[252:255], v[52:55]
  buffer_load_dwordx4 v32, s[12:15], s66 offen lds
  v_mfma_f32_16x16x32_bf16 v[172:175], a[152:155], v[248:251], v[172:175]
  s_add_u32 s66, s66, s68
  v_exp_f32 v125, v125
  v_mfma_f32_16x16x32_bf16 v[172:175], a[148:151], v[244:247], v[172:175]
  ds_read_b64_tr_b16 a[148:149], v14 offset:32768
  v_add_f32 v36, v36, v121
  v_mfma_f32_16x16x32_bf16 v[172:175], a[144:147], v[240:243], v[172:175]
  s_waitcnt lgkmcnt(1)
  v_exp_f32 v126, v126
  v_mfma_f32_16x16x32_bf16 v[112:115], a[128:131], v[192:195], v[40:43]
  ds_read_b64_tr_b16 a[144:145], v14 offset:24576
  v_cvt_pk_bf16_f32 v106, v120, v121
  v_mfma_f32_16x16x32_bf16 v[112:115], a[132:135], v[196:199], v[112:115]
  v_exp_f32 v127, v127
  v_mfma_f32_16x16x32_bf16 v[112:115], a[136:139], v[200:203], v[112:115]
  ds_read_b64_tr_b16 a[146:147], v14 offset:28672
  v_add_f32 v36, v36, v122
  v_and_b32 v0, 15, v2
  v_mfma_f32_16x16x32_bf16 v[112:115], a[140:143], v[204:207], v[112:115]
  ds_read_b64_tr_b16 a[150:151], v14 offset:36864
  v_add_f32 v36, v36, v123
  v_mfma_f32_16x16x32_bf16 v[116:119], a[140:143], v[220:223], v[44:47]
  v_exp_f32 v128, v128
  v_mfma_f32_16x16x32_bf16 v[116:119], a[136:139], v[216:219], v[116:119]
  ds_read_b64_tr_b16 a[152:153], v15 offset:24576
  v_cvt_pk_bf16_f32 v107, v122, v123
  v_mul_u32_u24 v0, 1280, v0
  v_mfma_f32_16x16x32_bf16 v[116:119], a[132:135], v[212:215], v[116:119]
  s_add_u32 m0, s69, 1024
  v_exp_f32 v129, v129
  v_mfma_f32_16x16x32_bf16 v[116:119], a[128:131], v[208:211], v[116:119]
  buffer_load_dwordx4 v32, s[12:15], s66 offen lds
  v_mfma_f32_16x16x32_bf16 v[120:123], a[128:131], v[224:227], v[48:51]
  s_add_u32 s66, s66, s68
  v_exp_f32 v130, v130
  v_lshrrev_b32 v1, 4, v2
  v_mfma_f32_16x16x32_bf16 v[120:123], a[132:135], v[228:231], v[120:123]
  ds_read_b64_tr_b16 a[154:155], v15 offset:28672
  v_cvt_pk_bf16_f32 v108, v108, v109
  v_mfma_f32_16x16x32_bf16 v[120:123], a[136:139], v[232:235], v[120:123]
  ds_read_b64_tr_b16 a[156:157], v15 offset:32768
  v_cvt_pk_bf16_f32 v109, v110, v111
  v_mfma_f32_16x16x32_bf16 v[120:123], a[140:143], v[236:239], v[120:123]
  v_exp_f32 v131, v131
  v_cvt_pk_bf16_f32 v110, v124, v125
  v_cvt_pk_bf16_f32 v111, v126, v127
  v_lshl_add_u32 v0, v1, 3, v0
  v_mfma_f32_16x16x32_bf16 v[124:127], a[140:143], v[252:255], v[52:55]
  ds_read_b64_tr_b16 a[158:159], v15 offset:36864
  v_add_f32 v34, v34, v128
  v_mfma_f32_16x16x32_bf16 v[124:127], a[136:139], v[248:251], v[124:127]
  v_exp_f32 v144, v144
  v_mfma_f32_16x16x32_bf16 v[124:127], a[132:135], v[244:247], v[124:127]
  ds_read_b64_tr_b16 a[132:133], v16 offset:32768
  v_add_f32 v34, v34, v129
  v_add_u32 v0, s38, v0
  v_mfma_f32_16x16x32_bf16 v[124:127], a[128:131], v[240:243], v[124:127]
  s_waitcnt lgkmcnt(5)
  ds_read_b64_tr_b16 a[128:129], v16 offset:24576
  v_cvt_pk_bf16_f32 v128, v128, v129
  v_mfma_f32_16x16x32_bf16 a[0:3], a[144:147], v[176:179], a[0:3]
  s_add_u32 m0, s69, 2048
  v_exp_f32 v145, v145
  v_mfma_f32_16x16x32_bf16 a[0:3], a[148:151], v[96:99], a[0:3]
  buffer_load_dwordx4 v32, s[12:15], s66 offen lds
  v_mfma_f32_16x16x32_bf16 a[4:7], a[148:151], v[100:103], a[4:7]
  s_add_u32 s66, s66, s68
  v_exp_f32 v146, v146
  v_mfma_f32_16x16x32_bf16 a[4:7], a[144:147], v[180:183], a[4:7]
  ds_read_b64_tr_b16 a[130:131], v16 offset:28672
  v_add_f32 v34, v34, v130
  v_mfma_f32_16x16x32_bf16 a[8:11], a[144:147], v[184:187], a[8:11]
  v_exp_f32 v147, v147
  v_mfma_f32_16x16x32_bf16 a[8:11], a[148:151], v[104:107], a[8:11]
  ds_read_b64_tr_b16 a[134:135], v16 offset:36864
  v_add_f32 v34, v34, v131
  v_mfma_f32_16x16x32_bf16 a[12:15], a[148:151], v[108:111], a[12:15]
  ds_read_b64_tr_b16 a[136:137], v17 offset:24576
  v_cvt_pk_bf16_f32 v129, v130, v131
  v_mfma_f32_16x16x32_bf16 a[12:15], a[144:147], v[188:191], a[12:15]
  s_waitcnt lgkmcnt(5)
  v_exp_f32 v132, v132
  v_mfma_f32_16x16x32_bf16 a[16:19], a[152:155], v[176:179], a[16:19]
  ds_read_b64_tr_b16 a[138:139], v17 offset:28672
  v_add_f32 v34, v34, v144
  v_mfma_f32_16x16x32_bf16 a[16:19], a[156:159], v[96:99], a[16:19]
  s_add_u32 m0, s69, 3072
  v_exp_f32 v133, v133
  v_mfma_f32_16x16x32_bf16 a[20:23], a[156:159], v[100:103], a[20:23]
  buffer_load_dwordx4 v32, s[12:15], s66 offen lds
  v_mfma_f32_16x16x32_bf16 a[20:23], a[152:155], v[180:183], a[20:23]
  s_add_u32 s66, s66, s70
  v_exp_f32 v134, v134
  v_mfma_f32_16x16x32_bf16 a[24:27], a[152:155], v[184:187], a[24:27]
  ds_read_b64_tr_b16 a[140:141], v17 offset:32768
  v_add_f32 v34, v34, v145
  v_mfma_f32_16x16x32_bf16 a[24:27], a[156:159], v[104:107], a[24:27]
  ds_read_b64_tr_b16 a[142:143], v17 offset:36864
  v_cvt_pk_bf16_f32 v130, v144, v145
  v_mfma_f32_16x16x32_bf16 a[28:31], a[156:159], v[108:111], a[28:31]
  v_exp_f32 v135, v135
  v_mfma_f32_16x16x32_bf16 a[28:31], a[152:155], v[188:191], a[28:31]
  s_waitcnt lgkmcnt(4)
  ds_read_b64_tr_b16 a[144:145], v18 offset:24576
  v_add_f32 v34, v34, v146
  v_mfma_f32_16x16x32_bf16 a[32:35], a[128:131], v[176:179], a[32:35]
  v_exp_f32 v148, v148
  v_mfma_f32_16x16x32_bf16 a[32:35], a[132:135], v[96:99], a[32:35]
  ds_read_b64_tr_b16 a[146:147], v18 offset:28672
  v_add_f32 v34, v34, v147
  v_mfma_f32_16x16x32_bf16 a[36:39], a[132:135], v[100:103], a[36:39]
  ds_read_b64_tr_b16 a[148:149], v18 offset:32768
  v_cvt_pk_bf16_f32 v131, v146, v147
  v_mfma_f32_16x16x32_bf16 a[36:39], a[128:131], v[180:183], a[36:39]
  v_exp_f32 v149, v149
  v_mfma_f32_16x16x32_bf16 a[40:43], a[128:131], v[184:187], a[40:43]
  buffer_load_dwordx4 v[56:59], v26, s[16:19], s67 offen offset:0 sc1
  v_mfma_f32_16x16x32_bf16 a[40:43], a[132:135], v[104:107], a[40:43]
  v_exp_f32 v150, v150
  v_mfma_f32_16x16x32_bf16 a[44:47], a[132:135], v[108:111], a[44:47]
  ds_read_b64_tr_b16 a[150:151], v18 offset:36864
  v_add_f32 v35, v35, v132
  v_mfma_f32_16x16x32_bf16 a[44:47], a[128:131], v[188:191], a[44:47]
  s_waitcnt lgkmcnt(4)
  v_exp_f32 v151, v151
  v_mfma_f32_16x16x32_bf16 a[48:51], a[136:139], v[176:179], a[48:51]
  ds_read_b64_tr_b16 a[152:153], v19 offset:24576
  v_add_f32 v35, v35, v133
  v_mfma_f32_16x16x32_bf16 a[48:51], a[140:143], v[96:99], a[48:51]
  ds_read_b64_tr_b16 a[154:155], v19 offset:28672
  v_cvt_pk_bf16_f32 v132, v132, v133
  v_mfma_f32_16x16x32_bf16 a[52:55], a[140:143], v[100:103], a[52:55]
  v_exp_f32 v136, v136
  v_mfma_f32_16x16x32_bf16 a[52:55], a[136:139], v[180:183], a[52:55]
  ds_read_b64_tr_b16 a[156:157], v19 offset:32768
  v_add_f32 v35, v35, v134
  v_mfma_f32_16x16x32_bf16 a[56:59], a[136:139], v[184:187], a[56:59]
  v_exp_f32 v137, v137
  v_mfma_f32_16x16x32_bf16 a[56:59], a[140:143], v[104:107], a[56:59]
  ds_read_b64_tr_b16 a[158:159], v19 offset:36864
  v_add_f32 v35, v35, v135
  v_mfma_f32_16x16x32_bf16 a[60:63], a[140:143], v[108:111], a[60:63]
  v_exp_f32 v138, v138
  v_mfma_f32_16x16x32_bf16 a[60:63], a[136:139], v[188:191], a[60:63]
  s_waitcnt lgkmcnt(4)
  buffer_load_dwordx4 v[60:63], v26, s[16:19], s67 offen offset:1024 sc1
  v_mfma_f32_16x16x32_bf16 a[64:67], a[144:147], v[176:179], a[64:67]
  ds_read_b64_tr_b16 a[128:129], v20 offset:24576
  v_cvt_pk_bf16_f32 v133, v134, v135
  v_mfma_f32_16x16x32_bf16 a[64:67], a[148:151], v[96:99], a[64:67]
  v_exp_f32 v139, v139
  v_mfma_f32_16x16x32_bf16 a[68:71], a[148:151], v[100:103], a[68:71]
  ds_read_b64_tr_b16 a[130:131], v20 offset:28672
  v_add_f32 v35, v35, v148
  v_mfma_f32_16x16x32_bf16 a[68:71], a[144:147], v[180:183], a[68:71]
  v_exp_f32 v152, v152
  v_mfma_f32_16x16x32_bf16 a[72:75], a[144:147], v[184:187], a[72:75]
  ds_read_b64_tr_b16 a[132:133], v20 offset:32768
  v_add_f32 v35, v35, v149
  v_mfma_f32_16x16x32_bf16 a[72:75], a[148:151], v[104:107], a[72:75]
  ds_read_b64_tr_b16 a[134:135], v20 offset:36864
  v_cvt_pk_bf16_f32 v134, v148, v149
  v_mfma_f32_16x16x32_bf16 a[76:79], a[148:151], v[108:111], a[76:79]
  v_exp_f32 v153, v153
  v_mfma_f32_16x16x32_bf16 a[76:79], a[144:147], v[188:191], a[76:79]
  s_waitcnt lgkmcnt(4)
  buffer_load_dwordx4 v[64:67], v26, s[16:19], s67 offen offset:2048 sc1
  v_mfma_f32_16x16x32_bf16 a[80:83], a[152:155], v[176:179], a[80:83]
  v_exp_f32 v154, v154
  v_mfma_f32_16x16x32_bf16 a[80:83], a[156:159], v[96:99], a[80:83]
  ds_read_b64_tr_b16 a[136:137], v21 offset:24576
  v_add_f32 v35, v35, v150
  v_mfma_f32_16x16x32_bf16 a[84:87], a[156:159], v[100:103], a[84:87]
  v_exp_f32 v155, v155
  v_mfma_f32_16x16x32_bf16 a[84:87], a[152:155], v[180:183], a[84:87]
  ds_read_b64_tr_b16 a[138:139], v21 offset:28672
  v_add_f32 v35, v35, v151
  v_mfma_f32_16x16x32_bf16 a[88:91], a[152:155], v[184:187], a[88:91]
  ds_read_b64_tr_b16 a[140:141], v21 offset:32768
  v_cvt_pk_bf16_f32 v135, v150, v151
  v_mfma_f32_16x16x32_bf16 a[88:91], a[156:159], v[104:107], a[88:91]
  v_exp_f32 v140, v140
  v_mfma_f32_16x16x32_bf16 a[92:95], a[156:159], v[108:111], a[92:95]
  ds_read_b64_tr_b16 a[142:143], v21 offset:36864
  v_add_f32 v36, v36, v136
  v_mfma_f32_16x16x32_bf16 a[92:95], a[152:155], v[188:191], a[92:95]
  s_waitcnt lgkmcnt(4)
  v_exp_f32 v141, v141
  v_mfma_f32_16x16x32_bf16 a[96:99], a[128:131], v[176:179], a[96:99]
  ds_read_b128 a[144:147], v10 offset:57344
  v_add_f32 v36, v36, v137
  v_mfma_f32_16x16x32_bf16 a[96:99], a[132:135], v[96:99], a[96:99]
  v_exp_f32 v142, v142
  v_mfma_f32_16x16x32_bf16 a[100:103], a[132:135], v[100:103], a[100:103]
  buffer_load_dwordx4 v[68:71], v26, s[16:19], s67 offen offset:3072 sc1
  v_mfma_f32_16x16x32_bf16 a[100:103], a[128:131], v[180:183], a[100:103]
  ds_read_b128 a[148:151], v11 offset:57344
  v_cvt_pk_bf16_f32 v136, v136, v137
  v_mfma_f32_16x16x32_bf16 a[104:107], a[128:131], v[184:187], a[104:107]
  v_exp_f32 v143, v143
  v_mfma_f32_16x16x32_bf16 a[104:107], a[132:135], v[104:107], a[104:107]
  ds_read_b128 a[152:155], v12 offset:57344
  v_add_f32 v36, v36, v138
  v_mfma_f32_16x16x32_bf16 a[108:111], a[132:135], v[108:111], a[108:111]
  v_exp_f32 v156, v156
  v_mfma_f32_16x16x32_bf16 a[108:111], a[128:131], v[188:191], a[108:111]
  s_waitcnt lgkmcnt(3)
  ds_read_b128 a[156:159], v13 offset:57344
  v_add_f32 v36, v36, v139
  v_mfma_f32_16x16x32_bf16 a[112:115], a[136:139], v[176:179], a[112:115]
  v_cvt_pk_bf16_f32 v137, v138, v139
  v_add_f32 v36, v36, v152
  v_mfma_f32_16x16x32_bf16 a[112:115], a[140:143], v[96:99], a[112:115]
  v_exp_f32 v157, v157
  v_mfma_f32_16x16x32_bf16 a[116:119], a[140:143], v[100:103], a[116:119]
  v_add_f32 v36, v36, v153
  v_cvt_pk_bf16_f32 v138, v152, v153
  v_mfma_f32_16x16x32_bf16 a[116:119], a[136:139], v[180:183], a[116:119]
  v_exp_f32 v158, v158
  v_mfma_f32_16x16x32_bf16 a[120:123], a[136:139], v[184:187], a[120:123]
  buffer_load_dwordx4 v[72:75], v27, s[16:19], s67 offen sc1
  v_mfma_f32_16x16x32_bf16 a[120:123], a[140:143], v[104:107], a[120:123]
  s_add_u32 s67, s67, 20480
  v_exp_f32 v159, v159
  v_mfma_f32_16x16x32_bf16 a[124:127], a[140:143], v[108:111], a[124:127]
  ds_read_b128 a[128:131], v10 offset:61440
  v_add_f32 v36, v36, v154
  v_mfma_f32_16x16x32_bf16 a[124:127], a[136:139], v[188:191], a[124:127]
  v_add_f32 v36, v36, v155
  v_cvt_pk_bf16_f32 v139, v154, v155
  v_mfma_f32_16x16x32_bf16 a[244:247], a[248:251], v[188:191], a[244:247]
  v_cvt_pk_bf16_f32 v140, v140, v141
  v_cvt_pk_bf16_f32 v141, v142, v143
  v_mfma_f32_16x16x32_bf16 a[244:247], a[248:251], v[108:111], a[244:247]
  s_waitcnt lgkmcnt(1)
  v_cvt_pk_bf16_f32 v142, v156, v157
  v_cvt_pk_bf16_f32 v143, v158, v159
  v_mfma_f32_16x16x32_bf16 v[176:179], a[144:147], v[192:195], v[40:43]
  s_waitcnt vmcnt(16)
  v_exp_f32 v160, v160
  v_mfma_f32_16x16x32_bf16 v[176:179], a[148:151], v[196:199], v[176:179]
  s_barrier
  v_mfma_f32_16x16x32_bf16 v[176:179], a[152:155], v[200:203], v[176:179]
  v_exp_f32 v161, v161
  v_mfma_f32_16x16x32_bf16 v[176:179], a[156:159], v[204:207], v[176:179]
  ds_read_b128 a[132:135], v11 offset:61440
  ds_read_b128 a[140:143], v13 offset:61440
  v_mfma_f32_16x16x32_bf16 v[180:183], a[156:159], v[220:223], v[44:47]
  v_exp_f32 v162, v162
  v_mfma_f32_16x16x32_bf16 v[180:183], a[152:155], v[216:219], v[180:183]
  ds_read_b128 a[136:139], v12 offset:61440
  v_add_f32 v34, v34, v160
  v_mfma_f32_16x16x32_bf16 v[180:183], a[148:151], v[212:215], v[180:183]
  v_exp_f32 v163, v163
  v_mfma_f32_16x16x32_bf16 v[180:183], a[144:147], v[208:211], v[180:183]
  v_exp_f32 v112, v112
  v_mfma_f32_16x16x32_bf16 v[184:187], a[144:147], v[224:227], v[48:51]
  v_add_f32 v34, v34, v161
  v_cvt_pk_bf16_f32 v160, v160, v161
  v_mfma_f32_16x16x32_bf16 v[184:187], a[148:151], v[228:231], v[184:187]
  v_exp_f32 v113, v113
  v_mfma_f32_16x16x32_bf16 v[184:187], a[152:155], v[232:235], v[184:187]
  v_add_f32 v34, v34, v162
  v_add_f32 v34, v34, v163
  v_mfma_f32_16x16x32_bf16 v[184:187], a[156:159], v[236:239], v[184:187]
  v_exp_f32 v114, v114
  v_mfma_f32_16x16x32_bf16 v[188:191], a[156:159], v[252:255], v[52:55]
  v_exp_f32 v115, v115
  v_mfma_f32_16x16x32_bf16 v[188:191], a[152:155], v[248:251], v[188:191]
  v_cvt_pk_bf16_f32 v161, v162, v163
  v_add_f32 v34, v34, v112
  v_mfma_f32_16x16x32_bf16 v[188:191], a[148:151], v[244:247], v[188:191]
  v_exp_f32 v164, v164
  v_mfma_f32_16x16x32_bf16 v[188:191], a[144:147], v[240:243], v[188:191]
  s_waitcnt lgkmcnt(0)
  ds_read_b64_tr_b16 a[144:145], v14 offset:40960
  v_add_f32 v34, v34, v113
  v_mfma_f32_16x16x32_bf16 v[144:147], a[128:131], v[192:195], v[40:43]
  s_add_u32 m0, s78, 4294942720
  v_exp_f32 v165, v165
  v_mfma_f32_16x16x32_bf16 v[144:147], a[132:135], v[196:199], v[144:147]
  buffer_load_dwordx4 v26, s[44:47], s42 offen sc1 lds
  v_mfma_f32_16x16x32_bf16 v[144:147], a[136:139], v[200:203], v[144:147]
  v_exp_f32 v166, v166
  v_mfma_f32_16x16x32_bf16 v[144:147], a[140:143], v[204:207], v[144:147]
  v_exp_f32 v167, v167
  v_mfma_f32_16x16x32_bf16 v[148:151], a[140:143], v[220:223], v[44:47]
  ds_read_b64_tr_b16 a[146:147], v14 offset:45056
  v_cvt_pk_bf16_f32 v162, v112, v113
  v_mfma_f32_16x16x32_bf16 v[148:151], a[136:139], v[216:219], v[148:151]
  v_exp_f32 v116, v116
  v_mfma_f32_16x16x32_bf16 v[148:151], a[132:135], v[212:215], v[148:151]
  ds_read_b64_tr_b16 a[148:149], v15 offset:40960
  v_add_f32 v34, v34, v114
  v_mfma_f32_16x16x32_bf16 v[148:151], a[128:131], v[208:211], v[148:151]
  v_exp_f32 v117, v117
  v_mfma_f32_16x16x32_bf16 v[152:155], a[128:131], v[224:227], v[48:51]
  v_exp_f32 v118, v118
  v_mfma_f32_16x16x32_bf16 v[152:155], a[132:135], v[228:231], v[152:155]
  ds_read_b64_tr_b16 a[150:151], v15 offset:45056
  v_add_f32 v34, v34, v115
  v_mfma_f32_16x16x32_bf16 v[152:155], a[136:139], v[232:235], v[152:155]
  v_exp_f32 v119, v119
  v_mfma_f32_16x16x32_bf16 v[152:155], a[140:143], v[236:239], v[152:155]
  ds_read_b64_tr_b16 a[152:153], v16 offset:40960
  v_cvt_pk_bf16_f32 v163, v114, v115
  v_mfma_f32_16x16x32_bf16 v[156:159], a[140:143], v[252:255], v[52:55]
  v_exp_f32 v168, v168
  v_mfma_f32_16x16x32_bf16 v[156:159], a[136:139], v[248:251], v[156:159]
  ds_read_b64_tr_b16 a[154:155], v16 offset:45056
  ds_read_b64_tr_b16 a[142:143], v21 offset:45056
  v_mfma_f32_16x16x32_bf16 v[156:159], a[132:135], v[244:247], v[156:159]
  v_exp_f32 v169, v169
  v_mfma_f32_16x16x32_bf16 v[156:159], a[128:131], v[240:243], v[156:159]
  s_waitcnt lgkmcnt(5)
  v_exp_f32 v170, v170
  v_mfma_f32_16x16x32_bf16 a[0:3], a[144:147], v[128:131], a[0:3]
  ds_read_b64_tr_b16 a[156:157], v17 offset:40960
  ds_read_b64_tr_b16 a[130:131], v18 offset:45056
  v_mfma_f32_16x16x32_bf16 a[4:7], a[144:147], v[132:135], a[4:7]
  v_exp_f32 v171, v171
  v_mfma_f32_16x16x32_bf16 a[8:11], a[144:147], v[136:139], a[8:11]
  ds_read_b64_tr_b16 a[158:159], v17 offset:45056
  ds_read_b64_tr_b16 a[132:133], v19 offset:40960
  v_mfma_f32_16x16x32_bf16 a[12:15], a[144:147], v[140:143], a[12:15]
  s_waitcnt lgkmcnt(7)
  v_exp_f32 v120, v120
  v_mfma_f32_16x16x32_bf16 a[16:19], a[148:151], v[128:131], a[16:19]
  s_add_u32 s42, s77, 0
  v_exp_f32 v121, v121
  v_mfma_f32_16x16x32_bf16 a[20:23], a[148:151], v[132:135], a[20:23]
  buffer_load_dwordx4 v[192:195], v26, s[44:47], s42 offen offset:0 sc1
  v_mfma_f32_16x16x32_bf16 a[24:27], a[148:151], v[136:139], a[24:27]
  v_exp_f32 v122, v122
  v_mfma_f32_16x16x32_bf16 a[28:31], a[148:151], v[140:143], a[28:31]
  s_waitcnt lgkmcnt(5)
  ds_read_b64_tr_b16 a[128:129], v18 offset:40960
  ds_read_b64_tr_b16 a[134:135], v19 offset:45056
  v_mfma_f32_16x16x32_bf16 a[32:35], a[152:155], v[128:131], a[32:35]
  v_exp_f32 v123, v123
  v_mfma_f32_16x16x32_bf16 a[36:39], a[152:155], v[132:135], a[36:39]
  buffer_load_dwordx4 v[196:199], v26, s[44:47], s42 offen offset:1024 sc1
  v_mfma_f32_16x16x32_bf16 a[40:43], a[152:155], v[136:139], a[40:43]
  v_exp_f32 v172, v172
  v_mfma_f32_16x16x32_bf16 a[44:47], a[152:155], v[140:143], a[44:47]
  s_waitcnt lgkmcnt(3)
  v_exp_f32 v173, v173
  v_mfma_f32_16x16x32_bf16 a[48:51], a[156:159], v[128:131], a[48:51]
  s_waitcnt vmcnt(28)
  ds_read_b64_tr_b16 a[136:137], v20 offset:40960
  ds_read_b64_tr_b16 a[144:145], v28 offset:4096
  v_mfma_f32_16x16x32_bf16 a[52:55], a[156:159], v[132:135], a[52:55]
  v_exp_f32 v174, v174
  v_mfma_f32_16x16x32_bf16 a[56:59], a[156:159], v[136:139], a[56:59]
  ds_read_b64_tr_b16 a[138:139], v20 offset:45056
  ds_read_b64_tr_b16 a[146:147], v28 offset:6144
  v_mfma_f32_16x16x32_bf16 a[60:63], a[156:159], v[140:143], a[60:63]
  s_waitcnt lgkmcnt(5)
  v_exp_f32 v175, v175
  v_mfma_f32_16x16x32_bf16 a[64:67], a[128:131], v[128:131], a[64:67]
  v_exp_f32 v124, v124
  v_mfma_f32_16x16x32_bf16 a[68:71], a[128:131], v[132:135], a[68:71]
  buffer_load_dwordx4 v[200:203], v26, s[44:47], s42 offen offset:2048 sc1
  v_mfma_f32_16x16x32_bf16 a[72:75], a[128:131], v[136:139], a[72:75]
  v_exp_f32 v125, v125
  v_mfma_f32_16x16x32_bf16 a[76:79], a[128:131], v[140:143], a[76:79]
  s_waitcnt lgkmcnt(4)
  ds_read_b64_tr_b16 a[140:141], v21 offset:40960
  ds_read_b64_tr_b16 a[154:155], v30 offset:6144
  v_mfma_f32_16x16x32_bf16 a[80:83], a[132:135], v[128:131], a[80:83]
  v_exp_f32 v126, v126
  v_mfma_f32_16x16x32_bf16 a[84:87], a[132:135], v[132:135], a[84:87]
  buffer_load_dwordx4 v[204:207], v26, s[44:47], s42 offen offset:3072 sc1
  v_mfma_f32_16x16x32_bf16 a[88:91], a[132:135], v[136:139], a[88:91]
  v_exp_f32 v127, v127
  v_mfma_f32_16x16x32_bf16 a[92:95], a[132:135], v[140:143], a[92:95]
  s_waitcnt lgkmcnt(3)
  v_exp_f32 v176, v176
  v_mfma_f32_16x16x32_bf16 a[96:99], a[136:139], v[128:131], a[96:99]
  ds_read_b64_tr_b16 a[148:149], v29 offset:4096
  ds_read_b64_tr_b16 a[130:131], v14 offset:53248
  v_mfma_f32_16x16x32_bf16 a[100:103], a[136:139], v[132:135], a[100:103]
  v_exp_f32 v177, v177
  v_mfma_f32_16x16x32_bf16 a[104:107], a[136:139], v[136:139], a[104:107]
  buffer_load_dwordx4 v[208:211], v27, s[44:47], s42 offen sc1
  v_mfma_f32_16x16x32_bf16 a[108:111], a[136:139], v[140:143], a[108:111]
  s_waitcnt lgkmcnt(3)
  v_exp_f32 v178, v178
  v_mfma_f32_16x16x32_bf16 a[112:115], a[140:143], v[128:131], a[112:115]
  ds_read_b64_tr_b16 a[150:151], v29 offset:6144
  ds_read_b64_tr_b16 a[134:135], v15 offset:53248
  v_mfma_f32_16x16x32_bf16 a[116:119], a[140:143], v[132:135], a[116:119]
  v_exp_f32 v179, v179
  v_mfma_f32_16x16x32_bf16 a[120:123], a[140:143], v[136:139], a[120:123]
  s_waitcnt lgkmcnt(6)
  ds_read_b64_tr_b16 a[152:153], v30 offset:4096
  ds_read_b64_tr_b16 a[138:139], v16 offset:53248
  v_mfma_f32_16x16x32_bf16 a[124:127], a[140:143], v[140:143], a[124:127]
  s_add_u32 s42, s77, 20480
  v_exp_f32 v144, v144
  v_mfma_f32_16x16x32_bf16 a[160:163], a[144:147], v[76:79], a[160:163]
  buffer_load_dwordx4 v[212:215], v26, s[44:47], s42 offen offset:0 sc1
  v_mfma_f32_16x16x32_bf16 a[164:167], a[144:147], v[80:83], a[164:167]
  v_exp_f32 v145, v145
  v_mfma_f32_16x16x32_bf16 a[168:171], a[144:147], v[84:87], a[168:171]
  ds_read_b64_tr_b16 a[156:157], v31 offset:4096
  v_add_f32 v35, v35, v164
  v_mfma_f32_16x16x32_bf16 a[172:175], a[144:147], v[88:91], a[172:175]
  v_exp_f32 v146, v146
  v_mfma_f32_16x16x32_bf16 a[176:179], a[144:147], v[92:95], a[176:179]
  s_waitcnt lgkmcnt(4)
  buffer_load_dwordx4 v[216:219], v26, s[44:47], s42 offen offset:1024 sc1
  v_mfma_f32_16x16x32_bf16 a[180:183], a[148:151], v[76:79], a[180:183]
  v_exp_f32 v147, v147
  v_mfma_f32_16x16x32_bf16 a[184:187], a[148:151], v[80:83], a[184:187]
  ds_read_b64_tr_b16 a[158:159], v31 offset:6144
  ds_read_b64_tr_b16 a[146:147], v18 offset:53248
  v_mfma_f32_16x16x32_bf16 a[188:191], a[148:151], v[84:87], a[188:191]
  v_exp_f32 v180, v180
  v_mfma_f32_16x16x32_bf16 a[192:195], a[148:151], v[88:91], a[192:195]
  ds_read_b64_tr_b16 a[128:129], v14 offset:49152
  v_add_f32 v35, v35, v165
  v_mfma_f32_16x16x32_bf16 a[196:199], a[148:151], v[92:95], a[196:199]
  s_waitcnt lgkmcnt(5)
  v_exp_f32 v181, v181
  v_mfma_f32_16x16x32_bf16 a[200:203], a[152:155], v[76:79], a[200:203]
  buffer_load_dwordx4 v[220:223], v26, s[44:47], s42 offen offset:2048 sc1
  v_mfma_f32_16x16x32_bf16 a[204:207], a[152:155], v[80:83], a[204:207]
  v_exp_f32 v182, v182
  v_mfma_f32_16x16x32_bf16 a[208:211], a[152:155], v[84:87], a[208:211]
  v_exp_f32 v183, v183
  v_mfma_f32_16x16x32_bf16 a[212:215], a[152:155], v[88:91], a[212:215]
  ds_read_b64_tr_b16 a[132:133], v15 offset:49152
  ds_read_b64_tr_b16 a[150:151], v19 offset:53248
  v_mfma_f32_16x16x32_bf16 a[216:219], a[152:155], v[92:95], a[216:219]
  s_waitcnt lgkmcnt(4)
  v_exp_f32 v148, v148
  v_mfma_f32_16x16x32_bf16 a[220:223], a[156:159], v[76:79], a[220:223]
  buffer_load_dwordx4 v[224:227], v26, s[44:47], s42 offen offset:3072 sc1
  v_mfma_f32_16x16x32_bf16 a[224:227], a[156:159], v[80:83], a[224:227]
  v_exp_f32 v149, v149
  v_mfma_f32_16x16x32_bf16 a[228:231], a[156:159], v[84:87], a[228:231]
  ds_read_b64_tr_b16 a[136:137], v16 offset:49152
  ds_read_b64_tr_b16 a[154:155], v20 offset:53248
  v_mfma_f32_16x16x32_bf16 a[232:235], a[156:159], v[88:91], a[232:235]
  v_exp_f32 v150, v150
  v_cvt_pk_bf16_f32 v164, v164, v165
  v_add_f32 v35, v35, v166
  v_add_f32 v35, v35, v167
  v_cvt_pk_bf16_f32 v165, v166, v167
  v_add_f32 v35, v35, v116
  v_add_f32 v35, v35, v117
  v_cvt_pk_bf16_f32 v166, v116, v117
  v_add_f32 v35, v35, v118
  v_add_f32 v35, v35, v119
  v_cvt_pk_bf16_f32 v167, v118, v119
  v_cvt_pk_bf16_f32 v168, v168, v169
  v_cvt_pk_bf16_f32 v169, v170, v171
  v_cvt_pk_bf16_f32 v170, v120, v121
  v_cvt_pk_bf16_f32 v171, v122, v123
  v_cvt_pk_bf16_f32 v172, v172, v173
  v_cvt_pk_bf16_f32 v173, v174, v175
  v_cvt_pk_bf16_f32 v174, v124, v125
  v_cvt_pk_bf16_f32 v175, v126, v127
  v_mfma_f32_16x16x32_bf16 a[236:239], a[156:159], v[92:95], a[236:239]
  s_waitcnt lgkmcnt(4)
  buffer_load_dwordx4 v[228:231], v27, s[44:47], s42 offen sc1
  v_mfma_f32_16x16x32_bf16 a[0:3], a[128:131], v[160:163], a[0:3]
  v_exp_f32 v151, v151
  v_mfma_f32_16x16x32_bf16 a[4:7], a[128:131], v[164:167], a[4:7]
  ds_read_b64_tr_b16 a[140:141], v17 offset:49152
  ds_read_b64_tr_b16 a[158:159], v21 offset:53248
  v_mfma_f32_16x16x32_bf16 a[8:11], a[128:131], v[168:171], a[8:11]
  v_exp_f32 v184, v184
  v_mfma_f32_16x16x32_bf16 a[12:15], a[128:131], v[172:175], a[12:15]
  s_waitcnt lgkmcnt(5)
  ds_read_b64_tr_b16 a[142:143], v17 offset:53248
  v_add_f32 v34, v34, v176
  v_mfma_f32_16x16x32_bf16 a[16:19], a[132:135], v[160:163], a[16:19]
  v_exp_f32 v185, v185
  v_mfma_f32_16x16x32_bf16 a[20:23], a[132:135], v[164:167], a[20:23]
  buffer_load_dwordx2 v[84:85], v0, s[24:27], s34 offen offset:0
  v_mfma_f32_16x16x32_bf16 a[24:27], a[132:135], v[168:171], a[24:27]
  v_exp_f32 v186, v186
  v_mfma_f32_16x16x32_bf16 a[28:31], a[132:135], v[172:175], a[28:31]
  s_waitcnt lgkmcnt(4)
  ds_read_b64_tr_b16 a[144:145], v18 offset:49152
  v_add_f32 v34, v34, v177
  v_mfma_f32_16x16x32_bf16 a[32:35], a[136:139], v[160:163], a[32:35]
  v_exp_f32 v187, v187
  v_mfma_f32_16x16x32_bf16 a[36:39], a[136:139], v[164:167], a[36:39]
  ds_read_b64_tr_b16 a[148:149], v19 offset:49152
  v_cvt_pk_bf16_f32 v176, v176, v177
  v_mfma_f32_16x16x32_bf16 a[40:43], a[136:139], v[168:171], a[40:43]
  v_exp_f32 v152, v152
  v_mfma_f32_16x16x32_bf16 a[44:47], a[136:139], v[172:175], a[44:47]
  s_waitcnt lgkmcnt(2)
  v_exp_f32 v153, v153
  v_mfma_f32_16x16x32_bf16 a[48:51], a[140:143], v[160:163], a[48:51]
  buffer_load_dwordx2 v[86:87], v0, s[24:27], s34 offen offset:32
  v_mfma_f32_16x16x32_bf16 a[52:55], a[140:143], v[164:167], a[52:55]
  v_exp_f32 v154, v154
  v_mfma_f32_16x16x32_bf16 a[56:59], a[140:143], v[168:171], a[56:59]
  ds_read_b64_tr_b16 a[152:153], v20 offset:49152
  v_add_f32 v34, v34, v178
  v_mfma_f32_16x16x32_bf16 a[60:63], a[140:143], v[172:175], a[60:63]
  s_waitcnt lgkmcnt(2)
  v_exp_f32 v155, v155
  v_mfma_f32_16x16x32_bf16 a[64:67], a[144:147], v[160:163], a[64:67]
  ds_read_b64_tr_b16 a[156:157], v21 offset:49152
  ds_read_b64_tr_b16 a[142:143], v17 offset:61440
  v_mfma_f32_16x16x32_bf16 a[68:71], a[144:147], v[164:167], a[68:71]
  v_exp_f32 v188, v188
  v_mfma_f32_16x16x32_bf16 a[72:75], a[144:147], v[168:171], a[72:75]
  buffer_load_dwordx2 v[88:89], v0, s[24:27], s34 offen offset:64
  v_mfma_f32_16x16x32_bf16 a[76:79], a[144:147], v[172:175], a[76:79]
  s_waitcnt lgkmcnt(3)
  v_exp_f32 v189, v189
  v_mfma_f32_16x16x32_bf16 a[80:83], a[148:151], v[160:163], a[80:83]
  ds_read_b64_tr_b16 a[128:129], v14 offset:57344
  ds_read_b64_tr_b16 a[144:145], v18 offset:57344
  v_mfma_f32_16x16x32_bf16 a[84:87], a[148:151], v[164:167], a[84:87]
  v_exp_f32 v190, v190
  v_mfma_f32_16x16x32_bf16 a[88:91], a[148:151], v[168:171], a[88:91]
  ds_read_b64_tr_b16 a[130:131], v14 offset:61440
  ds_read_b64_tr_b16 a[146:147], v18 offset:61440
  v_mfma_f32_16x16x32_bf16 a[92:95], a[148:151], v[172:175], a[92:95]
  s_waitcnt lgkmcnt(6)
  v_exp_f32 v191, v191
  v_mfma_f32_16x16x32_bf16 a[96:99], a[152:155], v[160:163], a[96:99]
  buffer_load_dwordx2 v[90:91], v0, s[24:27], s34 offen offset:96
  v_mfma_f32_16x16x32_bf16 a[100:103], a[152:155], v[164:167], a[100:103]
  v_exp_f32 v156, v156
  v_mfma_f32_16x16x32_bf16 a[104:107], a[152:155], v[168:171], a[104:107]
  ds_read_b64_tr_b16 a[132:133], v15 offset:57344
  v_add_f32 v34, v34, v179
  v_mfma_f32_16x16x32_bf16 a[108:111], a[152:155], v[172:175], a[108:111]
  s_waitcnt lgkmcnt(6)
  v_exp_f32 v157, v157
  v_mfma_f32_16x16x32_bf16 a[112:115], a[156:159], v[160:163], a[112:115]
  ds_read_b64_tr_b16 a[134:135], v15 offset:61440
  v_cvt_pk_bf16_f32 v177, v178, v179
  v_mfma_f32_16x16x32_bf16 a[116:119], a[156:159], v[164:167], a[116:119]
  v_exp_f32 v158, v158
  v_mfma_f32_16x16x32_bf16 a[120:123], a[156:159], v[168:171], a[120:123]
  buffer_load_dwordx2 v[92:93], v0, s[24:27], s34 offen offset:128
  v_mfma_f32_16x16x32_bf16 a[124:127], a[156:159], v[172:175], a[124:127]
  v_exp_f32 v159, v159
  v_mfma_f32_16x16x32_bf16 a[240:243], a[248:251], v[168:171], a[240:243]
  ds_read_b64_tr_b16 a[136:137], v16 offset:57344
  v_add_f32 v34, v34, v144
  v_mfma_f32_16x16x32_bf16 a[244:247], a[248:251], v[140:143], a[244:247]
  ds_read_b64_tr_b16 a[138:139], v16 offset:61440
  v_add_f32 v34, v34, v145
  v_mfma_f32_16x16x32_bf16 a[244:247], a[248:251], v[172:175], a[244:247]
  s_waitcnt lgkmcnt(5)
  ds_read_b64_tr_b16 a[140:141], v17 offset:57344
  v_cvt_pk_bf16_f32 v178, v144, v145
  v_add_f32 v34, v34, v146
  v_add_f32 v34, v34, v147
  v_cvt_pk_bf16_f32 v179, v146, v147
  v_add_f32 v35, v35, v180
  v_add_f32 v35, v35, v181
  v_cvt_pk_bf16_f32 v180, v180, v181
  v_add_f32 v35, v35, v182
  v_add_f32 v35, v35, v183
  v_cvt_pk_bf16_f32 v181, v182, v183
  v_add_f32 v35, v35, v148
  v_add_f32 v35, v35, v149
  v_cvt_pk_bf16_f32 v182, v148, v149
  v_add_f32 v35, v35, v150
  v_add_f32 v35, v35, v151
  v_cvt_pk_bf16_f32 v183, v150, v151
  v_cvt_pk_bf16_f32 v184, v184, v185
  v_cvt_pk_bf16_f32 v185, v186, v187
  v_cvt_pk_bf16_f32 v186, v152, v153
  v_cvt_pk_bf16_f32 v187, v154, v155
  v_cvt_pk_bf16_f32 v188, v188, v189
  v_cvt_pk_bf16_f32 v189, v190, v191
  v_cvt_pk_bf16_f32 v190, v156, v157
  v_cvt_pk_bf16_f32 v191, v158, v159
  v_mfma_f32_16x16x32_bf16 a[0:3], a[128:131], v[176:179], a[0:3]
  s_mov_b32 s4, s58
  v_mov_b32 v96, v34
  v_mov_b32 v97, v35
  v_mfma_f32_16x16x32_bf16 a[4:7], a[128:131], v[180:183], a[4:7]
  s_and_b32 s5, s59, 0xffff
  v_mov_b32 v98, v36
  v_mfma_f32_16x16x32_bf16 a[8:11], a[128:131], v[184:187], a[8:11]
  s_mov_b32 s6, 4096
  ds_read_b64_tr_b16 a[148:149], v19 offset:57344
  v_mfma_f32_16x16x32_bf16 a[12:15], a[128:131], v[188:191], a[12:15]
  s_lshl_b32 s38, s74, 2
  ds_read_b64_tr_b16 a[150:151], v19 offset:61440
  v_permlane16_swap_b32 v34, v96
  v_mfma_f32_16x16x32_bf16 a[240:243], a[248:251], v[184:187], a[240:243]
  s_add_u32 s38, s38, s28
  ds_read_b64_tr_b16 a[152:153], v20 offset:57344
  v_permlane16_swap_b32 v35, v97
  v_mfma_f32_16x16x32_bf16 a[244:247], a[248:251], v[188:191], a[244:247]
  s_waitcnt lgkmcnt(6)
  ds_read_b64_tr_b16 a[154:155], v20 offset:61440
  v_permlane16_swap_b32 v36, v98
  v_mfma_f32_16x16x32_bf16 a[16:19], a[132:135], v[176:179], a[16:19]
  s_lshl_b32 s38, s38, 4
  v_mfma_f32_16x16x32_bf16 a[20:23], a[132:135], v[180:183], a[20:23]
  s_lshl_b32 s39, s30, 2
  v_add_f32 v34, v34, v96
  v_add_f32 v35, v35, v97
  v_mfma_f32_16x16x32_bf16 a[24:27], a[132:135], v[184:187], a[24:27]
  s_add_u32 s42, s77, 40960
  ds_read_b64_tr_b16 a[156:157], v21 offset:57344
  v_add_f32 v36, v36, v98
  v_mfma_f32_16x16x32_bf16 a[28:31], a[132:135], v[188:191], a[28:31]
  s_waitcnt lgkmcnt(6)
  buffer_load_dwordx4 v[232:235], v26, s[44:47], s42 offen offset:0 sc1
  v_mfma_f32_16x16x32_bf16 a[32:35], a[136:139], v[176:179], a[32:35]
  s_add_u32 s39, s39, s28
  ds_read_b64_tr_b16 a[158:159], v21 offset:61440
  v_mov_b32 v96, v34
  v_mfma_f32_16x16x32_bf16 a[36:39], a[136:139], v[180:183], a[36:39]
  s_lshl_b32 s39, s39, 19
  buffer_load_dwordx4 v[236:239], v26, s[44:47], s42 offen offset:1024 sc1
  v_mfma_f32_16x16x32_bf16 a[40:43], a[136:139], v[184:187], a[40:43]
  s_lshl_b32 s79, s29, 14
  v_mov_b32 v97, v35
  v_mov_b32 v98, v36
  v_mfma_f32_16x16x32_bf16 a[44:47], a[136:139], v[188:191], a[44:47]
  s_waitcnt lgkmcnt(6)
  v_mfma_f32_16x16x32_bf16 a[48:51], a[140:143], v[176:179], a[48:51]
  s_add_u32 s39, s39, s79
  buffer_load_dwordx4 v[240:243], v26, s[44:47], s42 offen offset:2048 sc1
  v_mfma_f32_16x16x32_bf16 a[52:55], a[140:143], v[180:183], a[52:55]
  s_add_u32 s39, s39, 16777216
  v_permlane32_swap_b32 v34, v96
  v_permlane32_swap_b32 v35, v97
  v_mfma_f32_16x16x32_bf16 a[56:59], a[140:143], v[184:187], a[56:59]
  buffer_load_dwordx4 v[244:247], v26, s[44:47], s42 offen offset:3072 sc1
  v_mfma_f32_16x16x32_bf16 a[60:63], a[140:143], v[188:191], a[60:63]
  s_waitcnt lgkmcnt(11)
  v_permlane32_swap_b32 v36, v98
  v_mfma_f32_16x16x32_bf16 a[64:67], a[144:147], v[176:179], a[64:67]
  buffer_load_dwordx4 v[248:251], v27, s[44:47], s42 offen sc1
  v_mfma_f32_16x16x32_bf16 a[68:71], a[144:147], v[180:183], a[68:71]
  v_add_f32 v5, v34, v96
  v_add_f32 v6, v35, v97
  v_mfma_f32_16x16x32_bf16 a[72:75], a[144:147], v[184:187], a[72:75]
  s_add_u32 s42, s77, 61440
  v_add_f32 v7, v36, v98
  v_accvgpr_read_b32 v9, a240
  v_mfma_f32_16x16x32_bf16 a[76:79], a[144:147], v[188:191], a[76:79]
  s_waitcnt lgkmcnt(4)
  buffer_load_dwordx4 v[252:255], v26, s[44:47], s42 offen offset:0 sc1
  v_mfma_f32_16x16x32_bf16 a[80:83], a[148:151], v[176:179], a[80:83]
  v_accvgpr_read_b32 v8, a244
  v_add_f32 v7, v7, v9
  v_mfma_f32_16x16x32_bf16 a[84:87], a[148:151], v[180:183], a[84:87]
  buffer_load_dwordx4 v[40:43], v26, s[44:47], s42 offen offset:1024 sc1
  v_mfma_f32_16x16x32_bf16 a[88:91], a[148:151], v[184:187], a[88:91]
  v_and_b32 v12, 15, v2
  v_add_u32 v12, s38, v12
  v_mfma_f32_16x16x32_bf16 a[92:95], a[148:151], v[188:191], a[92:95]
  s_waitcnt lgkmcnt(2)
  v_lshlrev_b32 v13, 1, v12
  v_mfma_f32_16x16x32_bf16 a[96:99], a[152:155], v[176:179], a[96:99]
  buffer_load_dwordx4 v[44:47], v26, s[44:47], s42 offen offset:2048 sc1
  v_mfma_f32_16x16x32_bf16 a[100:103], a[152:155], v[180:183], a[100:103]
  v_rcp_f32 v76, v5
  v_mfma_f32_16x16x32_bf16 a[104:107], a[152:155], v[184:187], a[104:107]
  buffer_load_dwordx4 v[48:51], v26, s[44:47], s42 offen offset:3072 sc1
  v_mfma_f32_16x16x32_bf16 a[108:111], a[152:155], v[188:191], a[108:111]
  s_waitcnt lgkmcnt(0)
  v_rcp_f32 v78, v6
  v_mfma_f32_16x16x32_bf16 a[112:115], a[156:159], v[176:179], a[112:115]
  buffer_load_dwordx4 v[52:55], v27, s[44:47], s42 offen sc1
  v_mfma_f32_16x16x32_bf16 a[116:119], a[156:159], v[180:183], a[116:119]
  v_rcp_f32 v80, v7
  v_mfma_f32_16x16x32_bf16 a[120:123], a[156:159], v[184:187], a[120:123]
  v_rcp_f32 v82, v8
  v_mfma_f32_16x16x32_bf16 a[124:127], a[156:159], v[188:191], a[124:127]
  v_accvgpr_read_b32 v160, a0
  v_accvgpr_read_b32 v161, a1
  v_accvgpr_read_b32 v162, a2
  v_accvgpr_read_b32 v163, a3
  v_accvgpr_read_b32 v164, a16
  v_accvgpr_read_b32 v165, a17
  v_accvgpr_read_b32 v166, a18
  v_accvgpr_read_b32 v167, a19
  v_pk_mul_f32 v[160:161], v[160:161], v[76:77] op_sel_hi:[1,0]
  v_pk_mul_f32 v[162:163], v[162:163], v[76:77] op_sel_hi:[1,0]
  v_pk_mul_f32 v[164:165], v[164:165], v[76:77] op_sel_hi:[1,0]
  v_pk_mul_f32 v[166:167], v[166:167], v[76:77] op_sel_hi:[1,0]
  v_cvt_pk_bf16_f32 v96, v160, v161
  v_cvt_pk_bf16_f32 v97, v162, v163
  v_cvt_pk_bf16_f32 v98, v164, v165
  v_cvt_pk_bf16_f32 v99, v166, v167
  buffer_load_ushort v11, v13, s[4:7], 0 offen
  buffer_store_dwordx4 v[96:99], v26, s[20:23], s39 offen offset:0 sc1
  v_accvgpr_read_b32 v168, a4
  v_accvgpr_read_b32 v169, a5
  v_accvgpr_read_b32 v170, a6
  v_accvgpr_read_b32 v171, a7
  v_accvgpr_read_b32 v172, a20
  v_accvgpr_read_b32 v173, a21
  v_accvgpr_read_b32 v174, a22
  v_accvgpr_read_b32 v175, a23
  v_pk_mul_f32 v[168:169], v[168:169], v[78:79] op_sel_hi:[1,0]
  v_pk_mul_f32 v[170:171], v[170:171], v[78:79] op_sel_hi:[1,0]
  v_pk_mul_f32 v[172:173], v[172:173], v[78:79] op_sel_hi:[1,0]
  v_pk_mul_f32 v[174:175], v[174:175], v[78:79] op_sel_hi:[1,0]
  v_cvt_pk_bf16_f32 v100, v168, v169
  v_cvt_pk_bf16_f32 v101, v170, v171
  v_cvt_pk_bf16_f32 v102, v172, v173
  v_cvt_pk_bf16_f32 v103, v174, v175
  buffer_store_dwordx4 v[100:103], v26, s[20:23], s39 offen offset:1024 sc1
  v_accvgpr_read_b32 v176, a8
  v_accvgpr_read_b32 v177, a9
  v_accvgpr_read_b32 v178, a10
  v_accvgpr_read_b32 v179, a11
  v_accvgpr_read_b32 v180, a24
  v_accvgpr_read_b32 v181, a25
  v_accvgpr_read_b32 v182, a26
  v_accvgpr_read_b32 v183, a27
  v_pk_mul_f32 v[176:177], v[176:177], v[80:81] op_sel_hi:[1,0]
  v_pk_mul_f32 v[178:179], v[178:179], v[80:81] op_sel_hi:[1,0]
  v_pk_mul_f32 v[180:181], v[180:181], v[80:81] op_sel_hi:[1,0]
  v_pk_mul_f32 v[182:183], v[182:183], v[80:81] op_sel_hi:[1,0]
  v_cvt_pk_bf16_f32 v104, v176, v177
  v_cvt_pk_bf16_f32 v105, v178, v179
  v_cvt_pk_bf16_f32 v106, v180, v181
  v_cvt_pk_bf16_f32 v107, v182, v183
  s_waitcnt vmcnt(29)
  ds_read_b64_tr_b16 a[128:129], v28 offset:0
  ds_read_b64_tr_b16 a[130:131], v28 offset:2048
  buffer_store_dwordx4 v[104:107], v26, s[20:23], s39 offen offset:2048 sc1
  v_accvgpr_read_b32 v160, a12
  v_accvgpr_read_b32 v161, a13
  v_accvgpr_read_b32 v162, a14
  v_accvgpr_read_b32 v163, a15
  v_accvgpr_read_b32 v164, a28
  v_accvgpr_read_b32 v165, a29
  v_accvgpr_read_b32 v166, a30
  v_accvgpr_read_b32 v167, a31
  v_pk_mul_f32 v[160:161], v[160:161], v[82:83] op_sel_hi:[1,0]
  v_pk_mul_f32 v[162:163], v[162:163], v[82:83] op_sel_hi:[1,0]
  v_pk_mul_f32 v[164:165], v[164:165], v[82:83] op_sel_hi:[1,0]
  v_pk_mul_f32 v[166:167], v[166:167], v[82:83] op_sel_hi:[1,0]
  v_cvt_pk_bf16_f32 v108, v160, v161
  v_cvt_pk_bf16_f32 v109, v162, v163
  v_cvt_pk_bf16_f32 v110, v164, v165
  v_cvt_pk_bf16_f32 v111, v166, v167
  ds_read_b64_tr_b16 a[132:133], v29 offset:0
  ds_read_b64_tr_b16 a[134:135], v29 offset:2048
  buffer_store_dwordx4 v[108:111], v26, s[20:23], s39 offen offset:3072 sc1
  s_add_u32 s39, s39, 4096
  v_accvgpr_read_b32 v168, a32
  v_accvgpr_read_b32 v169, a33
  v_accvgpr_read_b32 v170, a34
  v_accvgpr_read_b32 v171, a35
  v_accvgpr_read_b32 v172, a48
  v_accvgpr_read_b32 v173, a49
  v_accvgpr_read_b32 v174, a50
  v_accvgpr_read_b32 v175, a51
  v_pk_mul_f32 v[168:169], v[168:169], v[76:77] op_sel_hi:[1,0]
  v_pk_mul_f32 v[170:171], v[170:171], v[76:77] op_sel_hi:[1,0]
  v_pk_mul_f32 v[172:173], v[172:173], v[76:77] op_sel_hi:[1,0]
  v_pk_mul_f32 v[174:175], v[174:175], v[76:77] op_sel_hi:[1,0]
  v_cvt_pk_bf16_f32 v112, v168, v169
  v_cvt_pk_bf16_f32 v113, v170, v171
  v_cvt_pk_bf16_f32 v114, v172, v173
  v_cvt_pk_bf16_f32 v115, v174, v175
  ds_read_b64_tr_b16 a[136:137], v30 offset:0
  ds_read_b64_tr_b16 a[138:139], v30 offset:2048
  buffer_store_dwordx4 v[112:115], v26, s[20:23], s39 offen offset:0 sc1
  v_accvgpr_read_b32 v176, a36
  v_accvgpr_read_b32 v177, a37
  v_accvgpr_read_b32 v178, a38
  v_accvgpr_read_b32 v179, a39
  v_accvgpr_read_b32 v180, a52
  v_accvgpr_read_b32 v181, a53
  v_accvgpr_read_b32 v182, a54
  v_accvgpr_read_b32 v183, a55
  v_pk_mul_f32 v[176:177], v[176:177], v[78:79] op_sel_hi:[1,0]
  v_pk_mul_f32 v[178:179], v[178:179], v[78:79] op_sel_hi:[1,0]
  v_pk_mul_f32 v[180:181], v[180:181], v[78:79] op_sel_hi:[1,0]
  v_pk_mul_f32 v[182:183], v[182:183], v[78:79] op_sel_hi:[1,0]
  v_cvt_pk_bf16_f32 v116, v176, v177
  v_cvt_pk_bf16_f32 v117, v178, v179
  v_cvt_pk_bf16_f32 v118, v180, v181
  v_cvt_pk_bf16_f32 v119, v182, v183
  ds_read_b64_tr_b16 a[140:141], v31 offset:0
  ds_read_b64_tr_b16 a[142:143], v31 offset:2048
  buffer_store_dwordx4 v[116:119], v26, s[20:23], s39 offen offset:1024 sc1
  v_accvgpr_read_b32 v160, a40
  v_accvgpr_read_b32 v161, a41
  v_accvgpr_read_b32 v162, a42
  v_accvgpr_read_b32 v163, a43
  v_accvgpr_read_b32 v164, a56
  v_accvgpr_read_b32 v165, a57
  v_accvgpr_read_b32 v166, a58
  v_accvgpr_read_b32 v167, a59
  v_pk_mul_f32 v[160:161], v[160:161], v[80:81] op_sel_hi:[1,0]
  v_pk_mul_f32 v[162:163], v[162:163], v[80:81] op_sel_hi:[1,0]
  v_pk_mul_f32 v[164:165], v[164:165], v[80:81] op_sel_hi:[1,0]
  v_pk_mul_f32 v[166:167], v[166:167], v[80:81] op_sel_hi:[1,0]
  v_cvt_pk_bf16_f32 v120, v160, v161
  v_cvt_pk_bf16_f32 v121, v162, v163
  v_cvt_pk_bf16_f32 v122, v164, v165
  v_cvt_pk_bf16_f32 v123, v166, v167
  buffer_store_dwordx4 v[120:123], v26, s[20:23], s39 offen offset:2048 sc1
  v_accvgpr_read_b32 v168, a44
  v_accvgpr_read_b32 v169, a45
  v_accvgpr_read_b32 v170, a46
  v_accvgpr_read_b32 v171, a47
  v_accvgpr_read_b32 v172, a60
  v_accvgpr_read_b32 v173, a61
  v_accvgpr_read_b32 v174, a62
  v_accvgpr_read_b32 v175, a63
  v_pk_mul_f32 v[168:169], v[168:169], v[82:83] op_sel_hi:[1,0]
  v_pk_mul_f32 v[170:171], v[170:171], v[82:83] op_sel_hi:[1,0]
  v_pk_mul_f32 v[172:173], v[172:173], v[82:83] op_sel_hi:[1,0]
  v_pk_mul_f32 v[174:175], v[174:175], v[82:83] op_sel_hi:[1,0]
  v_cvt_pk_bf16_f32 v124, v168, v169
  v_cvt_pk_bf16_f32 v125, v170, v171
  v_cvt_pk_bf16_f32 v126, v172, v173
  v_cvt_pk_bf16_f32 v127, v174, v175
  buffer_store_dwordx4 v[124:127], v26, s[20:23], s39 offen offset:3072 sc1
  s_add_u32 s39, s39, 4096
  v_accvgpr_read_b32 v176, a64
  v_accvgpr_read_b32 v177, a65
  v_accvgpr_read_b32 v178, a66
  v_accvgpr_read_b32 v179, a67
  v_accvgpr_read_b32 v180, a80
  v_accvgpr_read_b32 v181, a81
  v_accvgpr_read_b32 v182, a82
  v_accvgpr_read_b32 v183, a83
  v_pk_mul_f32 v[176:177], v[176:177], v[76:77] op_sel_hi:[1,0]
  v_pk_mul_f32 v[178:179], v[178:179], v[76:77] op_sel_hi:[1,0]
  v_pk_mul_f32 v[180:181], v[180:181], v[76:77] op_sel_hi:[1,0]
  v_pk_mul_f32 v[182:183], v[182:183], v[76:77] op_sel_hi:[1,0]
  v_cvt_pk_bf16_f32 v128, v176, v177
  v_cvt_pk_bf16_f32 v129, v178, v179
  v_cvt_pk_bf16_f32 v130, v180, v181
  v_cvt_pk_bf16_f32 v131, v182, v183
  buffer_store_dwordx4 v[128:131], v26, s[20:23], s39 offen offset:0 sc1
  v_accvgpr_read_b32 v160, a68
  v_accvgpr_read_b32 v161, a69
  v_accvgpr_read_b32 v162, a70
  v_accvgpr_read_b32 v163, a71
  v_accvgpr_read_b32 v164, a84
  v_accvgpr_read_b32 v165, a85
  v_accvgpr_read_b32 v166, a86
  v_accvgpr_read_b32 v167, a87
  v_pk_mul_f32 v[160:161], v[160:161], v[78:79] op_sel_hi:[1,0]
  v_pk_mul_f32 v[162:163], v[162:163], v[78:79] op_sel_hi:[1,0]
  v_pk_mul_f32 v[164:165], v[164:165], v[78:79] op_sel_hi:[1,0]
  v_pk_mul_f32 v[166:167], v[166:167], v[78:79] op_sel_hi:[1,0]
  v_cvt_pk_bf16_f32 v132, v160, v161
  v_cvt_pk_bf16_f32 v133, v162, v163
  v_cvt_pk_bf16_f32 v134, v164, v165
  v_cvt_pk_bf16_f32 v135, v166, v167
  buffer_store_dwordx4 v[132:135], v26, s[20:23], s39 offen offset:1024 sc1
  v_accvgpr_read_b32 v168, a72
  v_accvgpr_read_b32 v169, a73
  v_accvgpr_read_b32 v170, a74
  v_accvgpr_read_b32 v171, a75
  v_accvgpr_read_b32 v172, a88
  v_accvgpr_read_b32 v173, a89
  v_accvgpr_read_b32 v174, a90
  v_accvgpr_read_b32 v175, a91
  v_pk_mul_f32 v[168:169], v[168:169], v[80:81] op_sel_hi:[1,0]
  v_pk_mul_f32 v[170:171], v[170:171], v[80:81] op_sel_hi:[1,0]
  v_pk_mul_f32 v[172:173], v[172:173], v[80:81] op_sel_hi:[1,0]
  v_pk_mul_f32 v[174:175], v[174:175], v[80:81] op_sel_hi:[1,0]
  v_cvt_pk_bf16_f32 v136, v168, v169
  v_cvt_pk_bf16_f32 v137, v170, v171
  v_cvt_pk_bf16_f32 v138, v172, v173
  v_cvt_pk_bf16_f32 v139, v174, v175
  buffer_store_dwordx4 v[136:139], v26, s[20:23], s39 offen offset:2048 sc1
  v_accvgpr_read_b32 v176, a76
  v_accvgpr_read_b32 v177, a77
  v_accvgpr_read_b32 v178, a78
  v_accvgpr_read_b32 v179, a79
  v_accvgpr_read_b32 v180, a92
  v_accvgpr_read_b32 v181, a93
  v_accvgpr_read_b32 v182, a94
  v_accvgpr_read_b32 v183, a95
  v_pk_mul_f32 v[176:177], v[176:177], v[82:83] op_sel_hi:[1,0]
  v_pk_mul_f32 v[178:179], v[178:179], v[82:83] op_sel_hi:[1,0]
  v_pk_mul_f32 v[180:181], v[180:181], v[82:83] op_sel_hi:[1,0]
  v_pk_mul_f32 v[182:183], v[182:183], v[82:83] op_sel_hi:[1,0]
  v_cvt_pk_bf16_f32 v140, v176, v177
  v_cvt_pk_bf16_f32 v141, v178, v179
  v_cvt_pk_bf16_f32 v142, v180, v181
  v_cvt_pk_bf16_f32 v143, v182, v183
  buffer_store_dwordx4 v[140:143], v26, s[20:23], s39 offen offset:3072 sc1
  s_add_u32 s39, s39, 4096
  v_accvgpr_read_b32 v160, a96
  v_accvgpr_read_b32 v161, a97
  v_accvgpr_read_b32 v162, a98
  v_accvgpr_read_b32 v163, a99
  v_accvgpr_read_b32 v164, a112
  v_accvgpr_read_b32 v165, a113
  v_accvgpr_read_b32 v166, a114
  v_accvgpr_read_b32 v167, a115
  v_pk_mul_f32 v[160:161], v[160:161], v[76:77] op_sel_hi:[1,0]
  v_pk_mul_f32 v[162:163], v[162:163], v[76:77] op_sel_hi:[1,0]
  v_pk_mul_f32 v[164:165], v[164:165], v[76:77] op_sel_hi:[1,0]
  v_pk_mul_f32 v[166:167], v[166:167], v[76:77] op_sel_hi:[1,0]
  v_cvt_pk_bf16_f32 v144, v160, v161
  v_cvt_pk_bf16_f32 v145, v162, v163
  v_cvt_pk_bf16_f32 v146, v164, v165
  v_cvt_pk_bf16_f32 v147, v166, v167
  buffer_store_dwordx4 v[144:147], v26, s[20:23], s39 offen offset:0 sc1
  v_accvgpr_read_b32 v168, a100
  v_accvgpr_read_b32 v169, a101
  v_accvgpr_read_b32 v170, a102
  v_accvgpr_read_b32 v171, a103
  v_accvgpr_read_b32 v172, a116
  v_accvgpr_read_b32 v173, a117
  v_accvgpr_read_b32 v174, a118
  v_accvgpr_read_b32 v175, a119
  v_pk_mul_f32 v[168:169], v[168:169], v[78:79] op_sel_hi:[1,0]
  v_pk_mul_f32 v[170:171], v[170:171], v[78:79] op_sel_hi:[1,0]
  v_pk_mul_f32 v[172:173], v[172:173], v[78:79] op_sel_hi:[1,0]
  v_pk_mul_f32 v[174:175], v[174:175], v[78:79] op_sel_hi:[1,0]
  v_cvt_pk_bf16_f32 v148, v168, v169
  v_cvt_pk_bf16_f32 v149, v170, v171
  v_cvt_pk_bf16_f32 v150, v172, v173
  v_cvt_pk_bf16_f32 v151, v174, v175
  buffer_store_dwordx4 v[148:151], v26, s[20:23], s39 offen offset:1024 sc1
  v_accvgpr_read_b32 v176, a104
  v_accvgpr_read_b32 v177, a105
  v_accvgpr_read_b32 v178, a106
  v_accvgpr_read_b32 v179, a107
  v_accvgpr_read_b32 v180, a120
  v_accvgpr_read_b32 v181, a121
  v_accvgpr_read_b32 v182, a122
  v_accvgpr_read_b32 v183, a123
  v_pk_mul_f32 v[176:177], v[176:177], v[80:81] op_sel_hi:[1,0]
  v_pk_mul_f32 v[178:179], v[178:179], v[80:81] op_sel_hi:[1,0]
  v_pk_mul_f32 v[180:181], v[180:181], v[80:81] op_sel_hi:[1,0]
  v_pk_mul_f32 v[182:183], v[182:183], v[80:81] op_sel_hi:[1,0]
  v_cvt_pk_bf16_f32 v152, v176, v177
  v_cvt_pk_bf16_f32 v153, v178, v179
  v_cvt_pk_bf16_f32 v154, v180, v181
  v_cvt_pk_bf16_f32 v155, v182, v183
  buffer_store_dwordx4 v[152:155], v26, s[20:23], s39 offen offset:2048 sc1
  v_accvgpr_read_b32 v160, a108
  v_accvgpr_read_b32 v161, a109
  v_accvgpr_read_b32 v162, a110
  v_accvgpr_read_b32 v163, a111
  v_accvgpr_read_b32 v164, a124
  v_accvgpr_read_b32 v165, a125
  v_accvgpr_read_b32 v166, a126
  v_accvgpr_read_b32 v167, a127
  v_pk_mul_f32 v[160:161], v[160:161], v[82:83] op_sel_hi:[1,0]
  v_pk_mul_f32 v[162:163], v[162:163], v[82:83] op_sel_hi:[1,0]
  v_pk_mul_f32 v[164:165], v[164:165], v[82:83] op_sel_hi:[1,0]
  v_pk_mul_f32 v[166:167], v[166:167], v[82:83] op_sel_hi:[1,0]
  v_cvt_pk_bf16_f32 v156, v160, v161
  v_cvt_pk_bf16_f32 v157, v162, v163
  v_cvt_pk_bf16_f32 v158, v164, v165
  v_cvt_pk_bf16_f32 v159, v166, v167
  buffer_store_dwordx4 v[156:159], v26, s[20:23], s39 offen offset:3072 sc1
  s_waitcnt lgkmcnt(0)
  v_mfma_f32_16x16x32_bf16 a[160:163], a[128:131], v[56:59], a[160:163]
  v_add_f32 v9, v5, v6
  v_mfma_f32_16x16x32_bf16 a[164:167], a[128:131], v[60:63], a[164:167]
  v_add_f32 v36, v7, v8
  v_mfma_f32_16x16x32_bf16 a[168:171], a[128:131], v[64:67], a[168:171]
  v_add_f32 v9, v9, v36
  v_mfma_f32_16x16x32_bf16 a[172:175], a[128:131], v[68:71], a[172:175]
  v_mov_b32 v36, 0x5d800000
  v_mfma_f32_16x16x32_bf16 a[176:179], a[128:131], v[72:75], a[176:179]
  v_cmp_nlt_f32 vcc, v9, v36
  s_cmp_lg_u64 vcc, 0
  s_cselect_b32 s38, 1, 0
  v_mov_b32 v36, s38
  v_mfma_f32_16x16x32_bf16 a[180:183], a[132:135], v[56:59], a[180:183]
  s_lshl_b32 s38, s28, 2
  s_add_u32 s38, s38, 45056
  v_mov_b32 v9, s38
  v_mfma_f32_16x16x32_bf16 a[184:187], a[132:135], v[60:63], a[184:187]
  ds_write_b32 v9, v36
  v_mfma_f32_16x16x32_bf16 a[188:191], a[132:135], v[64:67], a[188:191]
  v_mov_b32 v9, 45056
  v_mfma_f32_16x16x32_bf16 a[192:195], a[132:135], v[68:71], a[192:195]
  v_lshrrev_b32 v4, 4, v2
  v_mfma_f32_16x16x32_bf16 a[196:199], a[132:135], v[72:75], a[196:199]
  v_and_b32 v3, 15, v2
  v_mfma_f32_16x16x32_bf16 a[200:203], a[136:139], v[56:59], a[200:203]
  v_xor_b32 v7, v2, v4
  v_mfma_f32_16x16x32_bf16 a[204:207], a[136:139], v[60:63], a[204:207]
  v_lshlrev_b32 v7, 4, v7
  v_mfma_f32_16x16x32_bf16 a[208:211], a[136:139], v[64:67], a[208:211]
  s_mul_i32 s38, s28, 5120
  s_add_u32 s38, s38, 81920
  v_add_u32 v7, s38, v7
  v_mfma_f32_16x16x32_bf16 a[212:215], a[136:139], v[68:71], a[212:215]
  v_add_u32 v8, 40960, v7
  v_mfma_f32_16x16x32_bf16 a[216:219], a[136:139], v[72:75], a[216:219]
  v_mfma_f32_16x16x32_bf16 a[220:223], a[140:143], v[56:59], a[220:223]
  v_mfma_f32_16x16x32_bf16 a[224:227], a[140:143], v[60:63], a[224:227]
  v_mfma_f32_16x16x32_bf16 a[228:231], a[140:143], v[64:67], a[228:231]
  v_mfma_f32_16x16x32_bf16 a[232:235], a[140:143], v[68:71], a[232:235]
  v_mfma_f32_16x16x32_bf16 a[236:239], a[140:143], v[72:75], a[236:239]
  s_lshr_b32 s38, s74, 1
  s_lshl_b32 s38, s38, 20
  s_add_u32 s38, s38, 16777216
  s_add_u32 s16, s64, s38
  s_addc_u32 s17, s65, 0
  s_and_b32 s17, s17, 0xffff
  s_mov_b32 s18, 1048576
  s_mov_b32 s19, 0x20000
  s_lshl_b32 s67, s28, 12
  s_mul_i32 s66, s76, 786432
  s_add_u32 s66, s66, s67
  s_xor_b32 s67, s66, 524288
  s_waitcnt lgkmcnt(0)
  s_barrier
  ds_read_b128 v[60:63], v9
  ds_write_b128 v7, a[160:163] offset:0
  ds_write_b128 v7, a[164:167] offset:1024
  ds_write_b128 v7, a[168:171] offset:2048
  ds_write_b128 v7, a[172:175] offset:3072
  ds_write_b128 v7, a[176:179] offset:4096
  ds_write_b128 v7, a[180:183] offset:20480
  ds_write_b128 v7, a[184:187] offset:21504
  ds_write_b128 v7, a[188:191] offset:22528
  ds_write_b128 v7, a[192:195] offset:23552
  ds_write_b128 v7, a[196:199] offset:24576
  ds_write_b128 v8, a[200:203] offset:0
  ds_write_b128 v8, a[204:207] offset:1024
  ds_write_b128 v8, a[208:211] offset:2048
  ds_write_b128 v8, a[212:215] offset:3072
  ds_write_b128 v8, a[216:219] offset:4096
  ds_write_b128 v8, a[220:223] offset:20480
  ds_write_b128 v8, a[224:227] offset:21504
  ds_write_b128 v8, a[228:231] offset:22528
  ds_write_b128 v8, a[232:235] offset:23552
  ds_write_b128 v8, a[236:239] offset:24576
  s_waitcnt lgkmcnt(15)
  v_or_b32 v60, v60, v61
  v_or_b32 v62, v62, v63
  v_or_b32 v60, v60, v62
  s_nop 0
  v_readfirstlane_b32 s38, v60
  s_nop 3
  s_cmp_gt_u32 s38, s37
  s_cbranch_scc1 ATT_FALLBACK
  s_mov_b32 s8, s60
  s_and_b32 s9, s61, 0xffff
  s_mov_b32 s10, 2621440
  s_mov_b32 s11, 0x20000
  v_mul_u32_u24 v10, 1280, v12
  v_lshl_add_u32 v10, v4, 3, v10
  s_mul_i32 s34, s75, 160
  s_lshr_b32 s38, s74, 2
  s_lshl_b32 s38, s38, 1
  s_add_u32 s38, s38, s76
  s_lshl_b32 s38, s38, 4
  v_and_b32 v38, 15, v2
  v_add_u32 v38, s38, v38
  v_lshlrev_b32 v38, 4, v38
  v_lshrrev_b32 v37, 2, v3
  v_lshlrev_b32 v36, 8, v37
  v_lshl_add_u32 v36, v4, 6, v36
  v_and_b32 v6, 3, v2
  v_lshl_add_u32 v36, v6, 2, v36
  s_mul_i32 s38, s28, 20480
  s_add_u32 s38, s38, 81920
  v_add_u32 v36, s38, v36
  v_xor_b32 v6, 0, v37
  v_lshl_add_u32 v56, v6, 4, v36
  v_xor_b32 v6, 1, v37
  v_lshl_add_u32 v57, v6, 4, v36
  v_xor_b32 v6, 2, v37
  v_lshl_add_u32 v58, v6, 4, v36
  v_xor_b32 v6, 3, v37
  v_lshl_add_u32 v59, v6, 4, v36
  s_lshl_b32 s38, s28, 10
  v_add_u32 v5, s38, v26
  v_add_u32 v6, 65536, v5
  s_waitcnt lgkmcnt(0)
  s_waitcnt vmcnt(0)
  s_barrier
  s_cmp_lg_u32 s28, 0
  s_cbranch_scc1 SIG_3_8543
  s_lshl_b32 s71, s2, 4
  s_add_u32 s71, s71, 14778368
  v_mov_b32 v8, s31
  v_mov_b32 v9, 0
  s_mov_b64 exec, 1
  buffer_store_dword v8, v9, s[20:23], s71 offen sc1
  s_mov_b64 exec, -1
SIG_3_8543:
  ds_read_b32 v100, v56 offset:0
  ds_read_b32 v101, v57 offset:0
  ds_read_b32 v102, v58 offset:0
  ds_read_b32 v103, v59 offset:0
  ds_read_b32 v104, v56 offset:5120
  ds_read_b32 v105, v57 offset:5120
  ds_read_b32 v106, v58 offset:5120
  ds_read_b32 v107, v59 offset:5120
  ds_read_b32 v108, v56 offset:10240
  ds_read_b32 v109, v57 offset:10240
  ds_read_b32 v110, v58 offset:10240
  ds_read_b32 v111, v59 offset:10240
  ds_read_b32 v112, v56 offset:15360
  ds_read_b32 v113, v57 offset:15360
  ds_read_b32 v114, v58 offset:15360
  ds_read_b32 v115, v59 offset:15360
  v_lshlrev_b32 v11, 16, v11
  s_mov_b32 s38, 0xbfb8aa3b
  s_add_u32 s42, s77, 81920
  buffer_load_dwordx4 a[0:3], v26, s[44:47], s42 offen offset:0 sc1
  buffer_load_dwordx4 a[4:7], v26, s[44:47], s42 offen offset:1024 sc1
  buffer_load_dwordx4 a[8:11], v26, s[44:47], s42 offen offset:2048 sc1
  buffer_load_dwordx4 a[12:15], v26, s[44:47], s42 offen offset:3072 sc1
  buffer_load_dwordx4 a[16:19], v27, s[44:47], s42 offen sc1
  s_waitcnt lgkmcnt(0)
  ds_read_b32 v116, v56 offset:1024
  ds_read_b32 v117, v57 offset:1024
  ds_read_b32 v118, v58 offset:1024
  ds_read_b32 v119, v59 offset:1024
  ds_read_b32 v120, v56 offset:6144
  ds_read_b32 v121, v57 offset:6144
  ds_read_b32 v122, v58 offset:6144
  ds_read_b32 v123, v59 offset:6144
  ds_read_b32 v124, v56 offset:11264
  ds_read_b32 v125, v57 offset:11264
  ds_read_b32 v126, v58 offset:11264
  ds_read_b32 v127, v59 offset:11264
  ds_read_b32 v128, v56 offset:16384
  ds_read_b32 v129, v57 offset:16384
  ds_read_b32 v130, v58 offset:16384
  ds_read_b32 v131, v59 offset:16384
  v_pk_add_f32 v[100:101], v[100:101], v[104:105]
  v_pk_add_f32 v[108:109], v[108:109], v[112:113]
  v_pk_add_f32 v[102:103], v[102:103], v[106:107]
  v_pk_add_f32 v[110:111], v[110:111], v[114:115]
  v_pk_add_f32 v[100:101], v[100:101], v[108:109]
  v_pk_add_f32 v[102:103], v[102:103], v[110:111]
  v_cvt_pk_bf16_f32 v104, v100, v101
  v_cvt_pk_bf16_f32 v105, v102, v103
  v_lshlrev_b32 v100, 16, v104
  v_and_b32 v101, 0xffff0000, v104
  v_lshlrev_b32 v102, 16, v105
  v_and_b32 v103, 0xffff0000, v105
  v_add_f32 v100, v100, v11
  v_add_f32 v101, v101, v11
  v_add_f32 v102, v102, v11
  v_add_f32 v103, v103, v11
  v_cvt_pk_bf16_f32 v104, v100, v101
  v_cvt_pk_bf16_f32 v105, v102, v103
  v_lshlrev_b32 v100, 16, v104
  v_and_b32 v101, 0xffff0000, v104
  v_lshlrev_b32 v102, 16, v105
  v_and_b32 v103, 0xffff0000, v105
  s_add_u32 s42, s77, 102400
  buffer_load_dwordx4 a[20:23], v26, s[44:47], s42 offen offset:0 sc1
  buffer_load_dwordx4 a[24:27], v26, s[44:47], s42 offen offset:1024 sc1
  buffer_load_dwordx4 a[28:31], v26, s[44:47], s42 offen offset:2048 sc1
  buffer_load_dwordx4 a[32:35], v26, s[44:47], s42 offen offset:3072 sc1
  buffer_load_dwordx4 a[36:39], v27, s[44:47], s42 offen sc1
  v_mul_f32 v104, s38, v100
  v_mul_f32 v105, s38, v101
  v_mul_f32 v106, s38, v102
  v_mul_f32 v107, s38, v103
  v_exp_f32 v104, v104
  v_exp_f32 v105, v105
  v_exp_f32 v106, v106
  v_exp_f32 v107, v107
  s_nop 0
  v_add_f32 v104, 1.0, v104
  v_add_f32 v105, 1.0, v105
  v_add_f32 v106, 1.0, v106
  v_add_f32 v107, 1.0, v107
  v_rcp_f32 v104, v104
  v_rcp_f32 v105, v105
  v_rcp_f32 v106, v106
  v_rcp_f32 v107, v107
  s_nop 0
  v_pk_mul_f32 v[100:101], v[100:101], v[104:105]
  v_pk_mul_f32 v[102:103], v[102:103], v[106:107]
  v_cvt_pk_bf16_f32 v12, v100, v101
  v_cvt_pk_bf16_f32 v13, v102, v103
  s_add_u32 s42, s77, 122880
  buffer_load_dwordx4 a[40:43], v26, s[44:47], s42 offen offset:0 sc1
  buffer_load_dwordx4 a[44:47], v26, s[44:47], s42 offen offset:1024 sc1
  buffer_load_dwordx4 a[48:51], v26, s[44:47], s42 offen offset:2048 sc1
  buffer_load_dwordx4 a[52:55], v26, s[44:47], s42 offen offset:3072 sc1
  buffer_load_dwordx4 a[56:59], v27, s[44:47], s42 offen sc1
  s_waitcnt lgkmcnt(0)
  ds_read_b32 v100, v56 offset:2048
  ds_read_b32 v101, v57 offset:2048
  ds_read_b32 v102, v58 offset:2048
  ds_read_b32 v103, v59 offset:2048
  ds_read_b32 v104, v56 offset:7168
  ds_read_b32 v105, v57 offset:7168
  ds_read_b32 v106, v58 offset:7168
  ds_read_b32 v107, v59 offset:7168
  ds_read_b32 v108, v56 offset:12288
  ds_read_b32 v109, v57 offset:12288
  ds_read_b32 v110, v58 offset:12288
  ds_read_b32 v111, v59 offset:12288
  ds_read_b32 v112, v56 offset:17408
  ds_read_b32 v113, v57 offset:17408
  ds_read_b32 v114, v58 offset:17408
  ds_read_b32 v115, v59 offset:17408
  v_pk_add_f32 v[116:117], v[116:117], v[120:121]
  v_pk_add_f32 v[124:125], v[124:125], v[128:129]
  v_pk_add_f32 v[118:119], v[118:119], v[122:123]
  v_pk_add_f32 v[126:127], v[126:127], v[130:131]
  v_pk_add_f32 v[116:117], v[116:117], v[124:125]
  v_pk_add_f32 v[118:119], v[118:119], v[126:127]
  v_cvt_pk_bf16_f32 v120, v116, v117
  v_cvt_pk_bf16_f32 v121, v118, v119
  v_lshlrev_b32 v116, 16, v120
  v_and_b32 v117, 0xffff0000, v120
  v_lshlrev_b32 v118, 16, v121
  v_and_b32 v119, 0xffff0000, v121
  v_add_f32 v116, v116, v11
  v_add_f32 v117, v117, v11
  v_add_f32 v118, v118, v11
  v_add_f32 v119, v119, v11
  v_cvt_pk_bf16_f32 v120, v116, v117
  v_cvt_pk_bf16_f32 v121, v118, v119
  v_lshlrev_b32 v116, 16, v120
  v_and_b32 v117, 0xffff0000, v120
  v_lshlrev_b32 v118, 16, v121
  v_and_b32 v119, 0xffff0000, v121
  s_add_u32 s42, s77, 143360
  buffer_load_dwordx4 a[60:63], v26, s[44:47], s42 offen offset:0 sc1
  buffer_load_dwordx4 a[64:67], v26, s[44:47], s42 offen offset:1024 sc1
  buffer_load_dwordx4 a[68:71], v26, s[44:47], s42 offen offset:2048 sc1
  buffer_load_dwordx4 a[72:75], v26, s[44:47], s42 offen offset:3072 sc1
  buffer_load_dwordx4 a[76:79], v27, s[44:47], s42 offen sc1
  v_mul_f32 v120, s38, v116
  v_mul_f32 v121, s38, v117
  v_mul_f32 v122, s38, v118
  v_mul_f32 v123, s38, v119
  v_exp_f32 v120, v120
  v_exp_f32 v121, v121
  v_exp_f32 v122, v122
  v_exp_f32 v123, v123
  s_nop 0
  v_add_f32 v120, 1.0, v120
  v_add_f32 v121, 1.0, v121
  v_add_f32 v122, 1.0, v122
  v_add_f32 v123, 1.0, v123
  v_rcp_f32 v120, v120
  v_rcp_f32 v121, v121
  v_rcp_f32 v122, v122
  v_rcp_f32 v123, v123
  s_nop 0
  v_pk_mul_f32 v[116:117], v[116:117], v[120:121]
  v_pk_mul_f32 v[118:119], v[118:119], v[122:123]
  v_cvt_pk_bf16_f32 v14, v116, v117
  v_cvt_pk_bf16_f32 v15, v118, v119
  s_add_u32 s42, s77, 163840
  buffer_load_dwordx4 a[80:83], v26, s[44:47], s42 offen offset:0 sc1
  buffer_load_dwordx4 a[84:87], v26, s[44:47], s42 offen offset:1024 sc1
  buffer_load_dwordx4 a[88:91], v26, s[44:47], s42 offen offset:2048 sc1
  buffer_load_dwordx4 a[92:95], v26, s[44:47], s42 offen offset:3072 sc1
  buffer_load_dwordx4 a[96:99], v27, s[44:47], s42 offen sc1
  s_waitcnt lgkmcnt(0)
  ds_read_b32 v116, v56 offset:3072
  ds_read_b32 v117, v57 offset:3072
  ds_read_b32 v118, v58 offset:3072
  ds_read_b32 v119, v59 offset:3072
  ds_read_b32 v120, v56 offset:8192
  ds_read_b32 v121, v57 offset:8192
  ds_read_b32 v122, v58 offset:8192
  ds_read_b32 v123, v59 offset:8192
  ds_read_b32 v124, v56 offset:13312
  ds_read_b32 v125, v57 offset:13312
  ds_read_b32 v126, v58 offset:13312
  ds_read_b32 v127, v59 offset:13312
  ds_read_b32 v128, v56 offset:18432
  ds_read_b32 v129, v57 offset:18432
  ds_read_b32 v130, v58 offset:18432
  ds_read_b32 v131, v59 offset:18432
  v_pk_add_f32 v[100:101], v[100:101], v[104:105]
  v_pk_add_f32 v[108:109], v[108:109], v[112:113]
  v_pk_add_f32 v[102:103], v[102:103], v[106:107]
  v_pk_add_f32 v[110:111], v[110:111], v[114:115]
  v_pk_add_f32 v[100:101], v[100:101], v[108:109]
  v_pk_add_f32 v[102:103], v[102:103], v[110:111]
  v_cvt_pk_bf16_f32 v104, v100, v101
  v_cvt_pk_bf16_f32 v105, v102, v103
  v_lshlrev_b32 v100, 16, v104
  v_and_b32 v101, 0xffff0000, v104
  v_lshlrev_b32 v102, 16, v105
  v_and_b32 v103, 0xffff0000, v105
  v_add_f32 v100, v100, v11
  v_add_f32 v101, v101, v11
  v_add_f32 v102, v102, v11
  v_add_f32 v103, v103, v11
  v_cvt_pk_bf16_f32 v104, v100, v101
  v_cvt_pk_bf16_f32 v105, v102, v103
  v_lshlrev_b32 v100, 16, v104
  v_and_b32 v101, 0xffff0000, v104
  v_lshlrev_b32 v102, 16, v105
  v_and_b32 v103, 0xffff0000, v105
  s_add_u32 s42, s77, 184320
  buffer_load_dwordx4 a[100:103], v26, s[44:47], s42 offen offset:0 sc1
  buffer_load_dwordx4 a[104:107], v26, s[44:47], s42 offen offset:1024 sc1
  buffer_load_dwordx4 a[108:111], v26, s[44:47], s42 offen offset:2048 sc1
  buffer_load_dwordx4 a[112:115], v26, s[44:47], s42 offen offset:3072 sc1
  buffer_load_dwordx4 a[116:119], v27, s[44:47], s42 offen sc1
  v_mul_f32 v104, s38, v100
  v_mul_f32 v105, s38, v101
  v_mul_f32 v106, s38, v102
  v_mul_f32 v107, s38, v103
  v_exp_f32 v104, v104
  v_exp_f32 v105, v105
  v_exp_f32 v106, v106
  v_exp_f32 v107, v107
  s_nop 0
  v_add_f32 v104, 1.0, v104
  v_add_f32 v105, 1.0, v105
  v_add_f32 v106, 1.0, v106
  v_add_f32 v107, 1.0, v107
  v_rcp_f32 v104, v104
  v_rcp_f32 v105, v105
  v_rcp_f32 v106, v106
  v_rcp_f32 v107, v107
  s_nop 0
  v_pk_mul_f32 v[100:101], v[100:101], v[104:105]
  v_pk_mul_f32 v[102:103], v[102:103], v[106:107]
  v_cvt_pk_bf16_f32 v16, v100, v101
  v_cvt_pk_bf16_f32 v17, v102, v103
  s_mov_b32 s71, 14778368
  buffer_load_dword v39, v38, s[20:23], s71 offen sc1
  s_add_u32 s42, s77, 204800
  buffer_load_dwordx4 a[120:123], v26, s[44:47], s42 offen offset:0 sc1
  buffer_load_dwordx4 a[124:127], v26, s[44:47], s42 offen offset:1024 sc1
  buffer_load_dwordx4 a[128:131], v26, s[44:47], s42 offen offset:2048 sc1
  buffer_load_dwordx4 a[132:135], v26, s[44:47], s42 offen offset:3072 sc1
  s_waitcnt lgkmcnt(0)
  ds_read_b32 v100, v56 offset:4096
  ds_read_b32 v101, v57 offset:4096
  ds_read_b32 v102, v58 offset:4096
  ds_read_b32 v103, v59 offset:4096
  ds_read_b32 v104, v56 offset:9216
  ds_read_b32 v105, v57 offset:9216
  ds_read_b32 v106, v58 offset:9216
  ds_read_b32 v107, v59 offset:9216
  ds_read_b32 v108, v56 offset:14336
  ds_read_b32 v109, v57 offset:14336
  ds_read_b32 v110, v58 offset:14336
  ds_read_b32 v111, v59 offset:14336
  ds_read_b32 v112, v56 offset:19456
  ds_read_b32 v113, v57 offset:19456
  ds_read_b32 v114, v58 offset:19456
  ds_read_b32 v115, v59 offset:19456
  v_pk_add_f32 v[116:117], v[116:117], v[120:121]
  v_pk_add_f32 v[124:125], v[124:125], v[128:129]
  v_pk_add_f32 v[118:119], v[118:119], v[122:123]
  v_pk_add_f32 v[126:127], v[126:127], v[130:131]
  v_pk_add_f32 v[116:117], v[116:117], v[124:125]
  v_pk_add_f32 v[118:119], v[118:119], v[126:127]
  v_cvt_pk_bf16_f32 v120, v116, v117
  v_cvt_pk_bf16_f32 v121, v118, v119
  v_lshlrev_b32 v116, 16, v120
  v_and_b32 v117, 0xffff0000, v120
  v_lshlrev_b32 v118, 16, v121
  v_and_b32 v119, 0xffff0000, v121
  v_add_f32 v116, v116, v11
  v_add_f32 v117, v117, v11
  v_add_f32 v118, v118, v11
  v_add_f32 v119, v119, v11
  v_cvt_pk_bf16_f32 v120, v116, v117
  v_cvt_pk_bf16_f32 v121, v118, v119
  v_lshlrev_b32 v116, 16, v120
  v_and_b32 v117, 0xffff0000, v120
  v_lshlrev_b32 v118, 16, v121
  v_and_b32 v119, 0xffff0000, v121
  buffer_load_dwordx4 a[136:139], v27, s[44:47], s42 offen sc1
  s_add_u32 s42, s77, 225280
  buffer_load_dwordx4 a[140:143], v26, s[44:47], s42 offen offset:0 sc1
  buffer_load_dwordx4 a[144:147], v26, s[44:47], s42 offen offset:1024 sc1
  buffer_load_dwordx4 a[148:151], v26, s[44:47], s42 offen offset:2048 sc1
  buffer_load_dwordx4 a[152:155], v26, s[44:47], s42 offen offset:3072 sc1
  v_mul_f32 v120, s38, v116
  v_mul_f32 v121, s38, v117
  v_mul_f32 v122, s38, v118
  v_mul_f32 v123, s38, v119
  v_exp_f32 v120, v120
  v_exp_f32 v121, v121
  v_exp_f32 v122, v122
  v_exp_f32 v123, v123
  s_nop 0
  v_add_f32 v120, 1.0, v120
  v_add_f32 v121, 1.0, v121
  v_add_f32 v122, 1.0, v122
  v_add_f32 v123, 1.0, v123
  v_rcp_f32 v120, v120
  v_rcp_f32 v121, v121
  v_rcp_f32 v122, v122
  v_rcp_f32 v123, v123
  s_nop 0
  v_pk_mul_f32 v[116:117], v[116:117], v[120:121]
  v_pk_mul_f32 v[118:119], v[118:119], v[122:123]
  v_cvt_pk_bf16_f32 v18, v116, v117
  v_cvt_pk_bf16_f32 v19, v118, v119
  buffer_load_dwordx4 a[156:159], v27, s[44:47], s42 offen sc1
  s_add_u32 s42, s77, 245760
  buffer_load_dwordx4 v[160:163], v26, s[44:47], s42 offen offset:0 sc1
  buffer_load_dwordx4 v[164:167], v26, s[44:47], s42 offen offset:1024 sc1
  buffer_load_dwordx4 v[168:171], v26, s[44:47], s42 offen offset:2048 sc1
  buffer_load_dwordx4 v[172:175], v26, s[44:47], s42 offen offset:3072 sc1
  s_waitcnt lgkmcnt(0)
  v_pk_add_f32 v[100:101], v[100:101], v[104:105]
  v_pk_add_f32 v[108:109], v[108:109], v[112:113]
  v_pk_add_f32 v[102:103], v[102:103], v[106:107]
  v_pk_add_f32 v[110:111], v[110:111], v[114:115]
  v_pk_add_f32 v[100:101], v[100:101], v[108:109]
  v_pk_add_f32 v[102:103], v[102:103], v[110:111]
  v_cvt_pk_bf16_f32 v104, v100, v101
  v_cvt_pk_bf16_f32 v105, v102, v103
  v_lshlrev_b32 v100, 16, v104
  v_and_b32 v101, 0xffff0000, v104
  v_lshlrev_b32 v102, 16, v105
  v_and_b32 v103, 0xffff0000, v105
  v_add_f32 v100, v100, v11
  v_add_f32 v101, v101, v11
  v_add_f32 v102, v102, v11
  v_add_f32 v103, v103, v11
  v_cvt_pk_bf16_f32 v104, v100, v101
  v_cvt_pk_bf16_f32 v105, v102, v103
  v_lshlrev_b32 v100, 16, v104
  v_and_b32 v101, 0xffff0000, v104
  v_lshlrev_b32 v102, 16, v105
  v_and_b32 v103, 0xffff0000, v105
  buffer_load_dwordx4 v[176:179], v27, s[44:47], s42 offen sc1
  v_mul_f32 v104, s38, v100
  v_mul_f32 v105, s38, v101
  v_mul_f32 v106, s38, v102
  v_mul_f32 v107, s38, v103
  v_exp_f32 v104, v104
  v_exp_f32 v105, v105
  v_exp_f32 v106, v106
  v_exp_f32 v107, v107
  s_nop 0
  v_add_f32 v104, 1.0, v104
  v_add_f32 v105, 1.0, v105
  v_add_f32 v106, 1.0, v106
  v_add_f32 v107, 1.0, v107
  v_rcp_f32 v104, v104
  v_rcp_f32 v105, v105
  v_rcp_f32 v106, v106
  v_rcp_f32 v107, v107
  s_nop 0
  v_pk_mul_f32 v[100:101], v[100:101], v[104:105]
  v_pk_mul_f32 v[102:103], v[102:103], v[106:107]
  v_cvt_pk_bf16_f32 v20, v100, v101
  v_cvt_pk_bf16_f32 v21, v102, v103
  s_waitcnt vmcnt(15)
  v_cmp_ne_u32 vcc, s31, v39
  s_cbranch_vccz POLL_O_OK
  s_mov_b32 s71, 14778368
  s_mov_b32 s79, 0
POLL_O:
  buffer_load_dword v39, v38, s[20:23], s71 offen sc1
  s_add_u32 s79, s79, 1
  s_waitcnt vmcnt(0)
  v_cmp_ne_u32 vcc, s31, v39
  s_cmp_gt_u32 s79, 1048576
  s_cbranch_scc1 POLL_O_X
  s_cbranch_vccnz POLL_O
POLL_O_X:
POLL_O_OK:
  s_add_u32 s70, s28, 1
  s_and_b32 s70, s70, 3
  s_lshl_b32 s70, s70, 10
  s_add_u32 s70, s70, s67
  buffer_load_dwordx4 a[160:163], v26, s[16:19], s70 offen sc1
  s_add_u32 s70, s70, 16384
  buffer_load_dwordx4 a[164:167], v26, s[16:19], s70 offen sc1
  s_add_u32 s70, s70, 16384
  buffer_load_dwordx4 a[168:171], v26, s[16:19], s70 offen sc1
  s_add_u32 s70, s70, 16384
  buffer_load_dwordx4 a[172:175], v26, s[16:19], s70 offen sc1
  s_add_u32 s70, s70, 16384
  buffer_load_dwordx4 a[176:179], v26, s[16:19], s70 offen sc1
  s_add_u32 s70, s70, 16384
  buffer_load_dwordx4 a[180:183], v26, s[16:19], s70 offen sc1
  s_add_u32 s70, s70, 16384
  buffer_load_dwordx4 a[184:187], v26, s[16:19], s70 offen sc1
  s_add_u32 s70, s70, 16384
  buffer_load_dwordx4 a[188:191], v26, s[16:19], s70 offen sc1
  s_add_u32 s70, s70, 16384
  buffer_load_dwordx4 a[192:195], v26, s[16:19], s70 offen sc1
  s_add_u32 s70, s70, 16384
  buffer_load_dwordx4 a[196:199], v26, s[16:19], s70 offen sc1
  s_waitcnt vmcnt(6)
  v_mfma_f32_16x16x32_bf16 v[60:63], v[192:195], a[160:163], 0
  s_add_u32 s70, s70, 16384
  v_mfma_f32_16x16x32_bf16 v[60:63], v[212:215], a[164:167], v[60:63]
  buffer_load_dwordx4 a[200:203], v26, s[16:19], s70 offen sc1
  v_mfma_f32_16x16x32_bf16 v[60:63], v[232:235], a[168:171], v[60:63]
  s_add_u32 s70, s70, 16384
  ds_read_b128 v[180:183], v5 offset:0
  v_mfma_f32_16x16x32_bf16 v[60:63], v[252:255], a[172:175], v[60:63]
  buffer_load_dwordx4 a[204:207], v26, s[16:19], s70 offen sc1
  v_mfma_f32_16x16x32_bf16 v[64:67], v[40:43], a[172:175], 0
  s_add_u32 s70, s70, 16384
  ds_read_b128 v[184:187], v5 offset:4096
  v_mfma_f32_16x16x32_bf16 v[64:67], v[236:239], a[168:171], v[64:67]
  buffer_load_dwordx4 a[208:211], v26, s[16:19], s70 offen sc1
  v_mfma_f32_16x16x32_bf16 v[64:67], v[216:219], a[164:167], v[64:67]
  s_add_u32 s70, s70, 16384
  ds_read_b128 v[188:191], v5 offset:8192
  v_mfma_f32_16x16x32_bf16 v[64:67], v[196:199], a[160:163], v[64:67]
  buffer_load_dwordx4 a[212:215], v26, s[16:19], s70 offen sc1
  v_mfma_f32_16x16x32_bf16 v[68:71], v[200:203], a[160:163], 0
  s_add_u32 s70, s70, 16384
  ds_read_b128 a[240:243], v5 offset:12288
  v_mfma_f32_16x16x32_bf16 v[68:71], v[220:223], a[164:167], v[68:71]
  buffer_load_dwordx4 a[216:219], v26, s[16:19], s70 offen sc1
  v_mfma_f32_16x16x32_bf16 v[68:71], v[240:243], a[168:171], v[68:71]
  s_add_u32 s70, s70, 16384
  ds_read_b128 a[244:247], v5 offset:16384
  v_mfma_f32_16x16x32_bf16 v[68:71], v[44:47], a[172:175], v[68:71]
  buffer_load_dwordx4 a[220:223], v26, s[16:19], s70 offen sc1
  v_mfma_f32_16x16x32_bf16 v[72:75], v[48:51], a[172:175], 0
  s_add_u32 s70, s28, 2
  s_and_b32 s70, s70, 3
  s_lshl_b32 s70, s70, 10
  s_add_u32 s70, s70, s67
  ds_read_b128 a[248:251], v5 offset:20480
  v_mfma_f32_16x16x32_bf16 v[72:75], v[244:247], a[168:171], v[72:75]
  buffer_load_dwordx4 a[224:227], v26, s[16:19], s70 offen sc1
  v_mfma_f32_16x16x32_bf16 v[72:75], v[224:227], a[164:167], v[72:75]
  s_add_u32 s70, s70, 16384
  ds_read_b128 a[252:255], v6 offset:0
  v_mfma_f32_16x16x32_bf16 v[72:75], v[204:207], a[160:163], v[72:75]
  buffer_load_dwordx4 a[228:231], v26, s[16:19], s70 offen sc1
  v_mfma_f32_16x16x32_bf16 v[76:79], v[208:211], a[160:163], 0
  ds_read_b128 v[22:25], v6 offset:4096
  v_mfma_f32_16x16x32_bf16 v[76:79], v[228:231], a[164:167], v[76:79]
  ds_read_b128 v[28:31], v5 offset:24576
  v_mfma_f32_16x16x32_bf16 v[76:79], v[248:251], a[168:171], v[76:79]
  ds_read_b128 v[32:35], v5 offset:28672
  v_mfma_f32_16x16x32_bf16 v[76:79], v[52:55], a[172:175], v[76:79]
  s_waitcnt vmcnt(10)
  ds_read_b128 v[140:143], v5 offset:32768
  v_mfma_f32_16x16x32_bf16 v[60:63], a[0:3], a[176:179], v[60:63]
  s_add_u32 s70, s70, 16384
  ds_read_b128 v[144:147], v5 offset:36864
  v_mfma_f32_16x16x32_bf16 v[60:63], a[20:23], a[180:183], v[60:63]
  buffer_load_dwordx4 a[232:235], v26, s[16:19], s70 offen sc1
  v_mfma_f32_16x16x32_bf16 v[60:63], a[40:43], a[184:187], v[60:63]
  s_add_u32 s70, s70, 16384
  ds_read_b128 v[148:151], v6 offset:8192
  v_mfma_f32_16x16x32_bf16 v[60:63], a[60:63], a[188:191], v[60:63]
  buffer_load_dwordx4 a[236:239], v26, s[16:19], s70 offen sc1
  v_mfma_f32_16x16x32_bf16 v[64:67], a[64:67], a[188:191], v[64:67]
  s_add_u32 s70, s70, 16384
  ds_read_b128 v[152:155], v6 offset:12288
  v_mfma_f32_16x16x32_bf16 v[64:67], a[44:47], a[184:187], v[64:67]
  buffer_load_dwordx4 a[160:163], v26, s[16:19], s70 offen sc1
  v_mfma_f32_16x16x32_bf16 v[64:67], a[24:27], a[180:183], v[64:67]
  s_add_u32 s70, s70, 16384
  ds_read_b128 v[156:159], v5 offset:40960
  v_mfma_f32_16x16x32_bf16 v[64:67], a[4:7], a[176:179], v[64:67]
  buffer_load_dwordx4 a[164:167], v26, s[16:19], s70 offen sc1
  v_mfma_f32_16x16x32_bf16 v[68:71], a[8:11], a[176:179], v[68:71]
  s_add_u32 s70, s70, 16384
  v_mov_b32 v0, v84
  v_mov_b32 v1, v85
  v_mfma_f32_16x16x32_bf16 v[68:71], a[28:31], a[180:183], v[68:71]
  buffer_load_dwordx4 a[168:171], v26, s[16:19], s70 offen sc1
  v_mfma_f32_16x16x32_bf16 v[68:71], a[48:51], a[184:187], v[68:71]
  s_add_u32 s70, s70, 16384
  v_mov_b32 v2, v86
  v_mov_b32 v3, v87
  v_mfma_f32_16x16x32_bf16 v[68:71], a[68:71], a[188:191], v[68:71]
  buffer_load_dwordx4 a[172:175], v26, s[16:19], s70 offen sc1
  v_mfma_f32_16x16x32_bf16 v[72:75], a[72:75], a[188:191], v[72:75]
  v_mov_b32 v36, v88
  v_mov_b32 v37, v89
  v_mfma_f32_16x16x32_bf16 v[72:75], a[52:55], a[184:187], v[72:75]
  v_mov_b32 v56, v90
  v_mov_b32 v57, v91
  v_mfma_f32_16x16x32_bf16 v[72:75], a[32:35], a[180:183], v[72:75]
  v_mov_b32 v58, v92
  v_mov_b32 v59, v93
  v_mfma_f32_16x16x32_bf16 v[72:75], a[12:15], a[176:179], v[72:75]
  v_mfma_f32_16x16x32_bf16 v[76:79], a[16:19], a[176:179], v[76:79]
  v_mfma_f32_16x16x32_bf16 v[76:79], a[36:39], a[180:183], v[76:79]
  v_mfma_f32_16x16x32_bf16 v[76:79], a[56:59], a[184:187], v[76:79]
  v_mfma_f32_16x16x32_bf16 v[76:79], a[76:79], a[188:191], v[76:79]
  s_waitcnt vmcnt(12)
  v_mfma_f32_16x16x32_bf16 v[60:63], a[80:83], a[192:195], v[60:63]
  s_add_u32 s70, s70, 16384
  v_mfma_f32_16x16x32_bf16 v[60:63], a[100:103], a[196:199], v[60:63]
  s_lshl_b32 s39, s74, 3
  buffer_load_dwordx4 a[176:179], v26, s[16:19], s70 offen sc1
  v_mfma_f32_16x16x32_bf16 v[60:63], a[120:123], a[200:203], v[60:63]
  s_add_u32 s39, s39, s75
  v_mfma_f32_16x16x32_bf16 v[60:63], a[140:143], a[204:207], v[60:63]
  s_lshl_b32 s39, s39, 2
  v_mfma_f32_16x16x32_bf16 v[64:67], a[144:147], a[204:207], v[64:67]
  s_add_u32 s70, s70, 16384
  v_mfma_f32_16x16x32_bf16 v[64:67], a[124:127], a[200:203], v[64:67]
  s_add_u32 s39, s39, s28
  buffer_load_dwordx4 a[180:183], v26, s[16:19], s70 offen sc1
  v_mfma_f32_16x16x32_bf16 v[64:67], a[104:107], a[196:199], v[64:67]
  s_xor_b32 s36, s39, 32
  v_mfma_f32_16x16x32_bf16 v[64:67], a[84:87], a[192:195], v[64:67]
  s_mul_i32 s68, s36, 5120
  v_mfma_f32_16x16x32_bf16 v[68:71], a[88:91], a[192:195], v[68:71]
  s_add_u32 s70, s70, 16384
  v_mfma_f32_16x16x32_bf16 v[68:71], a[108:111], a[196:199], v[68:71]
  s_add_u32 s68, s68, 33554432
  buffer_load_dwordx4 a[184:187], v26, s[16:19], s70 offen sc1
  v_mfma_f32_16x16x32_bf16 v[68:71], a[128:131], a[200:203], v[68:71]
  s_mul_i32 s35, s39, 5120
  v_mfma_f32_16x16x32_bf16 v[68:71], a[148:151], a[204:207], v[68:71]
  s_add_u32 s35, s35, 33554432
  v_mfma_f32_16x16x32_bf16 v[72:75], a[152:155], a[204:207], v[72:75]
  s_add_u32 s70, s70, 16384
  v_mfma_f32_16x16x32_bf16 v[72:75], a[132:135], a[200:203], v[72:75]
  s_lshl_b32 s36, s36, 7
  buffer_load_dwordx4 a[188:191], v26, s[16:19], s70 offen sc1
  v_mfma_f32_16x16x32_bf16 v[72:75], a[112:115], a[196:199], v[72:75]
  s_add_u32 s36, s36, 15466496
  v_mfma_f32_16x16x32_bf16 v[72:75], a[92:95], a[192:195], v[72:75]
  s_lshl_b32 s39, s39, 7
  v_mfma_f32_16x16x32_bf16 v[76:79], a[96:99], a[192:195], v[76:79]
  s_waitcnt lgkmcnt(0)
  v_mfma_f32_16x16x32_bf16 v[76:79], a[116:119], a[196:199], v[76:79]
  s_add_u32 s39, s39, 786432
  v_mfma_f32_16x16x32_bf16 v[76:79], a[136:139], a[200:203], v[76:79]
  s_mul_i32 s38, s28, 5120
  v_mfma_f32_16x16x32_bf16 v[76:79], a[156:159], a[204:207], v[76:79]
  s_waitcnt vmcnt(12)
  v_mfma_f32_16x16x32_bf16 v[60:63], v[160:163], a[208:211], v[60:63]
  s_add_u32 s70, s70, 16384
  v_mfma_f32_16x16x32_bf16 v[60:63], v[180:183], a[212:215], v[60:63]
  s_add_u32 s79, s28, 1
  buffer_load_dwordx4 a[192:195], v26, s[16:19], s70 offen sc1
  v_mfma_f32_16x16x32_bf16 v[60:63], a[248:251], a[216:219], v[60:63]
  s_and_b32 s79, s79, 3
  v_mfma_f32_16x16x32_bf16 v[60:63], v[140:143], a[220:223], v[60:63]
  s_mul_i32 s79, s79, 5120
  v_mfma_f32_16x16x32_bf16 v[64:67], v[144:147], a[220:223], v[64:67]
  s_add_u32 s70, s70, 16384
  v_mfma_f32_16x16x32_bf16 v[64:67], a[252:255], a[216:219], v[64:67]
  buffer_load_dwordx4 a[196:199], v26, s[16:19], s70 offen sc1
  v_mfma_f32_16x16x32_bf16 v[64:67], v[184:187], a[212:215], v[64:67]
  v_mfma_f32_16x16x32_bf16 v[64:67], v[164:167], a[208:211], v[64:67]
  v_mfma_f32_16x16x32_bf16 v[68:71], v[168:171], a[208:211], v[68:71]
  s_add_u32 s70, s70, 16384
  v_mfma_f32_16x16x32_bf16 v[68:71], v[188:191], a[212:215], v[68:71]
  buffer_load_dwordx4 a[200:203], v26, s[16:19], s70 offen sc1
  v_mfma_f32_16x16x32_bf16 v[68:71], v[22:25], a[216:219], v[68:71]
  s_barrier
  v_mfma_f32_16x16x32_bf16 v[68:71], v[148:151], a[220:223], v[68:71]
  v_mfma_f32_16x16x32_bf16 v[72:75], v[152:155], a[220:223], v[72:75]
  s_add_u32 s70, s70, 16384
  v_mfma_f32_16x16x32_bf16 v[72:75], v[28:31], a[216:219], v[72:75]
  buffer_load_dwordx4 a[204:207], v26, s[16:19], s70 offen sc1
  v_mfma_f32_16x16x32_bf16 v[72:75], a[240:243], a[212:215], v[72:75]
  v_mfma_f32_16x16x32_bf16 v[72:75], v[172:175], a[208:211], v[72:75]
  v_mfma_f32_16x16x32_bf16 v[76:79], v[176:179], a[208:211], v[76:79]
  v_mov_b32 v38, s39
  v_add_u32 v7, s38, v26
  v_mfma_f32_16x16x32_bf16 v[76:79], a[244:247], a[212:215], v[76:79]
  v_add_u32 v5, s79, v26
  v_mfma_f32_16x16x32_bf16 v[76:79], v[32:35], a[216:219], v[76:79]
  v_mfma_f32_16x16x32_bf16 v[76:79], v[156:159], a[220:223], v[76:79]
  s_waitcnt vmcnt(12)
  v_mfma_f32_16x16x32_bf16 v[80:83], v[192:195], a[224:227], 0
  s_add_u32 s70, s28, 3
  s_and_b32 s70, s70, 3
  s_lshl_b32 s70, s70, 10
  s_add_u32 s70, s70, s67
  v_mfma_f32_16x16x32_bf16 v[80:83], v[212:215], a[228:231], v[80:83]
  buffer_load_dwordx4 a[208:211], v26, s[16:19], s70 offen sc1
  v_mfma_f32_16x16x32_bf16 v[80:83], v[232:235], a[232:235], v[80:83]
  v_mfma_f32_16x16x32_bf16 v[80:83], v[252:255], a[236:239], v[80:83]
  v_mfma_f32_16x16x32_bf16 v[84:87], v[40:43], a[236:239], 0
  s_add_u32 s70, s70, 16384
  v_mfma_f32_16x16x32_bf16 v[84:87], v[236:239], a[232:235], v[84:87]
  buffer_load_dwordx4 a[212:215], v26, s[16:19], s70 offen sc1
  v_mfma_f32_16x16x32_bf16 v[84:87], v[216:219], a[228:231], v[84:87]
  ds_write_b128 v7, v[60:63] offset:0
  v_mfma_f32_16x16x32_bf16 v[84:87], v[196:199], a[224:227], v[84:87]
  v_mfma_f32_16x16x32_bf16 v[88:91], v[200:203], a[224:227], 0
  s_add_u32 s70, s70, 16384
  ds_write_b128 v7, v[64:67] offset:1024
  v_mfma_f32_16x16x32_bf16 v[88:91], v[220:223], a[228:231], v[88:91]
  buffer_load_dwordx4 a[216:219], v26, s[16:19], s70 offen sc1
  v_mfma_f32_16x16x32_bf16 v[88:91], v[240:243], a[232:235], v[88:91]
  ds_write_b128 v7, v[68:71] offset:2048
  v_mfma_f32_16x16x32_bf16 v[88:91], v[44:47], a[236:239], v[88:91]
  v_mfma_f32_16x16x32_bf16 v[92:95], v[48:51], a[236:239], 0
  s_add_u32 s70, s70, 16384
  ds_write_b128 v7, v[72:75] offset:3072
  v_mfma_f32_16x16x32_bf16 v[92:95], v[244:247], a[232:235], v[92:95]
  buffer_load_dwordx4 a[220:223], v26, s[16:19], s70 offen sc1
  v_mfma_f32_16x16x32_bf16 v[92:95], v[224:227], a[228:231], v[92:95]
  ds_write_b128 v7, v[76:79] offset:4096
  v_mfma_f32_16x16x32_bf16 v[92:95], v[204:207], a[224:227], v[92:95]
  v_mfma_f32_16x16x32_bf16 v[96:99], v[208:211], a[224:227], 0
  v_mfma_f32_16x16x32_bf16 v[96:99], v[228:231], a[228:231], v[96:99]
  v_mfma_f32_16x16x32_bf16 v[96:99], v[248:251], a[232:235], v[96:99]
  v_mfma_f32_16x16x32_bf16 v[96:99], v[52:55], a[236:239], v[96:99]
  s_waitcnt vmcnt(12)
  v_mfma_f32_16x16x32_bf16 v[80:83], a[0:3], a[160:163], v[80:83]
  s_add_u32 s70, s70, 16384
  v_mfma_f32_16x16x32_bf16 v[80:83], a[20:23], a[164:167], v[80:83]
  buffer_load_dwordx4 a[224:227], v26, s[16:19], s70 offen sc1
  v_mfma_f32_16x16x32_bf16 v[80:83], a[40:43], a[168:171], v[80:83]
  v_mfma_f32_16x16x32_bf16 v[80:83], a[60:63], a[172:175], v[80:83]
  v_mfma_f32_16x16x32_bf16 v[84:87], a[64:67], a[172:175], v[84:87]
  s_add_u32 s70, s70, 16384
  v_mfma_f32_16x16x32_bf16 v[84:87], a[44:47], a[168:171], v[84:87]
  s_waitcnt lgkmcnt(0)
  buffer_load_dwordx4 a[228:231], v26, s[16:19], s70 offen sc1
  v_mfma_f32_16x16x32_bf16 v[84:87], a[24:27], a[164:167], v[84:87]
  s_barrier
  v_mfma_f32_16x16x32_bf16 v[84:87], a[4:7], a[160:163], v[84:87]
  ds_read_b128 v[100:103], v5 offset:0
  v_mfma_f32_16x16x32_bf16 v[88:91], a[8:11], a[160:163], v[88:91]
  s_add_u32 s70, s70, 16384
  ds_read_b128 v[104:107], v5 offset:1024
  v_mfma_f32_16x16x32_bf16 v[88:91], a[28:31], a[164:167], v[88:91]
  buffer_load_dwordx4 a[232:235], v26, s[16:19], s70 offen sc1
  v_mfma_f32_16x16x32_bf16 v[88:91], a[48:51], a[168:171], v[88:91]
  ds_read_b128 v[108:111], v5 offset:2048
  v_mfma_f32_16x16x32_bf16 v[88:91], a[68:71], a[172:175], v[88:91]
  ds_read_b128 v[112:115], v5 offset:3072
  v_mfma_f32_16x16x32_bf16 v[92:95], a[72:75], a[172:175], v[92:95]
  s_add_u32 s70, s70, 16384
  ds_read_b128 v[116:119], v5 offset:4096
  v_mfma_f32_16x16x32_bf16 v[92:95], a[52:55], a[168:171], v[92:95]
  buffer_load_dwordx4 a[236:239], v26, s[16:19], s70 offen sc1
  v_mfma_f32_16x16x32_bf16 v[92:95], a[32:35], a[164:167], v[92:95]
  v_mfma_f32_16x16x32_bf16 v[92:95], a[12:15], a[160:163], v[92:95]
  v_mfma_f32_16x16x32_bf16 v[96:99], a[16:19], a[160:163], v[96:99]
  v_mfma_f32_16x16x32_bf16 v[96:99], a[36:39], a[164:167], v[96:99]
  v_mfma_f32_16x16x32_bf16 v[96:99], a[56:59], a[168:171], v[96:99]
  v_mfma_f32_16x16x32_bf16 v[96:99], a[76:79], a[172:175], v[96:99]
  s_waitcnt vmcnt(12)
  v_mfma_f32_16x16x32_bf16 v[80:83], a[80:83], a[176:179], v[80:83]
  s_add_u32 s70, s70, 16384
  v_mfma_f32_16x16x32_bf16 v[80:83], a[100:103], a[180:183], v[80:83]
  buffer_load_dwordx4 a[160:163], v26, s[16:19], s70 offen sc1
  v_mfma_f32_16x16x32_bf16 v[80:83], a[120:123], a[184:187], v[80:83]
  v_mfma_f32_16x16x32_bf16 v[80:83], a[140:143], a[188:191], v[80:83]
  v_mfma_f32_16x16x32_bf16 v[84:87], a[144:147], a[188:191], v[84:87]
  s_add_u32 s70, s70, 16384
  v_mfma_f32_16x16x32_bf16 v[84:87], a[124:127], a[184:187], v[84:87]
  buffer_load_dwordx4 a[164:167], v26, s[16:19], s70 offen sc1
  v_mfma_f32_16x16x32_bf16 v[84:87], a[104:107], a[180:183], v[84:87]
  v_mfma_f32_16x16x32_bf16 v[84:87], a[84:87], a[176:179], v[84:87]
  v_mfma_f32_16x16x32_bf16 v[88:91], a[88:91], a[176:179], v[88:91]
  s_add_u32 s70, s70, 16384
  v_mfma_f32_16x16x32_bf16 v[88:91], a[108:111], a[180:183], v[88:91]
  buffer_load_dwordx4 a[168:171], v26, s[16:19], s70 offen sc1
  v_mfma_f32_16x16x32_bf16 v[88:91], a[128:131], a[184:187], v[88:91]
  v_mfma_f32_16x16x32_bf16 v[88:91], a[148:151], a[188:191], v[88:91]
  v_mfma_f32_16x16x32_bf16 v[92:95], a[152:155], a[188:191], v[92:95]
  s_add_u32 s70, s70, 16384
  v_mfma_f32_16x16x32_bf16 v[92:95], a[132:135], a[184:187], v[92:95]
  buffer_load_dwordx4 a[172:175], v26, s[16:19], s70 offen sc1
  v_mfma_f32_16x16x32_bf16 v[92:95], a[112:115], a[180:183], v[92:95]
  v_mfma_f32_16x16x32_bf16 v[92:95], a[92:95], a[176:179], v[92:95]
  v_mfma_f32_16x16x32_bf16 v[96:99], a[96:99], a[176:179], v[96:99]
  v_mfma_f32_16x16x32_bf16 v[96:99], a[116:119], a[180:183], v[96:99]
  v_mfma_f32_16x16x32_bf16 v[96:99], a[136:139], a[184:187], v[96:99]
  v_mfma_f32_16x16x32_bf16 v[96:99], a[156:159], a[188:191], v[96:99]
  s_waitcnt vmcnt(12)
  v_mfma_f32_16x16x32_bf16 v[80:83], v[160:163], a[192:195], v[80:83]
  s_add_u32 s70, s70, 16384
  v_mfma_f32_16x16x32_bf16 v[80:83], v[180:183], a[196:199], v[80:83]
  buffer_load_dwordx4 a[176:179], v26, s[16:19], s70 offen sc1
  v_mfma_f32_16x16x32_bf16 v[80:83], a[248:251], a[200:203], v[80:83]
  v_mfma_f32_16x16x32_bf16 v[80:83], v[140:143], a[204:207], v[80:83]
  v_mfma_f32_16x16x32_bf16 v[84:87], v[144:147], a[204:207], v[84:87]
  s_add_u32 s70, s70, 16384
  v_mfma_f32_16x16x32_bf16 v[84:87], a[252:255], a[200:203], v[84:87]
  buffer_load_dwordx4 a[180:183], v26, s[16:19], s70 offen sc1
  v_mfma_f32_16x16x32_bf16 v[84:87], v[184:187], a[196:199], v[84:87]
  v_mfma_f32_16x16x32_bf16 v[84:87], v[164:167], a[192:195], v[84:87]
  v_mfma_f32_16x16x32_bf16 v[88:91], v[168:171], a[192:195], v[88:91]
  s_add_u32 s70, s70, 16384
  v_mfma_f32_16x16x32_bf16 v[88:91], v[188:191], a[196:199], v[88:91]
  buffer_load_dwordx4 a[184:187], v26, s[16:19], s70 offen sc1
  v_mfma_f32_16x16x32_bf16 v[88:91], v[22:25], a[200:203], v[88:91]
  v_mfma_f32_16x16x32_bf16 v[88:91], v[148:151], a[204:207], v[88:91]
  v_mfma_f32_16x16x32_bf16 v[92:95], v[152:155], a[204:207], v[92:95]
  s_add_u32 s70, s70, 16384
  v_mfma_f32_16x16x32_bf16 v[92:95], v[28:31], a[200:203], v[92:95]
  buffer_load_dwordx4 a[188:191], v26, s[16:19], s70 offen sc1
  v_mfma_f32_16x16x32_bf16 v[92:95], a[240:243], a[196:199], v[92:95]
  v_mfma_f32_16x16x32_bf16 v[92:95], v[172:175], a[192:195], v[92:95]
  v_mfma_f32_16x16x32_bf16 v[96:99], v[176:179], a[192:195], v[96:99]
  v_mfma_f32_16x16x32_bf16 v[96:99], a[244:247], a[196:199], v[96:99]
  v_mfma_f32_16x16x32_bf16 v[96:99], v[32:35], a[200:203], v[96:99]
  s_waitcnt lgkmcnt(0)
  v_mfma_f32_16x16x32_bf16 v[96:99], v[156:159], a[204:207], v[96:99]
  s_waitcnt vmcnt(12)
  v_mfma_f32_16x16x32_bf16 v[60:63], v[192:195], a[208:211], 0
  s_add_u32 s70, s28, 4
  s_and_b32 s70, s70, 3
  s_lshl_b32 s70, s70, 10
  s_add_u32 s70, s70, s67
  v_mfma_f32_16x16x32_bf16 v[60:63], v[212:215], a[212:215], v[60:63]
  buffer_load_dwordx4 a[192:195], v26, s[16:19], s70 offen sc1
  v_mfma_f32_16x16x32_bf16 v[60:63], v[232:235], a[216:219], v[60:63]
  v_mfma_f32_16x16x32_bf16 v[60:63], v[252:255], a[220:223], v[60:63]
  v_mfma_f32_16x16x32_bf16 v[64:67], v[40:43], a[220:223], 0
  s_add_u32 s70, s70, 16384
  v_add_f32 v80, v80, v100
  v_add_f32 v81, v81, v101
  v_mfma_f32_16x16x32_bf16 v[64:67], v[236:239], a[216:219], v[64:67]
  buffer_load_dwordx4 a[196:199], v26, s[16:19], s70 offen sc1
  v_mfma_f32_16x16x32_bf16 v[64:67], v[216:219], a[212:215], v[64:67]
  v_add_f32 v82, v82, v102
  v_add_f32 v83, v83, v103
  v_mfma_f32_16x16x32_bf16 v[64:67], v[196:199], a[208:211], v[64:67]
  v_add_f32 v84, v84, v104
  v_add_f32 v85, v85, v105
  v_mfma_f32_16x16x32_bf16 v[68:71], v[200:203], a[208:211], 0
  s_add_u32 s70, s70, 16384
  v_add_f32 v86, v86, v106
  v_add_f32 v87, v87, v107
  v_mfma_f32_16x16x32_bf16 v[68:71], v[220:223], a[212:215], v[68:71]
  buffer_load_dwordx4 a[200:203], v26, s[16:19], s70 offen sc1
  v_mfma_f32_16x16x32_bf16 v[68:71], v[240:243], a[216:219], v[68:71]
  v_add_f32 v88, v88, v108
  v_add_f32 v89, v89, v109
  v_mfma_f32_16x16x32_bf16 v[68:71], v[44:47], a[220:223], v[68:71]
  v_add_f32 v90, v90, v110
  v_add_f32 v91, v91, v111
  v_mfma_f32_16x16x32_bf16 v[72:75], v[48:51], a[220:223], 0
  s_add_u32 s70, s70, 16384
  v_add_f32 v92, v92, v112
  v_add_f32 v93, v93, v113
  v_mfma_f32_16x16x32_bf16 v[72:75], v[244:247], a[216:219], v[72:75]
  buffer_load_dwordx4 a[204:207], v26, s[16:19], s70 offen sc1
  v_mfma_f32_16x16x32_bf16 v[72:75], v[224:227], a[212:215], v[72:75]
  v_add_f32 v94, v94, v114
  v_add_f32 v95, v95, v115
  v_mfma_f32_16x16x32_bf16 v[72:75], v[204:207], a[208:211], v[72:75]
  v_add_f32 v96, v96, v116
  v_add_f32 v97, v97, v117
  v_mfma_f32_16x16x32_bf16 v[76:79], v[208:211], a[208:211], 0
  v_add_f32 v98, v98, v118
  v_add_f32 v99, v99, v119
  v_mfma_f32_16x16x32_bf16 v[76:79], v[228:231], a[212:215], v[76:79]
  ds_write_b128 v7, v[80:83] offset:20480
  v_mfma_f32_16x16x32_bf16 v[76:79], v[248:251], a[216:219], v[76:79]
  v_mfma_f32_16x16x32_bf16 v[76:79], v[52:55], a[220:223], v[76:79]
  s_waitcnt vmcnt(12)
  ds_write_b128 v7, v[84:87] offset:21504
  v_mfma_f32_16x16x32_bf16 v[60:63], a[0:3], a[224:227], v[60:63]
  s_add_u32 s70, s70, 16384
  v_mfma_f32_16x16x32_bf16 v[60:63], a[20:23], a[228:231], v[60:63]
  buffer_load_dwordx4 a[208:211], v26, s[16:19], s70 offen sc1
  v_mfma_f32_16x16x32_bf16 v[60:63], a[40:43], a[232:235], v[60:63]
  ds_write_b128 v7, v[88:91] offset:22528
  v_mfma_f32_16x16x32_bf16 v[60:63], a[60:63], a[236:239], v[60:63]
  v_mfma_f32_16x16x32_bf16 v[64:67], a[64:67], a[236:239], v[64:67]
  s_add_u32 s70, s70, 16384
  ds_write_b128 v7, v[92:95] offset:23552
  v_mfma_f32_16x16x32_bf16 v[64:67], a[44:47], a[232:235], v[64:67]
  buffer_load_dwordx4 a[212:215], v26, s[16:19], s70 offen sc1
  v_mfma_f32_16x16x32_bf16 v[64:67], a[24:27], a[228:231], v[64:67]
  ds_write_b128 v7, v[96:99] offset:24576
  v_mfma_f32_16x16x32_bf16 v[64:67], a[4:7], a[224:227], v[64:67]
  v_mfma_f32_16x16x32_bf16 v[68:71], a[8:11], a[224:227], v[68:71]
  s_add_u32 s70, s70, 16384
  v_mfma_f32_16x16x32_bf16 v[68:71], a[28:31], a[228:231], v[68:71]
  buffer_load_dwordx4 a[216:219], v26, s[16:19], s70 offen sc1
  v_mfma_f32_16x16x32_bf16 v[68:71], a[48:51], a[232:235], v[68:71]
  v_mfma_f32_16x16x32_bf16 v[68:71], a[68:71], a[236:239], v[68:71]
  v_mfma_f32_16x16x32_bf16 v[72:75], a[72:75], a[236:239], v[72:75]
  s_add_u32 s70, s70, 16384
  v_mfma_f32_16x16x32_bf16 v[72:75], a[52:55], a[232:235], v[72:75]
  buffer_load_dwordx4 a[220:223], v26, s[16:19], s70 offen sc1
  v_mfma_f32_16x16x32_bf16 v[72:75], a[32:35], a[228:231], v[72:75]
  v_mfma_f32_16x16x32_bf16 v[72:75], a[12:15], a[224:227], v[72:75]
  s_waitcnt lgkmcnt(0)
  v_mfma_f32_16x16x32_bf16 v[76:79], a[16:19], a[224:227], v[76:79]
  s_barrier
  v_mfma_f32_16x16x32_bf16 v[76:79], a[36:39], a[228:231], v[76:79]
  ds_read_b128 v[100:103], v5 offset:20480
  v_mfma_f32_16x16x32_bf16 v[76:79], a[56:59], a[232:235], v[76:79]
  ds_read_b128 v[104:107], v5 offset:21504
  v_mfma_f32_16x16x32_bf16 v[76:79], a[76:79], a[236:239], v[76:79]
  s_waitcnt vmcnt(12)
  ds_read_b128 v[108:111], v5 offset:22528
  v_mfma_f32_16x16x32_bf16 v[60:63], a[80:83], a[160:163], v[60:63]
  s_add_u32 s70, s70, 16384
  ds_read_b128 v[112:115], v5 offset:23552
  v_mfma_f32_16x16x32_bf16 v[60:63], a[100:103], a[164:167], v[60:63]
  buffer_load_dwordx4 a[224:227], v26, s[16:19], s70 offen sc1
  v_mfma_f32_16x16x32_bf16 v[60:63], a[120:123], a[168:171], v[60:63]
  ds_read_b128 v[116:119], v5 offset:24576
  v_mfma_f32_16x16x32_bf16 v[60:63], a[140:143], a[172:175], v[60:63]
  v_mfma_f32_16x16x32_bf16 v[64:67], a[144:147], a[172:175], v[64:67]
  s_add_u32 s70, s70, 16384
  v_mfma_f32_16x16x32_bf16 v[64:67], a[124:127], a[168:171], v[64:67]
  buffer_load_dwordx4 a[228:231], v26, s[16:19], s70 offen sc1
  v_mfma_f32_16x16x32_bf16 v[64:67], a[104:107], a[164:167], v[64:67]
  v_mfma_f32_16x16x32_bf16 v[64:67], a[84:87], a[160:163], v[64:67]
  v_mfma_f32_16x16x32_bf16 v[68:71], a[88:91], a[160:163], v[68:71]
  s_add_u32 s70, s70, 16384
  v_mfma_f32_16x16x32_bf16 v[68:71], a[108:111], a[164:167], v[68:71]
  buffer_load_dwordx4 a[232:235], v26, s[16:19], s70 offen sc1
  v_mfma_f32_16x16x32_bf16 v[68:71], a[128:131], a[168:171], v[68:71]
  v_mfma_f32_16x16x32_bf16 v[68:71], a[148:151], a[172:175], v[68:71]
  v_mfma_f32_16x16x32_bf16 v[72:75], a[152:155], a[172:175], v[72:75]
  s_add_u32 s70, s70, 16384
  v_mfma_f32_16x16x32_bf16 v[72:75], a[132:135], a[168:171], v[72:75]
  buffer_load_dwordx4 a[236:239], v26, s[16:19], s70 offen sc1
  v_mfma_f32_16x16x32_bf16 v[72:75], a[112:115], a[164:167], v[72:75]
  v_mfma_f32_16x16x32_bf16 v[72:75], a[92:95], a[160:163], v[72:75]
  v_mfma_f32_16x16x32_bf16 v[76:79], a[96:99], a[160:163], v[76:79]
  v_mfma_f32_16x16x32_bf16 v[76:79], a[116:119], a[164:167], v[76:79]
  v_mfma_f32_16x16x32_bf16 v[76:79], a[136:139], a[168:171], v[76:79]
  v_mfma_f32_16x16x32_bf16 v[76:79], a[156:159], a[172:175], v[76:79]
  s_waitcnt vmcnt(12)
  v_mfma_f32_16x16x32_bf16 v[60:63], v[160:163], a[176:179], v[60:63]
  s_add_u32 s70, s70, 16384
  v_mfma_f32_16x16x32_bf16 v[60:63], v[180:183], a[180:183], v[60:63]
  buffer_load_dwordx4 a[160:163], v26, s[16:19], s70 offen sc1
  v_mfma_f32_16x16x32_bf16 v[60:63], a[248:251], a[184:187], v[60:63]
  v_mfma_f32_16x16x32_bf16 v[60:63], v[140:143], a[188:191], v[60:63]
  v_mfma_f32_16x16x32_bf16 v[64:67], v[144:147], a[188:191], v[64:67]
  s_add_u32 s70, s70, 16384
  v_mfma_f32_16x16x32_bf16 v[64:67], a[252:255], a[184:187], v[64:67]
  buffer_load_dwordx4 a[164:167], v26, s[16:19], s70 offen sc1
  v_mfma_f32_16x16x32_bf16 v[64:67], v[184:187], a[180:183], v[64:67]
  v_mfma_f32_16x16x32_bf16 v[64:67], v[164:167], a[176:179], v[64:67]
  v_mfma_f32_16x16x32_bf16 v[68:71], v[168:171], a[176:179], v[68:71]
  s_add_u32 s70, s70, 16384
  v_mfma_f32_16x16x32_bf16 v[68:71], v[188:191], a[180:183], v[68:71]
  buffer_load_dwordx4 a[168:171], v26, s[16:19], s70 offen sc1
  v_mfma_f32_16x16x32_bf16 v[68:71], v[22:25], a[184:187], v[68:71]
  v_mfma_f32_16x16x32_bf16 v[68:71], v[148:151], a[188:191], v[68:71]
  v_mfma_f32_16x16x32_bf16 v[72:75], v[152:155], a[188:191], v[72:75]
  s_add_u32 s70, s70, 16384
  v_mfma_f32_16x16x32_bf16 v[72:75], v[28:31], a[184:187], v[72:75]
  buffer_load_dwordx4 a[172:175], v26, s[16:19], s70 offen sc1
  v_mfma_f32_16x16x32_bf16 v[72:75], a[240:243], a[180:183], v[72:75]
  v_mfma_f32_16x16x32_bf16 v[72:75], v[172:175], a[176:179], v[72:75]
  v_mfma_f32_16x16x32_bf16 v[76:79], v[176:179], a[176:179], v[76:79]
  v_mfma_f32_16x16x32_bf16 v[76:79], a[244:247], a[180:183], v[76:79]
  v_mfma_f32_16x16x32_bf16 v[76:79], v[32:35], a[184:187], v[76:79]
  s_waitcnt lgkmcnt(0)
  v_mfma_f32_16x16x32_bf16 v[76:79], v[156:159], a[188:191], v[76:79]
  s_waitcnt vmcnt(12)
  v_mfma_f32_16x16x32_bf16 v[80:83], v[192:195], a[192:195], 0
  s_add_u32 s70, s28, 1
  s_and_b32 s70, s70, 3
  s_lshl_b32 s70, s70, 10
  s_add_u32 s70, s70, s66
  v_mfma_f32_16x16x32_bf16 v[80:83], v[212:215], a[196:199], v[80:83]
  buffer_load_dwordx4 a[176:179], v26, s[16:19], s70 offen sc1
  v_mfma_f32_16x16x32_bf16 v[80:83], v[232:235], a[200:203], v[80:83]
  v_mfma_f32_16x16x32_bf16 v[80:83], v[252:255], a[204:207], v[80:83]
  v_mfma_f32_16x16x32_bf16 v[84:87], v[40:43], a[204:207], 0
  s_add_u32 s70, s70, 16384
  v_add_f32 v60, v60, v100
  v_add_f32 v61, v61, v101
  v_mfma_f32_16x16x32_bf16 v[84:87], v[236:239], a[200:203], v[84:87]
  buffer_load_dwordx4 a[180:183], v26, s[16:19], s70 offen sc1
  v_mfma_f32_16x16x32_bf16 v[84:87], v[216:219], a[196:199], v[84:87]
  v_add_f32 v62, v62, v102
  v_add_f32 v63, v63, v103
  v_mfma_f32_16x16x32_bf16 v[84:87], v[196:199], a[192:195], v[84:87]
  v_add_f32 v64, v64, v104
  v_add_f32 v65, v65, v105
  v_mfma_f32_16x16x32_bf16 v[88:91], v[200:203], a[192:195], 0
  s_add_u32 s70, s70, 16384
  v_add_f32 v66, v66, v106
  v_add_f32 v67, v67, v107
  v_mfma_f32_16x16x32_bf16 v[88:91], v[220:223], a[196:199], v[88:91]
  buffer_load_dwordx4 a[184:187], v26, s[16:19], s70 offen sc1
  v_mfma_f32_16x16x32_bf16 v[88:91], v[240:243], a[200:203], v[88:91]
  v_add_f32 v68, v68, v108
  v_add_f32 v69, v69, v109
  v_mfma_f32_16x16x32_bf16 v[88:91], v[44:47], a[204:207], v[88:91]
  v_add_f32 v70, v70, v110
  v_add_f32 v71, v71, v111
  v_mfma_f32_16x16x32_bf16 v[92:95], v[48:51], a[204:207], 0
  s_add_u32 s70, s70, 16384
  v_add_f32 v72, v72, v112
  v_add_f32 v73, v73, v113
  v_mfma_f32_16x16x32_bf16 v[92:95], v[244:247], a[200:203], v[92:95]
  buffer_load_dwordx4 a[188:191], v26, s[16:19], s70 offen sc1
  v_mfma_f32_16x16x32_bf16 v[92:95], v[224:227], a[196:199], v[92:95]
  v_add_f32 v74, v74, v114
  v_add_f32 v75, v75, v115
  v_mfma_f32_16x16x32_bf16 v[92:95], v[204:207], a[192:195], v[92:95]
  v_add_f32 v76, v76, v116
  v_add_f32 v77, v77, v117
  v_mfma_f32_16x16x32_bf16 v[96:99], v[208:211], a[192:195], 0
  v_add_f32 v78, v78, v118
  v_add_f32 v79, v79, v119
  v_mfma_f32_16x16x32_bf16 v[96:99], v[228:231], a[196:199], v[96:99]
  ds_write_b128 v7, v[60:63] offset:0
  v_mfma_f32_16x16x32_bf16 v[96:99], v[248:251], a[200:203], v[96:99]
  v_mfma_f32_16x16x32_bf16 v[96:99], v[52:55], a[204:207], v[96:99]
  s_waitcnt vmcnt(12)
  ds_write_b128 v7, v[64:67] offset:1024
  v_mfma_f32_16x16x32_bf16 v[80:83], a[0:3], a[208:211], v[80:83]
  s_add_u32 s70, s70, 16384
  v_mfma_f32_16x16x32_bf16 v[80:83], a[20:23], a[212:215], v[80:83]
  buffer_load_dwordx4 a[192:195], v26, s[16:19], s70 offen sc1
  v_mfma_f32_16x16x32_bf16 v[80:83], a[40:43], a[216:219], v[80:83]
  ds_write_b128 v7, v[68:71] offset:2048
  v_mfma_f32_16x16x32_bf16 v[80:83], a[60:63], a[220:223], v[80:83]
  v_mfma_f32_16x16x32_bf16 v[84:87], a[64:67], a[220:223], v[84:87]
  s_add_u32 s70, s70, 16384
  ds_write_b128 v7, v[72:75] offset:3072
  v_mfma_f32_16x16x32_bf16 v[84:87], a[44:47], a[216:219], v[84:87]
  buffer_load_dwordx4 a[196:199], v26, s[16:19], s70 offen sc1
  v_mfma_f32_16x16x32_bf16 v[84:87], a[24:27], a[212:215], v[84:87]
  ds_write_b128 v7, v[76:79] offset:4096
  v_mfma_f32_16x16x32_bf16 v[84:87], a[4:7], a[208:211], v[84:87]
  v_mfma_f32_16x16x32_bf16 v[88:91], a[8:11], a[208:211], v[88:91]
  s_add_u32 s70, s70, 16384
  v_mfma_f32_16x16x32_bf16 v[88:91], a[28:31], a[212:215], v[88:91]
  buffer_load_dwordx4 a[200:203], v26, s[16:19], s70 offen sc1
  v_mfma_f32_16x16x32_bf16 v[88:91], a[48:51], a[216:219], v[88:91]
  v_mfma_f32_16x16x32_bf16 v[88:91], a[68:71], a[220:223], v[88:91]
  v_mfma_f32_16x16x32_bf16 v[92:95], a[72:75], a[220:223], v[92:95]
  s_add_u32 s70, s70, 16384
  v_mfma_f32_16x16x32_bf16 v[92:95], a[52:55], a[216:219], v[92:95]
  buffer_load_dwordx4 a[204:207], v26, s[16:19], s70 offen sc1
  v_mfma_f32_16x16x32_bf16 v[92:95], a[32:35], a[212:215], v[92:95]
  v_mfma_f32_16x16x32_bf16 v[92:95], a[12:15], a[208:211], v[92:95]
  s_waitcnt lgkmcnt(0)
  v_mfma_f32_16x16x32_bf16 v[96:99], a[16:19], a[208:211], v[96:99]
  s_barrier
  v_mfma_f32_16x16x32_bf16 v[96:99], a[36:39], a[212:215], v[96:99]
  ds_read_b128 v[100:103], v5 offset:0
  v_mfma_f32_16x16x32_bf16 v[96:99], a[56:59], a[216:219], v[96:99]
  ds_read_b128 v[104:107], v5 offset:1024
  v_mfma_f32_16x16x32_bf16 v[96:99], a[76:79], a[220:223], v[96:99]
  s_waitcnt vmcnt(12)
  ds_read_b128 v[108:111], v5 offset:2048
  v_mfma_f32_16x16x32_bf16 v[80:83], a[80:83], a[224:227], v[80:83]
  s_add_u32 s70, s70, 16384
  ds_read_b128 v[112:115], v5 offset:3072
  v_mfma_f32_16x16x32_bf16 v[80:83], a[100:103], a[228:231], v[80:83]
  buffer_load_dwordx4 a[208:211], v26, s[16:19], s70 offen sc1
  v_mfma_f32_16x16x32_bf16 v[80:83], a[120:123], a[232:235], v[80:83]
  ds_read_b128 v[116:119], v5 offset:4096
  v_mfma_f32_16x16x32_bf16 v[80:83], a[140:143], a[236:239], v[80:83]
  v_mfma_f32_16x16x32_bf16 v[84:87], a[144:147], a[236:239], v[84:87]
  s_add_u32 s70, s70, 16384
  v_mfma_f32_16x16x32_bf16 v[84:87], a[124:127], a[232:235], v[84:87]
  buffer_load_dwordx4 a[212:215], v26, s[16:19], s70 offen sc1
  v_mfma_f32_16x16x32_bf16 v[84:87], a[104:107], a[228:231], v[84:87]
  v_mfma_f32_16x16x32_bf16 v[84:87], a[84:87], a[224:227], v[84:87]
  v_mfma_f32_16x16x32_bf16 v[88:91], a[88:91], a[224:227], v[88:91]
  s_add_u32 s70, s70, 16384
  v_mfma_f32_16x16x32_bf16 v[88:91], a[108:111], a[228:231], v[88:91]
  buffer_load_dwordx4 a[216:219], v26, s[16:19], s70 offen sc1
  v_mfma_f32_16x16x32_bf16 v[88:91], a[128:131], a[232:235], v[88:91]
  v_mfma_f32_16x16x32_bf16 v[88:91], a[148:151], a[236:239], v[88:91]
  v_mfma_f32_16x16x32_bf16 v[92:95], a[152:155], a[236:239], v[92:95]
  s_add_u32 s70, s70, 16384
  v_mfma_f32_16x16x32_bf16 v[92:95], a[132:135], a[232:235], v[92:95]
  buffer_load_dwordx4 a[220:223], v26, s[16:19], s70 offen sc1
  v_mfma_f32_16x16x32_bf16 v[92:95], a[112:115], a[228:231], v[92:95]
  v_mfma_f32_16x16x32_bf16 v[92:95], a[92:95], a[224:227], v[92:95]
  v_mfma_f32_16x16x32_bf16 v[96:99], a[96:99], a[224:227], v[96:99]
  v_mfma_f32_16x16x32_bf16 v[96:99], a[116:119], a[228:231], v[96:99]
  v_mfma_f32_16x16x32_bf16 v[96:99], a[136:139], a[232:235], v[96:99]
  v_mfma_f32_16x16x32_bf16 v[96:99], a[156:159], a[236:239], v[96:99]
  s_waitcnt vmcnt(12)
  v_mfma_f32_16x16x32_bf16 v[80:83], v[160:163], a[160:163], v[80:83]
  s_add_u32 s70, s70, 16384
  v_mfma_f32_16x16x32_bf16 v[80:83], v[180:183], a[164:167], v[80:83]
  buffer_load_dwordx4 a[224:227], v26, s[16:19], s70 offen sc1
  v_mfma_f32_16x16x32_bf16 v[80:83], a[248:251], a[168:171], v[80:83]
  v_mfma_f32_16x16x32_bf16 v[80:83], v[140:143], a[172:175], v[80:83]
  v_mfma_f32_16x16x32_bf16 v[84:87], v[144:147], a[172:175], v[84:87]
  s_add_u32 s70, s70, 16384
  v_mfma_f32_16x16x32_bf16 v[84:87], a[252:255], a[168:171], v[84:87]
  buffer_load_dwordx4 a[228:231], v26, s[16:19], s70 offen sc1
  v_mfma_f32_16x16x32_bf16 v[84:87], v[184:187], a[164:167], v[84:87]
  v_mfma_f32_16x16x32_bf16 v[84:87], v[164:167], a[160:163], v[84:87]
  v_mfma_f32_16x16x32_bf16 v[88:91], v[168:171], a[160:163], v[88:91]
  s_add_u32 s70, s70, 16384
  v_mfma_f32_16x16x32_bf16 v[88:91], v[188:191], a[164:167], v[88:91]
  buffer_load_dwordx4 a[232:235], v26, s[16:19], s70 offen sc1
  v_mfma_f32_16x16x32_bf16 v[88:91], v[22:25], a[168:171], v[88:91]
  v_mfma_f32_16x16x32_bf16 v[88:91], v[148:151], a[172:175], v[88:91]
  v_mfma_f32_16x16x32_bf16 v[92:95], v[152:155], a[172:175], v[92:95]
  s_add_u32 s70, s70, 16384
  v_mfma_f32_16x16x32_bf16 v[92:95], v[28:31], a[168:171], v[92:95]
  buffer_load_dwordx4 a[236:239], v26, s[16:19], s70 offen sc1
  v_mfma_f32_16x16x32_bf16 v[92:95], a[240:243], a[164:167], v[92:95]
  v_mfma_f32_16x16x32_bf16 v[92:95], v[172:175], a[160:163], v[92:95]
  v_mfma_f32_16x16x32_bf16 v[96:99], v[176:179], a[160:163], v[96:99]
  v_mfma_f32_16x16x32_bf16 v[96:99], a[244:247], a[164:167], v[96:99]
  v_mfma_f32_16x16x32_bf16 v[96:99], v[32:35], a[168:171], v[96:99]
  s_waitcnt lgkmcnt(0)
  v_mfma_f32_16x16x32_bf16 v[96:99], v[156:159], a[172:175], v[96:99]
  s_waitcnt vmcnt(12)
  v_mfma_f32_16x16x32_bf16 v[60:63], v[192:195], a[176:179], 0
  s_add_u32 s70, s28, 2
  s_and_b32 s70, s70, 3
  s_lshl_b32 s70, s70, 10
  s_add_u32 s70, s70, s66
  v_mfma_f32_16x16x32_bf16 v[60:63], v[212:215], a[180:183], v[60:63]
  buffer_load_dwordx4 a[160:163], v26, s[16:19], s70 offen sc1
  v_mfma_f32_16x16x32_bf16 v[60:63], v[232:235], a[184:187], v[60:63]
  v_mfma_f32_16x16x32_bf16 v[60:63], v[252:255], a[188:191], v[60:63]
  v_mfma_f32_16x16x32_bf16 v[64:67], v[40:43], a[188:191], 0
  s_add_u32 s70, s70, 16384
  v_add_f32 v80, v80, v100
  v_add_f32 v81, v81, v101
  v_mfma_f32_16x16x32_bf16 v[64:67], v[236:239], a[184:187], v[64:67]
  buffer_load_dwordx4 a[164:167], v26, s[16:19], s70 offen sc1
  v_mfma_f32_16x16x32_bf16 v[64:67], v[216:219], a[180:183], v[64:67]
  v_add_f32 v82, v82, v102
  v_add_f32 v83, v83, v103
  v_mfma_f32_16x16x32_bf16 v[64:67], v[196:199], a[176:179], v[64:67]
  v_add_f32 v84, v84, v104
  v_add_f32 v85, v85, v105
  v_mfma_f32_16x16x32_bf16 v[68:71], v[200:203], a[176:179], 0
  s_add_u32 s70, s70, 16384
  v_add_f32 v86, v86, v106
  v_add_f32 v87, v87, v107
  v_mfma_f32_16x16x32_bf16 v[68:71], v[220:223], a[180:183], v[68:71]
  buffer_load_dwordx4 a[168:171], v26, s[16:19], s70 offen sc1
  v_mfma_f32_16x16x32_bf16 v[68:71], v[240:243], a[184:187], v[68:71]
  v_add_f32 v88, v88, v108
  v_add_f32 v89, v89, v109
  v_mfma_f32_16x16x32_bf16 v[68:71], v[44:47], a[188:191], v[68:71]
  v_add_f32 v90, v90, v110
  v_add_f32 v91, v91, v111
  v_mfma_f32_16x16x32_bf16 v[72:75], v[48:51], a[188:191], 0
  s_add_u32 s70, s70, 16384
  v_add_f32 v92, v92, v112
  v_add_f32 v93, v93, v113
  v_mfma_f32_16x16x32_bf16 v[72:75], v[244:247], a[184:187], v[72:75]
  buffer_load_dwordx4 a[172:175], v26, s[16:19], s70 offen sc1
  v_mfma_f32_16x16x32_bf16 v[72:75], v[224:227], a[180:183], v[72:75]
  v_add_f32 v94, v94, v114
  v_add_f32 v95, v95, v115
  v_mfma_f32_16x16x32_bf16 v[72:75], v[204:207], a[176:179], v[72:75]
  v_add_f32 v96, v96, v116
  v_add_f32 v97, v97, v117
  v_mfma_f32_16x16x32_bf16 v[76:79], v[208:211], a[176:179], 0
  v_add_f32 v98, v98, v118
  v_add_f32 v99, v99, v119
  v_mfma_f32_16x16x32_bf16 v[76:79], v[228:231], a[180:183], v[76:79]
  v_cvt_pk_bf16_f32 v120, v80, v81
  v_cvt_pk_bf16_f32 v121, v82, v83
  v_mfma_f32_16x16x32_bf16 v[76:79], v[248:251], a[184:187], v[76:79]
  v_cvt_pk_bf16_f32 v122, v84, v85
  v_cvt_pk_bf16_f32 v123, v86, v87
  v_mfma_f32_16x16x32_bf16 v[76:79], v[52:55], a[188:191], v[76:79]
  s_waitcnt vmcnt(12)
  v_cvt_pk_bf16_f32 v124, v88, v89
  v_cvt_pk_bf16_f32 v125, v90, v91
  v_mfma_f32_16x16x32_bf16 v[60:63], a[0:3], a[192:195], v[60:63]
  s_add_u32 s70, s70, 16384
  v_cvt_pk_bf16_f32 v126, v92, v93
  v_cvt_pk_bf16_f32 v127, v94, v95
  v_mfma_f32_16x16x32_bf16 v[60:63], a[20:23], a[196:199], v[60:63]
  buffer_load_dwordx4 a[176:179], v26, s[16:19], s70 offen sc1
  v_mfma_f32_16x16x32_bf16 v[60:63], a[40:43], a[200:203], v[60:63]
  v_cvt_pk_bf16_f32 v128, v96, v97
  v_cvt_pk_bf16_f32 v129, v98, v99
  v_mfma_f32_16x16x32_bf16 v[60:63], a[60:63], a[204:207], v[60:63]
  v_lshrrev_b32 v6, 1, v26
  v_mfma_f32_16x16x32_bf16 v[64:67], a[64:67], a[204:207], v[64:67]
  s_add_u32 s70, s70, 16384
  v_mfma_f32_16x16x32_bf16 v[64:67], a[44:47], a[200:203], v[64:67]
  buffer_load_dwordx4 a[180:183], v26, s[16:19], s70 offen sc1
  v_mfma_f32_16x16x32_bf16 v[64:67], a[24:27], a[196:199], v[64:67]
  v_mfma_f32_16x16x32_bf16 v[64:67], a[4:7], a[192:195], v[64:67]
  v_mfma_f32_16x16x32_bf16 v[68:71], a[8:11], a[192:195], v[68:71]
  s_add_u32 s70, s70, 16384
  v_mfma_f32_16x16x32_bf16 v[68:71], a[28:31], a[196:199], v[68:71]
  buffer_load_dwordx4 a[184:187], v26, s[16:19], s70 offen sc1
  v_mfma_f32_16x16x32_bf16 v[68:71], a[48:51], a[200:203], v[68:71]
  v_mfma_f32_16x16x32_bf16 v[68:71], a[68:71], a[204:207], v[68:71]
  buffer_store_dwordx4 v[120:123], v26, s[20:23], s68 offen offset:0 sc1
  v_mfma_f32_16x16x32_bf16 v[72:75], a[72:75], a[204:207], v[72:75]
  s_add_u32 s70, s70, 16384
  v_mfma_f32_16x16x32_bf16 v[72:75], a[52:55], a[200:203], v[72:75]
  buffer_load_dwordx4 a[188:191], v26, s[16:19], s70 offen sc1
  v_mfma_f32_16x16x32_bf16 v[72:75], a[32:35], a[196:199], v[72:75]
  v_mfma_f32_16x16x32_bf16 v[72:75], a[12:15], a[192:195], v[72:75]
  v_mfma_f32_16x16x32_bf16 v[76:79], a[16:19], a[192:195], v[76:79]
  v_mfma_f32_16x16x32_bf16 v[76:79], a[36:39], a[196:199], v[76:79]
  v_mfma_f32_16x16x32_bf16 v[76:79], a[56:59], a[200:203], v[76:79]
  v_mfma_f32_16x16x32_bf16 v[76:79], a[76:79], a[204:207], v[76:79]
  s_waitcnt vmcnt(13)
  v_mfma_f32_16x16x32_bf16 v[60:63], a[80:83], a[208:211], v[60:63]
  s_add_u32 s70, s70, 16384
  v_mfma_f32_16x16x32_bf16 v[60:63], a[100:103], a[212:215], v[60:63]
  buffer_load_dwordx4 a[192:195], v26, s[16:19], s70 offen sc1
  v_mfma_f32_16x16x32_bf16 v[60:63], a[120:123], a[216:219], v[60:63]
  v_mfma_f32_16x16x32_bf16 v[60:63], a[140:143], a[220:223], v[60:63]
  v_mfma_f32_16x16x32_bf16 v[64:67], a[144:147], a[220:223], v[64:67]
  s_add_u32 s70, s70, 16384
  v_mfma_f32_16x16x32_bf16 v[64:67], a[124:127], a[216:219], v[64:67]
  buffer_load_dwordx4 a[196:199], v26, s[16:19], s70 offen sc1
  v_mfma_f32_16x16x32_bf16 v[64:67], a[104:107], a[212:215], v[64:67]
  v_mfma_f32_16x16x32_bf16 v[64:67], a[84:87], a[208:211], v[64:67]
  v_mfma_f32_16x16x32_bf16 v[68:71], a[88:91], a[208:211], v[68:71]
  s_add_u32 s70, s70, 16384
  v_mfma_f32_16x16x32_bf16 v[68:71], a[108:111], a[212:215], v[68:71]
  buffer_load_dwordx4 a[200:203], v26, s[16:19], s70 offen sc1
  v_mfma_f32_16x16x32_bf16 v[68:71], a[128:131], a[216:219], v[68:71]
  v_mfma_f32_16x16x32_bf16 v[68:71], a[148:151], a[220:223], v[68:71]
  v_mfma_f32_16x16x32_bf16 v[72:75], a[152:155], a[220:223], v[72:75]
  s_add_u32 s70, s70, 16384
  v_mfma_f32_16x16x32_bf16 v[72:75], a[132:135], a[216:219], v[72:75]
  buffer_load_dwordx4 a[204:207], v26, s[16:19], s70 offen sc1
  v_mfma_f32_16x16x32_bf16 v[72:75], a[112:115], a[212:215], v[72:75]
  v_mfma_f32_16x16x32_bf16 v[72:75], a[92:95], a[208:211], v[72:75]
  buffer_store_dwordx4 v[124:127], v26, s[20:23], s68 offen offset:1024 sc1
  v_mfma_f32_16x16x32_bf16 v[76:79], a[96:99], a[208:211], v[76:79]
  v_mfma_f32_16x16x32_bf16 v[76:79], a[116:119], a[212:215], v[76:79]
  v_mfma_f32_16x16x32_bf16 v[76:79], a[136:139], a[216:219], v[76:79]
  v_mfma_f32_16x16x32_bf16 v[76:79], a[156:159], a[220:223], v[76:79]
  s_waitcnt vmcnt(14)
  v_mfma_f32_16x16x32_bf16 v[60:63], v[160:163], a[224:227], v[60:63]
  s_add_u32 s70, s70, 16384
  v_mfma_f32_16x16x32_bf16 v[60:63], v[180:183], a[228:231], v[60:63]
  buffer_load_dwordx4 a[208:211], v26, s[16:19], s70 offen sc1
  v_mfma_f32_16x16x32_bf16 v[60:63], a[248:251], a[232:235], v[60:63]
  v_mfma_f32_16x16x32_bf16 v[60:63], v[140:143], a[236:239], v[60:63]
  v_mfma_f32_16x16x32_bf16 v[64:67], v[144:147], a[236:239], v[64:67]
  s_add_u32 s70, s70, 16384
  v_mfma_f32_16x16x32_bf16 v[64:67], a[252:255], a[232:235], v[64:67]
  buffer_load_dwordx4 a[212:215], v26, s[16:19], s70 offen sc1
  v_mfma_f32_16x16x32_bf16 v[64:67], v[184:187], a[228:231], v[64:67]
  v_mfma_f32_16x16x32_bf16 v[64:67], v[164:167], a[224:227], v[64:67]
  v_mfma_f32_16x16x32_bf16 v[68:71], v[168:171], a[224:227], v[68:71]
  s_add_u32 s70, s70, 16384
  v_mfma_f32_16x16x32_bf16 v[68:71], v[188:191], a[228:231], v[68:71]
  buffer_load_dwordx4 a[216:219], v26, s[16:19], s70 offen sc1
  v_mfma_f32_16x16x32_bf16 v[68:71], v[22:25], a[232:235], v[68:71]
  v_mfma_f32_16x16x32_bf16 v[68:71], v[148:151], a[236:239], v[68:71]
  v_mfma_f32_16x16x32_bf16 v[72:75], v[152:155], a[236:239], v[72:75]
  s_add_u32 s70, s70, 16384
  v_mfma_f32_16x16x32_bf16 v[72:75], v[28:31], a[232:235], v[72:75]
  buffer_load_dwordx4 a[220:223], v26, s[16:19], s70 offen sc1
  v_mfma_f32_16x16x32_bf16 v[72:75], a[240:243], a[228:231], v[72:75]
  v_mfma_f32_16x16x32_bf16 v[72:75], v[172:175], a[224:227], v[72:75]
  v_mfma_f32_16x16x32_bf16 v[76:79], v[176:179], a[224:227], v[76:79]
  v_mfma_f32_16x16x32_bf16 v[76:79], a[244:247], a[228:231], v[76:79]
  buffer_store_dwordx2 v[128:129], v6, s[20:23], s68 offen offset:2048 sc1
  v_mfma_f32_16x16x32_bf16 v[76:79], v[32:35], a[232:235], v[76:79]
  v_mfma_f32_16x16x32_bf16 v[76:79], v[156:159], a[236:239], v[76:79]
  s_waitcnt vmcnt(15)
  v_mfma_f32_16x16x32_bf16 v[80:83], v[192:195], a[160:163], 0
  s_add_u32 s70, s28, 3
  s_and_b32 s70, s70, 3
  s_lshl_b32 s70, s70, 10
  s_add_u32 s70, s70, s66
  v_mfma_f32_16x16x32_bf16 v[80:83], v[212:215], a[164:167], v[80:83]
  buffer_load_dwordx4 a[224:227], v26, s[16:19], s70 offen sc1
  v_mfma_f32_16x16x32_bf16 v[80:83], v[232:235], a[168:171], v[80:83]
  v_mfma_f32_16x16x32_bf16 v[80:83], v[252:255], a[172:175], v[80:83]
  v_mfma_f32_16x16x32_bf16 v[84:87], v[40:43], a[172:175], 0
  s_add_u32 s70, s70, 16384
  v_mfma_f32_16x16x32_bf16 v[84:87], v[236:239], a[168:171], v[84:87]
  buffer_load_dwordx4 a[228:231], v26, s[16:19], s70 offen sc1
  v_mfma_f32_16x16x32_bf16 v[84:87], v[216:219], a[164:167], v[84:87]
  ds_write_b128 v7, v[60:63] offset:20480
  v_mfma_f32_16x16x32_bf16 v[84:87], v[196:199], a[160:163], v[84:87]
  v_mfma_f32_16x16x32_bf16 v[88:91], v[200:203], a[160:163], 0
  s_add_u32 s70, s70, 16384
  ds_write_b128 v7, v[64:67] offset:21504
  v_mfma_f32_16x16x32_bf16 v[88:91], v[220:223], a[164:167], v[88:91]
  buffer_load_dwordx4 a[232:235], v26, s[16:19], s70 offen sc1
  v_mfma_f32_16x16x32_bf16 v[88:91], v[240:243], a[168:171], v[88:91]
  ds_write_b128 v7, v[68:71] offset:22528
  v_mfma_f32_16x16x32_bf16 v[88:91], v[44:47], a[172:175], v[88:91]
  v_mfma_f32_16x16x32_bf16 v[92:95], v[48:51], a[172:175], 0
  s_add_u32 s70, s70, 16384
  ds_write_b128 v7, v[72:75] offset:23552
  v_mfma_f32_16x16x32_bf16 v[92:95], v[244:247], a[168:171], v[92:95]
  buffer_load_dwordx4 a[236:239], v26, s[16:19], s70 offen sc1
  v_mfma_f32_16x16x32_bf16 v[92:95], v[224:227], a[164:167], v[92:95]
  ds_write_b128 v7, v[76:79] offset:24576
  v_mfma_f32_16x16x32_bf16 v[92:95], v[204:207], a[160:163], v[92:95]
  v_mfma_f32_16x16x32_bf16 v[96:99], v[208:211], a[160:163], 0
  v_mfma_f32_16x16x32_bf16 v[96:99], v[228:231], a[164:167], v[96:99]
  v_mfma_f32_16x16x32_bf16 v[96:99], v[248:251], a[168:171], v[96:99]
  v_mfma_f32_16x16x32_bf16 v[96:99], v[52:55], a[172:175], v[96:99]
  s_waitcnt vmcnt(14)
  v_mfma_f32_16x16x32_bf16 v[80:83], a[0:3], a[176:179], v[80:83]
  s_add_u32 s70, s70, 16384
  v_mfma_f32_16x16x32_bf16 v[80:83], a[20:23], a[180:183], v[80:83]
  buffer_load_dwordx4 a[160:163], v26, s[16:19], s70 offen sc1
  v_mfma_f32_16x16x32_bf16 v[80:83], a[40:43], a[184:187], v[80:83]
  v_mfma_f32_16x16x32_bf16 v[80:83], a[60:63], a[188:191], v[80:83]
  v_mfma_f32_16x16x32_bf16 v[84:87], a[64:67], a[188:191], v[84:87]
  s_add_u32 s70, s70, 16384
  v_mfma_f32_16x16x32_bf16 v[84:87], a[44:47], a[184:187], v[84:87]
  s_waitcnt lgkmcnt(0)
  buffer_load_dwordx4 a[164:167], v26, s[16:19], s70 offen sc1
  v_mfma_f32_16x16x32_bf16 v[84:87], a[24:27], a[180:183], v[84:87]
  s_barrier
  v_mfma_f32_16x16x32_bf16 v[84:87], a[4:7], a[176:179], v[84:87]
  ds_read_b128 v[100:103], v5 offset:20480
  v_mfma_f32_16x16x32_bf16 v[88:91], a[8:11], a[176:179], v[88:91]
  s_add_u32 s70, s70, 16384
  ds_read_b128 v[104:107], v5 offset:21504
  v_mfma_f32_16x16x32_bf16 v[88:91], a[28:31], a[180:183], v[88:91]
  buffer_load_dwordx4 a[168:171], v26, s[16:19], s70 offen sc1
  v_mfma_f32_16x16x32_bf16 v[88:91], a[48:51], a[184:187], v[88:91]
  ds_read_b128 v[108:111], v5 offset:22528
  v_mfma_f32_16x16x32_bf16 v[88:91], a[68:71], a[188:191], v[88:91]
  ds_read_b128 v[112:115], v5 offset:23552
  v_mfma_f32_16x16x32_bf16 v[92:95], a[72:75], a[188:191], v[92:95]
  s_add_u32 s70, s70, 16384
  ds_read_b128 v[116:119], v5 offset:24576
  v_mfma_f32_16x16x32_bf16 v[92:95], a[52:55], a[184:187], v[92:95]
  buffer_load_dwordx4 a[172:175], v26, s[16:19], s70 offen sc1
  v_mfma_f32_16x16x32_bf16 v[92:95], a[32:35], a[180:183], v[92:95]
  v_mfma_f32_16x16x32_bf16 v[92:95], a[12:15], a[176:179], v[92:95]
  v_mfma_f32_16x16x32_bf16 v[96:99], a[16:19], a[176:179], v[96:99]
  v_mfma_f32_16x16x32_bf16 v[96:99], a[36:39], a[180:183], v[96:99]
  v_mfma_f32_16x16x32_bf16 v[96:99], a[56:59], a[184:187], v[96:99]
  v_mfma_f32_16x16x32_bf16 v[96:99], a[76:79], a[188:191], v[96:99]
  s_waitcnt vmcnt(14)
  v_mfma_f32_16x16x32_bf16 v[80:83], a[80:83], a[192:195], v[80:83]
  s_add_u32 s70, s70, 16384
  v_mfma_f32_16x16x32_bf16 v[80:83], a[100:103], a[196:199], v[80:83]
  buffer_load_dwordx4 a[176:179], v26, s[16:19], s70 offen sc1
  v_mfma_f32_16x16x32_bf16 v[80:83], a[120:123], a[200:203], v[80:83]
  v_mfma_f32_16x16x32_bf16 v[80:83], a[140:143], a[204:207], v[80:83]
  v_mfma_f32_16x16x32_bf16 v[84:87], a[144:147], a[204:207], v[84:87]
  s_add_u32 s70, s70, 16384
  v_mfma_f32_16x16x32_bf16 v[84:87], a[124:127], a[200:203], v[84:87]
  buffer_load_dwordx4 a[180:183], v26, s[16:19], s70 offen sc1
  v_mfma_f32_16x16x32_bf16 v[84:87], a[104:107], a[196:199], v[84:87]
  v_mfma_f32_16x16x32_bf16 v[84:87], a[84:87], a[192:195], v[84:87]
  v_mfma_f32_16x16x32_bf16 v[88:91], a[88:91], a[192:195], v[88:91]
  s_add_u32 s70, s70, 16384
  v_mfma_f32_16x16x32_bf16 v[88:91], a[108:111], a[196:199], v[88:91]
  buffer_load_dwordx4 a[184:187], v26, s[16:19], s70 offen sc1
  v_mfma_f32_16x16x32_bf16 v[88:91], a[128:131], a[200:203], v[88:91]
  v_mfma_f32_16x16x32_bf16 v[88:91], a[148:151], a[204:207], v[88:91]
  s_waitcnt vmcnt(11)
  v_mov_b32 v8, s31
  v_mov_b32 v9, 0
  s_mov_b64 exec, 1
  buffer_store_dword v8, v9, s[20:23], s36 offen sc1
  s_mov_b64 exec, -1
  v_mfma_f32_16x16x32_bf16 v[92:95], a[152:155], a[204:207], v[92:95]
  s_add_u32 s70, s70, 16384
  v_mfma_f32_16x16x32_bf16 v[92:95], a[132:135], a[200:203], v[92:95]
  buffer_load_dwordx4 a[188:191], v26, s[16:19], s70 offen sc1
  v_mfma_f32_16x16x32_bf16 v[92:95], a[112:115], a[196:199], v[92:95]
  v_mfma_f32_16x16x32_bf16 v[92:95], a[92:95], a[192:195], v[92:95]
  v_mfma_f32_16x16x32_bf16 v[96:99], a[96:99], a[192:195], v[96:99]
  v_mfma_f32_16x16x32_bf16 v[96:99], a[116:119], a[196:199], v[96:99]
  v_mfma_f32_16x16x32_bf16 v[96:99], a[136:139], a[200:203], v[96:99]
  v_mfma_f32_16x16x32_bf16 v[96:99], a[156:159], a[204:207], v[96:99]
  s_waitcnt vmcnt(14)
  v_mfma_f32_16x16x32_bf16 v[80:83], v[160:163], a[208:211], v[80:83]
  s_add_u32 s70, s70, 16384
  v_mfma_f32_16x16x32_bf16 v[80:83], v[180:183], a[212:215], v[80:83]
  buffer_load_dwordx4 a[192:195], v26, s[16:19], s70 offen sc1
  v_mfma_f32_16x16x32_bf16 v[80:83], a[248:251], a[216:219], v[80:83]
  v_mfma_f32_16x16x32_bf16 v[80:83], v[140:143], a[220:223], v[80:83]
  v_mfma_f32_16x16x32_bf16 v[84:87], v[144:147], a[220:223], v[84:87]
  s_add_u32 s70, s70, 16384
  v_mfma_f32_16x16x32_bf16 v[84:87], a[252:255], a[216:219], v[84:87]
  buffer_load_dwordx4 a[196:199], v26, s[16:19], s70 offen sc1
  v_mfma_f32_16x16x32_bf16 v[84:87], v[184:187], a[212:215], v[84:87]
  v_mfma_f32_16x16x32_bf16 v[84:87], v[164:167], a[208:211], v[84:87]
  v_mfma_f32_16x16x32_bf16 v[88:91], v[168:171], a[208:211], v[88:91]
  s_add_u32 s70, s70, 16384
  v_mfma_f32_16x16x32_bf16 v[88:91], v[188:191], a[212:215], v[88:91]
  buffer_load_dwordx4 a[200:203], v26, s[16:19], s70 offen sc1
  v_mfma_f32_16x16x32_bf16 v[88:91], v[22:25], a[216:219], v[88:91]
  v_mfma_f32_16x16x32_bf16 v[88:91], v[148:151], a[220:223], v[88:91]
  v_mfma_f32_16x16x32_bf16 v[92:95], v[152:155], a[220:223], v[92:95]
  s_add_u32 s70, s70, 16384
  v_mfma_f32_16x16x32_bf16 v[92:95], v[28:31], a[216:219], v[92:95]
  buffer_load_dwordx4 a[204:207], v26, s[16:19], s70 offen sc1
  v_mfma_f32_16x16x32_bf16 v[92:95], a[240:243], a[212:215], v[92:95]
  v_mfma_f32_16x16x32_bf16 v[92:95], v[172:175], a[208:211], v[92:95]
  v_mfma_f32_16x16x32_bf16 v[96:99], v[176:179], a[208:211], v[96:99]
  v_mfma_f32_16x16x32_bf16 v[96:99], a[244:247], a[212:215], v[96:99]
  v_mfma_f32_16x16x32_bf16 v[96:99], v[32:35], a[216:219], v[96:99]
  s_waitcnt lgkmcnt(0)
  v_mfma_f32_16x16x32_bf16 v[96:99], v[156:159], a[220:223], v[96:99]
  s_waitcnt vmcnt(13)
  v_mfma_f32_16x16x32_bf16 v[60:63], v[192:195], a[224:227], 0
  s_add_u32 s70, s28, 4
  s_and_b32 s70, s70, 3
  s_lshl_b32 s70, s70, 10
  s_add_u32 s70, s70, s66
  v_mfma_f32_16x16x32_bf16 v[60:63], v[212:215], a[228:231], v[60:63]
  buffer_load_dwordx4 a[208:211], v26, s[16:19], s70 offen sc1
  v_mfma_f32_16x16x32_bf16 v[60:63], v[232:235], a[232:235], v[60:63]
  v_mfma_f32_16x16x32_bf16 v[60:63], v[252:255], a[236:239], v[60:63]
  v_mfma_f32_16x16x32_bf16 v[64:67], v[40:43], a[236:239], 0
  s_add_u32 s70, s70, 16384
  v_add_f32 v80, v80, v100
  v_add_f32 v81, v81, v101
  v_mfma_f32_16x16x32_bf16 v[64:67], v[236:239], a[232:235], v[64:67]
  buffer_load_dwordx4 a[212:215], v26, s[16:19], s70 offen sc1
  v_mfma_f32_16x16x32_bf16 v[64:67], v[216:219], a[228:231], v[64:67]
  v_add_f32 v82, v82, v102
  v_add_f32 v83, v83, v103
  v_mfma_f32_16x16x32_bf16 v[64:67], v[196:199], a[224:227], v[64:67]
  v_add_f32 v84, v84, v104
  v_add_f32 v85, v85, v105
  v_mfma_f32_16x16x32_bf16 v[68:71], v[200:203], a[224:227], 0
  s_add_u32 s70, s70, 16384
  v_add_f32 v86, v86, v106
  v_add_f32 v87, v87, v107
  v_mfma_f32_16x16x32_bf16 v[68:71], v[220:223], a[228:231], v[68:71]
  buffer_load_dwordx4 a[216:219], v26, s[16:19], s70 offen sc1
  v_mfma_f32_16x16x32_bf16 v[68:71], v[240:243], a[232:235], v[68:71]
  v_add_f32 v88, v88, v108
  v_add_f32 v89, v89, v109
  v_mfma_f32_16x16x32_bf16 v[68:71], v[44:47], a[236:239], v[68:71]
  v_add_f32 v90, v90, v110
  v_add_f32 v91, v91, v111
  v_mfma_f32_16x16x32_bf16 v[72:75], v[48:51], a[236:239], 0
  s_add_u32 s70, s70, 16384
  v_add_f32 v92, v92, v112
  v_add_f32 v93, v93, v113
  v_mfma_f32_16x16x32_bf16 v[72:75], v[244:247], a[232:235], v[72:75]
  buffer_load_dwordx4 a[220:223], v26, s[16:19], s70 offen sc1
  v_mfma_f32_16x16x32_bf16 v[72:75], v[224:227], a[228:231], v[72:75]
  v_add_f32 v94, v94, v114
  v_add_f32 v95, v95, v115
  v_mfma_f32_16x16x32_bf16 v[72:75], v[204:207], a[224:227], v[72:75]
  v_add_f32 v96, v96, v116
  v_add_f32 v97, v97, v117
  v_mfma_f32_16x16x32_bf16 v[76:79], v[208:211], a[224:227], 0
  v_add_f32 v98, v98, v118
  v_add_f32 v99, v99, v119
  v_mfma_f32_16x16x32_bf16 v[76:79], v[228:231], a[228:231], v[76:79]
  ds_write_b128 v7, v[80:83] offset:0
  v_mfma_f32_16x16x32_bf16 v[76:79], v[248:251], a[232:235], v[76:79]
  v_mfma_f32_16x16x32_bf16 v[76:79], v[52:55], a[236:239], v[76:79]
  s_waitcnt vmcnt(13)
  ds_write_b128 v7, v[84:87] offset:1024
  v_mfma_f32_16x16x32_bf16 v[60:63], a[0:3], a[160:163], v[60:63]
  s_add_u32 s70, s70, 16384
  v_mfma_f32_16x16x32_bf16 v[60:63], a[20:23], a[164:167], v[60:63]
  buffer_load_dwordx4 a[224:227], v26, s[16:19], s70 offen sc1
  v_mfma_f32_16x16x32_bf16 v[60:63], a[40:43], a[168:171], v[60:63]
  ds_write_b128 v7, v[88:91] offset:2048
  v_mfma_f32_16x16x32_bf16 v[60:63], a[60:63], a[172:175], v[60:63]
  v_mfma_f32_16x16x32_bf16 v[64:67], a[64:67], a[172:175], v[64:67]
  s_add_u32 s70, s70, 16384
  ds_write_b128 v7, v[92:95] offset:3072
  v_mfma_f32_16x16x32_bf16 v[64:67], a[44:47], a[168:171], v[64:67]
  buffer_load_dwordx4 a[228:231], v26, s[16:19], s70 offen sc1
  v_mfma_f32_16x16x32_bf16 v[64:67], a[24:27], a[164:167], v[64:67]
  ds_write_b128 v7, v[96:99] offset:4096
  v_mfma_f32_16x16x32_bf16 v[64:67], a[4:7], a[160:163], v[64:67]
  v_mfma_f32_16x16x32_bf16 v[68:71], a[8:11], a[160:163], v[68:71]
  s_add_u32 s70, s70, 16384
  v_mfma_f32_16x16x32_bf16 v[68:71], a[28:31], a[164:167], v[68:71]
  buffer_load_dwordx4 a[232:235], v26, s[16:19], s70 offen sc1
  v_mfma_f32_16x16x32_bf16 v[68:71], a[48:51], a[168:171], v[68:71]
  v_mfma_f32_16x16x32_bf16 v[68:71], a[68:71], a[172:175], v[68:71]
  v_mfma_f32_16x16x32_bf16 v[72:75], a[72:75], a[172:175], v[72:75]
  s_add_u32 s70, s70, 16384
  v_mfma_f32_16x16x32_bf16 v[72:75], a[52:55], a[168:171], v[72:75]
  buffer_load_dwordx4 a[236:239], v26, s[16:19], s70 offen sc1
  v_mfma_f32_16x16x32_bf16 v[72:75], a[32:35], a[164:167], v[72:75]
  v_mfma_f32_16x16x32_bf16 v[72:75], a[12:15], a[160:163], v[72:75]
  s_waitcnt lgkmcnt(0)
  v_mfma_f32_16x16x32_bf16 v[76:79], a[16:19], a[160:163], v[76:79]
  s_barrier
  v_mfma_f32_16x16x32_bf16 v[76:79], a[36:39], a[164:167], v[76:79]
  ds_read_b128 v[100:103], v5 offset:0
  v_mfma_f32_16x16x32_bf16 v[76:79], a[56:59], a[168:171], v[76:79]
  ds_read_b128 v[104:107], v5 offset:1024
  v_mfma_f32_16x16x32_bf16 v[76:79], a[76:79], a[172:175], v[76:79]
  s_waitcnt vmcnt(12)
  ds_read_b128 v[108:111], v5 offset:2048
  v_mfma_f32_16x16x32_bf16 v[60:63], a[80:83], a[176:179], v[60:63]
  s_add_u32 s70, s70, 16384
  ds_read_b128 v[112:115], v5 offset:3072
  v_mfma_f32_16x16x32_bf16 v[60:63], a[100:103], a[180:183], v[60:63]
  buffer_load_dwordx4 a[160:163], v26, s[16:19], s70 offen sc1
  v_mfma_f32_16x16x32_bf16 v[60:63], a[120:123], a[184:187], v[60:63]
  ds_read_b128 v[116:119], v5 offset:4096
  v_mfma_f32_16x16x32_bf16 v[60:63], a[140:143], a[188:191], v[60:63]
  v_mfma_f32_16x16x32_bf16 v[64:67], a[144:147], a[188:191], v[64:67]
  s_add_u32 s70, s70, 16384
  v_mfma_f32_16x16x32_bf16 v[64:67], a[124:127], a[184:187], v[64:67]
  buffer_load_dwordx4 a[164:167], v26, s[16:19], s70 offen sc1
  v_mfma_f32_16x16x32_bf16 v[64:67], a[104:107], a[180:183], v[64:67]
  v_mfma_f32_16x16x32_bf16 v[64:67], a[84:87], a[176:179], v[64:67]
  v_mfma_f32_16x16x32_bf16 v[68:71], a[88:91], a[176:179], v[68:71]
  s_add_u32 s70, s70, 16384
  v_mfma_f32_16x16x32_bf16 v[68:71], a[108:111], a[180:183], v[68:71]
  buffer_load_dwordx4 a[168:171], v26, s[16:19], s70 offen sc1
  v_mfma_f32_16x16x32_bf16 v[68:71], a[128:131], a[184:187], v[68:71]
  v_mfma_f32_16x16x32_bf16 v[68:71], a[148:151], a[188:191], v[68:71]
  v_mfma_f32_16x16x32_bf16 v[72:75], a[152:155], a[188:191], v[72:75]
  s_add_u32 s70, s70, 16384
  v_mfma_f32_16x16x32_bf16 v[72:75], a[132:135], a[184:187], v[72:75]
  buffer_load_dwordx4 a[172:175], v26, s[16:19], s70 offen sc1
  v_mfma_f32_16x16x32_bf16 v[72:75], a[112:115], a[180:183], v[72:75]
  v_mfma_f32_16x16x32_bf16 v[72:75], a[92:95], a[176:179], v[72:75]
  v_mfma_f32_16x16x32_bf16 v[76:79], a[96:99], a[176:179], v[76:79]
  v_mfma_f32_16x16x32_bf16 v[76:79], a[116:119], a[180:183], v[76:79]
  v_mfma_f32_16x16x32_bf16 v[76:79], a[136:139], a[184:187], v[76:79]
  v_mfma_f32_16x16x32_bf16 v[76:79], a[156:159], a[188:191], v[76:79]
  s_waitcnt vmcnt(12)
  v_mfma_f32_16x16x32_bf16 v[60:63], v[160:163], a[192:195], v[60:63]
  s_add_u32 s70, s70, 16384
  v_mfma_f32_16x16x32_bf16 v[60:63], v[180:183], a[196:199], v[60:63]
  buffer_load_dwordx4 a[176:179], v26, s[16:19], s70 offen sc1
  v_mfma_f32_16x16x32_bf16 v[60:63], a[248:251], a[200:203], v[60:63]
  s_mov_b32 s71, 14680064
  v_mfma_f32_16x16x32_bf16 v[60:63], v[140:143], a[204:207], v[60:63]
  buffer_load_dword v39, v38, s[20:23], s71 offen sc1
  v_mfma_f32_16x16x32_bf16 v[64:67], v[144:147], a[204:207], v[64:67]
  s_add_u32 s70, s70, 16384
  v_mfma_f32_16x16x32_bf16 v[64:67], a[252:255], a[200:203], v[64:67]
  buffer_load_dwordx4 a[180:183], v26, s[16:19], s70 offen sc1
  v_mfma_f32_16x16x32_bf16 v[64:67], v[184:187], a[196:199], v[64:67]
  v_mfma_f32_16x16x32_bf16 v[64:67], v[164:167], a[192:195], v[64:67]
  v_mfma_f32_16x16x32_bf16 v[68:71], v[168:171], a[192:195], v[68:71]
  s_add_u32 s70, s70, 16384
  v_mfma_f32_16x16x32_bf16 v[68:71], v[188:191], a[196:199], v[68:71]
  buffer_load_dwordx4 a[184:187], v26, s[16:19], s70 offen sc1
  v_mfma_f32_16x16x32_bf16 v[68:71], v[22:25], a[200:203], v[68:71]
  v_mfma_f32_16x16x32_bf16 v[68:71], v[148:151], a[204:207], v[68:71]
  v_mfma_f32_16x16x32_bf16 v[72:75], v[152:155], a[204:207], v[72:75]
  s_add_u32 s70, s70, 16384
  v_mfma_f32_16x16x32_bf16 v[72:75], v[28:31], a[200:203], v[72:75]
  buffer_load_dwordx4 a[188:191], v26, s[16:19], s70 offen sc1
  v_mfma_f32_16x16x32_bf16 v[72:75], a[240:243], a[196:199], v[72:75]
  v_mfma_f32_16x16x32_bf16 v[72:75], v[172:175], a[192:195], v[72:75]
  v_mfma_f32_16x16x32_bf16 v[76:79], v[176:179], a[192:195], v[76:79]
  v_mfma_f32_16x16x32_bf16 v[76:79], a[244:247], a[196:199], v[76:79]
  v_mfma_f32_16x16x32_bf16 v[76:79], v[32:35], a[200:203], v[76:79]
  s_waitcnt lgkmcnt(0)
  v_mfma_f32_16x16x32_bf16 v[76:79], v[156:159], a[204:207], v[76:79]
  s_waitcnt vmcnt(13)
  v_mfma_f32_16x16x32_bf16 v[80:83], v[192:195], a[208:211], 0
  v_mfma_f32_16x16x32_bf16 v[80:83], v[212:215], a[212:215], v[80:83]
  v_mfma_f32_16x16x32_bf16 v[80:83], v[232:235], a[216:219], v[80:83]
  v_mfma_f32_16x16x32_bf16 v[80:83], v[252:255], a[220:223], v[80:83]
  v_mfma_f32_16x16x32_bf16 v[84:87], v[40:43], a[220:223], 0
  v_add_f32 v60, v60, v100
  v_add_f32 v61, v61, v101
  v_mfma_f32_16x16x32_bf16 v[84:87], v[236:239], a[216:219], v[84:87]
  v_add_f32 v62, v62, v102
  v_add_f32 v63, v63, v103
  v_mfma_f32_16x16x32_bf16 v[84:87], v[216:219], a[212:215], v[84:87]
  v_add_f32 v64, v64, v104
  v_add_f32 v65, v65, v105
  v_mfma_f32_16x16x32_bf16 v[84:87], v[196:199], a[208:211], v[84:87]
  v_add_f32 v66, v66, v106
  v_add_f32 v67, v67, v107
  v_mfma_f32_16x16x32_bf16 v[88:91], v[200:203], a[208:211], 0
  v_add_f32 v68, v68, v108
  v_add_f32 v69, v69, v109
  v_mfma_f32_16x16x32_bf16 v[88:91], v[220:223], a[212:215], v[88:91]
  v_add_f32 v70, v70, v110
  v_add_f32 v71, v71, v111
  v_mfma_f32_16x16x32_bf16 v[88:91], v[240:243], a[216:219], v[88:91]
  v_add_f32 v72, v72, v112
  v_add_f32 v73, v73, v113
  v_mfma_f32_16x16x32_bf16 v[88:91], v[44:47], a[220:223], v[88:91]
  v_add_f32 v74, v74, v114
  v_add_f32 v75, v75, v115
  v_mfma_f32_16x16x32_bf16 v[92:95], v[48:51], a[220:223], 0
  v_add_f32 v76, v76, v116
  v_add_f32 v77, v77, v117
  v_mfma_f32_16x16x32_bf16 v[92:95], v[244:247], a[216:219], v[92:95]
  v_add_f32 v78, v78, v118
  v_add_f32 v79, v79, v119
  v_mfma_f32_16x16x32_bf16 v[92:95], v[224:227], a[212:215], v[92:95]
  ds_write_b128 v7, v[60:63] offset:20480
  v_mfma_f32_16x16x32_bf16 v[92:95], v[204:207], a[208:211], v[92:95]
  v_mfma_f32_16x16x32_bf16 v[96:99], v[208:211], a[208:211], 0
  ds_write_b128 v7, v[64:67] offset:21504
  v_mfma_f32_16x16x32_bf16 v[96:99], v[228:231], a[212:215], v[96:99]
  v_mfma_f32_16x16x32_bf16 v[96:99], v[248:251], a[216:219], v[96:99]
  ds_write_b128 v7, v[68:71] offset:22528
  v_mfma_f32_16x16x32_bf16 v[96:99], v[52:55], a[220:223], v[96:99]
  s_waitcnt vmcnt(9)
  v_mfma_f32_16x16x32_bf16 v[80:83], a[0:3], a[224:227], v[80:83]
  ds_write_b128 v7, v[72:75] offset:23552
  v_mfma_f32_16x16x32_bf16 v[80:83], a[20:23], a[228:231], v[80:83]
  v_mfma_f32_16x16x32_bf16 v[80:83], a[40:43], a[232:235], v[80:83]
  s_waitcnt vmcnt(3)
  v_cmp_ne_u32 vcc, s31, v39
  s_cbranch_vccz POLL_P_OK
  s_mov_b32 s71, 14680064
  s_mov_b32 s79, 0
POLL_P:
  buffer_load_dword v39, v38, s[20:23], s71 offen sc1
  s_add_u32 s79, s79, 1
  s_waitcnt vmcnt(0)
  v_cmp_ne_u32 vcc, s31, v39
  s_cmp_gt_u32 s79, 1048576
  s_cbranch_scc1 POLL_P_X
  s_cbranch_vccnz POLL_P
POLL_P_X:
POLL_P_OK:
  ds_write_b128 v7, v[76:79] offset:24576
  v_mfma_f32_16x16x32_bf16 v[80:83], a[60:63], a[236:239], v[80:83]
  buffer_load_dwordx4 v[120:123], v26, s[20:23], s35 offen offset:0 sc1
  v_mfma_f32_16x16x32_bf16 v[84:87], a[64:67], a[236:239], v[84:87]
  v_mfma_f32_16x16x32_bf16 v[84:87], a[44:47], a[232:235], v[84:87]
  buffer_load_dwordx4 v[124:127], v26, s[20:23], s35 offen offset:1024 sc1
  v_mfma_f32_16x16x32_bf16 v[84:87], a[24:27], a[228:231], v[84:87]
  v_mfma_f32_16x16x32_bf16 v[84:87], a[4:7], a[224:227], v[84:87]
  buffer_load_dwordx2 v[128:129], v6, s[20:23], s35 offen offset:2048 sc1
  v_mfma_f32_16x16x32_bf16 v[88:91], a[8:11], a[224:227], v[88:91]
  v_mfma_f32_16x16x32_bf16 v[88:91], a[28:31], a[228:231], v[88:91]
  v_mfma_f32_16x16x32_bf16 v[88:91], a[48:51], a[232:235], v[88:91]
  v_mfma_f32_16x16x32_bf16 v[88:91], a[68:71], a[236:239], v[88:91]
  s_waitcnt lgkmcnt(0)
  v_mfma_f32_16x16x32_bf16 v[92:95], a[72:75], a[236:239], v[92:95]
  s_barrier
  v_mfma_f32_16x16x32_bf16 v[92:95], a[52:55], a[232:235], v[92:95]
  ds_read_b128 v[100:103], v5 offset:20480
  v_mfma_f32_16x16x32_bf16 v[92:95], a[32:35], a[228:231], v[92:95]
  ds_read_b128 v[104:107], v5 offset:21504
  v_mfma_f32_16x16x32_bf16 v[92:95], a[12:15], a[224:227], v[92:95]
  ds_read_b128 v[108:111], v5 offset:22528
  v_mfma_f32_16x16x32_bf16 v[96:99], a[16:19], a[224:227], v[96:99]
  ds_read_b128 v[112:115], v5 offset:23552
  v_mfma_f32_16x16x32_bf16 v[96:99], a[36:39], a[228:231], v[96:99]
  ds_read_b128 v[116:119], v5 offset:24576
  v_mfma_f32_16x16x32_bf16 v[96:99], a[56:59], a[232:235], v[96:99]
  v_lshlrev_b32 v192, 16, v12
  v_and_b32 v193, 0xffff0000, v12
  v_mfma_f32_16x16x32_bf16 v[96:99], a[76:79], a[236:239], v[96:99]
  s_waitcnt vmcnt(8)
  v_lshlrev_b32 v194, 16, v13
  v_and_b32 v195, 0xffff0000, v13
  v_mfma_f32_16x16x32_bf16 v[80:83], a[80:83], a[160:163], v[80:83]
  v_lshlrev_b32 v196, 16, v14
  v_and_b32 v197, 0xffff0000, v14
  v_mfma_f32_16x16x32_bf16 v[80:83], a[100:103], a[164:167], v[80:83]
  v_lshlrev_b32 v198, 16, v15
  v_and_b32 v199, 0xffff0000, v15
  v_mfma_f32_16x16x32_bf16 v[80:83], a[120:123], a[168:171], v[80:83]
  v_lshlrev_b32 v200, 16, v16
  v_and_b32 v201, 0xffff0000, v16
  v_mfma_f32_16x16x32_bf16 v[80:83], a[140:143], a[172:175], v[80:83]
  v_lshlrev_b32 v202, 16, v17
  v_and_b32 v203, 0xffff0000, v17
  v_mfma_f32_16x16x32_bf16 v[84:87], a[144:147], a[172:175], v[84:87]
  v_lshlrev_b32 v204, 16, v18
  v_and_b32 v205, 0xffff0000, v18
  v_mfma_f32_16x16x32_bf16 v[84:87], a[124:127], a[168:171], v[84:87]
  v_lshlrev_b32 v206, 16, v19
  v_and_b32 v207, 0xffff0000, v19
  v_mfma_f32_16x16x32_bf16 v[84:87], a[104:107], a[164:167], v[84:87]
  v_lshlrev_b32 v208, 16, v20
  v_and_b32 v209, 0xffff0000, v20
  v_mfma_f32_16x16x32_bf16 v[84:87], a[84:87], a[160:163], v[84:87]
  v_lshlrev_b32 v210, 16, v21
  v_and_b32 v211, 0xffff0000, v21
  v_mfma_f32_16x16x32_bf16 v[88:91], a[88:91], a[160:163], v[88:91]
  v_lshlrev_b32 v232, 16, v0
  v_and_b32 v233, 0xffff0000, v0
  v_mfma_f32_16x16x32_bf16 v[88:91], a[108:111], a[164:167], v[88:91]
  v_lshlrev_b32 v234, 16, v1
  v_and_b32 v235, 0xffff0000, v1
  v_mfma_f32_16x16x32_bf16 v[88:91], a[128:131], a[168:171], v[88:91]
  v_lshlrev_b32 v236, 16, v2
  v_and_b32 v237, 0xffff0000, v2
  v_mfma_f32_16x16x32_bf16 v[88:91], a[148:151], a[172:175], v[88:91]
  v_lshlrev_b32 v238, 16, v3
  v_and_b32 v239, 0xffff0000, v3
  v_mfma_f32_16x16x32_bf16 v[92:95], a[152:155], a[172:175], v[92:95]
  v_lshlrev_b32 v240, 16, v36
  v_and_b32 v241, 0xffff0000, v36
  v_mfma_f32_16x16x32_bf16 v[92:95], a[132:135], a[168:171], v[92:95]
  v_lshlrev_b32 v242, 16, v37
  v_and_b32 v243, 0xffff0000, v37
  v_mfma_f32_16x16x32_bf16 v[92:95], a[112:115], a[164:167], v[92:95]
  v_lshlrev_b32 v244, 16, v56
  v_and_b32 v245, 0xffff0000, v56
  v_mfma_f32_16x16x32_bf16 v[92:95], a[92:95], a[160:163], v[92:95]
  v_lshlrev_b32 v246, 16, v57
  v_and_b32 v247, 0xffff0000, v57
  v_mfma_f32_16x16x32_bf16 v[96:99], a[96:99], a[160:163], v[96:99]
  v_lshlrev_b32 v248, 16, v58
  v_and_b32 v249, 0xffff0000, v58
  v_mfma_f32_16x16x32_bf16 v[96:99], a[116:119], a[164:167], v[96:99]
  v_lshlrev_b32 v250, 16, v59
  v_and_b32 v251, 0xffff0000, v59
  v_mfma_f32_16x16x32_bf16 v[96:99], a[136:139], a[168:171], v[96:99]
  v_mfma_f32_16x16x32_bf16 v[96:99], a[156:159], a[172:175], v[96:99]
  s_waitcnt vmcnt(3)
  v_mfma_f32_16x16x32_bf16 v[80:83], v[160:163], a[176:179], v[80:83]
  v_mfma_f32_16x16x32_bf16 v[80:83], v[180:183], a[180:183], v[80:83]
  v_mfma_f32_16x16x32_bf16 v[80:83], a[248:251], a[184:187], v[80:83]
  v_mfma_f32_16x16x32_bf16 v[80:83], v[140:143], a[188:191], v[80:83]
  v_mfma_f32_16x16x32_bf16 v[84:87], v[144:147], a[188:191], v[84:87]
  v_mfma_f32_16x16x32_bf16 v[84:87], a[252:255], a[184:187], v[84:87]
  v_mfma_f32_16x16x32_bf16 v[84:87], v[184:187], a[180:183], v[84:87]
  v_mfma_f32_16x16x32_bf16 v[84:87], v[164:167], a[176:179], v[84:87]
  v_mfma_f32_16x16x32_bf16 v[88:91], v[168:171], a[176:179], v[88:91]
  v_mfma_f32_16x16x32_bf16 v[88:91], v[188:191], a[180:183], v[88:91]
  v_mfma_f32_16x16x32_bf16 v[88:91], v[22:25], a[184:187], v[88:91]
  v_mfma_f32_16x16x32_bf16 v[88:91], v[148:151], a[188:191], v[88:91]
  v_mfma_f32_16x16x32_bf16 v[92:95], v[152:155], a[188:191], v[92:95]
  v_mfma_f32_16x16x32_bf16 v[92:95], v[28:31], a[184:187], v[92:95]
  v_mfma_f32_16x16x32_bf16 v[92:95], a[240:243], a[180:183], v[92:95]
  v_mfma_f32_16x16x32_bf16 v[92:95], v[172:175], a[176:179], v[92:95]
  v_mfma_f32_16x16x32_bf16 v[96:99], v[176:179], a[176:179], v[96:99]
  v_mfma_f32_16x16x32_bf16 v[96:99], a[244:247], a[180:183], v[96:99]
  v_mfma_f32_16x16x32_bf16 v[96:99], v[32:35], a[184:187], v[96:99]
  s_waitcnt lgkmcnt(0)
  v_mfma_f32_16x16x32_bf16 v[96:99], v[156:159], a[188:191], v[96:99]
  s_waitcnt vmcnt(0)
  v_lshlrev_b32 v212, 16, v120
  v_and_b32 v213, 0xffff0000, v120
  v_lshlrev_b32 v214, 16, v121
  v_and_b32 v215, 0xffff0000, v121
  v_lshlrev_b32 v216, 16, v122
  v_and_b32 v217, 0xffff0000, v122
  v_lshlrev_b32 v218, 16, v123
  v_and_b32 v219, 0xffff0000, v123
  v_lshlrev_b32 v220, 16, v124
  v_and_b32 v221, 0xffff0000, v124
  v_lshlrev_b32 v222, 16, v125
  v_and_b32 v223, 0xffff0000, v125
  v_lshlrev_b32 v224, 16, v126
  v_and_b32 v225, 0xffff0000, v126
  v_lshlrev_b32 v226, 16, v127
  v_and_b32 v227, 0xffff0000, v127
  v_lshlrev_b32 v228, 16, v128
  v_and_b32 v229, 0xffff0000, v128
  v_lshlrev_b32 v230, 16, v129
  v_and_b32 v231, 0xffff0000, v129
  v_pk_add_f32 v[100:101], v[100:101], v[212:213]
  v_pk_add_f32 v[102:103], v[102:103], v[214:215]
  v_pk_add_f32 v[104:105], v[104:105], v[216:217]
  v_pk_add_f32 v[106:107], v[106:107], v[218:219]
  v_pk_add_f32 v[108:109], v[108:109], v[220:221]
  v_pk_add_f32 v[110:111], v[110:111], v[222:223]
  v_pk_add_f32 v[112:113], v[112:113], v[224:225]
  v_pk_add_f32 v[114:115], v[114:115], v[226:227]
  v_pk_add_f32 v[116:117], v[116:117], v[228:229]
  v_pk_add_f32 v[118:119], v[118:119], v[230:231]
  v_pk_add_f32 v[80:81], v[80:81], v[100:101]
  v_pk_add_f32 v[82:83], v[82:83], v[102:103]
  v_cvt_pk_bf16_f32 v60, v80, v81
  v_cvt_pk_bf16_f32 v61, v82, v83
  v_lshlrev_b32 v80, 16, v60
  v_and_b32 v81, 0xffff0000, v60
  v_lshlrev_b32 v82, 16, v61
  v_and_b32 v83, 0xffff0000, v61
  v_pk_mul_f32 v[80:81], v[80:81], v[192:193]
  v_pk_mul_f32 v[82:83], v[82:83], v[194:195]
  v_cvt_pk_bf16_f32 v60, v80, v81
  v_cvt_pk_bf16_f32 v61, v82, v83
  v_lshlrev_b32 v80, 16, v60
  v_and_b32 v81, 0xffff0000, v60
  v_lshlrev_b32 v82, 16, v61
  v_and_b32 v83, 0xffff0000, v61
  v_pk_add_f32 v[80:81], v[80:81], v[232:233]
  v_pk_add_f32 v[82:83], v[82:83], v[234:235]
  v_cvt_pk_bf16_f32 v60, v80, v81
  v_cvt_pk_bf16_f32 v61, v82, v83
  buffer_store_dwordx2 v[60:61], v10, s[8:11], s34 offen offset:0
  v_pk_add_f32 v[84:85], v[84:85], v[104:105]
  v_pk_add_f32 v[86:87], v[86:87], v[106:107]
  v_cvt_pk_bf16_f32 v64, v84, v85
  v_cvt_pk_bf16_f32 v65, v86, v87
  v_lshlrev_b32 v84, 16, v64
  v_and_b32 v85, 0xffff0000, v64
  v_lshlrev_b32 v86, 16, v65
  v_and_b32 v87, 0xffff0000, v65
  v_pk_mul_f32 v[84:85], v[84:85], v[196:197]
  v_pk_mul_f32 v[86:87], v[86:87], v[198:199]
  v_cvt_pk_bf16_f32 v64, v84, v85
  v_cvt_pk_bf16_f32 v65, v86, v87
  v_lshlrev_b32 v84, 16, v64
  v_and_b32 v85, 0xffff0000, v64
  v_lshlrev_b32 v86, 16, v65
  v_and_b32 v87, 0xffff0000, v65
  v_pk_add_f32 v[84:85], v[84:85], v[236:237]
  v_pk_add_f32 v[86:87], v[86:87], v[238:239]
  v_cvt_pk_bf16_f32 v64, v84, v85
  v_cvt_pk_bf16_f32 v65, v86, v87
  buffer_store_dwordx2 v[64:65], v10, s[8:11], s34 offen offset:32
  v_pk_add_f32 v[88:89], v[88:89], v[108:109]
  v_pk_add_f32 v[90:91], v[90:91], v[110:111]
  v_cvt_pk_bf16_f32 v68, v88, v89
  v_cvt_pk_bf16_f32 v69, v90, v91
  v_lshlrev_b32 v88, 16, v68
  v_and_b32 v89, 0xffff0000, v68
  v_lshlrev_b32 v90, 16, v69
  v_and_b32 v91, 0xffff0000, v69
  v_pk_mul_f32 v[88:89], v[88:89], v[200:201]
  v_pk_mul_f32 v[90:91], v[90:91], v[202:203]
  v_cvt_pk_bf16_f32 v68, v88, v89
  v_cvt_pk_bf16_f32 v69, v90, v91
  v_lshlrev_b32 v88, 16, v68
  v_and_b32 v89, 0xffff0000, v68
  v_lshlrev_b32 v90, 16, v69
  v_and_b32 v91, 0xffff0000, v69
  v_pk_add_f32 v[88:89], v[88:89], v[240:241]
  v_pk_add_f32 v[90:91], v[90:91], v[242:243]
  v_cvt_pk_bf16_f32 v68, v88, v89
  v_cvt_pk_bf16_f32 v69, v90, v91
  buffer_store_dwordx2 v[68:69], v10, s[8:11], s34 offen offset:64
  v_pk_add_f32 v[92:93], v[92:93], v[112:113]
  v_pk_add_f32 v[94:95], v[94:95], v[114:115]
  v_cvt_pk_bf16_f32 v72, v92, v93
  v_cvt_pk_bf16_f32 v73, v94, v95
  v_lshlrev_b32 v92, 16, v72
  v_and_b32 v93, 0xffff0000, v72
  v_lshlrev_b32 v94, 16, v73
  v_and_b32 v95, 0xffff0000, v73
  v_pk_mul_f32 v[92:93], v[92:93], v[204:205]
  v_pk_mul_f32 v[94:95], v[94:95], v[206:207]
  v_cvt_pk_bf16_f32 v72, v92, v93
  v_cvt_pk_bf16_f32 v73, v94, v95
  v_lshlrev_b32 v92, 16, v72
  v_and_b32 v93, 0xffff0000, v72
  v_lshlrev_b32 v94, 16, v73
  v_and_b32 v95, 0xffff0000, v73
  v_pk_add_f32 v[92:93], v[92:93], v[244:245]
  v_pk_add_f32 v[94:95], v[94:95], v[246:247]
  v_cvt_pk_bf16_f32 v72, v92, v93
  v_cvt_pk_bf16_f32 v73, v94, v95
  buffer_store_dwordx2 v[72:73], v10, s[8:11], s34 offen offset:96
  v_pk_add_f32 v[96:97], v[96:97], v[116:117]
  v_pk_add_f32 v[98:99], v[98:99], v[118:119]
  v_cvt_pk_bf16_f32 v76, v96, v97
  v_cvt_pk_bf16_f32 v77, v98, v99
  v_lshlrev_b32 v96, 16, v76
  v_and_b32 v97, 0xffff0000, v76
  v_lshlrev_b32 v98, 16, v77
  v_and_b32 v99, 0xffff0000, v77
  v_pk_mul_f32 v[96:97], v[96:97], v[208:209]
  v_pk_mul_f32 v[98:99], v[98:99], v[210:211]
  v_cvt_pk_bf16_f32 v76, v96, v97
  v_cvt_pk_bf16_f32 v77, v98, v99
  v_lshlrev_b32 v96, 16, v76
  v_and_b32 v97, 0xffff0000, v76
  v_lshlrev_b32 v98, 16, v77
  v_and_b32 v99, 0xffff0000, v77
  v_pk_add_f32 v[96:97], v[96:97], v[248:249]
  v_pk_add_f32 v[98:99], v[98:99], v[250:251]
  v_cvt_pk_bf16_f32 v76, v96, v97
  v_cvt_pk_bf16_f32 v77, v98, v99
  buffer_store_dwordx2 v[76:77], v10, s[8:11], s34 offen offset:128
  s_or_b32 s38, s2, s28
  s_cmp_lg_u32 s38, 0
  s_cbranch_scc1 L_NOEP
  s_mov_b32 s71, 14942208
  v_mov_b32 v8, s31
  v_mov_b32 v9, 0
  s_mov_b64 exec, 1
  buffer_store_dword v8, v9, s[20:23], s71 offen sc1
  s_mov_b64 exec, -1
L_NOEP:
L_END:
  s_endpgm
ATT_FALLBACK:
  s_mov_b32 s37, 1
  s_lshl_b32 s38, s28, 6
  v_add_u32 v0, s38, v2
  s_waitcnt vmcnt(0) lgkmcnt(0)
  s_barrier
  s_branch L_RESTART
ATT_EXACT:
  s_waitcnt vmcnt(0) lgkmcnt(0)
  v_mov_b32 v5, 0xff800000
  v_mov_b32 v6, 0xff800000
  v_mov_b32 v7, 0xff800000
  v_mov_b32 v8, 0xff800000
  s_mov_b32 s34, 0
  s_mov_b32 m0, s32
ATT_FB_LOOP:
  s_barrier
  buffer_load_dwordx4 v22, s[4:7], s34 offen offset:0 lds
  buffer_load_dwordx4 v23, s[4:7], s34 offen offset:1024 lds
  s_waitcnt vmcnt(0)
  s_barrier
  ds_read_b128 a[128:131], v10 offset:0
  ds_read_b128 a[132:135], v11 offset:0
  ds_read_b128 a[136:139], v12 offset:0
  ds_read_b128 a[140:143], v13 offset:0
  ds_read_b128 a[144:147], v10 offset:4096
  ds_read_b128 a[148:151], v11 offset:4096
  ds_read_b128 a[152:155], v12 offset:4096
  ds_read_b128 a[156:159], v13 offset:4096
  s_waitcnt lgkmcnt(0)
  v_mfma_f32_16x16x32_bf16 v[96:99], a[128:131], v[192:195], 0
  v_mfma_f32_16x16x32_bf16 v[100:103], a[128:131], v[208:211], 0
  v_mfma_f32_16x16x32_bf16 v[104:107], a[128:131], v[224:227], 0
  v_mfma_f32_16x16x32_bf16 v[108:111], a[128:131], v[240:243], 0
  v_mfma_f32_16x16x32_bf16 v[96:99], a[132:135], v[196:199], v[96:99]
  v_mfma_f32_16x16x32_bf16 v[100:103], a[132:135], v[212:215], v[100:103]
  v_mfma_f32_16x16x32_bf16 v[104:107], a[132:135], v[228:231], v[104:107]
  v_mfma_f32_16x16x32_bf16 v[108:111], a[132:135], v[244:247], v[108:111]
  v_mfma_f32_16x16x32_bf16 v[96:99], a[136:139], v[200:203], v[96:99]
  v_mfma_f32_16x16x32_bf16 v[100:103], a[136:139], v[216:219], v[100:103]
  v_mfma_f32_16x16x32_bf16 v[104:107], a[136:139], v[232:235], v[104:107]
  v_mfma_f32_16x16x32_bf16 v[108:111], a[136:139], v[248:251], v[108:111]
  v_mfma_f32_16x16x32_bf16 v[96:99], a[140:143], v[204:207], v[96:99]
  v_mfma_f32_16x16x32_bf16 v[100:103], a[140:143], v[220:223], v[100:103]
  v_mfma_f32_16x16x32_bf16 v[104:107], a[140:143], v[236:239], v[104:107]
  v_mfma_f32_16x16x32_bf16 v[108:111], a[140:143], v[252:255], v[108:111]
  v_mfma_f32_16x16x32_bf16 v[112:115], a[144:147], v[192:195], 0
  v_mfma_f32_16x16x32_bf16 v[116:119], a[144:147], v[208:211], 0
  v_mfma_f32_16x16x32_bf16 v[120:123], a[144:147], v[224:227], 0
  v_mfma_f32_16x16x32_bf16 v[124:127], a[144:147], v[240:243], 0
  v_mfma_f32_16x16x32_bf16 v[112:115], a[148:151], v[196:199], v[112:115]
  v_mfma_f32_16x16x32_bf16 v[116:119], a[148:151], v[212:215], v[116:119]
  v_mfma_f32_16x16x32_bf16 v[120:123], a[148:151], v[228:231], v[120:123]
  v_mfma_f32_16x16x32_bf16 v[124:127], a[148:151], v[244:247], v[124:127]
  v_mfma_f32_16x16x32_bf16 v[112:115], a[152:155], v[200:203], v[112:115]
  v_mfma_f32_16x16x32_bf16 v[116:119], a[152:155], v[216:219], v[116:119]
  v_mfma_f32_16x16x32_bf16 v[120:123], a[152:155], v[232:235], v[120:123]
  v_mfma_f32_16x16x32_bf16 v[124:127], a[152:155], v[248:251], v[124:127]
  v_mfma_f32_16x16x32_bf16 v[112:115], a[156:159], v[204:207], v[112:115]
  v_mfma_f32_16x16x32_bf16 v[116:119], a[156:159], v[220:223], v[116:119]
  v_mfma_f32_16x16x32_bf16 v[120:123], a[156:159], v[236:239], v[120:123]
  v_mfma_f32_16x16x32_bf16 v[124:127], a[156:159], v[252:255], v[124:127]
  s_nop 7
  v_max3_f32 v5, v5, v96, v97
  v_max3_f32 v5, v5, v98, v99
  v_max3_f32 v5, v5, v112, v113
  v_max3_f32 v5, v5, v114, v115
  v_max3_f32 v6, v6, v100, v101
  v_max3_f32 v6, v6, v102, v103
  v_max3_f32 v6, v6, v116, v117
  v_max3_f32 v6, v6, v118, v119
  v_max3_f32 v7, v7, v104, v105
  v_max3_f32 v7, v7, v106, v107
  v_max3_f32 v7, v7, v120, v121
  v_max3_f32 v7, v7, v122, v123
  v_max3_f32 v8, v8, v108, v109
  v_max3_f32 v8, v8, v110, v111
  v_max3_f32 v8, v8, v124, v125
  v_max3_f32 v8, v8, v126, v127
  s_add_u32 s34, s34, 8192
  s_cmp_lt_u32 s34, 524288
  s_cbranch_scc1 ATT_FB_LOOP
  v_mov_b32 v60, v5
  v_mov_b32 v61, v6
  v_mov_b32 v62, v7
  v_mov_b32 v63, v8
  s_nop 1
  v_permlane16_swap_b32 v5, v60
  v_permlane16_swap_b32 v6, v61
  v_permlane16_swap_b32 v7, v62
  v_permlane16_swap_b32 v8, v63
  s_nop 1
  v_max_f32 v5, v5, v60
  v_max_f32 v6, v6, v61
  v_max_f32 v7, v7, v62
  v_max_f32 v8, v8, v63
  v_mov_b32 v60, v5
  v_mov_b32 v61, v6
  v_mov_b32 v62, v7
  v_mov_b32 v63, v8
  s_nop 1
  v_permlane32_swap_b32 v5, v60
  v_permlane32_swap_b32 v6, v61
  v_permlane32_swap_b32 v7, v62
  v_permlane32_swap_b32 v8, v63
  s_nop 1
  v_max_f32 v5, v5, v60
  v_max_f32 v6, v6, v61
  v_max_f32 v7, v7, v62
  v_max_f32 v8, v8, v63
  v_sub_f32 v40, 0, v5
  v_sub_f32 v41, 0, v5
  v_sub_f32 v42, 0, v5
  v_sub_f32 v43, 0, v5
  v_sub_f32 v44, 0, v6
  v_sub_f32 v45, 0, v6
  v_sub_f32 v46, 0, v6
  v_sub_f32 v47, 0, v6
  v_sub_f32 v48, 0, v7
  v_sub_f32 v49, 0, v7
  v_sub_f32 v50, 0, v7
  v_sub_f32 v51, 0, v7
  v_sub_f32 v52, 0, v8
  v_sub_f32 v53, 0, v8
  v_sub_f32 v54, 0, v8
  v_sub_f32 v55, 0, v8
  v_mov_b32 v34, 0
  v_mov_b32 v35, 0
  v_mov_b32 v36, 0
  v_mov_b32 v37, 0
  s_barrier
  s_mul_i32 s34, s29, 16384
  s_and_b32 s34, s34, 0x7ffff
  s_mov_b32 s35, s34
  s_add_u32 m0, s32, 0
  s_nop 0
  buffer_load_dwordx4 v22, s[4:7], s34 offen offset:0 lds
  buffer_load_dwordx4 v23, s[4:7], s34 offen offset:1024 lds
  s_add_u32 s34, s34, 8192
  s_and_b32 s34, s34, 0x7ffff
  s_add_u32 m0, s32, 8192
  s_nop 0
  buffer_load_dwordx4 v22, s[4:7], s34 offen offset:0 lds
  buffer_load_dwordx4 v23, s[4:7], s34 offen offset:1024 lds
  s_add_u32 s34, s34, 8192
  s_and_b32 s34, s34, 0x7ffff
  s_add_u32 m0, s33, 0
  s_nop 0
  buffer_load_dwordx4 v24, s[8:11], s35 offen offset:0 lds
  buffer_load_dwordx4 v25, s[8:11], s35 offen offset:1024 lds
  s_add_u32 s35, s35, 8192
  s_and_b32 s35, s35, 0x7ffff
  s_add_u32 m0, s32, 16384
  s_nop 0
  buffer_load_dwordx4 v22, s[4:7], s34 offen offset:0 lds
  buffer_load_dwordx4 v23, s[4:7], s34 offen offset:1024 lds
  s_add_u32 s34, s34, 8192
  s_and_b32 s34, s34, 0x7ffff
  s_add_u32 m0, s33, 8192
  s_nop 0
  buffer_load_dwordx4 v24, s[8:11], s35 offen offset:0 lds
  buffer_load_dwordx4 v25, s[8:11], s35 offen offset:1024 lds
  s_add_u32 s35, s35, 8192
  s_and_b32 s35, s35, 0x7ffff
  s_add_u32 m0, s33, 16384
  s_nop 0
  buffer_load_dwordx4 v24, s[8:11], s35 offen offset:0 lds
  buffer_load_dwordx4 v25, s[8:11], s35 offen offset:1024 lds
  s_add_u32 s35, s35, 8192
  s_and_b32 s35, s35, 0x7ffff
  s_add_u32 m0, s32, 24576
  s_nop 0
  buffer_load_dwordx4 v22, s[4:7], s34 offen offset:0 lds
  buffer_load_dwordx4 v23, s[4:7], s34 offen offset:1024 lds
  s_add_u32 s34, s34, 8192
  s_and_b32 s34, s34, 0x7ffff
  s_add_u32 m0, s32, 32768
  s_nop 0
  buffer_load_dwordx4 v22, s[4:7], s34 offen offset:0 lds
  buffer_load_dwordx4 v23, s[4:7], s34 offen offset:1024 lds
  s_add_u32 s34, s34, 8192
  s_and_b32 s34, s34, 0x7ffff
  s_add_u32 m0, s32, 40960
  s_nop 0
  buffer_load_dwordx4 v22, s[4:7], s34 offen offset:0 lds
  buffer_load_dwordx4 v23, s[4:7], s34 offen offset:1024 lds
  s_add_u32 s34, s34, 8192
  s_and_b32 s34, s34, 0x7ffff
  s_mov_b32 s12, s52
  s_and_b32 s13, s53, 0xffff
  s_cmp_lt_u32 s72, 216
  s_cselect_b32 s14, 7077888, 0
  s_mul_i32 s38, s73, 327680
  s_add_u32 s38, s38, 3145728
  s_add_u32 s16, s64, s38
  s_addc_u32 s17, s65, 0
  s_and_b32 s17, s17, 0xffff
  s_cmp_lt_u32 s72, 216
  s_cselect_b32 s18, 327680, 0
  s_lshr_b32 s38, s72, 3
  s_lshl_b32 s38, s38, 7
  s_mul_i32 s66, s28, 110592
  s_add_u32 s66, s66, s38
  s_mul_i32 s67, s28, 5120
  s_mov_b32 s68, 27648
  s_mov_b32 s70, 359424
  s_lshl_b32 s69, s28, 13
  s_add_u32 s69, s69, 131072
  v_mul_u32_u24 v32, 3456, v3
  v_add_u32 v32, v32, v4
  s_add_u32 m0, s69, 0
  s_nop 0
  buffer_load_dwordx4 v32, s[12:15], s66 offen lds
  s_add_u32 s66, s66, s68
  s_add_u32 m0, s69, 1024
  s_nop 0
  buffer_load_dwordx4 v32, s[12:15], s66 offen lds
  s_add_u32 s66, s66, s68
  s_add_u32 m0, s69, 2048
  s_nop 0
  buffer_load_dwordx4 v32, s[12:15], s66 offen lds
  s_add_u32 s66, s66, s68
  s_add_u32 m0, s69, 3072
  s_nop 0
  buffer_load_dwordx4 v32, s[12:15], s66 offen lds
  s_add_u32 s66, s66, s70
  buffer_load_dwordx4 v[56:59], v26, s[16:19], s67 offen offset:0 sc1
  buffer_load_dwordx4 v[60:63], v26, s[16:19], s67 offen offset:1024 sc1
  buffer_load_dwordx4 v[64:67], v26, s[16:19], s67 offen offset:2048 sc1
  buffer_load_dwordx4 v[68:71], v26, s[16:19], s67 offen offset:3072 sc1
  buffer_load_dwordx4 v[72:75], v27, s[16:19], s67 offen sc1
  s_add_u32 s67, s67, 20480
  s_add_u32 m0, s69, 4096
  s_nop 0
  buffer_load_dwordx4 v32, s[12:15], s66 offen lds
  s_add_u32 s66, s66, s68
  s_add_u32 m0, s69, 5120
  s_nop 0
  buffer_load_dwordx4 v32, s[12:15], s66 offen lds
  s_add_u32 s66, s66, s68
  s_add_u32 m0, s69, 6144
  s_nop 0
  buffer_load_dwordx4 v32, s[12:15], s66 offen lds
  s_add_u32 s66, s66, s68
  s_add_u32 m0, s69, 7168
  s_nop 0
  buffer_load_dwordx4 v32, s[12:15], s66 offen lds
  s_add_u32 s66, s66, s70
  buffer_load_dwordx4 v[76:79], v26, s[16:19], s67 offen offset:0 sc1
  buffer_load_dwordx4 v[80:83], v26, s[16:19], s67 offen offset:1024 sc1
  buffer_load_dwordx4 v[84:87], v26, s[16:19], s67 offen offset:2048 sc1
  buffer_load_dwordx4 v[88:91], v26, s[16:19], s67 offen offset:3072 sc1
  buffer_load_dwordx4 v[92:95], v27, s[16:19], s67 offen sc1
  s_add_u32 s67, s67, 20480
  s_waitcnt vmcnt(0)
  s_barrier
  ds_read_b128 a[128:131], v10 offset:0
  ds_read_b128 a[132:135], v11 offset:0
  ds_read_b128 a[136:139], v12 offset:0
  ds_read_b128 a[140:143], v13 offset:0
  ds_read_b128 a[144:147], v10 offset:4096
  ds_read_b128 a[148:151], v11 offset:4096
  ds_read_b128 a[152:155], v12 offset:4096
  ds_read_b128 a[156:159], v13 offset:4096
  s_waitcnt lgkmcnt(0)
  v_mfma_f32_16x16x32_bf16 v[96:99], a[128:131], v[192:195], v[40:43]
  v_mfma_f32_16x16x32_bf16 v[100:103], a[128:131], v[208:211], v[44:47]
  v_mfma_f32_16x16x32_bf16 v[104:107], a[128:131], v[224:227], v[48:51]
  v_mfma_f32_16x16x32_bf16 v[108:111], a[128:131], v[240:243], v[52:55]
  v_mfma_f32_16x16x32_bf16 v[96:99], a[132:135], v[196:199], v[96:99]
  v_mfma_f32_16x16x32_bf16 v[100:103], a[132:135], v[212:215], v[100:103]
  v_mfma_f32_16x16x32_bf16 v[104:107], a[132:135], v[228:231], v[104:107]
  v_mfma_f32_16x16x32_bf16 v[108:111], a[132:135], v[244:247], v[108:111]
  v_mfma_f32_16x16x32_bf16 v[96:99], a[136:139], v[200:203], v[96:99]
  v_mfma_f32_16x16x32_bf16 v[100:103], a[136:139], v[216:219], v[100:103]
  v_mfma_f32_16x16x32_bf16 v[104:107], a[136:139], v[232:235], v[104:107]
  v_mfma_f32_16x16x32_bf16 v[108:111], a[136:139], v[248:251], v[108:111]
  v_mfma_f32_16x16x32_bf16 v[96:99], a[140:143], v[204:207], v[96:99]
  v_mfma_f32_16x16x32_bf16 v[100:103], a[140:143], v[220:223], v[100:103]
  v_mfma_f32_16x16x32_bf16 v[104:107], a[140:143], v[236:239], v[104:107]
  v_mfma_f32_16x16x32_bf16 v[108:111], a[140:143], v[252:255], v[108:111]
  v_mfma_f32_16x16x32_bf16 v[112:115], a[144:147], v[192:195], v[40:43]
  v_mfma_f32_16x16x32_bf16 v[116:119], a[144:147], v[208:211], v[44:47]
  v_mfma_f32_16x16x32_bf16 v[120:123], a[144:147], v[224:227], v[48:51]
  v_mfma_f32_16x16x32_bf16 v[124:127], a[144:147], v[240:243], v[52:55]
  v_mfma_f32_16x16x32_bf16 v[112:115], a[148:151], v[196:199], v[112:115]
  v_mfma_f32_16x16x32_bf16 v[116:119], a[148:151], v[212:215], v[116:119]
  v_mfma_f32_16x16x32_bf16 v[120:123], a[148:151], v[228:231], v[120:123]
  v_mfma_f32_16x16x32_bf16 v[124:127], a[148:151], v[244:247], v[124:127]
  v_mfma_f32_16x16x32_bf16 v[112:115], a[152:155], v[200:203], v[112:115]
  v_mfma_f32_16x16x32_bf16 v[116:119], a[152:155], v[216:219], v[116:119]
  v_mfma_f32_16x16x32_bf16 v[120:123], a[152:155], v[232:235], v[120:123]
  v_mfma_f32_16x16x32_bf16 v[124:127], a[152:155], v[248:251], v[124:127]
  v_mfma_f32_16x16x32_bf16 v[112:115], a[156:159], v[204:207], v[112:115]
  v_mfma_f32_16x16x32_bf16 v[116:119], a[156:159], v[220:223], v[116:119]
  v_mfma_f32_16x16x32_bf16 v[120:123], a[156:159], v[236:239], v[120:123]
  v_mfma_f32_16x16x32_bf16 v[124:127], a[156:159], v[252:255], v[124:127]
  ds_read_b128 a[128:131], v10 offset:8192
  ds_read_b128 a[132:135], v11 offset:8192
  ds_read_b128 a[136:139], v12 offset:8192
  ds_read_b128 a[140:143], v13 offset:8192
  ds_read_b128 a[144:147], v10 offset:12288
  s_nop 7
  s_branch ATT_START
L_CODE_END:
.section .rodata,"a"
.p2align 6
.amdhsa_kernel recurrent_scan__mha_block_cached__mixer_token_mlp__prompt_kernel
  .amdhsa_next_free_vgpr 512
  .amdhsa_next_free_sgpr 102
  .amdhsa_accum_offset 256
  .amdhsa_group_segment_fixed_size 0
  .amdhsa_kernarg_size 104
  .amdhsa_user_sgpr_count 2
  .amdhsa_user_sgpr_kernarg_segment_ptr 1
  .amdhsa_system_sgpr_workgroup_id_x 1
  .amdhsa_float_denorm_mode_32 3
.end_amdhsa_kernel
```
